```python
import torch

def _softmax(x, axis=-1):
    return torch.softmax(x, dim=axis)

def _gelu(x):
    return torch.nn.functional.gelu(x, approximate='tanh')

def _silu(x):
    return torch.nn.functional.silu(x)

def _sigmoid(x):
    return torch.sigmoid(x)

def _layernorm(x, axis=-1, eps=1e-05):
    m = x.mean(dim=axis, keepdim=True)
    v = x.var(dim=axis, keepdim=True, unbiased=False)
    return (x - m) / torch.sqrt(v + eps)

def _scatter_add(tgt, idx, src, axis=0):
    return tgt.clone().index_add_(axis, idx, src)

def _segment_sum(src, seg, n):
    out = torch.zeros((n,) + src.shape[1:], dtype=src.dtype)
    return out.index_add_(0, seg, src)

def _pad(x, pw):
    flat = tuple((v for pair in reversed(pw) for v in pair))
    return torch.nn.functional.pad(x, flat)
kernel_name = 'adaLN_cond__spectral_gfnet__dense_activation_silu__prompt'

def setup_inputs():

    _w = lambda a: (lambda t: t.to(torch.bfloat16) if t.is_floating_point() else t)(torch.as_tensor(a))

    def _A_setup():
        B, S, D = (1, 2048, 512)
        Df = D // 2 + 1
        return {'x': _w((lambda *s: torch.randn(*s, dtype=torch.bfloat16) * 0.05)(B, S, D)), 'w_r': _w((lambda *s: torch.randn(*s, dtype=torch.bfloat16) * 1.6)(S, Df) * 0.02), 'w_i': _w((lambda *s: torch.randn(*s, dtype=torch.bfloat16) * 1.6)(S, Df) * 0.02)}
    _A_in = _A_setup()

    def _B_setup():
        B, S, D, F = (1, 2048, 512, 1792)
        return {'x': _w((lambda *s: torch.randn(*s, dtype=torch.bfloat16) * 0.05)(B, S, D)), 'w1': _w((lambda *s: torch.randn(*s, dtype=torch.bfloat16) * 0.8)(D, F) * D ** (-0.5)), 'w2': _w((lambda *s: torch.randn(*s, dtype=torch.bfloat16) * 0.2)(F, D) * F ** (-0.5))}
    _B_in = _B_setup()
    return {'A_x': _A_in['x'], 'A_w_r': _A_in['w_r'], 'A_w_i': _A_in['w_i'], 'B_x': _B_in['x'], 'B_w1': _B_in['w1'], 'B_w2': _B_in['w2'], 'c': _w((lambda *s: torch.randn(*s, dtype=torch.bfloat16) * 0.2)(1, 512) * 8.0), 'w_mod': _w((lambda *s: torch.randn(*s, dtype=torch.bfloat16) * 0.2)(512, 6 * 512) * 512 ** (-0.5) * 8.0)}

def reference(A_x, A_w_r, A_w_i, B_x, B_w1, B_w2, c, w_mod):

    def _A_ref(x, w_r, w_i):
        B, S, D = x.shape
        X = (lambda x, axes=(-2, -1): torch.fft.rfft2(x.float(), dim=axes))(x, axes=(-2, -1))
        W = w_r + 1j * w_i
        X = X * W
        y = (lambda x, s, axes=(-2, -1): torch.fft.irfft2(x, s=s, dim=axes).to(torch.bfloat16))(X, (S, D), axes=(-2, -1))
        return y

    def _B_ref(x, w1, w2):
        h = torch.einsum('bsd,df->bsf', x, w1)
        h = _silu(h)
        out = torch.einsum('bsf,fd->bsd', h, w2)
        return out
    x = A_x
    mod = (_silu(c) @ w_mod).reshape(c.shape[0], 6, 1, -1)
    sa, ca, ga, sb, cb, gb = (mod[:, 0].clone(), mod[:, 1].clone(), mod[:, 2].clone(), mod[:, 3].clone(), mod[:, 4].clone(), mod[:, 5].clone())
    h = _layernorm(x, axis=-1) * (1 + ca) + sa
    x = x + ga * _A_ref(h, A_w_r, A_w_i)
    h = _layernorm(x, axis=-1) * (1 + cb) + sb
    x = x + gb * _B_ref(h, B_w1, B_w2)
    return x
```

```asm
; @launch kernel=prep_kernel grid=(400,1,1) block=(256,1,1) lds=5120
; @launch kernel=p1_kernel grid=(256,1,1) block=(256,1,1) lds=17408
; @launch kernel=p2_kernel grid=(257,1,1) block=(256,1,1) lds=22528
; @launch kernel=p3_kernel grid=(256,1,1) block=(512,1,1) lds=23552
; @launch kernel=g1_kernel grid=(256,1,1) block=(256,1,1) lds=114688
; @launch kernel=adaLN_cond__spectral_gfnet__dense_activation_silu__prompt_kernel grid=(256,1,1) block=(256,1,1) lds=131072
.amdgcn_target "amdgcn-amd-amdhsa--gfx950"
.text
.globl prep_kernel
.p2align 8
.type prep_kernel,@function
prep_kernel:
    s_load_dwordx16 s[16:31], s[0:1], 0
    s_load_dwordx2 s[32:33], s[0:1], 64
    s_load_dwordx4 s[36:39], s[0:1], 72
    s_load_dwordx2 s[34:35], s[0:1], 80
    s_cmp_ge_u32 s2, 400
    s_cbranch_scc1 .Lk0_done
    v_and_b32 v1, 63, v0
    v_lshrrev_b32 v2, 6, v0
    s_waitcnt lgkmcnt(0)
    s_cmp_ge_u32 s2, 96
    s_cbranch_scc1 .Lk0_wt
    v_lshlrev_b32 v3, 2, v0
    global_load_dword v4, v3, s[28:29]
    v_lshrrev_b32 v5, 4, v0
    v_and_b32 v6, 15, v0
    v_mul_u32_u24 v7, 0x30000, v5
    v_lshl_add_u32 v7, v6, 2, v7
    s_lshl_b32 s3, s2, 6
    v_add_u32 v7, s3, v7
    global_load_dword v32, v7, s[30:31]
    v_add_u32 v7, 0x1800, v7
    global_load_dword v33, v7, s[30:31]
    v_add_u32 v7, 0x1800, v7
    global_load_dword v34, v7, s[30:31]
    v_add_u32 v7, 0x1800, v7
    global_load_dword v35, v7, s[30:31]
    v_add_u32 v7, 0x1800, v7
    global_load_dword v36, v7, s[30:31]
    v_add_u32 v7, 0x1800, v7
    global_load_dword v37, v7, s[30:31]
    v_add_u32 v7, 0x1800, v7
    global_load_dword v38, v7, s[30:31]
    v_add_u32 v7, 0x1800, v7
    global_load_dword v39, v7, s[30:31]
    v_add_u32 v7, 0x1800, v7
    global_load_dword v40, v7, s[30:31]
    v_add_u32 v7, 0x1800, v7
    global_load_dword v41, v7, s[30:31]
    v_add_u32 v7, 0x1800, v7
    global_load_dword v42, v7, s[30:31]
    v_add_u32 v7, 0x1800, v7
    global_load_dword v43, v7, s[30:31]
    v_add_u32 v7, 0x1800, v7
    global_load_dword v44, v7, s[30:31]
    v_add_u32 v7, 0x1800, v7
    global_load_dword v45, v7, s[30:31]
    v_add_u32 v7, 0x1800, v7
    global_load_dword v46, v7, s[30:31]
    v_add_u32 v7, 0x1800, v7
    global_load_dword v47, v7, s[30:31]
    v_add_u32 v7, 0x1800, v7
    global_load_dword v48, v7, s[30:31]
    v_add_u32 v7, 0x1800, v7
    global_load_dword v49, v7, s[30:31]
    v_add_u32 v7, 0x1800, v7
    global_load_dword v50, v7, s[30:31]
    v_add_u32 v7, 0x1800, v7
    global_load_dword v51, v7, s[30:31]
    v_add_u32 v7, 0x1800, v7
    global_load_dword v52, v7, s[30:31]
    v_add_u32 v7, 0x1800, v7
    global_load_dword v53, v7, s[30:31]
    v_add_u32 v7, 0x1800, v7
    global_load_dword v54, v7, s[30:31]
    v_add_u32 v7, 0x1800, v7
    global_load_dword v55, v7, s[30:31]
    v_add_u32 v7, 0x1800, v7
    global_load_dword v56, v7, s[30:31]
    v_add_u32 v7, 0x1800, v7
    global_load_dword v57, v7, s[30:31]
    v_add_u32 v7, 0x1800, v7
    global_load_dword v58, v7, s[30:31]
    v_add_u32 v7, 0x1800, v7
    global_load_dword v59, v7, s[30:31]
    v_add_u32 v7, 0x1800, v7
    global_load_dword v60, v7, s[30:31]
    v_add_u32 v7, 0x1800, v7
    global_load_dword v61, v7, s[30:31]
    v_add_u32 v7, 0x1800, v7
    global_load_dword v62, v7, s[30:31]
    v_add_u32 v7, 0x1800, v7
    global_load_dword v63, v7, s[30:31]
    s_waitcnt vmcnt(32)
    v_lshlrev_b32 v8, 16, v4
    v_and_b32 v9, 0xffff0000, v4
    s_mov_b32 s4, 0xbfb8aa3b
    v_mul_f32 v10, s4, v8
    v_exp_f32 v10, v10
    s_nop 0
    v_add_f32 v10, 1.0, v10
    v_rcp_f32 v10, v10
    s_nop 0
    v_mul_f32 v8, v8, v10
    v_mul_f32 v10, s4, v9
    v_exp_f32 v10, v10
    s_nop 0
    v_add_f32 v10, 1.0, v10
    v_rcp_f32 v10, v10
    s_nop 0
    v_mul_f32 v9, v9, v10
    v_cvt_pk_bf16_f32 v10, v8, v9
    v_lshlrev_b32 v8, 16, v10
    v_and_b32 v9, 0xffff0000, v10
    v_lshlrev_b32 v11, 3, v0
    ds_write_b64 v11, v[8:9]
    s_waitcnt lgkmcnt(0)
    s_barrier
    v_lshlrev_b32 v11, 7, v5
    ds_read_b128 v[64:67], v11 offset:0
    ds_read_b128 v[68:71], v11 offset:16
    ds_read_b128 v[72:75], v11 offset:32
    ds_read_b128 v[76:79], v11 offset:48
    ds_read_b128 v[80:83], v11 offset:64
    ds_read_b128 v[84:87], v11 offset:80
    ds_read_b128 v[88:91], v11 offset:96
    ds_read_b128 v[92:95], v11 offset:112
    v_mov_b32 v12, 0
    v_mov_b32 v13, 0
    s_waitcnt vmcnt(0) lgkmcnt(0)
    v_lshlrev_b32 v14, 16, v32
    v_and_b32 v15, 0xffff0000, v32
    v_fmac_f32 v12, v14, v64
    v_fmac_f32 v13, v15, v64
    v_lshlrev_b32 v14, 16, v33
    v_and_b32 v15, 0xffff0000, v33
    v_fmac_f32 v12, v14, v65
    v_fmac_f32 v13, v15, v65
    v_lshlrev_b32 v14, 16, v34
    v_and_b32 v15, 0xffff0000, v34
    v_fmac_f32 v12, v14, v66
    v_fmac_f32 v13, v15, v66
    v_lshlrev_b32 v14, 16, v35
    v_and_b32 v15, 0xffff0000, v35
    v_fmac_f32 v12, v14, v67
    v_fmac_f32 v13, v15, v67
    v_lshlrev_b32 v14, 16, v36
    v_and_b32 v15, 0xffff0000, v36
    v_fmac_f32 v12, v14, v68
    v_fmac_f32 v13, v15, v68
    v_lshlrev_b32 v14, 16, v37
    v_and_b32 v15, 0xffff0000, v37
    v_fmac_f32 v12, v14, v69
    v_fmac_f32 v13, v15, v69
    v_lshlrev_b32 v14, 16, v38
    v_and_b32 v15, 0xffff0000, v38
    v_fmac_f32 v12, v14, v70
    v_fmac_f32 v13, v15, v70
    v_lshlrev_b32 v14, 16, v39
    v_and_b32 v15, 0xffff0000, v39
    v_fmac_f32 v12, v14, v71
    v_fmac_f32 v13, v15, v71
    v_lshlrev_b32 v14, 16, v40
    v_and_b32 v15, 0xffff0000, v40
    v_fmac_f32 v12, v14, v72
    v_fmac_f32 v13, v15, v72
    v_lshlrev_b32 v14, 16, v41
    v_and_b32 v15, 0xffff0000, v41
    v_fmac_f32 v12, v14, v73
    v_fmac_f32 v13, v15, v73
    v_lshlrev_b32 v14, 16, v42
    v_and_b32 v15, 0xffff0000, v42
    v_fmac_f32 v12, v14, v74
    v_fmac_f32 v13, v15, v74
    v_lshlrev_b32 v14, 16, v43
    v_and_b32 v15, 0xffff0000, v43
    v_fmac_f32 v12, v14, v75
    v_fmac_f32 v13, v15, v75
    v_lshlrev_b32 v14, 16, v44
    v_and_b32 v15, 0xffff0000, v44
    v_fmac_f32 v12, v14, v76
    v_fmac_f32 v13, v15, v76
    v_lshlrev_b32 v14, 16, v45
    v_and_b32 v15, 0xffff0000, v45
    v_fmac_f32 v12, v14, v77
    v_fmac_f32 v13, v15, v77
    v_lshlrev_b32 v14, 16, v46
    v_and_b32 v15, 0xffff0000, v46
    v_fmac_f32 v12, v14, v78
    v_fmac_f32 v13, v15, v78
    v_lshlrev_b32 v14, 16, v47
    v_and_b32 v15, 0xffff0000, v47
    v_fmac_f32 v12, v14, v79
    v_fmac_f32 v13, v15, v79
    v_lshlrev_b32 v14, 16, v48
    v_and_b32 v15, 0xffff0000, v48
    v_fmac_f32 v12, v14, v80
    v_fmac_f32 v13, v15, v80
    v_lshlrev_b32 v14, 16, v49
    v_and_b32 v15, 0xffff0000, v49
    v_fmac_f32 v12, v14, v81
    v_fmac_f32 v13, v15, v81
    v_lshlrev_b32 v14, 16, v50
    v_and_b32 v15, 0xffff0000, v50
    v_fmac_f32 v12, v14, v82
    v_fmac_f32 v13, v15, v82
    v_lshlrev_b32 v14, 16, v51
    v_and_b32 v15, 0xffff0000, v51
    v_fmac_f32 v12, v14, v83
    v_fmac_f32 v13, v15, v83
    v_lshlrev_b32 v14, 16, v52
    v_and_b32 v15, 0xffff0000, v52
    v_fmac_f32 v12, v14, v84
    v_fmac_f32 v13, v15, v84
    v_lshlrev_b32 v14, 16, v53
    v_and_b32 v15, 0xffff0000, v53
    v_fmac_f32 v12, v14, v85
    v_fmac_f32 v13, v15, v85
    v_lshlrev_b32 v14, 16, v54
    v_and_b32 v15, 0xffff0000, v54
    v_fmac_f32 v12, v14, v86
    v_fmac_f32 v13, v15, v86
    v_lshlrev_b32 v14, 16, v55
    v_and_b32 v15, 0xffff0000, v55
    v_fmac_f32 v12, v14, v87
    v_fmac_f32 v13, v15, v87
    v_lshlrev_b32 v14, 16, v56
    v_and_b32 v15, 0xffff0000, v56
    v_fmac_f32 v12, v14, v88
    v_fmac_f32 v13, v15, v88
    v_lshlrev_b32 v14, 16, v57
    v_and_b32 v15, 0xffff0000, v57
    v_fmac_f32 v12, v14, v89
    v_fmac_f32 v13, v15, v89
    v_lshlrev_b32 v14, 16, v58
    v_and_b32 v15, 0xffff0000, v58
    v_fmac_f32 v12, v14, v90
    v_fmac_f32 v13, v15, v90
    v_lshlrev_b32 v14, 16, v59
    v_and_b32 v15, 0xffff0000, v59
    v_fmac_f32 v12, v14, v91
    v_fmac_f32 v13, v15, v91
    v_lshlrev_b32 v14, 16, v60
    v_and_b32 v15, 0xffff0000, v60
    v_fmac_f32 v12, v14, v92
    v_fmac_f32 v13, v15, v92
    v_lshlrev_b32 v14, 16, v61
    v_and_b32 v15, 0xffff0000, v61
    v_fmac_f32 v12, v14, v93
    v_fmac_f32 v13, v15, v93
    v_lshlrev_b32 v14, 16, v62
    v_and_b32 v15, 0xffff0000, v62
    v_fmac_f32 v12, v14, v94
    v_fmac_f32 v13, v15, v94
    v_lshlrev_b32 v14, 16, v63
    v_and_b32 v15, 0xffff0000, v63
    v_fmac_f32 v12, v14, v95
    v_fmac_f32 v13, v15, v95
    v_lshlrev_b32 v11, 7, v5
    v_lshl_add_u32 v11, v6, 3, v11
    ds_write_b64 v11, v[12:13] offset:2048
    s_waitcnt lgkmcnt(0)
    s_barrier
    v_cmp_gt_u32 vcc, 32, v0
    s_and_saveexec_b64 s[6:7], vcc
    s_cbranch_execz .Lk0_done
    v_lshlrev_b32 v11, 2, v0
    ds_read_b32 v32, v11 offset:2048
    ds_read_b32 v33, v11 offset:2176
    ds_read_b32 v34, v11 offset:2304
    ds_read_b32 v35, v11 offset:2432
    ds_read_b32 v36, v11 offset:2560
    ds_read_b32 v37, v11 offset:2688
    ds_read_b32 v38, v11 offset:2816
    ds_read_b32 v39, v11 offset:2944
    ds_read_b32 v40, v11 offset:3072
    ds_read_b32 v41, v11 offset:3200
    ds_read_b32 v42, v11 offset:3328
    ds_read_b32 v43, v11 offset:3456
    ds_read_b32 v44, v11 offset:3584
    ds_read_b32 v45, v11 offset:3712
    ds_read_b32 v46, v11 offset:3840
    ds_read_b32 v47, v11 offset:3968
    s_waitcnt lgkmcnt(0)
    v_add_f32 v32, v32, v40
    v_add_f32 v33, v33, v41
    v_add_f32 v34, v34, v42
    v_add_f32 v35, v35, v43
    v_add_f32 v36, v36, v44
    v_add_f32 v37, v37, v45
    v_add_f32 v38, v38, v46
    v_add_f32 v39, v39, v47
    v_add_f32 v32, v32, v36
    v_add_f32 v33, v33, v37
    v_add_f32 v34, v34, v38
    v_add_f32 v35, v35, v39
    v_add_f32 v32, v32, v34
    v_add_f32 v33, v33, v35
    v_add_f32 v32, v32, v33
    v_cvt_pk_bf16_f32 v12, v32, v32
    v_lshlrev_b32 v12, 16, v12
    s_lshl_b32 s3, s2, 7
    v_add_u32 v11, s3, v11
    global_store_dword v11, v12, s[34:35]
    s_endpgm
.Lk0_wt:
    s_cmp_ge_u32 s2, 176
    s_cbranch_scc1 .Lk0_w1
    s_sub_u32 s3, s2, 96
    s_lshl_b32 s3, s3, 2
    v_add_u32 v3, s3, v2
    v_and_b32 v4, 63, v3
    v_lshrrev_b32 v5, 6, v3
    v_lshl_add_u32 v6, v5, 6, v1
    v_cmp_gt_u32 vcc, 257, v6
    s_and_saveexec_b64 s[6:7], vcc
    s_cbranch_execz .Lk0_done
    v_mul_u32_u24 v7, 514, v4
    v_lshl_add_u32 v7, v6, 1, v7
    global_load_ushort v32, v7, s[18:19]
    global_load_ushort v64, v7, s[20:21]
    v_add_u32 v7, 0x8080, v7
    global_load_ushort v33, v7, s[18:19]
    global_load_ushort v65, v7, s[20:21]
    v_add_u32 v7, 0x8080, v7
    global_load_ushort v34, v7, s[18:19]
    global_load_ushort v66, v7, s[20:21]
    v_add_u32 v7, 0x8080, v7
    global_load_ushort v35, v7, s[18:19]
    global_load_ushort v67, v7, s[20:21]
    v_add_u32 v7, 0x8080, v7
    global_load_ushort v36, v7, s[18:19]
    global_load_ushort v68, v7, s[20:21]
    v_add_u32 v7, 0x8080, v7
    global_load_ushort v37, v7, s[18:19]
    global_load_ushort v69, v7, s[20:21]
    v_add_u32 v7, 0x8080, v7
    global_load_ushort v38, v7, s[18:19]
    global_load_ushort v70, v7, s[20:21]
    v_add_u32 v7, 0x8080, v7
    global_load_ushort v39, v7, s[18:19]
    global_load_ushort v71, v7, s[20:21]
    v_add_u32 v7, 0x8080, v7
    global_load_ushort v40, v7, s[18:19]
    global_load_ushort v72, v7, s[20:21]
    v_add_u32 v7, 0x8080, v7
    global_load_ushort v41, v7, s[18:19]
    global_load_ushort v73, v7, s[20:21]
    v_add_u32 v7, 0x8080, v7
    global_load_ushort v42, v7, s[18:19]
    global_load_ushort v74, v7, s[20:21]
    v_add_u32 v7, 0x8080, v7
    global_load_ushort v43, v7, s[18:19]
    global_load_ushort v75, v7, s[20:21]
    v_add_u32 v7, 0x8080, v7
    global_load_ushort v44, v7, s[18:19]
    global_load_ushort v76, v7, s[20:21]
    v_add_u32 v7, 0x8080, v7
    global_load_ushort v45, v7, s[18:19]
    global_load_ushort v77, v7, s[20:21]
    v_add_u32 v7, 0x8080, v7
    global_load_ushort v46, v7, s[18:19]
    global_load_ushort v78, v7, s[20:21]
    v_add_u32 v7, 0x8080, v7
    global_load_ushort v47, v7, s[18:19]
    global_load_ushort v79, v7, s[20:21]
    v_add_u32 v7, 0x8080, v7
    global_load_ushort v48, v7, s[18:19]
    global_load_ushort v80, v7, s[20:21]
    v_add_u32 v7, 0x8080, v7
    global_load_ushort v49, v7, s[18:19]
    global_load_ushort v81, v7, s[20:21]
    v_add_u32 v7, 0x8080, v7
    global_load_ushort v50, v7, s[18:19]
    global_load_ushort v82, v7, s[20:21]
    v_add_u32 v7, 0x8080, v7
    global_load_ushort v51, v7, s[18:19]
    global_load_ushort v83, v7, s[20:21]
    v_add_u32 v7, 0x8080, v7
    global_load_ushort v52, v7, s[18:19]
    global_load_ushort v84, v7, s[20:21]
    v_add_u32 v7, 0x8080, v7
    global_load_ushort v53, v7, s[18:19]
    global_load_ushort v85, v7, s[20:21]
    v_add_u32 v7, 0x8080, v7
    global_load_ushort v54, v7, s[18:19]
    global_load_ushort v86, v7, s[20:21]
    v_add_u32 v7, 0x8080, v7
    global_load_ushort v55, v7, s[18:19]
    global_load_ushort v87, v7, s[20:21]
    v_add_u32 v7, 0x8080, v7
    global_load_ushort v56, v7, s[18:19]
    global_load_ushort v88, v7, s[20:21]
    v_add_u32 v7, 0x8080, v7
    global_load_ushort v57, v7, s[18:19]
    global_load_ushort v89, v7, s[20:21]
    v_add_u32 v7, 0x8080, v7
    global_load_ushort v58, v7, s[18:19]
    global_load_ushort v90, v7, s[20:21]
    v_add_u32 v7, 0x8080, v7
    global_load_ushort v59, v7, s[18:19]
    global_load_ushort v91, v7, s[20:21]
    v_add_u32 v7, 0x8080, v7
    global_load_ushort v60, v7, s[18:19]
    global_load_ushort v92, v7, s[20:21]
    v_add_u32 v7, 0x8080, v7
    global_load_ushort v61, v7, s[18:19]
    global_load_ushort v93, v7, s[20:21]
    v_add_u32 v7, 0x8080, v7
    global_load_ushort v62, v7, s[18:19]
    global_load_ushort v94, v7, s[20:21]
    v_add_u32 v7, 0x8080, v7
    global_load_ushort v63, v7, s[18:19]
    global_load_ushort v95, v7, s[20:21]
    v_lshrrev_b32 v8, 4, v4
    v_and_b32 v9, 15, v4
    v_lshlrev_b32 v10, 13, v6
    v_lshl_add_u32 v10, v8, 11, v10
    v_lshl_add_u32 v10, v9, 4, v10
    s_add_u32 s8, s34, 0x10000
    s_addc_u32 s9, s35, 0
    s_waitcnt vmcnt(0)
    v_lshl_or_b32 v32, v64, 16, v32
    v_lshl_or_b32 v33, v65, 16, v33
    v_lshl_or_b32 v34, v66, 16, v34
    v_lshl_or_b32 v35, v67, 16, v35
    v_lshl_or_b32 v36, v68, 16, v36
    v_lshl_or_b32 v37, v69, 16, v37
    v_lshl_or_b32 v38, v70, 16, v38
    v_lshl_or_b32 v39, v71, 16, v39
    v_lshl_or_b32 v40, v72, 16, v40
    v_lshl_or_b32 v41, v73, 16, v41
    v_lshl_or_b32 v42, v74, 16, v42
    v_lshl_or_b32 v43, v75, 16, v43
    v_lshl_or_b32 v44, v76, 16, v44
    v_lshl_or_b32 v45, v77, 16, v45
    v_lshl_or_b32 v46, v78, 16, v46
    v_lshl_or_b32 v47, v79, 16, v47
    v_lshl_or_b32 v48, v80, 16, v48
    v_lshl_or_b32 v49, v81, 16, v49
    v_lshl_or_b32 v50, v82, 16, v50
    v_lshl_or_b32 v51, v83, 16, v51
    v_lshl_or_b32 v52, v84, 16, v52
    v_lshl_or_b32 v53, v85, 16, v53
    v_lshl_or_b32 v54, v86, 16, v54
    v_lshl_or_b32 v55, v87, 16, v55
    v_lshl_or_b32 v56, v88, 16, v56
    v_lshl_or_b32 v57, v89, 16, v57
    v_lshl_or_b32 v58, v90, 16, v58
    v_lshl_or_b32 v59, v91, 16, v59
    v_lshl_or_b32 v60, v92, 16, v60
    v_lshl_or_b32 v61, v93, 16, v61
    v_lshl_or_b32 v62, v94, 16, v62
    v_lshl_or_b32 v63, v95, 16, v63
    global_store_dwordx4 v10, v[32:35], s[8:9] offset:0
    global_store_dwordx4 v10, v[36:39], s[8:9] offset:256
    global_store_dwordx4 v10, v[40:43], s[8:9] offset:512
    global_store_dwordx4 v10, v[44:47], s[8:9] offset:768
    global_store_dwordx4 v10, v[48:51], s[8:9] offset:1024
    global_store_dwordx4 v10, v[52:55], s[8:9] offset:1280
    global_store_dwordx4 v10, v[56:59], s[8:9] offset:1536
    global_store_dwordx4 v10, v[60:63], s[8:9] offset:1792
    s_endpgm
.Lk0_w1:
    s_cmp_ge_u32 s2, 288
    s_cbranch_scc1 .Lk0_w2
    s_sub_u32 s3, s2, 176
    s_lshl_b32 s3, s3, 2
    v_add_u32 v3, s3, v2
    v_and_b32 v4, 15, v3
    v_lshrrev_b32 v5, 4, v3
    v_and_b32 v6, 15, v1
    v_lshrrev_b32 v7, 4, v1
    v_lshlrev_b32 v8, 5, v4
    v_lshl_add_u32 v8, v7, 2, v8
    v_mul_u32_u24 v8, 3584, v8
    v_lshl_add_u32 v8, v5, 7, v8
    v_lshl_add_u32 v8, v6, 1, v8
    v_add_u32 v9, 0x0, v8
    global_load_ushort v32, v9, s[24:25] offset:0
    global_load_ushort v36, v9, s[24:25] offset:32
    global_load_ushort v40, v9, s[24:25] offset:64
    global_load_ushort v44, v9, s[24:25] offset:96
    v_add_u32 v9, 0xe00, v8
    global_load_ushort v48, v9, s[24:25] offset:0
    global_load_ushort v52, v9, s[24:25] offset:32
    global_load_ushort v56, v9, s[24:25] offset:64
    global_load_ushort v60, v9, s[24:25] offset:96
    v_add_u32 v9, 0x1c00, v8
    global_load_ushort v33, v9, s[24:25] offset:0
    global_load_ushort v37, v9, s[24:25] offset:32
    global_load_ushort v41, v9, s[24:25] offset:64
    global_load_ushort v45, v9, s[24:25] offset:96
    v_add_u32 v9, 0x2a00, v8
    global_load_ushort v49, v9, s[24:25] offset:0
    global_load_ushort v53, v9, s[24:25] offset:32
    global_load_ushort v57, v9, s[24:25] offset:64
    global_load_ushort v61, v9, s[24:25] offset:96
    v_add_u32 v9, 0xe000, v8
    global_load_ushort v34, v9, s[24:25] offset:0
    global_load_ushort v38, v9, s[24:25] offset:32
    global_load_ushort v42, v9, s[24:25] offset:64
    global_load_ushort v46, v9, s[24:25] offset:96
    v_add_u32 v9, 0xee00, v8
    global_load_ushort v50, v9, s[24:25] offset:0
    global_load_ushort v54, v9, s[24:25] offset:32
    global_load_ushort v58, v9, s[24:25] offset:64
    global_load_ushort v62, v9, s[24:25] offset:96
    v_add_u32 v9, 0xfc00, v8
    global_load_ushort v35, v9, s[24:25] offset:0
    global_load_ushort v39, v9, s[24:25] offset:32
    global_load_ushort v43, v9, s[24:25] offset:64
    global_load_ushort v47, v9, s[24:25] offset:96
    v_add_u32 v9, 0x10a00, v8
    global_load_ushort v51, v9, s[24:25] offset:0
    global_load_ushort v55, v9, s[24:25] offset:32
    global_load_ushort v59, v9, s[24:25] offset:64
    global_load_ushort v63, v9, s[24:25] offset:96
    v_lshlrev_b32 v10, 16, v5
    v_lshl_add_u32 v10, v4, 10, v10
    v_lshl_add_u32 v10, v1, 4, v10
    s_add_u32 s8, s34, 0x300000
    s_addc_u32 s9, s35, 0
    s_waitcnt vmcnt(0)
    v_lshl_or_b32 v32, v48, 16, v32
    v_lshl_or_b32 v33, v49, 16, v33
    v_lshl_or_b32 v34, v50, 16, v34
    v_lshl_or_b32 v35, v51, 16, v35
    v_lshl_or_b32 v36, v52, 16, v36
    v_lshl_or_b32 v37, v53, 16, v37
    v_lshl_or_b32 v38, v54, 16, v38
    v_lshl_or_b32 v39, v55, 16, v39
    v_lshl_or_b32 v40, v56, 16, v40
    v_lshl_or_b32 v41, v57, 16, v41
    v_lshl_or_b32 v42, v58, 16, v42
    v_lshl_or_b32 v43, v59, 16, v43
    v_lshl_or_b32 v44, v60, 16, v44
    v_lshl_or_b32 v45, v61, 16, v45
    v_lshl_or_b32 v46, v62, 16, v46
    v_lshl_or_b32 v47, v63, 16, v47
    v_add_u32 v11, 0x0, v10
    global_store_dwordx4 v11, v[32:35], s[8:9]
    v_add_u32 v11, 0x4000, v10
    global_store_dwordx4 v11, v[36:39], s[8:9]
    v_add_u32 v11, 0x8000, v10
    global_store_dwordx4 v11, v[40:43], s[8:9]
    v_add_u32 v11, 0xc000, v10
    global_store_dwordx4 v11, v[44:47], s[8:9]
    s_endpgm
.Lk0_w2:
    s_sub_u32 s3, s2, 288
    s_lshl_b32 s3, s3, 2
    v_add_u32 v3, s3, v2
    v_and_b32 v4, 7, v3
    v_lshrrev_b32 v5, 3, v3
    v_and_b32 v6, 15, v1
    v_lshrrev_b32 v7, 4, v1
    v_lshlrev_b32 v8, 5, v5
    v_lshl_add_u32 v8, v7, 2, v8
    v_lshlrev_b32 v8, 10, v8
    v_lshl_add_u32 v8, v4, 7, v8
    v_lshrrev_b32 v9, 2, v6
    v_lshl_add_u32 v8, v9, 4, v8
    v_and_b32 v9, 3, v6
    v_lshl_add_u32 v8, v9, 1, v8
    v_add_u32 v9, 0x0, v8
    global_load_ushort v32, v9, s[26:27] offset:0
    global_load_ushort v36, v9, s[26:27] offset:8
    global_load_ushort v40, v9, s[26:27] offset:64
    global_load_ushort v44, v9, s[26:27] offset:72
    v_add_u32 v9, 0x400, v8
    global_load_ushort v48, v9, s[26:27] offset:0
    global_load_ushort v52, v9, s[26:27] offset:8
    global_load_ushort v56, v9, s[26:27] offset:64
    global_load_ushort v60, v9, s[26:27] offset:72
    v_add_u32 v9, 0x800, v8
    global_load_ushort v33, v9, s[26:27] offset:0
    global_load_ushort v37, v9, s[26:27] offset:8
    global_load_ushort v41, v9, s[26:27] offset:64
    global_load_ushort v45, v9, s[26:27] offset:72
    v_add_u32 v9, 0xc00, v8
    global_load_ushort v49, v9, s[26:27] offset:0
    global_load_ushort v53, v9, s[26:27] offset:8
    global_load_ushort v57, v9, s[26:27] offset:64
    global_load_ushort v61, v9, s[26:27] offset:72
    v_add_u32 v9, 0x4000, v8
    global_load_ushort v34, v9, s[26:27] offset:0
    global_load_ushort v38, v9, s[26:27] offset:8
    global_load_ushort v42, v9, s[26:27] offset:64
    global_load_ushort v46, v9, s[26:27] offset:72
    v_add_u32 v9, 0x4400, v8
    global_load_ushort v50, v9, s[26:27] offset:0
    global_load_ushort v54, v9, s[26:27] offset:8
    global_load_ushort v58, v9, s[26:27] offset:64
    global_load_ushort v62, v9, s[26:27] offset:72
    v_add_u32 v9, 0x4800, v8
    global_load_ushort v35, v9, s[26:27] offset:0
    global_load_ushort v39, v9, s[26:27] offset:8
    global_load_ushort v43, v9, s[26:27] offset:64
    global_load_ushort v47, v9, s[26:27] offset:72
    v_add_u32 v9, 0x4c00, v8
    global_load_ushort v51, v9, s[26:27] offset:0
    global_load_ushort v55, v9, s[26:27] offset:8
    global_load_ushort v59, v9, s[26:27] offset:64
    global_load_ushort v63, v9, s[26:27] offset:72
    v_mul_u32_u24 v10, 229376, v4
    v_lshl_add_u32 v10, v5, 10, v10
    v_lshl_add_u32 v10, v1, 4, v10
    s_add_u32 s8, s34, 0x500000
    s_addc_u32 s9, s35, 0
    s_waitcnt vmcnt(0)
    v_lshl_or_b32 v32, v48, 16, v32
    v_lshl_or_b32 v33, v49, 16, v33
    v_lshl_or_b32 v34, v50, 16, v34
    v_lshl_or_b32 v35, v51, 16, v35
    v_lshl_or_b32 v36, v52, 16, v36
    v_lshl_or_b32 v37, v53, 16, v37
    v_lshl_or_b32 v38, v54, 16, v38
    v_lshl_or_b32 v39, v55, 16, v39
    v_lshl_or_b32 v40, v56, 16, v40
    v_lshl_or_b32 v41, v57, 16, v41
    v_lshl_or_b32 v42, v58, 16, v42
    v_lshl_or_b32 v43, v59, 16, v43
    v_lshl_or_b32 v44, v60, 16, v44
    v_lshl_or_b32 v45, v61, 16, v45
    v_lshl_or_b32 v46, v62, 16, v46
    v_lshl_or_b32 v47, v63, 16, v47
    v_add_u32 v11, 0x0, v10
    global_store_dwordx4 v11, v[32:35], s[8:9]
    v_add_u32 v11, 0xe000, v10
    global_store_dwordx4 v11, v[36:39], s[8:9]
    v_add_u32 v11, 0x1c000, v10
    global_store_dwordx4 v11, v[40:43], s[8:9]
    v_add_u32 v11, 0x2a000, v10
    global_store_dwordx4 v11, v[44:47], s[8:9]
.Lk0_done:
    s_endpgm
.globl p1_kernel
.p2align 8
.type p1_kernel,@function
p1_kernel:
    s_load_dwordx16 s[16:31], s[0:1], 0
    s_load_dwordx2 s[32:33], s[0:1], 64
    s_load_dwordx4 s[36:39], s[0:1], 72
    s_load_dwordx2 s[34:35], s[0:1], 80
    s_cmp_ge_u32 s2, 256
    s_cbranch_scc1 .Lp1_done
    s_getpc_b64 s[10:11]
.Lpc_p1:
    s_add_u32 s10, s10, tbl_p1-.Lpc_p1
    s_addc_u32 s11, s11, 0
    v_and_b32 v1, 63, v0
    v_lshrrev_b32 v2, 6, v0
    s_and_b32 s3, s2, 31
    s_lshr_b32 s4, s2, 5
    v_lshlrev_b32 v3, 4, v1
    global_load_dwordx4 v[100:103], v3, s[10:11] offset:0
    global_load_dwordx4 v[104:107], v3, s[10:11] offset:1024
    global_load_dwordx4 v[108:111], v3, s[10:11] offset:2048
    global_load_dwordx4 v[112:115], v3, s[10:11] offset:3072
    v_add_u32 v4, 0x1000, v3
    global_load_dwordx4 v[116:119], v4, s[10:11]
    global_load_dwordx4 v[120:123], v4, s[10:11] offset:1024
    global_load_dwordx4 v[124:127], v4, s[10:11] offset:2048
    global_load_dwordx4 v[128:131], v4, s[10:11] offset:3072
    v_add_u32 v4, 0x2000, v3
    global_load_dwordx4 v[132:135], v4, s[10:11]
    v_lshlrev_b32 v5, 1, v2
    s_lshl_b32 s5, s4, 3
    v_add_u32 v5, s5, v5
    v_lshlrev_b32 v6, 5, v5
    v_add_u32 v6, s3, v6
    v_lshlrev_b32 v7, 10, v6
    v_add_u32 v7, v7, v3
    s_waitcnt lgkmcnt(0)
    global_load_dwordx4 v[8:11], v7, s[16:17]
    v_add_u32 v7, 0x8000, v7
    global_load_dwordx4 v[12:15], v7, s[16:17]
    v_lshlrev_b32 v4, 5, v1
    global_load_dwordx4 v[136:139], v4, s[34:35]
    global_load_dwordx4 v[140:143], v4, s[34:35] offset:16
    global_load_dwordx4 v[144:147], v4, s[34:35] offset:2048
    global_load_dwordx4 v[148:151], v4, s[34:35] offset:2064
    s_waitcnt vmcnt(4)
    v_lshlrev_b32 v16, 16, v8
    v_and_b32 v17, 0xffff0000, v8
    v_lshlrev_b32 v18, 16, v9
    v_and_b32 v19, 0xffff0000, v9
    v_lshlrev_b32 v20, 16, v10
    v_and_b32 v21, 0xffff0000, v10
    v_lshlrev_b32 v22, 16, v11
    v_and_b32 v23, 0xffff0000, v11
    v_lshlrev_b32 v24, 16, v12
    v_and_b32 v25, 0xffff0000, v12
    v_lshlrev_b32 v26, 16, v13
    v_and_b32 v27, 0xffff0000, v13
    v_lshlrev_b32 v28, 16, v14
    v_and_b32 v29, 0xffff0000, v14
    v_lshlrev_b32 v30, 16, v15
    v_and_b32 v31, 0xffff0000, v15
    v_add_f32 v32, v16, v17
    v_add_f32 v33, v18, v19
    v_add_f32 v34, v20, v21
    v_add_f32 v35, v22, v23
    v_add_f32 v32, v32, v33
    v_add_f32 v34, v34, v35
    v_add_f32 v56, v32, v34
    v_add_f32 v40, v24, v25
    v_add_f32 v41, v26, v27
    v_add_f32 v42, v28, v29
    v_add_f32 v43, v30, v31
    v_add_f32 v40, v40, v41
    v_add_f32 v42, v42, v43
    v_add_f32 v60, v40, v42
    s_nop 1
    v_add_f32_dpp v56, v56, v56 quad_perm:[1,0,3,2] row_mask:0xf bank_mask:0xf
    v_add_f32_dpp v60, v60, v60 quad_perm:[1,0,3,2] row_mask:0xf bank_mask:0xf
    s_nop 1
    v_add_f32_dpp v56, v56, v56 quad_perm:[2,3,0,1] row_mask:0xf bank_mask:0xf
    v_add_f32_dpp v60, v60, v60 quad_perm:[2,3,0,1] row_mask:0xf bank_mask:0xf
    s_nop 1
    v_add_f32_dpp v56, v56, v56 row_half_mirror row_mask:0xf bank_mask:0xf
    v_add_f32_dpp v60, v60, v60 row_half_mirror row_mask:0xf bank_mask:0xf
    s_nop 1
    v_add_f32_dpp v56, v56, v56 row_mirror row_mask:0xf bank_mask:0xf
    v_add_f32_dpp v60, v60, v60 row_mirror row_mask:0xf bank_mask:0xf
    v_mov_b32 v57, v56
    v_mov_b32 v61, v60
    s_nop 1
    v_permlane16_swap_b32 v56, v57
    v_permlane16_swap_b32 v60, v61
    s_nop 1
    v_add_f32 v56, v56, v57
    v_add_f32 v60, v60, v61
    v_mov_b32 v57, v56
    v_mov_b32 v61, v60
    s_nop 1
    v_permlane32_swap_b32 v56, v57
    v_permlane32_swap_b32 v60, v61
    s_nop 1
    v_add_f32 v56, v56, v57
    v_add_f32 v60, v60, v61
    v_mul_f32 v56, 0x3b000000, v56
    v_mul_f32 v60, 0x3b000000, v60
    v_sub_f32 v32, v16, v56
    v_sub_f32 v33, v17, v56
    v_sub_f32 v34, v18, v56
    v_sub_f32 v35, v19, v56
    v_sub_f32 v36, v20, v56
    v_sub_f32 v37, v21, v56
    v_sub_f32 v38, v22, v56
    v_sub_f32 v39, v23, v56
    v_mul_f32 v58, v32, v32
    v_fmac_f32 v58, v33, v33
    v_fmac_f32 v58, v34, v34
    v_fmac_f32 v58, v35, v35
    v_fmac_f32 v58, v36, v36
    v_fmac_f32 v58, v37, v37
    v_fmac_f32 v58, v38, v38
    v_fmac_f32 v58, v39, v39
    v_sub_f32 v40, v24, v60
    v_sub_f32 v41, v25, v60
    v_sub_f32 v42, v26, v60
    v_sub_f32 v43, v27, v60
    v_sub_f32 v44, v28, v60
    v_sub_f32 v45, v29, v60
    v_sub_f32 v46, v30, v60
    v_sub_f32 v47, v31, v60
    v_mul_f32 v62, v40, v40
    v_fmac_f32 v62, v41, v41
    v_fmac_f32 v62, v42, v42
    v_fmac_f32 v62, v43, v43
    v_fmac_f32 v62, v44, v44
    v_fmac_f32 v62, v45, v45
    v_fmac_f32 v62, v46, v46
    v_fmac_f32 v62, v47, v47
    s_nop 1
    v_add_f32_dpp v58, v58, v58 quad_perm:[1,0,3,2] row_mask:0xf bank_mask:0xf
    v_add_f32_dpp v62, v62, v62 quad_perm:[1,0,3,2] row_mask:0xf bank_mask:0xf
    s_nop 1
    v_add_f32_dpp v58, v58, v58 quad_perm:[2,3,0,1] row_mask:0xf bank_mask:0xf
    v_add_f32_dpp v62, v62, v62 quad_perm:[2,3,0,1] row_mask:0xf bank_mask:0xf
    s_nop 1
    v_add_f32_dpp v58, v58, v58 row_half_mirror row_mask:0xf bank_mask:0xf
    v_add_f32_dpp v62, v62, v62 row_half_mirror row_mask:0xf bank_mask:0xf
    s_nop 1
    v_add_f32_dpp v58, v58, v58 row_mirror row_mask:0xf bank_mask:0xf
    v_add_f32_dpp v62, v62, v62 row_mirror row_mask:0xf bank_mask:0xf
    v_mov_b32 v57, v58
    v_mov_b32 v61, v62
    s_nop 1
    v_permlane16_swap_b32 v58, v57
    v_permlane16_swap_b32 v62, v61
    s_nop 1
    v_add_f32 v58, v58, v57
    v_add_f32 v62, v62, v61
    v_mov_b32 v57, v58
    v_mov_b32 v61, v62
    s_nop 1
    v_permlane32_swap_b32 v58, v57
    v_permlane32_swap_b32 v62, v61
    s_nop 1
    v_add_f32 v58, v58, v57
    v_add_f32 v62, v62, v61
    s_mov_b32 s6, 0x3727c5ac
    v_mul_f32 v58, 0x3b000000, v58
    v_mul_f32 v62, 0x3b000000, v62
    v_cvt_pk_bf16_f32 v58, v58, v58
    v_lshlrev_b32 v58, 16, v58
    v_cvt_pk_bf16_f32 v62, v62, v62
    v_lshlrev_b32 v62, 16, v62
    v_add_f32 v58, s6, v58
    v_add_f32 v62, s6, v62
    v_cvt_pk_bf16_f32 v58, v58, v58
    v_lshlrev_b32 v58, 16, v58
    v_cvt_pk_bf16_f32 v62, v62, v62
    v_lshlrev_b32 v62, 16, v62
    v_sqrt_f32 v58, v58
    v_sqrt_f32 v62, v62
    s_nop 0
    v_cvt_pk_bf16_f32 v58, v58, v58
    v_lshlrev_b32 v58, 16, v58
    v_cvt_pk_bf16_f32 v62, v62, v62
    v_lshlrev_b32 v62, 16, v62
    v_rcp_f32 v58, v58
    v_rcp_f32 v62, v62
    v_cvt_pk_bf16_f32 v56, v56, v56
    v_lshlrev_b32 v56, 16, v56
    v_cvt_pk_bf16_f32 v60, v60, v60
    v_lshlrev_b32 v60, 16, v60
    v_sub_f32 v16, v16, v56
    v_sub_f32 v17, v17, v56
    v_sub_f32 v18, v18, v56
    v_sub_f32 v19, v19, v56
    v_sub_f32 v20, v20, v56
    v_sub_f32 v21, v21, v56
    v_sub_f32 v22, v22, v56
    v_sub_f32 v23, v23, v56
    v_cvt_pk_bf16_f32 v48, v16, v17
    v_cvt_pk_bf16_f32 v49, v18, v19
    v_cvt_pk_bf16_f32 v50, v20, v21
    v_cvt_pk_bf16_f32 v51, v22, v23
    v_lshlrev_b32 v16, 16, v48
    v_and_b32 v17, 0xffff0000, v48
    v_lshlrev_b32 v18, 16, v49
    v_and_b32 v19, 0xffff0000, v49
    v_lshlrev_b32 v20, 16, v50
    v_and_b32 v21, 0xffff0000, v50
    v_lshlrev_b32 v22, 16, v51
    v_and_b32 v23, 0xffff0000, v51
    v_mul_f32 v16, v16, v58
    v_mul_f32 v17, v17, v58
    v_mul_f32 v18, v18, v58
    v_mul_f32 v19, v19, v58
    v_mul_f32 v20, v20, v58
    v_mul_f32 v21, v21, v58
    v_mul_f32 v22, v22, v58
    v_mul_f32 v23, v23, v58
    v_cvt_pk_bf16_f32 v48, v16, v17
    v_cvt_pk_bf16_f32 v49, v18, v19
    v_cvt_pk_bf16_f32 v50, v20, v21
    v_cvt_pk_bf16_f32 v51, v22, v23
    v_lshlrev_b32 v16, 16, v48
    v_and_b32 v17, 0xffff0000, v48
    v_lshlrev_b32 v18, 16, v49
    v_and_b32 v19, 0xffff0000, v49
    v_lshlrev_b32 v20, 16, v50
    v_and_b32 v21, 0xffff0000, v50
    v_lshlrev_b32 v22, 16, v51
    v_and_b32 v23, 0xffff0000, v51
    v_sub_f32 v24, v24, v60
    v_sub_f32 v25, v25, v60
    v_sub_f32 v26, v26, v60
    v_sub_f32 v27, v27, v60
    v_sub_f32 v28, v28, v60
    v_sub_f32 v29, v29, v60
    v_sub_f32 v30, v30, v60
    v_sub_f32 v31, v31, v60
    v_cvt_pk_bf16_f32 v52, v24, v25
    v_cvt_pk_bf16_f32 v53, v26, v27
    v_cvt_pk_bf16_f32 v54, v28, v29
    v_cvt_pk_bf16_f32 v55, v30, v31
    v_lshlrev_b32 v24, 16, v52
    v_and_b32 v25, 0xffff0000, v52
    v_lshlrev_b32 v26, 16, v53
    v_and_b32 v27, 0xffff0000, v53
    v_lshlrev_b32 v28, 16, v54
    v_and_b32 v29, 0xffff0000, v54
    v_lshlrev_b32 v30, 16, v55
    v_and_b32 v31, 0xffff0000, v55
    v_mul_f32 v24, v24, v62
    v_mul_f32 v25, v25, v62
    v_mul_f32 v26, v26, v62
    v_mul_f32 v27, v27, v62
    v_mul_f32 v28, v28, v62
    v_mul_f32 v29, v29, v62
    v_mul_f32 v30, v30, v62
    v_mul_f32 v31, v31, v62
    v_cvt_pk_bf16_f32 v52, v24, v25
    v_cvt_pk_bf16_f32 v53, v26, v27
    v_cvt_pk_bf16_f32 v54, v28, v29
    v_cvt_pk_bf16_f32 v55, v30, v31
    v_lshlrev_b32 v24, 16, v52
    v_and_b32 v25, 0xffff0000, v52
    v_lshlrev_b32 v26, 16, v53
    v_and_b32 v27, 0xffff0000, v53
    v_lshlrev_b32 v28, 16, v54
    v_and_b32 v29, 0xffff0000, v54
    v_lshlrev_b32 v30, 16, v55
    v_and_b32 v31, 0xffff0000, v55
    s_waitcnt vmcnt(0)
    v_add_f32 v144, 1.0, v144
    v_add_f32 v145, 1.0, v145
    v_add_f32 v146, 1.0, v146
    v_add_f32 v147, 1.0, v147
    v_add_f32 v148, 1.0, v148
    v_add_f32 v149, 1.0, v149
    v_add_f32 v150, 1.0, v150
    v_add_f32 v151, 1.0, v151
    v_cvt_pk_bf16_f32 v32, v144, v145
    v_cvt_pk_bf16_f32 v33, v146, v147
    v_cvt_pk_bf16_f32 v34, v148, v149
    v_cvt_pk_bf16_f32 v35, v150, v151
    v_lshlrev_b32 v144, 16, v32
    v_and_b32 v145, 0xffff0000, v32
    v_lshlrev_b32 v146, 16, v33
    v_and_b32 v147, 0xffff0000, v33
    v_lshlrev_b32 v148, 16, v34
    v_and_b32 v149, 0xffff0000, v34
    v_lshlrev_b32 v150, 16, v35
    v_and_b32 v151, 0xffff0000, v35
    v_mul_f32 v16, v16, v144
    v_mul_f32 v17, v17, v145
    v_mul_f32 v18, v18, v146
    v_mul_f32 v19, v19, v147
    v_mul_f32 v20, v20, v148
    v_mul_f32 v21, v21, v149
    v_mul_f32 v22, v22, v150
    v_mul_f32 v23, v23, v151
    v_cvt_pk_bf16_f32 v48, v16, v17
    v_cvt_pk_bf16_f32 v49, v18, v19
    v_cvt_pk_bf16_f32 v50, v20, v21
    v_cvt_pk_bf16_f32 v51, v22, v23
    v_lshlrev_b32 v16, 16, v48
    v_and_b32 v17, 0xffff0000, v48
    v_lshlrev_b32 v18, 16, v49
    v_and_b32 v19, 0xffff0000, v49
    v_lshlrev_b32 v20, 16, v50
    v_and_b32 v21, 0xffff0000, v50
    v_lshlrev_b32 v22, 16, v51
    v_and_b32 v23, 0xffff0000, v51
    v_add_f32 v16, v16, v136
    v_add_f32 v17, v17, v137
    v_add_f32 v18, v18, v138
    v_add_f32 v19, v19, v139
    v_add_f32 v20, v20, v140
    v_add_f32 v21, v21, v141
    v_add_f32 v22, v22, v142
    v_add_f32 v23, v23, v143
    v_cvt_pk_bf16_f32 v48, v16, v17
    v_cvt_pk_bf16_f32 v49, v18, v19
    v_cvt_pk_bf16_f32 v50, v20, v21
    v_cvt_pk_bf16_f32 v51, v22, v23
    v_lshlrev_b32 v16, 16, v48
    v_and_b32 v17, 0xffff0000, v48
    v_lshlrev_b32 v18, 16, v49
    v_and_b32 v19, 0xffff0000, v49
    v_lshlrev_b32 v20, 16, v50
    v_and_b32 v21, 0xffff0000, v50
    v_lshlrev_b32 v22, 16, v51
    v_and_b32 v23, 0xffff0000, v51
    v_sub_f32 v32, v16, v17
    v_sub_f32 v33, v18, v19
    v_sub_f32 v34, v20, v21
    v_sub_f32 v35, v22, v23
    v_add_f32 v32, v32, v33
    v_add_f32 v34, v34, v35
    v_add_f32 v59, v32, v34
    v_cvt_pk_f16_f32 v48, v16, v17
    v_cvt_pk_f16_f32 v49, v18, v19
    v_cvt_pk_f16_f32 v50, v20, v21
    v_cvt_pk_f16_f32 v51, v22, v23
    v_mul_f32 v24, v24, v144
    v_mul_f32 v25, v25, v145
    v_mul_f32 v26, v26, v146
    v_mul_f32 v27, v27, v147
    v_mul_f32 v28, v28, v148
    v_mul_f32 v29, v29, v149
    v_mul_f32 v30, v30, v150
    v_mul_f32 v31, v31, v151
    v_cvt_pk_bf16_f32 v52, v24, v25
    v_cvt_pk_bf16_f32 v53, v26, v27
    v_cvt_pk_bf16_f32 v54, v28, v29
    v_cvt_pk_bf16_f32 v55, v30, v31
    v_lshlrev_b32 v24, 16, v52
    v_and_b32 v25, 0xffff0000, v52
    v_lshlrev_b32 v26, 16, v53
    v_and_b32 v27, 0xffff0000, v53
    v_lshlrev_b32 v28, 16, v54
    v_and_b32 v29, 0xffff0000, v54
    v_lshlrev_b32 v30, 16, v55
    v_and_b32 v31, 0xffff0000, v55
    v_add_f32 v24, v24, v136
    v_add_f32 v25, v25, v137
    v_add_f32 v26, v26, v138
    v_add_f32 v27, v27, v139
    v_add_f32 v28, v28, v140
    v_add_f32 v29, v29, v141
    v_add_f32 v30, v30, v142
    v_add_f32 v31, v31, v143
    v_cvt_pk_bf16_f32 v52, v24, v25
    v_cvt_pk_bf16_f32 v53, v26, v27
    v_cvt_pk_bf16_f32 v54, v28, v29
    v_cvt_pk_bf16_f32 v55, v30, v31
    v_lshlrev_b32 v24, 16, v52
    v_and_b32 v25, 0xffff0000, v52
    v_lshlrev_b32 v26, 16, v53
    v_and_b32 v27, 0xffff0000, v53
    v_lshlrev_b32 v28, 16, v54
    v_and_b32 v29, 0xffff0000, v54
    v_lshlrev_b32 v30, 16, v55
    v_and_b32 v31, 0xffff0000, v55
    v_sub_f32 v40, v24, v25
    v_sub_f32 v41, v26, v27
    v_sub_f32 v42, v28, v29
    v_sub_f32 v43, v30, v31
    v_add_f32 v40, v40, v41
    v_add_f32 v42, v42, v43
    v_add_f32 v63, v40, v42
    v_cvt_pk_f16_f32 v52, v24, v25
    v_cvt_pk_f16_f32 v53, v26, v27
    v_cvt_pk_f16_f32 v54, v28, v29
    v_cvt_pk_f16_f32 v55, v30, v31
    v_lshl_add_u32 v4, v2, 11, v3
    ds_write_b128 v4, v[48:51]
    ds_write_b128 v4, v[52:55] offset:1024
    v_lshrrev_b32 v5, 4, v1
    v_lshlrev_b32 v6, 8, v5
    v_bfe_u32 v8, v1, 2, 2
    v_lshl_add_u32 v6, v8, 5, v6
    v_and_b32 v8, 3, v1
    v_lshl_add_u32 v6, v8, 3, v6
    v_lshl_add_u32 v6, v2, 11, v6
    s_nop 1
    v_add_f32_dpp v59, v59, v59 quad_perm:[1,0,3,2] row_mask:0xf bank_mask:0xf
    v_add_f32_dpp v63, v63, v63 quad_perm:[1,0,3,2] row_mask:0xf bank_mask:0xf
    s_nop 1
    v_add_f32_dpp v59, v59, v59 quad_perm:[2,3,0,1] row_mask:0xf bank_mask:0xf
    v_add_f32_dpp v63, v63, v63 quad_perm:[2,3,0,1] row_mask:0xf bank_mask:0xf
    s_nop 1
    v_add_f32_dpp v59, v59, v59 row_half_mirror row_mask:0xf bank_mask:0xf
    v_add_f32_dpp v63, v63, v63 row_half_mirror row_mask:0xf bank_mask:0xf
    s_nop 1
    v_add_f32_dpp v59, v59, v59 row_mirror row_mask:0xf bank_mask:0xf
    v_add_f32_dpp v63, v63, v63 row_mirror row_mask:0xf bank_mask:0xf
    v_mov_b32 v57, v59
    v_mov_b32 v61, v63
    s_nop 1
    v_permlane16_swap_b32 v59, v57
    v_permlane16_swap_b32 v63, v61
    s_nop 1
    v_add_f32 v59, v59, v57
    v_add_f32 v63, v63, v61
    v_mov_b32 v57, v59
    v_mov_b32 v61, v63
    s_nop 1
    v_permlane32_swap_b32 v59, v57
    v_permlane32_swap_b32 v63, v61
    s_nop 1
    v_add_f32 v59, v59, v57
    v_add_f32 v63, v63, v61
    s_waitcnt lgkmcnt(0)
    ds_read_b64_tr_b16 v[64:65], v6 offset:0
    ds_read_b64_tr_b16 v[66:67], v6 offset:128
    ds_read_b64_tr_b16 v[68:69], v6 offset:1024
    ds_read_b64_tr_b16 v[70:71], v6 offset:1152
    s_waitcnt lgkmcnt(0)
    v_mfma_f32_16x16x32_f16 v[72:75], v[64:67], v[100:103], 0
    v_mfma_f32_16x16x32_f16 v[76:79], v[64:67], v[108:111], 0
    v_mfma_f32_16x16x32_f16 v[80:83], v[64:67], v[104:107], 0
    v_mfma_f32_16x16x32_f16 v[84:87], v[64:67], v[112:115], 0
    v_mfma_f32_16x16x32_f16 v[88:91], v[68:71], v[100:103], 0
    v_mfma_f32_16x16x32_f16 v[92:95], v[68:71], v[108:111], 0
    v_mfma_f32_16x16x32_f16 v[96:99], v[68:71], v[104:107], 0
    v_mfma_f32_16x16x32_f16 v[100:103], v[68:71], v[112:115], 0
    s_nop 7
    s_nop 1
    v_mul_f32 v32, v76, v121
    v_mul_f32 v33, v76, v120
    v_fma_f32 v32, v72, v120, -v32
    v_fma_f32 v33, v72, v121, v33
    v_cvt_pk_f16_f32 v16, v32, v33
    v_mul_f32 v32, v77, v123
    v_mul_f32 v33, v77, v122
    v_fma_f32 v32, v73, v122, -v32
    v_fma_f32 v33, v73, v123, v33
    v_cvt_pk_f16_f32 v17, v32, v33
    v_mul_f32 v32, v78, v125
    v_mul_f32 v33, v78, v124
    v_fma_f32 v32, v74, v124, -v32
    v_fma_f32 v33, v74, v125, v33
    v_cvt_pk_f16_f32 v18, v32, v33
    v_mul_f32 v32, v79, v127
    v_mul_f32 v33, v79, v126
    v_fma_f32 v32, v75, v126, -v32
    v_fma_f32 v33, v75, v127, v33
    v_cvt_pk_f16_f32 v19, v32, v33
    v_mul_f32 v32, v84, v129
    v_mul_f32 v33, v84, v128
    v_fma_f32 v32, v80, v128, -v32
    v_fma_f32 v33, v80, v129, v33
    v_cvt_pk_f16_f32 v20, v32, v33
    v_mul_f32 v32, v85, v131
    v_mul_f32 v33, v85, v130
    v_fma_f32 v32, v81, v130, -v32
    v_fma_f32 v33, v81, v131, v33
    v_cvt_pk_f16_f32 v21, v32, v33
    v_mul_f32 v32, v86, v133
    v_mul_f32 v33, v86, v132
    v_fma_f32 v32, v82, v132, -v32
    v_fma_f32 v33, v82, v133, v33
    v_cvt_pk_f16_f32 v22, v32, v33
    v_mul_f32 v32, v87, v135
    v_mul_f32 v33, v87, v134
    v_fma_f32 v32, v83, v134, -v32
    v_fma_f32 v33, v83, v135, v33
    v_cvt_pk_f16_f32 v23, v32, v33
    v_mul_f32 v32, v92, v121
    v_mul_f32 v33, v92, v120
    v_fma_f32 v32, v88, v120, -v32
    v_fma_f32 v33, v88, v121, v33
    v_cvt_pk_f16_f32 v24, v32, v33
    v_mul_f32 v32, v93, v123
    v_mul_f32 v33, v93, v122
    v_fma_f32 v32, v89, v122, -v32
    v_fma_f32 v33, v89, v123, v33
    v_cvt_pk_f16_f32 v25, v32, v33
    v_mul_f32 v32, v94, v125
    v_mul_f32 v33, v94, v124
    v_fma_f32 v32, v90, v124, -v32
    v_fma_f32 v33, v90, v125, v33
    v_cvt_pk_f16_f32 v26, v32, v33
    v_mul_f32 v32, v95, v127
    v_mul_f32 v33, v95, v126
    v_fma_f32 v32, v91, v126, -v32
    v_fma_f32 v33, v91, v127, v33
    v_cvt_pk_f16_f32 v27, v32, v33
    v_mul_f32 v32, v100, v129
    v_mul_f32 v33, v100, v128
    v_fma_f32 v32, v96, v128, -v32
    v_fma_f32 v33, v96, v129, v33
    v_cvt_pk_f16_f32 v28, v32, v33
    v_mul_f32 v32, v101, v131
    v_mul_f32 v33, v101, v130
    v_fma_f32 v32, v97, v130, -v32
    v_fma_f32 v33, v97, v131, v33
    v_cvt_pk_f16_f32 v29, v32, v33
    v_mul_f32 v32, v102, v133
    v_mul_f32 v33, v102, v132
    v_fma_f32 v32, v98, v132, -v32
    v_fma_f32 v33, v98, v133, v33
    v_cvt_pk_f16_f32 v30, v32, v33
    v_mul_f32 v32, v103, v135
    v_mul_f32 v33, v103, v134
    v_fma_f32 v32, v99, v134, -v32
    v_fma_f32 v33, v99, v135, v33
    v_cvt_pk_f16_f32 v31, v32, v33
    s_nop 1
    v_mfma_f32_16x16x32_f16 v[72:75], v[116:119], v[16:19], 0
    v_mfma_f32_16x16x32_f16 v[76:79], v[116:119], v[20:23], 0
    v_mfma_f32_16x16x32_f16 v[80:83], v[116:119], v[24:27], 0
    v_mfma_f32_16x16x32_f16 v[84:87], v[116:119], v[28:31], 0
    v_and_b32 v8, 15, v1
    v_lshl_add_u32 v8, v5, 6, v8
    v_lshlrev_b32 v8, 5, v8
    v_lshl_add_u32 v8, v2, 3, v8
    v_mul_f32 v40, 0x3d800000, v59
    v_mul_f32 v41, 0x3d800000, v63
    v_cvt_pk_f16_f32 v40, v40, 0
    v_cvt_pk_f16_f32 v41, v41, 0
    v_lshlrev_b32 v9, 3, v2
    s_nop 2
    v_cvt_pk_f16_f32 v32, v72, v73
    v_cvt_pk_f16_f32 v34, v74, v75
    v_cvt_pk_f16_f32 v36, v76, v77
    v_cvt_pk_f16_f32 v38, v78, v79
    v_cvt_pk_f16_f32 v33, v80, v81
    v_cvt_pk_f16_f32 v35, v82, v83
    v_cvt_pk_f16_f32 v37, v84, v85
    v_cvt_pk_f16_f32 v39, v86, v87
    ds_write_b64 v8, v[32:33] offset:8192
    ds_write_b64 v8, v[34:35] offset:9216
    ds_write_b64 v8, v[36:37] offset:8704
    ds_write_b64 v8, v[38:39] offset:9728
    ds_write_b64 v9, v[40:41] offset:16384
    s_waitcnt lgkmcnt(0)
    s_barrier
    v_lshl_add_u32 v9, v2, 10, v3
    ds_read_b128 v[32:35], v9 offset:8192
    ds_read_b128 v[36:39], v9 offset:12288
    v_mov_b32 v10, 0x4000
    v_lshl_add_u32 v10, v1, 4, v10
    ds_read_b128 v[40:43], v10
    v_lshrrev_b32 v8, 1, v1
    v_lshl_add_u32 v8, v2, 5, v8
    v_lshlrev_b32 v8, 13, v8
    v_and_b32 v9, 1, v1
    v_lshl_add_u32 v8, v9, 4, v8
    s_lshl_b32 s6, s3, 8
    s_lshl_b32 s7, s4, 5
    s_add_u32 s6, s6, s7
    v_add_u32 v8, s6, v8
    s_add_u32 s8, s34, 0x700000
    s_addc_u32 s9, s35, 0
    s_waitcnt lgkmcnt(0)
    global_store_dwordx4 v8, v[32:35], s[8:9]
    v_add_u32 v9, 0x100000, v8
    global_store_dwordx4 v9, v[36:39], s[8:9]
    v_cmp_gt_u32 vcc, 2, v0
    s_and_saveexec_b64 s[6:7], vcc
    s_cbranch_execz .Lp1_skip
    v_add_u32 v9, 0x200000, v8
    global_store_dwordx4 v9, v[40:43], s[8:9]
.Lp1_skip:
    s_mov_b64 exec, -1
.Lp1_done:
    s_endpgm
.globl p2_kernel
.p2align 8
.type p2_kernel,@function
p2_kernel:
    s_load_dwordx16 s[16:31], s[0:1], 0
    s_load_dwordx2 s[32:33], s[0:1], 64
    s_load_dwordx4 s[36:39], s[0:1], 72
    s_load_dwordx2 s[34:35], s[0:1], 80
    s_cmp_ge_u32 s2, 257
    s_cbranch_scc1 .Lp2_done
    s_getpc_b64 s[10:11]
.Lpc_p2:
    s_add_u32 s10, s10, tbl_p2-.Lpc_p2
    s_addc_u32 s11, s11, 0
    v_and_b32 v1, 63, v0
    v_lshrrev_b32 v2, 6, v0
    v_lshlrev_b32 v3, 4, v1
    v_lshl_add_u32 v4, v2, 14, v3
    global_load_dwordx4 v[64:67], v4, s[10:11] offset:0
    global_load_dwordx4 v[68:71], v4, s[10:11] offset:1024
    global_load_dwordx4 v[72:75], v4, s[10:11] offset:2048
    global_load_dwordx4 v[76:79], v4, s[10:11] offset:3072
    v_add_u32 v4, 0x1000, v4
    global_load_dwordx4 v[80:83], v4, s[10:11] offset:0
    global_load_dwordx4 v[84:87], v4, s[10:11] offset:1024
    global_load_dwordx4 v[88:91], v4, s[10:11] offset:2048
    global_load_dwordx4 v[92:95], v4, s[10:11] offset:3072
    v_add_u32 v4, 0x1000, v4
    global_load_dwordx4 v[96:99], v4, s[10:11] offset:0
    global_load_dwordx4 v[100:103], v4, s[10:11] offset:1024
    global_load_dwordx4 v[104:107], v4, s[10:11] offset:2048
    global_load_dwordx4 v[108:111], v4, s[10:11] offset:3072
    v_add_u32 v4, 0x1000, v4
    global_load_dwordx4 v[112:115], v4, s[10:11] offset:0
    global_load_dwordx4 v[116:119], v4, s[10:11] offset:1024
    global_load_dwordx4 v[120:123], v4, s[10:11] offset:2048
    global_load_dwordx4 v[124:127], v4, s[10:11] offset:3072
    s_nop 0
    v_readfirstlane_b32 s40, v2
    s_lshl_b32 s41, s40, 10
    s_add_u32 m0, s41, 0x4000
    v_add_u32 v4, 0x10000, v3
    v_add_u32 v4, s41, v4
    global_load_lds_dwordx4 v4, s[10:11]
    s_cmp_lt_u32 s40, 2
    s_cbranch_scc0 .Lp2_a
    s_add_u32 m0, s41, 0x5000
    v_add_u32 v4, 0x1000, v4
    global_load_lds_dwordx4 v4, s[10:11]
.Lp2_a:
    s_waitcnt lgkmcnt(0)
    s_add_u32 s8, s34, 0x700000
    s_addc_u32 s9, s35, 0
    s_add_u32 s12, s34, 0x10000
    s_addc_u32 s13, s35, 0
    s_lshl_b32 s3, s2, 13
    v_and_b32 v5, 15, v1
    v_lshrrev_b32 v6, 4, v1
    v_lshlrev_b32 v7, 8, v5
    v_lshl_add_u32 v7, v6, 4, v7
    v_add_u32 v7, s3, v7
    v_lshl_add_u32 v7, v2, 6, v7
    s_add_u32 m0, s41, 0x2000
    s_nop 0
    global_load_lds_dwordx4 v7, s[8:9]
    s_add_u32 m0, s41, 0x3000
    v_add_u32 v7, 0x1000, v7
    global_load_lds_dwordx4 v7, s[8:9]
    v_lshl_add_u32 v8, v2, 11, v3
    v_add_u32 v8, s3, v8
    global_load_dwordx4 v[152:155], v8, s[12:13]
    global_load_dwordx4 v[156:159], v8, s[12:13] offset:1024
    s_waitcnt vmcnt(2)
    s_barrier
    ds_read_b128 v[16:19], v3 offset:8192
    ds_read_b128 v[20:23], v3 offset:9216
    ds_read_b128 v[24:27], v3 offset:10240
    ds_read_b128 v[28:31], v3 offset:11264
    ds_read_b128 v[32:35], v3 offset:12288
    ds_read_b128 v[36:39], v3 offset:13312
    ds_read_b128 v[40:43], v3 offset:14336
    ds_read_b128 v[44:47], v3 offset:15360
    ds_read_b128 v[128:131], v3 offset:16384
    ds_read_b128 v[132:135], v3 offset:17408
    ds_read_b128 v[136:139], v3 offset:18432
    ds_read_b128 v[140:143], v3 offset:19456
    ds_read_b128 v[144:147], v3 offset:20480
    ds_read_b128 v[148:151], v3 offset:21504
    s_waitcnt lgkmcnt(6)
    v_mfma_f32_16x16x32_f16 v[160:163], v[16:19], v[64:67], 0
    v_mfma_f32_16x16x32_f16 v[164:167], v[16:19], v[68:71], 0
    v_mfma_f32_16x16x32_f16 v[160:163], v[20:23], v[72:75], v[160:163]
    v_mfma_f32_16x16x32_f16 v[164:167], v[20:23], v[76:79], v[164:167]
    v_mfma_f32_16x16x32_f16 v[160:163], v[24:27], v[80:83], v[160:163]
    v_mfma_f32_16x16x32_f16 v[164:167], v[24:27], v[84:87], v[164:167]
    v_mfma_f32_16x16x32_f16 v[160:163], v[28:31], v[88:91], v[160:163]
    v_mfma_f32_16x16x32_f16 v[164:167], v[28:31], v[92:95], v[164:167]
    v_mfma_f32_16x16x32_f16 v[168:171], v[32:35], v[64:67], 0
    v_mfma_f32_16x16x32_f16 v[172:175], v[32:35], v[68:71], 0
    v_mfma_f32_16x16x32_f16 v[168:171], v[36:39], v[72:75], v[168:171]
    v_mfma_f32_16x16x32_f16 v[172:175], v[36:39], v[76:79], v[172:175]
    v_mfma_f32_16x16x32_f16 v[168:171], v[40:43], v[80:83], v[168:171]
    v_mfma_f32_16x16x32_f16 v[172:175], v[40:43], v[84:87], v[172:175]
    v_mfma_f32_16x16x32_f16 v[168:171], v[44:47], v[88:91], v[168:171]
    v_mfma_f32_16x16x32_f16 v[172:175], v[44:47], v[92:95], v[172:175]
    s_waitcnt lgkmcnt(0)
    s_nop 7
    v_mul_f32 v32, v164, v97
    v_mul_f32 v33, v164, v96
    v_fma_f32 v16, v160, v96, -v32
    v_fma_f32 v24, v160, v97, v33
    v_mul_f32 v32, v165, v99
    v_mul_f32 v33, v165, v98
    v_fma_f32 v17, v161, v98, -v32
    v_fma_f32 v25, v161, v99, v33
    v_mul_f32 v32, v166, v101
    v_mul_f32 v33, v166, v100
    v_fma_f32 v18, v162, v100, -v32
    v_fma_f32 v26, v162, v101, v33
    v_mul_f32 v32, v167, v103
    v_mul_f32 v33, v167, v102
    v_fma_f32 v19, v163, v102, -v32
    v_fma_f32 v27, v163, v103, v33
    v_mul_f32 v32, v172, v105
    v_mul_f32 v33, v172, v104
    v_fma_f32 v20, v168, v104, -v32
    v_fma_f32 v28, v168, v105, v33
    v_mul_f32 v32, v173, v107
    v_mul_f32 v33, v173, v106
    v_fma_f32 v21, v169, v106, -v32
    v_fma_f32 v29, v169, v107, v33
    v_mul_f32 v32, v174, v109
    v_mul_f32 v33, v174, v108
    v_fma_f32 v22, v170, v108, -v32
    v_fma_f32 v30, v170, v109, v33
    v_mul_f32 v32, v175, v111
    v_mul_f32 v33, v175, v110
    v_fma_f32 v23, v171, v110, -v32
    v_fma_f32 v31, v171, v111, v33
    v_cvt_pk_f16_f32 v32, v16, v17
    v_cvt_pk_f16_f32 v36, v24, v25
    v_cvt_pk_f16_f32 v33, v18, v19
    v_cvt_pk_f16_f32 v37, v26, v27
    v_cvt_pk_f16_f32 v34, v20, v21
    v_cvt_pk_f16_f32 v38, v28, v29
    v_cvt_pk_f16_f32 v35, v22, v23
    v_cvt_pk_f16_f32 v39, v30, v31
    s_nop 1
    v_mfma_f32_16x16x32_f16 v[160:163], v[128:131], v[32:35], 0
    v_mfma_f32_16x16x32_f16 v[164:167], v[128:131], v[36:39], 0
    v_mfma_f32_16x16x32_f16 v[160:163], v[132:135], v[36:39], v[160:163]
    v_mfma_f32_16x16x32_f16 v[164:167], v[136:139], v[32:35], v[164:167]
    v_mfma_f32_16x16x32_f16 v[168:171], v[140:143], v[32:35], 0
    v_mfma_f32_16x16x32_f16 v[172:175], v[140:143], v[36:39], 0
    v_mfma_f32_16x16x32_f16 v[168:171], v[144:147], v[36:39], v[168:171]
    v_mfma_f32_16x16x32_f16 v[172:175], v[148:151], v[32:35], v[172:175]
    s_waitcnt vmcnt(0)
    v_lshlrev_b32 v40, 16, v152
    v_and_b32 v48, 0xffff0000, v152
    v_lshlrev_b32 v41, 16, v153
    v_and_b32 v49, 0xffff0000, v153
    v_lshlrev_b32 v42, 16, v154
    v_and_b32 v50, 0xffff0000, v154
    v_lshlrev_b32 v43, 16, v155
    v_and_b32 v51, 0xffff0000, v155
    v_lshlrev_b32 v44, 16, v156
    v_and_b32 v52, 0xffff0000, v156
    v_lshlrev_b32 v45, 16, v157
    v_and_b32 v53, 0xffff0000, v157
    v_lshlrev_b32 v46, 16, v158
    v_and_b32 v54, 0xffff0000, v158
    v_lshlrev_b32 v47, 16, v159
    v_and_b32 v55, 0xffff0000, v159
    s_nop 3
    v_mul_f32 v56, v164, v48
    v_mul_f32 v57, v164, v40
    v_fma_f32 v16, v160, v40, -v56
    v_fma_f32 v24, v160, v48, v57
    v_mul_f32 v56, v165, v49
    v_mul_f32 v57, v165, v41
    v_fma_f32 v17, v161, v41, -v56
    v_fma_f32 v25, v161, v49, v57
    v_mul_f32 v56, v166, v50
    v_mul_f32 v57, v166, v42
    v_fma_f32 v18, v162, v42, -v56
    v_fma_f32 v26, v162, v50, v57
    v_mul_f32 v56, v167, v51
    v_mul_f32 v57, v167, v43
    v_fma_f32 v19, v163, v43, -v56
    v_fma_f32 v27, v163, v51, v57
    v_mul_f32 v56, v172, v52
    v_mul_f32 v57, v172, v44
    v_fma_f32 v20, v168, v44, -v56
    v_fma_f32 v28, v168, v52, v57
    v_mul_f32 v56, v173, v53
    v_mul_f32 v57, v173, v45
    v_fma_f32 v21, v169, v45, -v56
    v_fma_f32 v29, v169, v53, v57
    v_mul_f32 v56, v174, v54
    v_mul_f32 v57, v174, v46
    v_fma_f32 v22, v170, v46, -v56
    v_fma_f32 v30, v170, v54, v57
    v_mul_f32 v56, v175, v55
    v_mul_f32 v57, v175, v47
    v_fma_f32 v23, v171, v47, -v56
    v_fma_f32 v31, v171, v55, v57
    v_cvt_pk_f16_f32 v32, v16, v17
    v_cvt_pk_f16_f32 v36, v24, v25
    v_cvt_pk_f16_f32 v33, v18, v19
    v_cvt_pk_f16_f32 v37, v26, v27
    v_cvt_pk_f16_f32 v34, v20, v21
    v_cvt_pk_f16_f32 v38, v28, v29
    v_cvt_pk_f16_f32 v35, v22, v23
    v_cvt_pk_f16_f32 v39, v30, v31
    s_nop 1
    v_mfma_f32_16x16x32_f16 v[160:163], v[32:35], v[128:131], 0
    v_mfma_f32_16x16x32_f16 v[164:167], v[32:35], v[132:135], 0
    v_mfma_f32_16x16x32_f16 v[160:163], v[36:39], v[136:139], v[160:163]
    v_mfma_f32_16x16x32_f16 v[164:167], v[36:39], v[128:131], v[164:167]
    v_mfma_f32_16x16x32_f16 v[168:171], v[32:35], v[140:143], 0
    v_mfma_f32_16x16x32_f16 v[172:175], v[32:35], v[144:147], 0
    v_mfma_f32_16x16x32_f16 v[168:171], v[36:39], v[148:151], v[168:171]
    v_mfma_f32_16x16x32_f16 v[172:175], v[36:39], v[140:143], v[172:175]
    s_nop 7
    s_nop 1
    v_mul_f32 v32, v164, v113
    v_mul_f32 v33, v164, v112
    v_fma_f32 v32, v160, v112, -v32
    v_fma_f32 v33, v160, v113, v33
    v_cvt_pk_f16_f32 v16, v32, -v33
    v_mul_f32 v32, v165, v115
    v_mul_f32 v33, v165, v114
    v_fma_f32 v32, v161, v114, -v32
    v_fma_f32 v33, v161, v115, v33
    v_cvt_pk_f16_f32 v17, v32, -v33
    v_mul_f32 v32, v166, v117
    v_mul_f32 v33, v166, v116
    v_fma_f32 v32, v162, v116, -v32
    v_fma_f32 v33, v162, v117, v33
    v_cvt_pk_f16_f32 v18, v32, -v33
    v_mul_f32 v32, v167, v119
    v_mul_f32 v33, v167, v118
    v_fma_f32 v32, v163, v118, -v32
    v_fma_f32 v33, v163, v119, v33
    v_cvt_pk_f16_f32 v19, v32, -v33
    v_mul_f32 v32, v172, v121
    v_mul_f32 v33, v172, v120
    v_fma_f32 v32, v168, v120, -v32
    v_fma_f32 v33, v168, v121, v33
    v_cvt_pk_f16_f32 v20, v32, -v33
    v_mul_f32 v32, v173, v123
    v_mul_f32 v33, v173, v122
    v_fma_f32 v32, v169, v122, -v32
    v_fma_f32 v33, v169, v123, v33
    v_cvt_pk_f16_f32 v21, v32, -v33
    v_mul_f32 v32, v174, v125
    v_mul_f32 v33, v174, v124
    v_fma_f32 v32, v170, v124, -v32
    v_fma_f32 v33, v170, v125, v33
    v_cvt_pk_f16_f32 v22, v32, -v33
    v_mul_f32 v32, v175, v127
    v_mul_f32 v33, v175, v126
    v_fma_f32 v32, v171, v126, -v32
    v_fma_f32 v33, v171, v127, v33
    v_cvt_pk_f16_f32 v23, v32, -v33
    v_lshl_add_u32 v9, v2, 11, v3
    ds_write_b128 v9, v[16:19]
    ds_write_b128 v9, v[20:23] offset:1024
    s_waitcnt lgkmcnt(0)
    s_barrier
    ds_read_b128 v[16:19], v3 offset:0
    ds_read_b128 v[32:35], v3 offset:1024
    ds_read_b128 v[20:23], v3 offset:2048
    ds_read_b128 v[36:39], v3 offset:3072
    ds_read_b128 v[24:27], v3 offset:4096
    ds_read_b128 v[40:43], v3 offset:5120
    ds_read_b128 v[28:31], v3 offset:6144
    ds_read_b128 v[44:47], v3 offset:7168
    s_waitcnt lgkmcnt(0)
    v_mfma_f32_16x16x32_f16 v[160:163], v[16:19], v[64:67], 0
    v_mfma_f32_16x16x32_f16 v[164:167], v[16:19], v[68:71], 0
    v_mfma_f32_16x16x32_f16 v[160:163], v[20:23], v[72:75], v[160:163]
    v_mfma_f32_16x16x32_f16 v[164:167], v[20:23], v[76:79], v[164:167]
    v_mfma_f32_16x16x32_f16 v[160:163], v[24:27], v[80:83], v[160:163]
    v_mfma_f32_16x16x32_f16 v[164:167], v[24:27], v[84:87], v[164:167]
    v_mfma_f32_16x16x32_f16 v[160:163], v[28:31], v[88:91], v[160:163]
    v_mfma_f32_16x16x32_f16 v[164:167], v[28:31], v[92:95], v[164:167]
    v_mfma_f32_16x16x32_f16 v[168:171], v[32:35], v[64:67], 0
    v_mfma_f32_16x16x32_f16 v[172:175], v[32:35], v[68:71], 0
    v_mfma_f32_16x16x32_f16 v[168:171], v[36:39], v[72:75], v[168:171]
    v_mfma_f32_16x16x32_f16 v[172:175], v[36:39], v[76:79], v[172:175]
    v_mfma_f32_16x16x32_f16 v[168:171], v[40:43], v[80:83], v[168:171]
    v_mfma_f32_16x16x32_f16 v[172:175], v[40:43], v[84:87], v[172:175]
    v_mfma_f32_16x16x32_f16 v[168:171], v[44:47], v[88:91], v[168:171]
    v_mfma_f32_16x16x32_f16 v[172:175], v[44:47], v[92:95], v[172:175]
    s_and_b32 s4, s2, 255
    s_cmp_eq_u32 s4, 0
    s_mov_b32 s5, 0x3e000000
    s_cselect_b32 s5, 0x3d800000, s5
    s_xor_b32 s6, s5, 0x80000000
    v_lshl_add_u32 v9, v2, 4, v5
    v_lshlrev_b32 v9, 7, v9
    v_lshl_add_u32 v9, v6, 4, v9
    v_add_u32 v9, s3, v9
    s_add_u32 s8, s34, 0xa00000
    s_addc_u32 s9, s35, 0
    s_nop 3
    v_mul_f32 v32, s5, v160
    v_mul_f32 v33, s6, v164
    v_cvt_pk_f16_f32 v16, v32, v33
    v_mul_f32 v32, s5, v161
    v_mul_f32 v33, s6, v165
    v_cvt_pk_f16_f32 v17, v32, v33
    v_mul_f32 v32, s5, v162
    v_mul_f32 v33, s6, v166
    v_cvt_pk_f16_f32 v18, v32, v33
    v_mul_f32 v32, s5, v163
    v_mul_f32 v33, s6, v167
    v_cvt_pk_f16_f32 v19, v32, v33
    v_mul_f32 v32, s5, v168
    v_mul_f32 v33, s6, v172
    v_cvt_pk_f16_f32 v20, v32, v33
    v_mul_f32 v32, s5, v169
    v_mul_f32 v33, s6, v173
    v_cvt_pk_f16_f32 v21, v32, v33
    v_mul_f32 v32, s5, v170
    v_mul_f32 v33, s6, v174
    v_cvt_pk_f16_f32 v22, v32, v33
    v_mul_f32 v32, s5, v171
    v_mul_f32 v33, s6, v175
    v_cvt_pk_f16_f32 v23, v32, v33
    global_store_dwordx4 v9, v[16:19], s[8:9]
    global_store_dwordx4 v9, v[20:23], s[8:9] offset:64
.Lp2_done:
    s_endpgm
.globl p3_kernel
.p2align 8
.type p3_kernel,@function
p3_kernel:
    s_load_dwordx16 s[16:31], s[0:1], 0
    s_load_dwordx2 s[32:33], s[0:1], 64
    s_load_dwordx4 s[36:39], s[0:1], 72
    s_load_dwordx2 s[34:35], s[0:1], 80
    s_cmp_ge_u32 s2, 256
    s_cbranch_scc1 .Lp3_done
    s_and_b32 s3, s2, 7
    s_lshl_b32 s3, s3, 5
    s_lshr_b32 s2, s2, 3
    s_add_u32 s2, s2, s3
    s_getpc_b64 s[10:11]
.Lpc_p3:
    s_add_u32 s10, s10, tbl_p3-.Lpc_p3
    s_addc_u32 s11, s11, 0
    v_and_b32 v1, 63, v0
    v_lshrrev_b32 v2, 6, v0
    v_lshlrev_b32 v3, 4, v1
    s_nop 0
    v_readfirstlane_b32 s40, v2
    s_lshl_b32 s41, s40, 10
    v_add_u32 v4, s41, v3
    s_mov_b32 m0, s41
    s_nop 0
    global_load_lds_dwordx4 v4, s[10:11]
    v_and_b32 v5, 15, v1
    v_lshrrev_b32 v6, 4, v1
    s_lshl_b32 s3, s2, 3
    v_add_u32 v7, s3, v2
    v_lshrrev_b32 v8, 1, v1
    v_lshlrev_b32 v8, 13, v8
    v_and_b32 v9, 1, v1
    v_lshl_add_u32 v8, v9, 4, v8
    s_lshl_b32 s4, s2, 5
    s_lshl_b32 s5, s40, 18
    s_add_u32 s4, s4, s5
    v_add_u32 v8, s4, v8
    s_waitcnt lgkmcnt(0)
    s_add_u32 s8, s34, 0xa00000
    s_addc_u32 s9, s35, 0
    s_add_u32 m0, s41, 0x3c00
    s_nop 0
    global_load_lds_dwordx4 v8, s[8:9]
    s_cmp_lt_u32 s40, 6
    s_cbranch_scc0 .Lp3_a
    s_add_u32 m0, s41, 0x2400
    v_add_u32 v13, 0x1000, v4
    global_load_lds_dwordx4 v13, s[34:35]
    s_branch .Lp3_b
.Lp3_a:
    s_movk_i32 m0, 0x2000
    v_add_u32 v13, 0x2000, v3
    global_load_lds_dwordx4 v13, s[10:11]
.Lp3_b:
    v_lshlrev_b32 v9, 2, v7
    v_add_u32 v9, 0x200000, v9
    global_load_dword v24, v9, s[8:9]
    v_lshlrev_b32 v10, 6, v5
    v_lshl_add_u32 v10, v6, 3, v10
    v_lshl_add_u32 v11, v7, 10, v10
    global_load_dwordx2 v[28:29], v11, s[16:17] offset:0
    global_load_dwordx2 v[30:31], v11, s[16:17] offset:32
    v_lshl_add_u32 v8, v6, 6, v5
    v_lshlrev_b32 v8, 5, v8
    v_lshl_add_u32 v8, v2, 2, v8
    v_lshlrev_b32 v12, 1, v10
    s_waitcnt vmcnt(0)
    s_barrier
    ds_read_b32 v36, v8 offset:15360
    ds_read_b32 v37, v8 offset:15872
    ds_read_b32 v38, v8 offset:16384
    ds_read_b32 v39, v8 offset:16896
    ds_read_b128 v[64:67], v3 offset:0
    ds_read_b128 v[68:71], v3 offset:1024
    ds_read_b128 v[72:75], v3 offset:2048
    ds_read_b128 v[76:79], v3 offset:3072
    ds_read_b128 v[80:83], v3 offset:4096
    ds_read_b128 v[84:87], v3 offset:5120
    ds_read_b128 v[88:91], v3 offset:6144
    ds_read_b128 v[92:95], v3 offset:7168
    ds_read_b128 v[96:99], v3 offset:8192
    s_waitcnt lgkmcnt(5)
    v_mfma_f32_16x16x32_f16 v[104:107], v[36:39], v[64:67], 0
    v_mfma_f32_16x16x32_f16 v[108:111], v[36:39], v[68:71], 0
    v_mfma_f32_16x16x32_f16 v[112:115], v[36:39], v[72:75], 0
    v_mfma_f32_16x16x32_f16 v[116:119], v[36:39], v[76:79], 0
    ds_read_b128 v[40:43], v12 offset:9216
    ds_read_b128 v[44:47], v12 offset:9280
    ds_read_b128 v[48:51], v12 offset:11264
    ds_read_b128 v[52:55], v12 offset:11328
    ds_read_b128 v[56:59], v12 offset:13312
    ds_read_b128 v[60:63], v12 offset:13376
    s_waitcnt lgkmcnt(6)
    v_mul_f32 v14, v108, v85
    v_mul_f32 v15, v108, v84
    v_fma_f32 v14, v104, v84, -v14
    v_fma_f32 v15, v104, v85, v15
    v_cvt_pk_f16_f32 v16, v14, v15
    v_mul_f32 v8, v109, v87
    v_mul_f32 v9, v109, v86
    v_fma_f32 v8, v105, v86, -v8
    v_fma_f32 v9, v105, v87, v9
    v_cvt_pk_f16_f32 v17, v8, v9
    v_mul_f32 v14, v110, v89
    v_mul_f32 v15, v110, v88
    v_fma_f32 v14, v106, v88, -v14
    v_fma_f32 v15, v106, v89, v15
    v_cvt_pk_f16_f32 v18, v14, v15
    v_mul_f32 v8, v111, v91
    v_mul_f32 v9, v111, v90
    v_fma_f32 v8, v107, v90, -v8
    v_fma_f32 v9, v107, v91, v9
    v_cvt_pk_f16_f32 v19, v8, v9
    v_mul_f32 v14, v116, v93
    v_mul_f32 v15, v116, v92
    v_fma_f32 v14, v112, v92, -v14
    v_fma_f32 v15, v112, v93, v15
    v_cvt_pk_f16_f32 v20, v14, v15
    v_mul_f32 v8, v117, v95
    v_mul_f32 v9, v117, v94
    v_fma_f32 v8, v113, v94, -v8
    v_fma_f32 v9, v113, v95, v9
    v_cvt_pk_f16_f32 v21, v8, v9
    v_mul_f32 v14, v118, v97
    v_mul_f32 v15, v118, v96
    v_fma_f32 v14, v114, v96, -v14
    v_fma_f32 v15, v114, v97, v15
    v_cvt_pk_f16_f32 v22, v14, v15
    v_mul_f32 v8, v119, v99
    v_mul_f32 v9, v119, v98
    v_fma_f32 v8, v115, v98, -v8
    v_fma_f32 v9, v115, v99, v9
    v_cvt_pk_f16_f32 v23, v8, v9
    s_nop 1
    v_mfma_f32_16x16x32_f16 v[120:123], v[16:19], v[80:83], 0
    v_mfma_f32_16x16x32_f16 v[124:127], v[20:23], v[80:83], 0
    v_cvt_f32_f16 v24, v24
    v_lshlrev_b32 v104, 16, v28
    v_and_b32 v105, 0xffff0000, v28
    v_lshlrev_b32 v106, 16, v29
    v_and_b32 v107, 0xffff0000, v29
    v_lshlrev_b32 v108, 16, v30
    v_and_b32 v109, 0xffff0000, v30
    v_lshlrev_b32 v110, 16, v31
    v_and_b32 v111, 0xffff0000, v31
    v_mul_f32 v24, 0x3b800000, v24
    s_waitcnt lgkmcnt(0)
    v_add_f32 v120, v120, v24
    v_sub_f32 v121, v121, v24
    v_add_f32 v122, v122, v24
    v_sub_f32 v123, v123, v24
    v_add_f32 v124, v124, v24
    v_sub_f32 v125, v125, v24
    v_add_f32 v126, v126, v24
    v_sub_f32 v127, v127, v24
    v_cvt_pk_bf16_f32 v16, v120, v121
    v_cvt_pk_bf16_f32 v17, v122, v123
    v_cvt_pk_bf16_f32 v18, v124, v125
    v_cvt_pk_bf16_f32 v19, v126, v127
    v_lshlrev_b32 v120, 16, v16
    v_and_b32 v121, 0xffff0000, v16
    v_lshlrev_b32 v122, 16, v17
    v_and_b32 v123, 0xffff0000, v17
    v_lshlrev_b32 v124, 16, v18
    v_and_b32 v125, 0xffff0000, v18
    v_lshlrev_b32 v126, 16, v19
    v_and_b32 v127, 0xffff0000, v19
    v_mul_f32 v120, v120, v40
    v_mul_f32 v121, v121, v41
    v_mul_f32 v122, v122, v42
    v_mul_f32 v123, v123, v43
    v_mul_f32 v124, v124, v44
    v_mul_f32 v125, v125, v45
    v_mul_f32 v126, v126, v46
    v_mul_f32 v127, v127, v47
    v_cvt_pk_bf16_f32 v16, v120, v121
    v_cvt_pk_bf16_f32 v17, v122, v123
    v_cvt_pk_bf16_f32 v18, v124, v125
    v_cvt_pk_bf16_f32 v19, v126, v127
    v_lshlrev_b32 v120, 16, v16
    v_and_b32 v121, 0xffff0000, v16
    v_lshlrev_b32 v122, 16, v17
    v_and_b32 v123, 0xffff0000, v17
    v_lshlrev_b32 v124, 16, v18
    v_and_b32 v125, 0xffff0000, v18
    v_lshlrev_b32 v126, 16, v19
    v_and_b32 v127, 0xffff0000, v19
    v_add_f32 v64, v104, v120
    v_add_f32 v65, v105, v121
    v_add_f32 v66, v106, v122
    v_add_f32 v67, v107, v123
    v_add_f32 v68, v108, v124
    v_add_f32 v69, v109, v125
    v_add_f32 v70, v110, v126
    v_add_f32 v71, v111, v127
    v_cvt_pk_bf16_f32 v120, v64, v65
    v_cvt_pk_bf16_f32 v121, v66, v67
    v_cvt_pk_bf16_f32 v122, v68, v69
    v_cvt_pk_bf16_f32 v123, v70, v71
    v_lshlrev_b32 v64, 16, v120
    v_and_b32 v65, 0xffff0000, v120
    v_lshlrev_b32 v66, 16, v121
    v_and_b32 v67, 0xffff0000, v121
    v_lshlrev_b32 v68, 16, v122
    v_and_b32 v69, 0xffff0000, v122
    v_lshlrev_b32 v70, 16, v123
    v_and_b32 v71, 0xffff0000, v123
    s_add_u32 s8, s34, 0xd00000
    s_addc_u32 s9, s35, 0
    global_store_dwordx2 v11, v[120:121], s[8:9] offset:0
    global_store_dwordx2 v11, v[122:123], s[8:9] offset:32
    v_add_f32 v56, 1.0, v56
    v_add_f32 v57, 1.0, v57
    v_add_f32 v58, 1.0, v58
    v_add_f32 v59, 1.0, v59
    v_add_f32 v60, 1.0, v60
    v_add_f32 v61, 1.0, v61
    v_add_f32 v62, 1.0, v62
    v_add_f32 v63, 1.0, v63
    v_cvt_pk_bf16_f32 v112, v56, v57
    v_cvt_pk_bf16_f32 v113, v58, v59
    v_cvt_pk_bf16_f32 v114, v60, v61
    v_cvt_pk_bf16_f32 v115, v62, v63
    v_lshlrev_b32 v56, 16, v112
    v_and_b32 v57, 0xffff0000, v112
    v_lshlrev_b32 v58, 16, v113
    v_and_b32 v59, 0xffff0000, v113
    v_lshlrev_b32 v60, 16, v114
    v_and_b32 v61, 0xffff0000, v114
    v_lshlrev_b32 v62, 16, v115
    v_and_b32 v63, 0xffff0000, v115
    v_add_f32 v112, v64, v65
    v_add_f32 v113, v66, v67
    v_add_f32 v114, v68, v69
    v_add_f32 v115, v70, v71
    v_add_f32 v112, v112, v113
    v_add_f32 v114, v114, v115
    v_add_f32 v20, v112, v114
    s_nop 1
    v_add_f32_dpp v20, v20, v20 quad_perm:[1,0,3,2] row_mask:0xf bank_mask:0xf
    s_nop 1
    v_add_f32_dpp v20, v20, v20 quad_perm:[2,3,0,1] row_mask:0xf bank_mask:0xf
    s_nop 1
    v_add_f32_dpp v20, v20, v20 row_half_mirror row_mask:0xf bank_mask:0xf
    s_nop 1
    v_add_f32_dpp v20, v20, v20 row_mirror row_mask:0xf bank_mask:0xf
    v_mov_b32 v21, v20
    s_nop 1
    v_permlane16_swap_b32 v20, v21
    s_nop 1
    v_add_f32 v20, v20, v21
    v_mov_b32 v21, v20
    s_nop 1
    v_permlane32_swap_b32 v20, v21
    s_nop 1
    v_add_f32 v20, v20, v21
    v_mul_f32 v20, 0x3b000000, v20
    v_sub_f32 v112, v64, v20
    v_sub_f32 v113, v65, v20
    v_sub_f32 v114, v66, v20
    v_sub_f32 v115, v67, v20
    v_sub_f32 v116, v68, v20
    v_sub_f32 v117, v69, v20
    v_sub_f32 v118, v70, v20
    v_sub_f32 v119, v71, v20
    v_mul_f32 v22, v112, v112
    v_fmac_f32 v22, v113, v113
    v_fmac_f32 v22, v114, v114
    v_fmac_f32 v22, v115, v115
    v_fmac_f32 v22, v116, v116
    v_fmac_f32 v22, v117, v117
    v_fmac_f32 v22, v118, v118
    v_fmac_f32 v22, v119, v119
    s_nop 1
    v_add_f32_dpp v22, v22, v22 quad_perm:[1,0,3,2] row_mask:0xf bank_mask:0xf
    s_nop 1
    v_add_f32_dpp v22, v22, v22 quad_perm:[2,3,0,1] row_mask:0xf bank_mask:0xf
    s_nop 1
    v_add_f32_dpp v22, v22, v22 row_half_mirror row_mask:0xf bank_mask:0xf
    s_nop 1
    v_add_f32_dpp v22, v22, v22 row_mirror row_mask:0xf bank_mask:0xf
    v_mov_b32 v21, v22
    s_nop 1
    v_permlane16_swap_b32 v22, v21
    s_nop 1
    v_add_f32 v22, v22, v21
    v_mov_b32 v21, v22
    s_nop 1
    v_permlane32_swap_b32 v22, v21
    s_nop 1
    v_add_f32 v22, v22, v21
    s_mov_b32 s6, 0x3727c5ac
    v_mul_f32 v22, 0x3b000000, v22
    v_cvt_pk_bf16_f32 v22, v22, v22
    v_lshlrev_b32 v22, 16, v22
    v_add_f32 v22, s6, v22
    v_cvt_pk_bf16_f32 v22, v22, v22
    v_lshlrev_b32 v22, 16, v22
    v_sqrt_f32 v22, v22
    s_nop 0
    v_cvt_pk_bf16_f32 v22, v22, v22
    v_lshlrev_b32 v22, 16, v22
    v_rcp_f32 v22, v22
    v_cvt_pk_bf16_f32 v20, v20, v20
    v_lshlrev_b32 v20, 16, v20
    v_sub_f32 v64, v64, v20
    v_sub_f32 v65, v65, v20
    v_sub_f32 v66, v66, v20
    v_sub_f32 v67, v67, v20
    v_sub_f32 v68, v68, v20
    v_sub_f32 v69, v69, v20
    v_sub_f32 v70, v70, v20
    v_sub_f32 v71, v71, v20
    v_cvt_pk_bf16_f32 v16, v64, v65
    v_cvt_pk_bf16_f32 v17, v66, v67
    v_cvt_pk_bf16_f32 v18, v68, v69
    v_cvt_pk_bf16_f32 v19, v70, v71
    v_lshlrev_b32 v64, 16, v16
    v_and_b32 v65, 0xffff0000, v16
    v_lshlrev_b32 v66, 16, v17
    v_and_b32 v67, 0xffff0000, v17
    v_lshlrev_b32 v68, 16, v18
    v_and_b32 v69, 0xffff0000, v18
    v_lshlrev_b32 v70, 16, v19
    v_and_b32 v71, 0xffff0000, v19
    v_mul_f32 v64, v64, v22
    v_mul_f32 v65, v65, v22
    v_mul_f32 v66, v66, v22
    v_mul_f32 v67, v67, v22
    v_mul_f32 v68, v68, v22
    v_mul_f32 v69, v69, v22
    v_mul_f32 v70, v70, v22
    v_mul_f32 v71, v71, v22
    v_cvt_pk_bf16_f32 v16, v64, v65
    v_cvt_pk_bf16_f32 v17, v66, v67
    v_cvt_pk_bf16_f32 v18, v68, v69
    v_cvt_pk_bf16_f32 v19, v70, v71
    v_lshlrev_b32 v64, 16, v16
    v_and_b32 v65, 0xffff0000, v16
    v_lshlrev_b32 v66, 16, v17
    v_and_b32 v67, 0xffff0000, v17
    v_lshlrev_b32 v68, 16, v18
    v_and_b32 v69, 0xffff0000, v18
    v_lshlrev_b32 v70, 16, v19
    v_and_b32 v71, 0xffff0000, v19
    s_lshr_b32 s4, s2, 1
    s_lshl_b32 s4, s4, 14
    s_and_b32 s5, s2, 1
    s_lshl_b32 s5, s5, 7
    s_add_u32 s4, s4, s5
    v_lshlrev_b32 v12, 10, v5
    v_lshl_add_u32 v12, v6, 8, v12
    v_lshl_add_u32 v12, v2, 4, v12
    v_add_u32 v12, s4, v12
    s_add_u32 s12, s34, 0xf00000
    s_addc_u32 s13, s35, 0
    v_mul_f32 v64, v64, v56
    v_mul_f32 v65, v65, v57
    v_mul_f32 v66, v66, v58
    v_mul_f32 v67, v67, v59
    v_mul_f32 v68, v68, v60
    v_mul_f32 v69, v69, v61
    v_mul_f32 v70, v70, v62
    v_mul_f32 v71, v71, v63
    v_cvt_pk_bf16_f32 v16, v64, v65
    v_cvt_pk_bf16_f32 v17, v66, v67
    v_cvt_pk_bf16_f32 v18, v68, v69
    v_cvt_pk_bf16_f32 v19, v70, v71
    v_lshlrev_b32 v64, 16, v16
    v_and_b32 v65, 0xffff0000, v16
    v_lshlrev_b32 v66, 16, v17
    v_and_b32 v67, 0xffff0000, v17
    v_lshlrev_b32 v68, 16, v18
    v_and_b32 v69, 0xffff0000, v18
    v_lshlrev_b32 v70, 16, v19
    v_and_b32 v71, 0xffff0000, v19
    v_add_f32 v64, v64, v48
    v_add_f32 v65, v65, v49
    v_add_f32 v66, v66, v50
    v_add_f32 v67, v67, v51
    v_add_f32 v68, v68, v52
    v_add_f32 v69, v69, v53
    v_add_f32 v70, v70, v54
    v_add_f32 v71, v71, v55
    v_cvt_pk_bf16_f32 v16, v64, v65
    v_cvt_pk_bf16_f32 v17, v66, v67
    v_cvt_pk_bf16_f32 v18, v68, v69
    v_cvt_pk_bf16_f32 v19, v70, v71
    global_store_dwordx4 v12, v[16:19], s[12:13]
.Lp3_done:
    s_endpgm
.globl g1_kernel
.p2align 8
.type g1_kernel,@function
g1_kernel:
    s_load_dwordx16 s[16:31], s[0:1], 0
    s_load_dwordx2 s[32:33], s[0:1], 64
    s_load_dwordx4 s[36:39], s[0:1], 72
    s_load_dwordx2 s[34:35], s[0:1], 80
    s_cmp_ge_u32 s2, 256
    s_cbranch_scc1 .Lg1_done
    v_and_b32 v1, 63, v0
    v_lshrrev_b32 v2, 6, v0
    v_lshlrev_b32 v3, 4, v1
    v_add_u32 v4, 0x10000, v3
    s_nop 0
    v_readfirstlane_b32 s40, v2
    s_and_b32 s3, s2, 3
    s_lshl_b32 s3, s3, 2
    s_bfe_u32 s4, s2, 0x20003
    s_add_u32 s3, s3, s4
    s_bfe_u32 s4, s2, 0x10002
    s_lshl_b32 s4, s4, 3
    s_lshr_b32 s5, s2, 5
    s_add_u32 s4, s4, s5
    s_waitcnt lgkmcnt(0)
    s_add_u32 s8, s34, 0xf00000
    s_addc_u32 s9, s35, 0
    s_add_u32 s12, s34, 0x300000
    s_addc_u32 s13, s35, 0
    s_lshl_b32 s5, s3, 3
    s_lshl_b32 s6, s40, 1
    s_add_u32 s5, s5, s6
    s_lshl_b32 s6, s5, 14
    s_add_u32 s8, s8, s6
    s_addc_u32 s9, s9, 0
    s_mul_i32 s6, s4, 7
    s_lshl_b32 s7, s6, 14
    s_lshl_b32 s41, s40, 10
    s_add_u32 s7, s7, s41
    s_add_u32 s12, s12, s7
    s_addc_u32 s13, s13, 0
    s_mul_i32 s42, s40, 7168
    v_add_u32 v5, 0x0, v3
    global_load_dwordx4 v[64:67], v5, s[8:9]
    v_add_u32 v5, 0x4000, v3
    global_load_dwordx4 v[128:131], v5, s[8:9]
    v_add_u32 v5, 0x400, v3
    global_load_dwordx4 v[68:71], v5, s[8:9]
    v_add_u32 v5, 0x4400, v3
    global_load_dwordx4 v[132:135], v5, s[8:9]
    v_add_u32 v5, 0x800, v3
    global_load_dwordx4 v[72:75], v5, s[8:9]
    v_add_u32 v5, 0x4800, v3
    global_load_dwordx4 v[136:139], v5, s[8:9]
    v_add_u32 v5, 0xc00, v3
    global_load_dwordx4 v[76:79], v5, s[8:9]
    v_add_u32 v5, 0x4c00, v3
    global_load_dwordx4 v[140:143], v5, s[8:9]
    s_add_u32 m0, s42, 0x0
    v_add_u32 v5, 0x0, v3
    global_load_lds_dwordx4 v5, s[12:13]
    s_add_u32 m0, s42, 0x400
    v_add_u32 v5, 0x4000, v3
    global_load_lds_dwordx4 v5, s[12:13]
    s_add_u32 m0, s42, 0x800
    v_add_u32 v5, 0x8000, v3
    global_load_lds_dwordx4 v5, s[12:13]
    s_add_u32 m0, s42, 0xc00
    v_add_u32 v5, 0xc000, v3
    global_load_lds_dwordx4 v5, s[12:13]
    s_add_u32 m0, s42, 0x1000
    v_add_u32 v5, 0x10000, v3
    global_load_lds_dwordx4 v5, s[12:13]
    s_add_u32 m0, s42, 0x1400
    v_add_u32 v5, 0x14000, v3
    global_load_lds_dwordx4 v5, s[12:13]
    s_add_u32 m0, s42, 0x1800
    v_add_u32 v5, 0x18000, v3
    global_load_lds_dwordx4 v5, s[12:13]
    v_add_u32 v5, 0x1000, v3
    global_load_dwordx4 v[80:83], v5, s[8:9]
    v_add_u32 v5, 0x5000, v3
    global_load_dwordx4 v[144:147], v5, s[8:9]
    v_add_u32 v5, 0x1400, v3
    global_load_dwordx4 v[84:87], v5, s[8:9]
    v_add_u32 v5, 0x5400, v3
    global_load_dwordx4 v[148:151], v5, s[8:9]
    v_add_u32 v5, 0x1800, v3
    global_load_dwordx4 v[88:91], v5, s[8:9]
    v_add_u32 v5, 0x5800, v3
    global_load_dwordx4 v[152:155], v5, s[8:9]
    v_add_u32 v5, 0x1c00, v3
    global_load_dwordx4 v[92:95], v5, s[8:9]
    v_add_u32 v5, 0x5c00, v3
    global_load_dwordx4 v[156:159], v5, s[8:9]
    s_add_u32 m0, s42, 0x7000
    v_add_u32 v5, 0x1000, v3
    global_load_lds_dwordx4 v5, s[12:13]
    s_add_u32 m0, s42, 0x7400
    v_add_u32 v5, 0x5000, v3
    global_load_lds_dwordx4 v5, s[12:13]
    s_add_u32 m0, s42, 0x7800
    v_add_u32 v5, 0x9000, v3
    global_load_lds_dwordx4 v5, s[12:13]
    s_add_u32 m0, s42, 0x7c00
    v_add_u32 v5, 0xd000, v3
    global_load_lds_dwordx4 v5, s[12:13]
    s_add_u32 m0, s42, 0x8000
    v_add_u32 v5, 0x11000, v3
    global_load_lds_dwordx4 v5, s[12:13]
    s_add_u32 m0, s42, 0x8400
    v_add_u32 v5, 0x15000, v3
    global_load_lds_dwordx4 v5, s[12:13]
    s_add_u32 m0, s42, 0x8800
    v_add_u32 v5, 0x19000, v3
    global_load_lds_dwordx4 v5, s[12:13]
    s_waitcnt vmcnt(15)
    s_barrier
    v_add_u32 v5, 0x2000, v3
    global_load_dwordx4 v[96:99], v5, s[8:9]
    v_add_u32 v5, 0x6000, v3
    global_load_dwordx4 v[160:163], v5, s[8:9]
    v_add_u32 v5, 0x2400, v3
    global_load_dwordx4 v[100:103], v5, s[8:9]
    v_add_u32 v5, 0x6400, v3
    global_load_dwordx4 v[164:167], v5, s[8:9]
    v_add_u32 v5, 0x2800, v3
    global_load_dwordx4 v[104:107], v5, s[8:9]
    v_add_u32 v5, 0x6800, v3
    global_load_dwordx4 v[168:171], v5, s[8:9]
    v_add_u32 v5, 0x2c00, v3
    global_load_dwordx4 v[108:111], v5, s[8:9]
    v_add_u32 v5, 0x6c00, v3
    global_load_dwordx4 v[172:175], v5, s[8:9]
    s_add_u32 m0, s42, 0xe000
    v_add_u32 v5, 0x2000, v3
    global_load_lds_dwordx4 v5, s[12:13]
    s_add_u32 m0, s42, 0xe400
    v_add_u32 v5, 0x6000, v3
    global_load_lds_dwordx4 v5, s[12:13]
    s_add_u32 m0, s42, 0xe800
    v_add_u32 v5, 0xa000, v3
    global_load_lds_dwordx4 v5, s[12:13]
    s_add_u32 m0, s42, 0xec00
    v_add_u32 v5, 0xe000, v3
    global_load_lds_dwordx4 v5, s[12:13]
    s_add_u32 m0, s42, 0xf000
    v_add_u32 v5, 0x12000, v3
    global_load_lds_dwordx4 v5, s[12:13]
    s_add_u32 m0, s42, 0xf400
    v_add_u32 v5, 0x16000, v3
    global_load_lds_dwordx4 v5, s[12:13]
    s_add_u32 m0, s42, 0xf800
    v_add_u32 v5, 0x1a000, v3
    global_load_lds_dwordx4 v5, s[12:13]
    ds_read_b128 v[8:11], v3 offset:0
    ds_read_b128 v[12:15], v3 offset:1024
    ds_read_b128 v[16:19], v3 offset:2048
    ds_read_b128 v[20:23], v3 offset:3072
    ds_read_b128 v[24:27], v3 offset:4096
    ds_read_b128 v[28:31], v3 offset:5120
    ds_read_b128 v[32:35], v3 offset:6144
    ds_read_b128 v[36:39], v3 offset:7168
    ds_read_b128 v[40:43], v3 offset:8192
    ds_read_b128 v[44:47], v3 offset:9216
    ds_read_b128 v[48:51], v3 offset:10240
    ds_read_b128 v[52:55], v3 offset:11264
    ds_read_b128 v[56:59], v3 offset:12288
    ds_read_b128 v[60:63], v3 offset:13312
    s_waitcnt lgkmcnt(7)
    v_mfma_f32_16x16x32_bf16 v[192:195], v[8:11], v[64:67], 0
    v_mfma_f32_16x16x32_bf16 v[196:199], v[8:11], v[128:131], 0
    v_mfma_f32_16x16x32_bf16 v[200:203], v[12:15], v[64:67], 0
    v_mfma_f32_16x16x32_bf16 v[204:207], v[12:15], v[128:131], 0
    v_mfma_f32_16x16x32_bf16 v[208:211], v[16:19], v[64:67], 0
    v_mfma_f32_16x16x32_bf16 v[212:215], v[16:19], v[128:131], 0
    v_mfma_f32_16x16x32_bf16 v[216:219], v[20:23], v[64:67], 0
    v_mfma_f32_16x16x32_bf16 v[220:223], v[20:23], v[128:131], 0
    v_mfma_f32_16x16x32_bf16 v[224:227], v[24:27], v[64:67], 0
    v_mfma_f32_16x16x32_bf16 v[228:231], v[24:27], v[128:131], 0
    v_mfma_f32_16x16x32_bf16 v[232:235], v[28:31], v[64:67], 0
    v_mfma_f32_16x16x32_bf16 v[236:239], v[28:31], v[128:131], 0
    v_mfma_f32_16x16x32_bf16 v[240:243], v[32:35], v[64:67], 0
    v_mfma_f32_16x16x32_bf16 v[244:247], v[32:35], v[128:131], 0
    ds_read_b128 v[8:11], v3 offset:14336
    ds_read_b128 v[12:15], v3 offset:15360
    ds_read_b128 v[16:19], v3 offset:16384
    ds_read_b128 v[20:23], v3 offset:17408
    ds_read_b128 v[24:27], v3 offset:18432
    ds_read_b128 v[28:31], v3 offset:19456
    ds_read_b128 v[32:35], v3 offset:20480
    s_waitcnt lgkmcnt(7)
    v_mfma_f32_16x16x32_bf16 v[192:195], v[36:39], v[68:71], v[192:195]
    v_mfma_f32_16x16x32_bf16 v[196:199], v[36:39], v[132:135], v[196:199]
    v_mfma_f32_16x16x32_bf16 v[200:203], v[40:43], v[68:71], v[200:203]
    v_mfma_f32_16x16x32_bf16 v[204:207], v[40:43], v[132:135], v[204:207]
    v_mfma_f32_16x16x32_bf16 v[208:211], v[44:47], v[68:71], v[208:211]
    v_mfma_f32_16x16x32_bf16 v[212:215], v[44:47], v[132:135], v[212:215]
    v_mfma_f32_16x16x32_bf16 v[216:219], v[48:51], v[68:71], v[216:219]
    v_mfma_f32_16x16x32_bf16 v[220:223], v[48:51], v[132:135], v[220:223]
    v_mfma_f32_16x16x32_bf16 v[224:227], v[52:55], v[68:71], v[224:227]
    v_mfma_f32_16x16x32_bf16 v[228:231], v[52:55], v[132:135], v[228:231]
    v_mfma_f32_16x16x32_bf16 v[232:235], v[56:59], v[68:71], v[232:235]
    v_mfma_f32_16x16x32_bf16 v[236:239], v[56:59], v[132:135], v[236:239]
    v_mfma_f32_16x16x32_bf16 v[240:243], v[60:63], v[68:71], v[240:243]
    v_mfma_f32_16x16x32_bf16 v[244:247], v[60:63], v[132:135], v[244:247]
    ds_read_b128 v[36:39], v3 offset:21504
    ds_read_b128 v[40:43], v3 offset:22528
    ds_read_b128 v[44:47], v3 offset:23552
    ds_read_b128 v[48:51], v3 offset:24576
    ds_read_b128 v[52:55], v3 offset:25600
    ds_read_b128 v[56:59], v3 offset:26624
    ds_read_b128 v[60:63], v3 offset:27648
    s_waitcnt lgkmcnt(7)
    v_mfma_f32_16x16x32_bf16 v[192:195], v[8:11], v[72:75], v[192:195]
    v_mfma_f32_16x16x32_bf16 v[196:199], v[8:11], v[136:139], v[196:199]
    v_mfma_f32_16x16x32_bf16 v[200:203], v[12:15], v[72:75], v[200:203]
    v_mfma_f32_16x16x32_bf16 v[204:207], v[12:15], v[136:139], v[204:207]
    v_mfma_f32_16x16x32_bf16 v[208:211], v[16:19], v[72:75], v[208:211]
    v_mfma_f32_16x16x32_bf16 v[212:215], v[16:19], v[136:139], v[212:215]
    v_mfma_f32_16x16x32_bf16 v[216:219], v[20:23], v[72:75], v[216:219]
    v_mfma_f32_16x16x32_bf16 v[220:223], v[20:23], v[136:139], v[220:223]
    v_mfma_f32_16x16x32_bf16 v[224:227], v[24:27], v[72:75], v[224:227]
    v_mfma_f32_16x16x32_bf16 v[228:231], v[24:27], v[136:139], v[228:231]
    v_mfma_f32_16x16x32_bf16 v[232:235], v[28:31], v[72:75], v[232:235]
    v_mfma_f32_16x16x32_bf16 v[236:239], v[28:31], v[136:139], v[236:239]
    v_mfma_f32_16x16x32_bf16 v[240:243], v[32:35], v[72:75], v[240:243]
    v_mfma_f32_16x16x32_bf16 v[244:247], v[32:35], v[136:139], v[244:247]
    s_waitcnt lgkmcnt(0)
    v_mfma_f32_16x16x32_bf16 v[192:195], v[36:39], v[76:79], v[192:195]
    v_mfma_f32_16x16x32_bf16 v[196:199], v[36:39], v[140:143], v[196:199]
    v_mfma_f32_16x16x32_bf16 v[200:203], v[40:43], v[76:79], v[200:203]
    v_mfma_f32_16x16x32_bf16 v[204:207], v[40:43], v[140:143], v[204:207]
    v_mfma_f32_16x16x32_bf16 v[208:211], v[44:47], v[76:79], v[208:211]
    v_mfma_f32_16x16x32_bf16 v[212:215], v[44:47], v[140:143], v[212:215]
    v_mfma_f32_16x16x32_bf16 v[216:219], v[48:51], v[76:79], v[216:219]
    v_mfma_f32_16x16x32_bf16 v[220:223], v[48:51], v[140:143], v[220:223]
    v_mfma_f32_16x16x32_bf16 v[224:227], v[52:55], v[76:79], v[224:227]
    v_mfma_f32_16x16x32_bf16 v[228:231], v[52:55], v[140:143], v[228:231]
    v_mfma_f32_16x16x32_bf16 v[232:235], v[56:59], v[76:79], v[232:235]
    v_mfma_f32_16x16x32_bf16 v[236:239], v[56:59], v[140:143], v[236:239]
    v_mfma_f32_16x16x32_bf16 v[240:243], v[60:63], v[76:79], v[240:243]
    v_mfma_f32_16x16x32_bf16 v[244:247], v[60:63], v[140:143], v[244:247]
    s_waitcnt vmcnt(15)
    s_barrier
    v_add_u32 v5, 0x3000, v3
    global_load_dwordx4 v[112:115], v5, s[8:9]
    v_add_u32 v5, 0x7000, v3
    global_load_dwordx4 v[176:179], v5, s[8:9]
    v_add_u32 v5, 0x3400, v3
    global_load_dwordx4 v[116:119], v5, s[8:9]
    v_add_u32 v5, 0x7400, v3
    global_load_dwordx4 v[180:183], v5, s[8:9]
    v_add_u32 v5, 0x3800, v3
    global_load_dwordx4 v[120:123], v5, s[8:9]
    v_add_u32 v5, 0x7800, v3
    global_load_dwordx4 v[184:187], v5, s[8:9]
    v_add_u32 v5, 0x3c00, v3
    global_load_dwordx4 v[124:127], v5, s[8:9]
    v_add_u32 v5, 0x7c00, v3
    global_load_dwordx4 v[188:191], v5, s[8:9]
    s_add_u32 m0, s42, 0x15000
    v_add_u32 v5, 0x3000, v3
    global_load_lds_dwordx4 v5, s[12:13]
    s_add_u32 m0, s42, 0x15400
    v_add_u32 v5, 0x7000, v3
    global_load_lds_dwordx4 v5, s[12:13]
    s_add_u32 m0, s42, 0x15800
    v_add_u32 v5, 0xb000, v3
    global_load_lds_dwordx4 v5, s[12:13]
    s_add_u32 m0, s42, 0x15c00
    v_add_u32 v5, 0xf000, v3
    global_load_lds_dwordx4 v5, s[12:13]
    s_add_u32 m0, s42, 0x16000
    v_add_u32 v5, 0x13000, v3
    global_load_lds_dwordx4 v5, s[12:13]
    s_add_u32 m0, s42, 0x16400
    v_add_u32 v5, 0x17000, v3
    global_load_lds_dwordx4 v5, s[12:13]
    s_add_u32 m0, s42, 0x16800
    v_add_u32 v5, 0x1b000, v3
    global_load_lds_dwordx4 v5, s[12:13]
    ds_read_b128 v[8:11], v3 offset:28672
    ds_read_b128 v[12:15], v3 offset:29696
    ds_read_b128 v[16:19], v3 offset:30720
    ds_read_b128 v[20:23], v3 offset:31744
    ds_read_b128 v[24:27], v3 offset:32768
    ds_read_b128 v[28:31], v3 offset:33792
    ds_read_b128 v[32:35], v3 offset:34816
    ds_read_b128 v[36:39], v3 offset:35840
    ds_read_b128 v[40:43], v3 offset:36864
    ds_read_b128 v[44:47], v3 offset:37888
    ds_read_b128 v[48:51], v3 offset:38912
    ds_read_b128 v[52:55], v3 offset:39936
    ds_read_b128 v[56:59], v3 offset:40960
    ds_read_b128 v[60:63], v3 offset:41984
    s_waitcnt lgkmcnt(7)
    v_mfma_f32_16x16x32_bf16 v[192:195], v[8:11], v[80:83], v[192:195]
    v_mfma_f32_16x16x32_bf16 v[196:199], v[8:11], v[144:147], v[196:199]
    v_mfma_f32_16x16x32_bf16 v[200:203], v[12:15], v[80:83], v[200:203]
    v_mfma_f32_16x16x32_bf16 v[204:207], v[12:15], v[144:147], v[204:207]
    v_mfma_f32_16x16x32_bf16 v[208:211], v[16:19], v[80:83], v[208:211]
    v_mfma_f32_16x16x32_bf16 v[212:215], v[16:19], v[144:147], v[212:215]
    v_mfma_f32_16x16x32_bf16 v[216:219], v[20:23], v[80:83], v[216:219]
    v_mfma_f32_16x16x32_bf16 v[220:223], v[20:23], v[144:147], v[220:223]
    v_mfma_f32_16x16x32_bf16 v[224:227], v[24:27], v[80:83], v[224:227]
    v_mfma_f32_16x16x32_bf16 v[228:231], v[24:27], v[144:147], v[228:231]
    v_mfma_f32_16x16x32_bf16 v[232:235], v[28:31], v[80:83], v[232:235]
    v_mfma_f32_16x16x32_bf16 v[236:239], v[28:31], v[144:147], v[236:239]
    v_mfma_f32_16x16x32_bf16 v[240:243], v[32:35], v[80:83], v[240:243]
    v_mfma_f32_16x16x32_bf16 v[244:247], v[32:35], v[144:147], v[244:247]
    ds_read_b128 v[8:11], v3 offset:43008
    ds_read_b128 v[12:15], v3 offset:44032
    ds_read_b128 v[16:19], v3 offset:45056
    ds_read_b128 v[20:23], v3 offset:46080
    ds_read_b128 v[24:27], v3 offset:47104
    ds_read_b128 v[28:31], v3 offset:48128
    ds_read_b128 v[32:35], v3 offset:49152
    s_waitcnt lgkmcnt(7)
    v_mfma_f32_16x16x32_bf16 v[192:195], v[36:39], v[84:87], v[192:195]
    v_mfma_f32_16x16x32_bf16 v[196:199], v[36:39], v[148:151], v[196:199]
    v_mfma_f32_16x16x32_bf16 v[200:203], v[40:43], v[84:87], v[200:203]
    v_mfma_f32_16x16x32_bf16 v[204:207], v[40:43], v[148:151], v[204:207]
    v_mfma_f32_16x16x32_bf16 v[208:211], v[44:47], v[84:87], v[208:211]
    v_mfma_f32_16x16x32_bf16 v[212:215], v[44:47], v[148:151], v[212:215]
    v_mfma_f32_16x16x32_bf16 v[216:219], v[48:51], v[84:87], v[216:219]
    v_mfma_f32_16x16x32_bf16 v[220:223], v[48:51], v[148:151], v[220:223]
    v_mfma_f32_16x16x32_bf16 v[224:227], v[52:55], v[84:87], v[224:227]
    v_mfma_f32_16x16x32_bf16 v[228:231], v[52:55], v[148:151], v[228:231]
    v_mfma_f32_16x16x32_bf16 v[232:235], v[56:59], v[84:87], v[232:235]
    v_mfma_f32_16x16x32_bf16 v[236:239], v[56:59], v[148:151], v[236:239]
    v_mfma_f32_16x16x32_bf16 v[240:243], v[60:63], v[84:87], v[240:243]
    v_mfma_f32_16x16x32_bf16 v[244:247], v[60:63], v[148:151], v[244:247]
    ds_read_b128 v[36:39], v3 offset:50176
    ds_read_b128 v[40:43], v3 offset:51200
    ds_read_b128 v[44:47], v3 offset:52224
    ds_read_b128 v[48:51], v3 offset:53248
    ds_read_b128 v[52:55], v3 offset:54272
    ds_read_b128 v[56:59], v3 offset:55296
    ds_read_b128 v[60:63], v3 offset:56320
    s_waitcnt lgkmcnt(7)
    v_mfma_f32_16x16x32_bf16 v[192:195], v[8:11], v[88:91], v[192:195]
    v_mfma_f32_16x16x32_bf16 v[196:199], v[8:11], v[152:155], v[196:199]
    v_mfma_f32_16x16x32_bf16 v[200:203], v[12:15], v[88:91], v[200:203]
    v_mfma_f32_16x16x32_bf16 v[204:207], v[12:15], v[152:155], v[204:207]
    v_mfma_f32_16x16x32_bf16 v[208:211], v[16:19], v[88:91], v[208:211]
    v_mfma_f32_16x16x32_bf16 v[212:215], v[16:19], v[152:155], v[212:215]
    v_mfma_f32_16x16x32_bf16 v[216:219], v[20:23], v[88:91], v[216:219]
    v_mfma_f32_16x16x32_bf16 v[220:223], v[20:23], v[152:155], v[220:223]
    v_mfma_f32_16x16x32_bf16 v[224:227], v[24:27], v[88:91], v[224:227]
    v_mfma_f32_16x16x32_bf16 v[228:231], v[24:27], v[152:155], v[228:231]
    v_mfma_f32_16x16x32_bf16 v[232:235], v[28:31], v[88:91], v[232:235]
    v_mfma_f32_16x16x32_bf16 v[236:239], v[28:31], v[152:155], v[236:239]
    v_mfma_f32_16x16x32_bf16 v[240:243], v[32:35], v[88:91], v[240:243]
    v_mfma_f32_16x16x32_bf16 v[244:247], v[32:35], v[152:155], v[244:247]
    s_waitcnt lgkmcnt(0)
    v_mfma_f32_16x16x32_bf16 v[192:195], v[36:39], v[92:95], v[192:195]
    v_mfma_f32_16x16x32_bf16 v[196:199], v[36:39], v[156:159], v[196:199]
    v_mfma_f32_16x16x32_bf16 v[200:203], v[40:43], v[92:95], v[200:203]
    v_mfma_f32_16x16x32_bf16 v[204:207], v[40:43], v[156:159], v[204:207]
    v_mfma_f32_16x16x32_bf16 v[208:211], v[44:47], v[92:95], v[208:211]
    v_mfma_f32_16x16x32_bf16 v[212:215], v[44:47], v[156:159], v[212:215]
    v_mfma_f32_16x16x32_bf16 v[216:219], v[48:51], v[92:95], v[216:219]
    v_mfma_f32_16x16x32_bf16 v[220:223], v[48:51], v[156:159], v[220:223]
    v_mfma_f32_16x16x32_bf16 v[224:227], v[52:55], v[92:95], v[224:227]
    v_mfma_f32_16x16x32_bf16 v[228:231], v[52:55], v[156:159], v[228:231]
    v_mfma_f32_16x16x32_bf16 v[232:235], v[56:59], v[92:95], v[232:235]
    v_mfma_f32_16x16x32_bf16 v[236:239], v[56:59], v[156:159], v[236:239]
    v_mfma_f32_16x16x32_bf16 v[240:243], v[60:63], v[92:95], v[240:243]
    v_mfma_f32_16x16x32_bf16 v[244:247], v[60:63], v[156:159], v[244:247]
    s_waitcnt vmcnt(15)
    s_barrier
    ds_read_b128 v[8:11], v3 offset:57344
    ds_read_b128 v[12:15], v3 offset:58368
    ds_read_b128 v[16:19], v3 offset:59392
    ds_read_b128 v[20:23], v3 offset:60416
    ds_read_b128 v[24:27], v3 offset:61440
    ds_read_b128 v[28:31], v3 offset:62464
    ds_read_b128 v[32:35], v3 offset:63488
    ds_read_b128 v[36:39], v3 offset:64512
    ds_read_b128 v[40:43], v4 offset:0
    ds_read_b128 v[44:47], v4 offset:1024
    ds_read_b128 v[48:51], v4 offset:2048
    ds_read_b128 v[52:55], v4 offset:3072
    ds_read_b128 v[56:59], v4 offset:4096
    ds_read_b128 v[60:63], v4 offset:5120
    s_waitcnt lgkmcnt(7)
    v_mfma_f32_16x16x32_bf16 v[192:195], v[8:11], v[96:99], v[192:195]
    v_mfma_f32_16x16x32_bf16 v[196:199], v[8:11], v[160:163], v[196:199]
    v_mfma_f32_16x16x32_bf16 v[200:203], v[12:15], v[96:99], v[200:203]
    v_mfma_f32_16x16x32_bf16 v[204:207], v[12:15], v[160:163], v[204:207]
    v_mfma_f32_16x16x32_bf16 v[208:211], v[16:19], v[96:99], v[208:211]
    v_mfma_f32_16x16x32_bf16 v[212:215], v[16:19], v[160:163], v[212:215]
    v_mfma_f32_16x16x32_bf16 v[216:219], v[20:23], v[96:99], v[216:219]
    v_mfma_f32_16x16x32_bf16 v[220:223], v[20:23], v[160:163], v[220:223]
    v_mfma_f32_16x16x32_bf16 v[224:227], v[24:27], v[96:99], v[224:227]
    v_mfma_f32_16x16x32_bf16 v[228:231], v[24:27], v[160:163], v[228:231]
    v_mfma_f32_16x16x32_bf16 v[232:235], v[28:31], v[96:99], v[232:235]
    v_mfma_f32_16x16x32_bf16 v[236:239], v[28:31], v[160:163], v[236:239]
    v_mfma_f32_16x16x32_bf16 v[240:243], v[32:35], v[96:99], v[240:243]
    v_mfma_f32_16x16x32_bf16 v[244:247], v[32:35], v[160:163], v[244:247]
    ds_read_b128 v[8:11], v4 offset:6144
    ds_read_b128 v[12:15], v4 offset:7168
    ds_read_b128 v[16:19], v4 offset:8192
    ds_read_b128 v[20:23], v4 offset:9216
    ds_read_b128 v[24:27], v4 offset:10240
    ds_read_b128 v[28:31], v4 offset:11264
    ds_read_b128 v[32:35], v4 offset:12288
    s_waitcnt lgkmcnt(7)
    v_mfma_f32_16x16x32_bf16 v[192:195], v[36:39], v[100:103], v[192:195]
    v_mfma_f32_16x16x32_bf16 v[196:199], v[36:39], v[164:167], v[196:199]
    v_mfma_f32_16x16x32_bf16 v[200:203], v[40:43], v[100:103], v[200:203]
    v_mfma_f32_16x16x32_bf16 v[204:207], v[40:43], v[164:167], v[204:207]
    v_mfma_f32_16x16x32_bf16 v[208:211], v[44:47], v[100:103], v[208:211]
    v_mfma_f32_16x16x32_bf16 v[212:215], v[44:47], v[164:167], v[212:215]
    v_mfma_f32_16x16x32_bf16 v[216:219], v[48:51], v[100:103], v[216:219]
    v_mfma_f32_16x16x32_bf16 v[220:223], v[48:51], v[164:167], v[220:223]
    v_mfma_f32_16x16x32_bf16 v[224:227], v[52:55], v[100:103], v[224:227]
    v_mfma_f32_16x16x32_bf16 v[228:231], v[52:55], v[164:167], v[228:231]
    v_mfma_f32_16x16x32_bf16 v[232:235], v[56:59], v[100:103], v[232:235]
    v_mfma_f32_16x16x32_bf16 v[236:239], v[56:59], v[164:167], v[236:239]
    v_mfma_f32_16x16x32_bf16 v[240:243], v[60:63], v[100:103], v[240:243]
    v_mfma_f32_16x16x32_bf16 v[244:247], v[60:63], v[164:167], v[244:247]
    ds_read_b128 v[36:39], v4 offset:13312
    ds_read_b128 v[40:43], v4 offset:14336
    ds_read_b128 v[44:47], v4 offset:15360
    ds_read_b128 v[48:51], v4 offset:16384
    ds_read_b128 v[52:55], v4 offset:17408
    ds_read_b128 v[56:59], v4 offset:18432
    ds_read_b128 v[60:63], v4 offset:19456
    s_waitcnt lgkmcnt(7)
    v_mfma_f32_16x16x32_bf16 v[192:195], v[8:11], v[104:107], v[192:195]
    v_mfma_f32_16x16x32_bf16 v[196:199], v[8:11], v[168:171], v[196:199]
    v_mfma_f32_16x16x32_bf16 v[200:203], v[12:15], v[104:107], v[200:203]
    v_mfma_f32_16x16x32_bf16 v[204:207], v[12:15], v[168:171], v[204:207]
    v_mfma_f32_16x16x32_bf16 v[208:211], v[16:19], v[104:107], v[208:211]
    v_mfma_f32_16x16x32_bf16 v[212:215], v[16:19], v[168:171], v[212:215]
    v_mfma_f32_16x16x32_bf16 v[216:219], v[20:23], v[104:107], v[216:219]
    v_mfma_f32_16x16x32_bf16 v[220:223], v[20:23], v[168:171], v[220:223]
    v_mfma_f32_16x16x32_bf16 v[224:227], v[24:27], v[104:107], v[224:227]
    v_mfma_f32_16x16x32_bf16 v[228:231], v[24:27], v[168:171], v[228:231]
    v_mfma_f32_16x16x32_bf16 v[232:235], v[28:31], v[104:107], v[232:235]
    v_mfma_f32_16x16x32_bf16 v[236:239], v[28:31], v[168:171], v[236:239]
    v_mfma_f32_16x16x32_bf16 v[240:243], v[32:35], v[104:107], v[240:243]
    v_mfma_f32_16x16x32_bf16 v[244:247], v[32:35], v[168:171], v[244:247]
    s_waitcnt lgkmcnt(0)
    v_mfma_f32_16x16x32_bf16 v[192:195], v[36:39], v[108:111], v[192:195]
    v_mfma_f32_16x16x32_bf16 v[196:199], v[36:39], v[172:175], v[196:199]
    v_mfma_f32_16x16x32_bf16 v[200:203], v[40:43], v[108:111], v[200:203]
    v_mfma_f32_16x16x32_bf16 v[204:207], v[40:43], v[172:175], v[204:207]
    v_mfma_f32_16x16x32_bf16 v[208:211], v[44:47], v[108:111], v[208:211]
    v_mfma_f32_16x16x32_bf16 v[212:215], v[44:47], v[172:175], v[212:215]
    v_mfma_f32_16x16x32_bf16 v[216:219], v[48:51], v[108:111], v[216:219]
    v_mfma_f32_16x16x32_bf16 v[220:223], v[48:51], v[172:175], v[220:223]
    v_mfma_f32_16x16x32_bf16 v[224:227], v[52:55], v[108:111], v[224:227]
    v_mfma_f32_16x16x32_bf16 v[228:231], v[52:55], v[172:175], v[228:231]
    v_mfma_f32_16x16x32_bf16 v[232:235], v[56:59], v[108:111], v[232:235]
    v_mfma_f32_16x16x32_bf16 v[236:239], v[56:59], v[172:175], v[236:239]
    v_mfma_f32_16x16x32_bf16 v[240:243], v[60:63], v[108:111], v[240:243]
    v_mfma_f32_16x16x32_bf16 v[244:247], v[60:63], v[172:175], v[244:247]
    s_waitcnt vmcnt(0)
    s_barrier
    s_add_u32 s8, s34, 0x1100000
    s_addc_u32 s9, s35, 0
    s_mul_i32 s7, s5, 57344
    s_add_u32 s8, s8, s7
    s_addc_u32 s9, s9, 0
    s_mov_b32 s46, 0xbfb8aa3b
    s_mov_b32 s47, 0xbfb8aa3b
    s_mov_b32 s48, 1.0
    s_mov_b32 s49, 1.0
    ds_read_b128 v[8:11], v4 offset:20480
    ds_read_b128 v[12:15], v4 offset:27648
    ds_read_b128 v[16:19], v4 offset:34816
    ds_read_b128 v[20:23], v4 offset:41984
    ds_read_b128 v[24:27], v4 offset:21504
    ds_read_b128 v[28:31], v4 offset:28672
    ds_read_b128 v[32:35], v4 offset:35840
    ds_read_b128 v[36:39], v4 offset:43008
    s_waitcnt lgkmcnt(4)
    v_mfma_f32_16x16x32_bf16 v[192:195], v[8:11], v[112:115], v[192:195]
    v_mfma_f32_16x16x32_bf16 v[196:199], v[8:11], v[176:179], v[196:199]
    v_mfma_f32_16x16x32_bf16 v[192:195], v[12:15], v[116:119], v[192:195]
    v_mfma_f32_16x16x32_bf16 v[196:199], v[12:15], v[180:183], v[196:199]
    v_mfma_f32_16x16x32_bf16 v[192:195], v[16:19], v[120:123], v[192:195]
    v_mfma_f32_16x16x32_bf16 v[196:199], v[16:19], v[184:187], v[196:199]
    v_mfma_f32_16x16x32_bf16 v[192:195], v[20:23], v[124:127], v[192:195]
    v_mfma_f32_16x16x32_bf16 v[196:199], v[20:23], v[188:191], v[196:199]
    ds_read_b128 v[8:11], v4 offset:22528
    ds_read_b128 v[12:15], v4 offset:29696
    ds_read_b128 v[16:19], v4 offset:36864
    ds_read_b128 v[20:23], v4 offset:44032
    s_waitcnt lgkmcnt(4)
    v_mfma_f32_16x16x32_bf16 v[200:203], v[24:27], v[112:115], v[200:203]
    v_mfma_f32_16x16x32_bf16 v[204:207], v[24:27], v[176:179], v[204:207]
    v_mfma_f32_16x16x32_bf16 v[200:203], v[28:31], v[116:119], v[200:203]
    v_mfma_f32_16x16x32_bf16 v[204:207], v[28:31], v[180:183], v[204:207]
    v_mfma_f32_16x16x32_bf16 v[200:203], v[32:35], v[120:123], v[200:203]
    v_mfma_f32_16x16x32_bf16 v[204:207], v[32:35], v[184:187], v[204:207]
    v_mfma_f32_16x16x32_bf16 v[200:203], v[36:39], v[124:127], v[200:203]
    v_mfma_f32_16x16x32_bf16 v[204:207], v[36:39], v[188:191], v[204:207]
    s_add_u32 s44, s6, 0
    s_lshr_b32 s45, s44, 1
    s_lshl_b32 s45, s45, 10
    s_and_b32 s44, s44, 1
    s_lshl_b32 s44, s44, 3
    s_add_u32 s45, s45, s44
    v_cvt_pk_bf16_f32 v56, v192, v193
    v_cvt_pk_bf16_f32 v57, v194, v195
    v_cvt_pk_bf16_f32 v58, v196, v197
    v_cvt_pk_bf16_f32 v59, v198, v199
    v_lshlrev_b32 v192, 16, v56
    v_and_b32 v193, 0xffff0000, v56
    v_lshlrev_b32 v194, 16, v57
    v_and_b32 v195, 0xffff0000, v57
    v_lshlrev_b32 v196, 16, v58
    v_and_b32 v197, 0xffff0000, v58
    v_lshlrev_b32 v198, 16, v59
    v_and_b32 v199, 0xffff0000, v59
    v_pk_mul_f32 v[48:49], v[192:193], s[46:47]
    v_pk_mul_f32 v[50:51], v[194:195], s[46:47]
    v_pk_mul_f32 v[52:53], v[196:197], s[46:47]
    v_pk_mul_f32 v[54:55], v[198:199], s[46:47]
    v_exp_f32 v48, v48
    v_exp_f32 v49, v49
    v_exp_f32 v50, v50
    v_exp_f32 v51, v51
    v_exp_f32 v52, v52
    v_exp_f32 v53, v53
    v_exp_f32 v54, v54
    v_exp_f32 v55, v55
    v_pk_add_f32 v[48:49], v[48:49], s[48:49]
    v_pk_add_f32 v[50:51], v[50:51], s[48:49]
    v_pk_add_f32 v[52:53], v[52:53], s[48:49]
    v_pk_add_f32 v[54:55], v[54:55], s[48:49]
    v_rcp_f32 v48, v48
    v_rcp_f32 v49, v49
    v_rcp_f32 v50, v50
    v_rcp_f32 v51, v51
    v_rcp_f32 v52, v52
    v_rcp_f32 v53, v53
    v_rcp_f32 v54, v54
    v_rcp_f32 v55, v55
    s_nop 0
    v_pk_mul_f32 v[192:193], v[192:193], v[48:49]
    v_pk_mul_f32 v[194:195], v[194:195], v[50:51]
    v_pk_mul_f32 v[196:197], v[196:197], v[52:53]
    v_pk_mul_f32 v[198:199], v[198:199], v[54:55]
    v_cvt_pk_bf16_f32 v60, v192, v193
    v_cvt_pk_bf16_f32 v61, v194, v195
    v_cvt_pk_bf16_f32 v62, v196, v197
    v_cvt_pk_bf16_f32 v63, v198, v199
    v_add_u32 v5, s45, v3
    global_store_dwordx2 v5, v[60:61], s[8:9]
    v_add_u32 v5, 0xe000, v5
    global_store_dwordx2 v5, v[62:63], s[8:9]
    s_nop 0
    ds_read_b128 v[24:27], v4 offset:23552
    ds_read_b128 v[28:31], v4 offset:30720
    ds_read_b128 v[32:35], v4 offset:37888
    ds_read_b128 v[36:39], v4 offset:45056
    s_waitcnt lgkmcnt(4)
    v_mfma_f32_16x16x32_bf16 v[208:211], v[8:11], v[112:115], v[208:211]
    v_mfma_f32_16x16x32_bf16 v[212:215], v[8:11], v[176:179], v[212:215]
    v_mfma_f32_16x16x32_bf16 v[208:211], v[12:15], v[116:119], v[208:211]
    v_mfma_f32_16x16x32_bf16 v[212:215], v[12:15], v[180:183], v[212:215]
    v_mfma_f32_16x16x32_bf16 v[208:211], v[16:19], v[120:123], v[208:211]
    v_mfma_f32_16x16x32_bf16 v[212:215], v[16:19], v[184:187], v[212:215]
    v_mfma_f32_16x16x32_bf16 v[208:211], v[20:23], v[124:127], v[208:211]
    v_mfma_f32_16x16x32_bf16 v[212:215], v[20:23], v[188:191], v[212:215]
    s_add_u32 s44, s6, 1
    s_lshr_b32 s45, s44, 1
    s_lshl_b32 s45, s45, 10
    s_and_b32 s44, s44, 1
    s_lshl_b32 s44, s44, 3
    s_add_u32 s45, s45, s44
    v_cvt_pk_bf16_f32 v56, v200, v201
    v_cvt_pk_bf16_f32 v57, v202, v203
    v_cvt_pk_bf16_f32 v58, v204, v205
    v_cvt_pk_bf16_f32 v59, v206, v207
    v_lshlrev_b32 v200, 16, v56
    v_and_b32 v201, 0xffff0000, v56
    v_lshlrev_b32 v202, 16, v57
    v_and_b32 v203, 0xffff0000, v57
    v_lshlrev_b32 v204, 16, v58
    v_and_b32 v205, 0xffff0000, v58
    v_lshlrev_b32 v206, 16, v59
    v_and_b32 v207, 0xffff0000, v59
    v_pk_mul_f32 v[48:49], v[200:201], s[46:47]
    v_pk_mul_f32 v[50:51], v[202:203], s[46:47]
    v_pk_mul_f32 v[52:53], v[204:205], s[46:47]
    v_pk_mul_f32 v[54:55], v[206:207], s[46:47]
    v_exp_f32 v48, v48
    v_exp_f32 v49, v49
    v_exp_f32 v50, v50
    v_exp_f32 v51, v51
    v_exp_f32 v52, v52
    v_exp_f32 v53, v53
    v_exp_f32 v54, v54
    v_exp_f32 v55, v55
    v_pk_add_f32 v[48:49], v[48:49], s[48:49]
    v_pk_add_f32 v[50:51], v[50:51], s[48:49]
    v_pk_add_f32 v[52:53], v[52:53], s[48:49]
    v_pk_add_f32 v[54:55], v[54:55], s[48:49]
    v_rcp_f32 v48, v48
    v_rcp_f32 v49, v49
    v_rcp_f32 v50, v50
    v_rcp_f32 v51, v51
    v_rcp_f32 v52, v52
    v_rcp_f32 v53, v53
    v_rcp_f32 v54, v54
    v_rcp_f32 v55, v55
    s_nop 0
    v_pk_mul_f32 v[200:201], v[200:201], v[48:49]
    v_pk_mul_f32 v[202:203], v[202:203], v[50:51]
    v_pk_mul_f32 v[204:205], v[204:205], v[52:53]
    v_pk_mul_f32 v[206:207], v[206:207], v[54:55]
    v_cvt_pk_bf16_f32 v60, v200, v201
    v_cvt_pk_bf16_f32 v61, v202, v203
    v_cvt_pk_bf16_f32 v62, v204, v205
    v_cvt_pk_bf16_f32 v63, v206, v207
    v_add_u32 v5, s45, v3
    global_store_dwordx2 v5, v[60:61], s[8:9]
    v_add_u32 v5, 0xe000, v5
    global_store_dwordx2 v5, v[62:63], s[8:9]
    s_nop 0
    ds_read_b128 v[8:11], v4 offset:24576
    ds_read_b128 v[12:15], v4 offset:31744
    ds_read_b128 v[16:19], v4 offset:38912
    ds_read_b128 v[20:23], v4 offset:46080
    s_waitcnt lgkmcnt(4)
    v_mfma_f32_16x16x32_bf16 v[216:219], v[24:27], v[112:115], v[216:219]
    v_mfma_f32_16x16x32_bf16 v[220:223], v[24:27], v[176:179], v[220:223]
    v_mfma_f32_16x16x32_bf16 v[216:219], v[28:31], v[116:119], v[216:219]
    v_mfma_f32_16x16x32_bf16 v[220:223], v[28:31], v[180:183], v[220:223]
    v_mfma_f32_16x16x32_bf16 v[216:219], v[32:35], v[120:123], v[216:219]
    v_mfma_f32_16x16x32_bf16 v[220:223], v[32:35], v[184:187], v[220:223]
    v_mfma_f32_16x16x32_bf16 v[216:219], v[36:39], v[124:127], v[216:219]
    v_mfma_f32_16x16x32_bf16 v[220:223], v[36:39], v[188:191], v[220:223]
    s_add_u32 s44, s6, 2
    s_lshr_b32 s45, s44, 1
    s_lshl_b32 s45, s45, 10
    s_and_b32 s44, s44, 1
    s_lshl_b32 s44, s44, 3
    s_add_u32 s45, s45, s44
    v_cvt_pk_bf16_f32 v56, v208, v209
    v_cvt_pk_bf16_f32 v57, v210, v211
    v_cvt_pk_bf16_f32 v58, v212, v213
    v_cvt_pk_bf16_f32 v59, v214, v215
    v_lshlrev_b32 v208, 16, v56
    v_and_b32 v209, 0xffff0000, v56
    v_lshlrev_b32 v210, 16, v57
    v_and_b32 v211, 0xffff0000, v57
    v_lshlrev_b32 v212, 16, v58
    v_and_b32 v213, 0xffff0000, v58
    v_lshlrev_b32 v214, 16, v59
    v_and_b32 v215, 0xffff0000, v59
    v_pk_mul_f32 v[48:49], v[208:209], s[46:47]
    v_pk_mul_f32 v[50:51], v[210:211], s[46:47]
    v_pk_mul_f32 v[52:53], v[212:213], s[46:47]
    v_pk_mul_f32 v[54:55], v[214:215], s[46:47]
    v_exp_f32 v48, v48
    v_exp_f32 v49, v49
    v_exp_f32 v50, v50
    v_exp_f32 v51, v51
    v_exp_f32 v52, v52
    v_exp_f32 v53, v53
    v_exp_f32 v54, v54
    v_exp_f32 v55, v55
    v_pk_add_f32 v[48:49], v[48:49], s[48:49]
    v_pk_add_f32 v[50:51], v[50:51], s[48:49]
    v_pk_add_f32 v[52:53], v[52:53], s[48:49]
    v_pk_add_f32 v[54:55], v[54:55], s[48:49]
    v_rcp_f32 v48, v48
    v_rcp_f32 v49, v49
    v_rcp_f32 v50, v50
    v_rcp_f32 v51, v51
    v_rcp_f32 v52, v52
    v_rcp_f32 v53, v53
    v_rcp_f32 v54, v54
    v_rcp_f32 v55, v55
    s_nop 0
    v_pk_mul_f32 v[208:209], v[208:209], v[48:49]
    v_pk_mul_f32 v[210:211], v[210:211], v[50:51]
    v_pk_mul_f32 v[212:213], v[212:213], v[52:53]
    v_pk_mul_f32 v[214:215], v[214:215], v[54:55]
    v_cvt_pk_bf16_f32 v60, v208, v209
    v_cvt_pk_bf16_f32 v61, v210, v211
    v_cvt_pk_bf16_f32 v62, v212, v213
    v_cvt_pk_bf16_f32 v63, v214, v215
    v_add_u32 v5, s45, v3
    global_store_dwordx2 v5, v[60:61], s[8:9]
    v_add_u32 v5, 0xe000, v5
    global_store_dwordx2 v5, v[62:63], s[8:9]
    s_nop 0
    ds_read_b128 v[24:27], v4 offset:25600
    ds_read_b128 v[28:31], v4 offset:32768
    ds_read_b128 v[32:35], v4 offset:39936
    ds_read_b128 v[36:39], v4 offset:47104
    s_waitcnt lgkmcnt(4)
    v_mfma_f32_16x16x32_bf16 v[224:227], v[8:11], v[112:115], v[224:227]
    v_mfma_f32_16x16x32_bf16 v[228:231], v[8:11], v[176:179], v[228:231]
    v_mfma_f32_16x16x32_bf16 v[224:227], v[12:15], v[116:119], v[224:227]
    v_mfma_f32_16x16x32_bf16 v[228:231], v[12:15], v[180:183], v[228:231]
    v_mfma_f32_16x16x32_bf16 v[224:227], v[16:19], v[120:123], v[224:227]
    v_mfma_f32_16x16x32_bf16 v[228:231], v[16:19], v[184:187], v[228:231]
    v_mfma_f32_16x16x32_bf16 v[224:227], v[20:23], v[124:127], v[224:227]
    v_mfma_f32_16x16x32_bf16 v[228:231], v[20:23], v[188:191], v[228:231]
    s_add_u32 s44, s6, 3
    s_lshr_b32 s45, s44, 1
    s_lshl_b32 s45, s45, 10
    s_and_b32 s44, s44, 1
    s_lshl_b32 s44, s44, 3
    s_add_u32 s45, s45, s44
    v_cvt_pk_bf16_f32 v56, v216, v217
    v_cvt_pk_bf16_f32 v57, v218, v219
    v_cvt_pk_bf16_f32 v58, v220, v221
    v_cvt_pk_bf16_f32 v59, v222, v223
    v_lshlrev_b32 v216, 16, v56
    v_and_b32 v217, 0xffff0000, v56
    v_lshlrev_b32 v218, 16, v57
    v_and_b32 v219, 0xffff0000, v57
    v_lshlrev_b32 v220, 16, v58
    v_and_b32 v221, 0xffff0000, v58
    v_lshlrev_b32 v222, 16, v59
    v_and_b32 v223, 0xffff0000, v59
    v_pk_mul_f32 v[48:49], v[216:217], s[46:47]
    v_pk_mul_f32 v[50:51], v[218:219], s[46:47]
    v_pk_mul_f32 v[52:53], v[220:221], s[46:47]
    v_pk_mul_f32 v[54:55], v[222:223], s[46:47]
    v_exp_f32 v48, v48
    v_exp_f32 v49, v49
    v_exp_f32 v50, v50
    v_exp_f32 v51, v51
    v_exp_f32 v52, v52
    v_exp_f32 v53, v53
    v_exp_f32 v54, v54
    v_exp_f32 v55, v55
    v_pk_add_f32 v[48:49], v[48:49], s[48:49]
    v_pk_add_f32 v[50:51], v[50:51], s[48:49]
    v_pk_add_f32 v[52:53], v[52:53], s[48:49]
    v_pk_add_f32 v[54:55], v[54:55], s[48:49]
    v_rcp_f32 v48, v48
    v_rcp_f32 v49, v49
    v_rcp_f32 v50, v50
    v_rcp_f32 v51, v51
    v_rcp_f32 v52, v52
    v_rcp_f32 v53, v53
    v_rcp_f32 v54, v54
    v_rcp_f32 v55, v55
    s_nop 0
    v_pk_mul_f32 v[216:217], v[216:217], v[48:49]
    v_pk_mul_f32 v[218:219], v[218:219], v[50:51]
    v_pk_mul_f32 v[220:221], v[220:221], v[52:53]
    v_pk_mul_f32 v[222:223], v[222:223], v[54:55]
    v_cvt_pk_bf16_f32 v60, v216, v217
    v_cvt_pk_bf16_f32 v61, v218, v219
    v_cvt_pk_bf16_f32 v62, v220, v221
    v_cvt_pk_bf16_f32 v63, v222, v223
    v_add_u32 v5, s45, v3
    global_store_dwordx2 v5, v[60:61], s[8:9]
    v_add_u32 v5, 0xe000, v5
    global_store_dwordx2 v5, v[62:63], s[8:9]
    s_nop 0
    ds_read_b128 v[8:11], v4 offset:26624
    ds_read_b128 v[12:15], v4 offset:33792
    ds_read_b128 v[16:19], v4 offset:40960
    ds_read_b128 v[20:23], v4 offset:48128
    s_waitcnt lgkmcnt(4)
    v_mfma_f32_16x16x32_bf16 v[232:235], v[24:27], v[112:115], v[232:235]
    v_mfma_f32_16x16x32_bf16 v[236:239], v[24:27], v[176:179], v[236:239]
    v_mfma_f32_16x16x32_bf16 v[232:235], v[28:31], v[116:119], v[232:235]
    v_mfma_f32_16x16x32_bf16 v[236:239], v[28:31], v[180:183], v[236:239]
    v_mfma_f32_16x16x32_bf16 v[232:235], v[32:35], v[120:123], v[232:235]
    v_mfma_f32_16x16x32_bf16 v[236:239], v[32:35], v[184:187], v[236:239]
    v_mfma_f32_16x16x32_bf16 v[232:235], v[36:39], v[124:127], v[232:235]
    v_mfma_f32_16x16x32_bf16 v[236:239], v[36:39], v[188:191], v[236:239]
    s_add_u32 s44, s6, 4
    s_lshr_b32 s45, s44, 1
    s_lshl_b32 s45, s45, 10
    s_and_b32 s44, s44, 1
    s_lshl_b32 s44, s44, 3
    s_add_u32 s45, s45, s44
    v_cvt_pk_bf16_f32 v56, v224, v225
    v_cvt_pk_bf16_f32 v57, v226, v227
    v_cvt_pk_bf16_f32 v58, v228, v229
    v_cvt_pk_bf16_f32 v59, v230, v231
    v_lshlrev_b32 v224, 16, v56
    v_and_b32 v225, 0xffff0000, v56
    v_lshlrev_b32 v226, 16, v57
    v_and_b32 v227, 0xffff0000, v57
    v_lshlrev_b32 v228, 16, v58
    v_and_b32 v229, 0xffff0000, v58
    v_lshlrev_b32 v230, 16, v59
    v_and_b32 v231, 0xffff0000, v59
    v_pk_mul_f32 v[48:49], v[224:225], s[46:47]
    v_pk_mul_f32 v[50:51], v[226:227], s[46:47]
    v_pk_mul_f32 v[52:53], v[228:229], s[46:47]
    v_pk_mul_f32 v[54:55], v[230:231], s[46:47]
    v_exp_f32 v48, v48
    v_exp_f32 v49, v49
    v_exp_f32 v50, v50
    v_exp_f32 v51, v51
    v_exp_f32 v52, v52
    v_exp_f32 v53, v53
    v_exp_f32 v54, v54
    v_exp_f32 v55, v55
    v_pk_add_f32 v[48:49], v[48:49], s[48:49]
    v_pk_add_f32 v[50:51], v[50:51], s[48:49]
    v_pk_add_f32 v[52:53], v[52:53], s[48:49]
    v_pk_add_f32 v[54:55], v[54:55], s[48:49]
    v_rcp_f32 v48, v48
    v_rcp_f32 v49, v49
    v_rcp_f32 v50, v50
    v_rcp_f32 v51, v51
    v_rcp_f32 v52, v52
    v_rcp_f32 v53, v53
    v_rcp_f32 v54, v54
    v_rcp_f32 v55, v55
    s_nop 0
    v_pk_mul_f32 v[224:225], v[224:225], v[48:49]
    v_pk_mul_f32 v[226:227], v[226:227], v[50:51]
    v_pk_mul_f32 v[228:229], v[228:229], v[52:53]
    v_pk_mul_f32 v[230:231], v[230:231], v[54:55]
    v_cvt_pk_bf16_f32 v60, v224, v225
    v_cvt_pk_bf16_f32 v61, v226, v227
    v_cvt_pk_bf16_f32 v62, v228, v229
    v_cvt_pk_bf16_f32 v63, v230, v231
    v_add_u32 v5, s45, v3
    global_store_dwordx2 v5, v[60:61], s[8:9]
    v_add_u32 v5, 0xe000, v5
    global_store_dwordx2 v5, v[62:63], s[8:9]
    s_nop 0
    s_waitcnt lgkmcnt(0)
    v_mfma_f32_16x16x32_bf16 v[240:243], v[8:11], v[112:115], v[240:243]
    v_mfma_f32_16x16x32_bf16 v[244:247], v[8:11], v[176:179], v[244:247]
    v_mfma_f32_16x16x32_bf16 v[240:243], v[12:15], v[116:119], v[240:243]
    v_mfma_f32_16x16x32_bf16 v[244:247], v[12:15], v[180:183], v[244:247]
    v_mfma_f32_16x16x32_bf16 v[240:243], v[16:19], v[120:123], v[240:243]
    v_mfma_f32_16x16x32_bf16 v[244:247], v[16:19], v[184:187], v[244:247]
    v_mfma_f32_16x16x32_bf16 v[240:243], v[20:23], v[124:127], v[240:243]
    v_mfma_f32_16x16x32_bf16 v[244:247], v[20:23], v[188:191], v[244:247]
    s_add_u32 s44, s6, 5
    s_lshr_b32 s45, s44, 1
    s_lshl_b32 s45, s45, 10
    s_and_b32 s44, s44, 1
    s_lshl_b32 s44, s44, 3
    s_add_u32 s45, s45, s44
    v_cvt_pk_bf16_f32 v56, v232, v233
    v_cvt_pk_bf16_f32 v57, v234, v235
    v_cvt_pk_bf16_f32 v58, v236, v237
    v_cvt_pk_bf16_f32 v59, v238, v239
    v_lshlrev_b32 v232, 16, v56
    v_and_b32 v233, 0xffff0000, v56
    v_lshlrev_b32 v234, 16, v57
    v_and_b32 v235, 0xffff0000, v57
    v_lshlrev_b32 v236, 16, v58
    v_and_b32 v237, 0xffff0000, v58
    v_lshlrev_b32 v238, 16, v59
    v_and_b32 v239, 0xffff0000, v59
    v_pk_mul_f32 v[48:49], v[232:233], s[46:47]
    v_pk_mul_f32 v[50:51], v[234:235], s[46:47]
    v_pk_mul_f32 v[52:53], v[236:237], s[46:47]
    v_pk_mul_f32 v[54:55], v[238:239], s[46:47]
    v_exp_f32 v48, v48
    v_exp_f32 v49, v49
    v_exp_f32 v50, v50
    v_exp_f32 v51, v51
    v_exp_f32 v52, v52
    v_exp_f32 v53, v53
    v_exp_f32 v54, v54
    v_exp_f32 v55, v55
    v_pk_add_f32 v[48:49], v[48:49], s[48:49]
    v_pk_add_f32 v[50:51], v[50:51], s[48:49]
    v_pk_add_f32 v[52:53], v[52:53], s[48:49]
    v_pk_add_f32 v[54:55], v[54:55], s[48:49]
    v_rcp_f32 v48, v48
    v_rcp_f32 v49, v49
    v_rcp_f32 v50, v50
    v_rcp_f32 v51, v51
    v_rcp_f32 v52, v52
    v_rcp_f32 v53, v53
    v_rcp_f32 v54, v54
    v_rcp_f32 v55, v55
    s_nop 0
    v_pk_mul_f32 v[232:233], v[232:233], v[48:49]
    v_pk_mul_f32 v[234:235], v[234:235], v[50:51]
    v_pk_mul_f32 v[236:237], v[236:237], v[52:53]
    v_pk_mul_f32 v[238:239], v[238:239], v[54:55]
    v_cvt_pk_bf16_f32 v60, v232, v233
    v_cvt_pk_bf16_f32 v61, v234, v235
    v_cvt_pk_bf16_f32 v62, v236, v237
    v_cvt_pk_bf16_f32 v63, v238, v239
    v_add_u32 v5, s45, v3
    global_store_dwordx2 v5, v[60:61], s[8:9]
    v_add_u32 v5, 0xe000, v5
    global_store_dwordx2 v5, v[62:63], s[8:9]
    s_nop 0
    s_nop 7
    s_add_u32 s44, s6, 6
    s_lshr_b32 s45, s44, 1
    s_lshl_b32 s45, s45, 10
    s_and_b32 s44, s44, 1
    s_lshl_b32 s44, s44, 3
    s_add_u32 s45, s45, s44
    v_cvt_pk_bf16_f32 v56, v240, v241
    v_cvt_pk_bf16_f32 v57, v242, v243
    v_cvt_pk_bf16_f32 v58, v244, v245
    v_cvt_pk_bf16_f32 v59, v246, v247
    v_lshlrev_b32 v240, 16, v56
    v_and_b32 v241, 0xffff0000, v56
    v_lshlrev_b32 v242, 16, v57
    v_and_b32 v243, 0xffff0000, v57
    v_lshlrev_b32 v244, 16, v58
    v_and_b32 v245, 0xffff0000, v58
    v_lshlrev_b32 v246, 16, v59
    v_and_b32 v247, 0xffff0000, v59
    v_pk_mul_f32 v[48:49], v[240:241], s[46:47]
    v_pk_mul_f32 v[50:51], v[242:243], s[46:47]
    v_pk_mul_f32 v[52:53], v[244:245], s[46:47]
    v_pk_mul_f32 v[54:55], v[246:247], s[46:47]
    v_exp_f32 v48, v48
    v_exp_f32 v49, v49
    v_exp_f32 v50, v50
    v_exp_f32 v51, v51
    v_exp_f32 v52, v52
    v_exp_f32 v53, v53
    v_exp_f32 v54, v54
    v_exp_f32 v55, v55
    v_pk_add_f32 v[48:49], v[48:49], s[48:49]
    v_pk_add_f32 v[50:51], v[50:51], s[48:49]
    v_pk_add_f32 v[52:53], v[52:53], s[48:49]
    v_pk_add_f32 v[54:55], v[54:55], s[48:49]
    v_rcp_f32 v48, v48
    v_rcp_f32 v49, v49
    v_rcp_f32 v50, v50
    v_rcp_f32 v51, v51
    v_rcp_f32 v52, v52
    v_rcp_f32 v53, v53
    v_rcp_f32 v54, v54
    v_rcp_f32 v55, v55
    s_nop 0
    v_pk_mul_f32 v[240:241], v[240:241], v[48:49]
    v_pk_mul_f32 v[242:243], v[242:243], v[50:51]
    v_pk_mul_f32 v[244:245], v[244:245], v[52:53]
    v_pk_mul_f32 v[246:247], v[246:247], v[54:55]
    v_cvt_pk_bf16_f32 v60, v240, v241
    v_cvt_pk_bf16_f32 v61, v242, v243
    v_cvt_pk_bf16_f32 v62, v244, v245
    v_cvt_pk_bf16_f32 v63, v246, v247
    v_add_u32 v5, s45, v3
    global_store_dwordx2 v5, v[60:61], s[8:9]
    v_add_u32 v5, 0xe000, v5
    global_store_dwordx2 v5, v[62:63], s[8:9]
    s_nop 0
.Lg1_done:
    s_endpgm
.globl adaLN_cond__spectral_gfnet__dense_activation_silu__prompt_kernel
.p2align 8
.type adaLN_cond__spectral_gfnet__dense_activation_silu__prompt_kernel,@function
adaLN_cond__spectral_gfnet__dense_activation_silu__prompt_kernel:
    s_load_dwordx16 s[16:31], s[0:1], 0
    s_load_dwordx2 s[32:33], s[0:1], 64
    s_load_dwordx4 s[36:39], s[0:1], 72
    s_load_dwordx2 s[34:35], s[0:1], 80
    s_cmp_ge_u32 s2, 256
    s_cbranch_scc1 .Lg2_done
    v_and_b32 v1, 63, v0
    v_lshrrev_b32 v2, 6, v0
    v_lshlrev_b32 v3, 4, v1
    v_add_u32 v4, 0x10000, v3
    s_nop 0
    v_readfirstlane_b32 s40, v2
    s_and_b32 s3, s2, 31
    s_lshr_b32 s4, s2, 5
    s_and_b32 s46, s40, 1
    s_lshr_b32 s47, s40, 1
    s_waitcnt lgkmcnt(0)
    v_and_b32 v5, 15, v1
    v_lshrrev_b32 v6, 4, v1
    s_lshl_b32 s5, s3, 6
    s_lshl_b32 s6, s46, 5
    s_add_u32 s5, s5, s6
    v_add_u32 v7, s5, v5
    v_lshlrev_b32 v7, 10, v7
    s_lshl_b32 s6, s4, 1
    s_add_u32 s6, s6, s47
    s_lshl_b32 s7, s6, 6
    v_lshl_add_u32 v7, v6, 4, v7
    v_add_u32 v7, s7, v7
    s_add_u32 s8, s34, 0xd00000
    s_addc_u32 s9, s35, 0
    global_load_dwordx4 v[72:75], v7, s[8:9]
    v_add_u32 v8, 0x4000, v7
    global_load_dwordx4 v[76:79], v8, s[8:9]
    s_lshl_b32 s7, s6, 7
    v_lshlrev_b32 v9, 5, v6
    v_add_u32 v9, s7, v9
    v_add_u32 v9, 0x2800, v9
    global_load_dwordx4 v[80:83], v9, s[34:35]
    global_load_dwordx4 v[84:87], v9, s[34:35] offset:16
    s_add_u32 s8, s34, 0x1100000
    s_addc_u32 s9, s35, 0
    s_add_u32 s12, s34, 0x500000
    s_addc_u32 s13, s35, 0
    s_mul_i32 s7, s3, 229376
    s_lshl_b32 s41, s40, 10
    s_add_u32 s7, s7, s41
    s_add_u32 s8, s8, s7
    s_addc_u32 s9, s9, 0
    s_mul_i32 s7, s4, 229376
    s_add_u32 s7, s7, s41
    s_add_u32 s12, s12, s7
    s_addc_u32 s13, s13, 0
    s_lshl_b32 s42, s40, 13
    s_add_u32 m0, s42, 0x0
    v_add_u32 v10, 0x0, v3
    global_load_lds_dwordx4 v10, s[8:9]
    s_add_u32 m0, s42, 0x400
    v_add_u32 v10, 0xe000, v3
    global_load_lds_dwordx4 v10, s[8:9]
    s_add_u32 m0, s42, 0x800
    v_add_u32 v10, 0x1c000, v3
    global_load_lds_dwordx4 v10, s[8:9]
    s_add_u32 m0, s42, 0xc00
    v_add_u32 v10, 0x2a000, v3
    global_load_lds_dwordx4 v10, s[8:9]
    s_add_u32 m0, s42, 0x1000
    v_add_u32 v10, 0x0, v3
    global_load_lds_dwordx4 v10, s[12:13]
    s_add_u32 m0, s42, 0x1400
    v_add_u32 v10, 0xe000, v3
    global_load_lds_dwordx4 v10, s[12:13]
    s_add_u32 m0, s42, 0x1800
    v_add_u32 v10, 0x1c000, v3
    global_load_lds_dwordx4 v10, s[12:13]
    s_add_u32 m0, s42, 0x1c00
    v_add_u32 v10, 0x2a000, v3
    global_load_lds_dwordx4 v10, s[12:13]
    s_add_u32 m0, s42, 0x8000
    v_add_u32 v10, 0x1000, v3
    global_load_lds_dwordx4 v10, s[8:9]
    s_add_u32 m0, s42, 0x8400
    v_add_u32 v10, 0xf000, v3
    global_load_lds_dwordx4 v10, s[8:9]
    s_add_u32 m0, s42, 0x8800
    v_add_u32 v10, 0x1d000, v3
    global_load_lds_dwordx4 v10, s[8:9]
    s_add_u32 m0, s42, 0x8c00
    v_add_u32 v10, 0x2b000, v3
    global_load_lds_dwordx4 v10, s[8:9]
    s_add_u32 m0, s42, 0x9000
    v_add_u32 v10, 0x1000, v3
    global_load_lds_dwordx4 v10, s[12:13]
    s_add_u32 m0, s42, 0x9400
    v_add_u32 v10, 0xf000, v3
    global_load_lds_dwordx4 v10, s[12:13]
    s_add_u32 m0, s42, 0x9800
    v_add_u32 v10, 0x1d000, v3
    global_load_lds_dwordx4 v10, s[12:13]
    s_add_u32 m0, s42, 0x9c00
    v_add_u32 v10, 0x2b000, v3
    global_load_lds_dwordx4 v10, s[12:13]
    s_add_u32 m0, s42, 0x10000
    v_add_u32 v10, 0x2000, v3
    global_load_lds_dwordx4 v10, s[8:9]
    s_add_u32 m0, s42, 0x10400
    v_add_u32 v10, 0x10000, v3
    global_load_lds_dwordx4 v10, s[8:9]
    s_add_u32 m0, s42, 0x10800
    v_add_u32 v10, 0x1e000, v3
    global_load_lds_dwordx4 v10, s[8:9]
    s_add_u32 m0, s42, 0x10c00
    v_add_u32 v10, 0x2c000, v3
    global_load_lds_dwordx4 v10, s[8:9]
    s_add_u32 m0, s42, 0x11000
    v_add_u32 v10, 0x2000, v3
    global_load_lds_dwordx4 v10, s[12:13]
    s_add_u32 m0, s42, 0x11400
    v_add_u32 v10, 0x10000, v3
    global_load_lds_dwordx4 v10, s[12:13]
    s_add_u32 m0, s42, 0x11800
    v_add_u32 v10, 0x1e000, v3
    global_load_lds_dwordx4 v10, s[12:13]
    s_add_u32 m0, s42, 0x11c00
    v_add_u32 v10, 0x2c000, v3
    global_load_lds_dwordx4 v10, s[12:13]
    s_lshl_b32 s43, s46, 11
    v_add_u32 v11, s43, v3
    v_add_u32 v12, 0x10000, v11
    s_lshl_b32 s43, s47, 11
    s_add_u32 s43, s43, 0x1000
    v_add_u32 v13, s43, v3
    v_add_u32 v14, 0x10000, v13
    s_waitcnt vmcnt(16)
    s_barrier
    s_add_u32 m0, s42, 0x18000
    v_add_u32 v10, 0x3000, v3
    global_load_lds_dwordx4 v10, s[8:9]
    s_add_u32 m0, s42, 0x18400
    v_add_u32 v10, 0x11000, v3
    global_load_lds_dwordx4 v10, s[8:9]
    s_add_u32 m0, s42, 0x18800
    v_add_u32 v10, 0x1f000, v3
    global_load_lds_dwordx4 v10, s[8:9]
    s_add_u32 m0, s42, 0x18c00
    v_add_u32 v10, 0x2d000, v3
    global_load_lds_dwordx4 v10, s[8:9]
    s_add_u32 m0, s42, 0x19000
    v_add_u32 v10, 0x3000, v3
    global_load_lds_dwordx4 v10, s[12:13]
    s_add_u32 m0, s42, 0x19400
    v_add_u32 v10, 0x11000, v3
    global_load_lds_dwordx4 v10, s[12:13]
    s_add_u32 m0, s42, 0x19800
    v_add_u32 v10, 0x1f000, v3
    global_load_lds_dwordx4 v10, s[12:13]
    s_add_u32 m0, s42, 0x19c00
    v_add_u32 v10, 0x2d000, v3
    global_load_lds_dwordx4 v10, s[12:13]
    ds_read_b128 v[16:19], v11 offset:0
    ds_read_b128 v[20:23], v11 offset:1024
    ds_read_b128 v[24:27], v13 offset:0
    ds_read_b128 v[28:31], v13 offset:1024
    ds_read_b128 v[32:35], v11 offset:8192
    ds_read_b128 v[36:39], v11 offset:9216
    ds_read_b128 v[40:43], v13 offset:8192
    ds_read_b128 v[44:47], v13 offset:9216
    s_waitcnt lgkmcnt(4)
    v_mfma_f32_16x16x32_bf16 v[56:59], v[24:27], v[16:19], 0
    v_mfma_f32_16x16x32_bf16 v[60:63], v[24:27], v[20:23], 0
    v_mfma_f32_16x16x32_bf16 v[64:67], v[28:31], v[16:19], 0
    v_mfma_f32_16x16x32_bf16 v[68:71], v[28:31], v[20:23], 0
    ds_read_b128 v[16:19], v11 offset:16384
    ds_read_b128 v[20:23], v11 offset:17408
    ds_read_b128 v[24:27], v13 offset:16384
    ds_read_b128 v[28:31], v13 offset:17408
    s_waitcnt lgkmcnt(4)
    v_mfma_f32_16x16x32_bf16 v[56:59], v[40:43], v[32:35], v[56:59]
    v_mfma_f32_16x16x32_bf16 v[60:63], v[40:43], v[36:39], v[60:63]
    v_mfma_f32_16x16x32_bf16 v[64:67], v[44:47], v[32:35], v[64:67]
    v_mfma_f32_16x16x32_bf16 v[68:71], v[44:47], v[36:39], v[68:71]
    ds_read_b128 v[32:35], v11 offset:24576
    ds_read_b128 v[36:39], v11 offset:25600
    ds_read_b128 v[40:43], v13 offset:24576
    ds_read_b128 v[44:47], v13 offset:25600
    s_waitcnt lgkmcnt(4)
    v_mfma_f32_16x16x32_bf16 v[56:59], v[24:27], v[16:19], v[56:59]
    v_mfma_f32_16x16x32_bf16 v[60:63], v[24:27], v[20:23], v[60:63]
    v_mfma_f32_16x16x32_bf16 v[64:67], v[28:31], v[16:19], v[64:67]
    v_mfma_f32_16x16x32_bf16 v[68:71], v[28:31], v[20:23], v[68:71]
    s_waitcnt lgkmcnt(0)
    v_mfma_f32_16x16x32_bf16 v[56:59], v[40:43], v[32:35], v[56:59]
    v_mfma_f32_16x16x32_bf16 v[60:63], v[40:43], v[36:39], v[60:63]
    v_mfma_f32_16x16x32_bf16 v[64:67], v[44:47], v[32:35], v[64:67]
    v_mfma_f32_16x16x32_bf16 v[68:71], v[44:47], v[36:39], v[68:71]
    s_waitcnt vmcnt(16)
    s_barrier
    s_add_u32 m0, s42, 0x0
    v_add_u32 v10, 0x4000, v3
    global_load_lds_dwordx4 v10, s[8:9]
    s_add_u32 m0, s42, 0x400
    v_add_u32 v10, 0x12000, v3
    global_load_lds_dwordx4 v10, s[8:9]
    s_add_u32 m0, s42, 0x800
    v_add_u32 v10, 0x20000, v3
    global_load_lds_dwordx4 v10, s[8:9]
    s_add_u32 m0, s42, 0xc00
    v_add_u32 v10, 0x2e000, v3
    global_load_lds_dwordx4 v10, s[8:9]
    s_add_u32 m0, s42, 0x1000
    v_add_u32 v10, 0x4000, v3
    global_load_lds_dwordx4 v10, s[12:13]
    s_add_u32 m0, s42, 0x1400
    v_add_u32 v10, 0x12000, v3
    global_load_lds_dwordx4 v10, s[12:13]
    s_add_u32 m0, s42, 0x1800
    v_add_u32 v10, 0x20000, v3
    global_load_lds_dwordx4 v10, s[12:13]
    s_add_u32 m0, s42, 0x1c00
    v_add_u32 v10, 0x2e000, v3
    global_load_lds_dwordx4 v10, s[12:13]
    ds_read_b128 v[16:19], v11 offset:32768
    ds_read_b128 v[20:23], v11 offset:33792
    ds_read_b128 v[24:27], v13 offset:32768
    ds_read_b128 v[28:31], v13 offset:33792
    ds_read_b128 v[32:35], v11 offset:40960
    ds_read_b128 v[36:39], v11 offset:41984
    ds_read_b128 v[40:43], v13 offset:40960
    ds_read_b128 v[44:47], v13 offset:41984
    s_waitcnt lgkmcnt(4)
    v_mfma_f32_16x16x32_bf16 v[56:59], v[24:27], v[16:19], v[56:59]
    v_mfma_f32_16x16x32_bf16 v[60:63], v[24:27], v[20:23], v[60:63]
    v_mfma_f32_16x16x32_bf16 v[64:67], v[28:31], v[16:19], v[64:67]
    v_mfma_f32_16x16x32_bf16 v[68:71], v[28:31], v[20:23], v[68:71]
    ds_read_b128 v[16:19], v11 offset:49152
    ds_read_b128 v[20:23], v11 offset:50176
    ds_read_b128 v[24:27], v13 offset:49152
    ds_read_b128 v[28:31], v13 offset:50176
    s_waitcnt lgkmcnt(4)
    v_mfma_f32_16x16x32_bf16 v[56:59], v[40:43], v[32:35], v[56:59]
    v_mfma_f32_16x16x32_bf16 v[60:63], v[40:43], v[36:39], v[60:63]
    v_mfma_f32_16x16x32_bf16 v[64:67], v[44:47], v[32:35], v[64:67]
    v_mfma_f32_16x16x32_bf16 v[68:71], v[44:47], v[36:39], v[68:71]
    ds_read_b128 v[32:35], v11 offset:57344
    ds_read_b128 v[36:39], v11 offset:58368
    ds_read_b128 v[40:43], v13 offset:57344
    ds_read_b128 v[44:47], v13 offset:58368
    s_waitcnt lgkmcnt(4)
    v_mfma_f32_16x16x32_bf16 v[56:59], v[24:27], v[16:19], v[56:59]
    v_mfma_f32_16x16x32_bf16 v[60:63], v[24:27], v[20:23], v[60:63]
    v_mfma_f32_16x16x32_bf16 v[64:67], v[28:31], v[16:19], v[64:67]
    v_mfma_f32_16x16x32_bf16 v[68:71], v[28:31], v[20:23], v[68:71]
    s_waitcnt lgkmcnt(0)
    v_mfma_f32_16x16x32_bf16 v[56:59], v[40:43], v[32:35], v[56:59]
    v_mfma_f32_16x16x32_bf16 v[60:63], v[40:43], v[36:39], v[60:63]
    v_mfma_f32_16x16x32_bf16 v[64:67], v[44:47], v[32:35], v[64:67]
    v_mfma_f32_16x16x32_bf16 v[68:71], v[44:47], v[36:39], v[68:71]
    s_waitcnt vmcnt(16)
    s_barrier
    s_add_u32 m0, s42, 0x8000
    v_add_u32 v10, 0x5000, v3
    global_load_lds_dwordx4 v10, s[8:9]
    s_add_u32 m0, s42, 0x8400
    v_add_u32 v10, 0x13000, v3
    global_load_lds_dwordx4 v10, s[8:9]
    s_add_u32 m0, s42, 0x8800
    v_add_u32 v10, 0x21000, v3
    global_load_lds_dwordx4 v10, s[8:9]
    s_add_u32 m0, s42, 0x8c00
    v_add_u32 v10, 0x2f000, v3
    global_load_lds_dwordx4 v10, s[8:9]
    s_add_u32 m0, s42, 0x9000
    v_add_u32 v10, 0x5000, v3
    global_load_lds_dwordx4 v10, s[12:13]
    s_add_u32 m0, s42, 0x9400
    v_add_u32 v10, 0x13000, v3
    global_load_lds_dwordx4 v10, s[12:13]
    s_add_u32 m0, s42, 0x9800
    v_add_u32 v10, 0x21000, v3
    global_load_lds_dwordx4 v10, s[12:13]
    s_add_u32 m0, s42, 0x9c00
    v_add_u32 v10, 0x2f000, v3
    global_load_lds_dwordx4 v10, s[12:13]
    ds_read_b128 v[16:19], v12 offset:0
    ds_read_b128 v[20:23], v12 offset:1024
    ds_read_b128 v[24:27], v14 offset:0
    ds_read_b128 v[28:31], v14 offset:1024
    ds_read_b128 v[32:35], v12 offset:8192
    ds_read_b128 v[36:39], v12 offset:9216
    ds_read_b128 v[40:43], v14 offset:8192
    ds_read_b128 v[44:47], v14 offset:9216
    s_waitcnt lgkmcnt(4)
    v_mfma_f32_16x16x32_bf16 v[56:59], v[24:27], v[16:19], v[56:59]
    v_mfma_f32_16x16x32_bf16 v[60:63], v[24:27], v[20:23], v[60:63]
    v_mfma_f32_16x16x32_bf16 v[64:67], v[28:31], v[16:19], v[64:67]
    v_mfma_f32_16x16x32_bf16 v[68:71], v[28:31], v[20:23], v[68:71]
    ds_read_b128 v[16:19], v12 offset:16384
    ds_read_b128 v[20:23], v12 offset:17408
    ds_read_b128 v[24:27], v14 offset:16384
    ds_read_b128 v[28:31], v14 offset:17408
    s_waitcnt lgkmcnt(4)
    v_mfma_f32_16x16x32_bf16 v[56:59], v[40:43], v[32:35], v[56:59]
    v_mfma_f32_16x16x32_bf16 v[60:63], v[40:43], v[36:39], v[60:63]
    v_mfma_f32_16x16x32_bf16 v[64:67], v[44:47], v[32:35], v[64:67]
    v_mfma_f32_16x16x32_bf16 v[68:71], v[44:47], v[36:39], v[68:71]
    ds_read_b128 v[32:35], v12 offset:24576
    ds_read_b128 v[36:39], v12 offset:25600
    ds_read_b128 v[40:43], v14 offset:24576
    ds_read_b128 v[44:47], v14 offset:25600
    s_waitcnt lgkmcnt(4)
    v_mfma_f32_16x16x32_bf16 v[56:59], v[24:27], v[16:19], v[56:59]
    v_mfma_f32_16x16x32_bf16 v[60:63], v[24:27], v[20:23], v[60:63]
    v_mfma_f32_16x16x32_bf16 v[64:67], v[28:31], v[16:19], v[64:67]
    v_mfma_f32_16x16x32_bf16 v[68:71], v[28:31], v[20:23], v[68:71]
    s_waitcnt lgkmcnt(0)
    v_mfma_f32_16x16x32_bf16 v[56:59], v[40:43], v[32:35], v[56:59]
    v_mfma_f32_16x16x32_bf16 v[60:63], v[40:43], v[36:39], v[60:63]
    v_mfma_f32_16x16x32_bf16 v[64:67], v[44:47], v[32:35], v[64:67]
    v_mfma_f32_16x16x32_bf16 v[68:71], v[44:47], v[36:39], v[68:71]
    s_waitcnt vmcnt(16)
    s_barrier
    s_add_u32 m0, s42, 0x10000
    v_add_u32 v10, 0x6000, v3
    global_load_lds_dwordx4 v10, s[8:9]
    s_add_u32 m0, s42, 0x10400
    v_add_u32 v10, 0x14000, v3
    global_load_lds_dwordx4 v10, s[8:9]
    s_add_u32 m0, s42, 0x10800
    v_add_u32 v10, 0x22000, v3
    global_load_lds_dwordx4 v10, s[8:9]
    s_add_u32 m0, s42, 0x10c00
    v_add_u32 v10, 0x30000, v3
    global_load_lds_dwordx4 v10, s[8:9]
    s_add_u32 m0, s42, 0x11000
    v_add_u32 v10, 0x6000, v3
    global_load_lds_dwordx4 v10, s[12:13]
    s_add_u32 m0, s42, 0x11400
    v_add_u32 v10, 0x14000, v3
    global_load_lds_dwordx4 v10, s[12:13]
    s_add_u32 m0, s42, 0x11800
    v_add_u32 v10, 0x22000, v3
    global_load_lds_dwordx4 v10, s[12:13]
    s_add_u32 m0, s42, 0x11c00
    v_add_u32 v10, 0x30000, v3
    global_load_lds_dwordx4 v10, s[12:13]
    ds_read_b128 v[16:19], v12 offset:32768
    ds_read_b128 v[20:23], v12 offset:33792
    ds_read_b128 v[24:27], v14 offset:32768
    ds_read_b128 v[28:31], v14 offset:33792
    ds_read_b128 v[32:35], v12 offset:40960
    ds_read_b128 v[36:39], v12 offset:41984
    ds_read_b128 v[40:43], v14 offset:40960
    ds_read_b128 v[44:47], v14 offset:41984
    s_waitcnt lgkmcnt(4)
    v_mfma_f32_16x16x32_bf16 v[56:59], v[24:27], v[16:19], v[56:59]
    v_mfma_f32_16x16x32_bf16 v[60:63], v[24:27], v[20:23], v[60:63]
    v_mfma_f32_16x16x32_bf16 v[64:67], v[28:31], v[16:19], v[64:67]
    v_mfma_f32_16x16x32_bf16 v[68:71], v[28:31], v[20:23], v[68:71]
    ds_read_b128 v[16:19], v12 offset:49152
    ds_read_b128 v[20:23], v12 offset:50176
    ds_read_b128 v[24:27], v14 offset:49152
    ds_read_b128 v[28:31], v14 offset:50176
    s_waitcnt lgkmcnt(4)
    v_mfma_f32_16x16x32_bf16 v[56:59], v[40:43], v[32:35], v[56:59]
    v_mfma_f32_16x16x32_bf16 v[60:63], v[40:43], v[36:39], v[60:63]
    v_mfma_f32_16x16x32_bf16 v[64:67], v[44:47], v[32:35], v[64:67]
    v_mfma_f32_16x16x32_bf16 v[68:71], v[44:47], v[36:39], v[68:71]
    ds_read_b128 v[32:35], v12 offset:57344
    ds_read_b128 v[36:39], v12 offset:58368
    ds_read_b128 v[40:43], v14 offset:57344
    ds_read_b128 v[44:47], v14 offset:58368
    s_waitcnt lgkmcnt(4)
    v_mfma_f32_16x16x32_bf16 v[56:59], v[24:27], v[16:19], v[56:59]
    v_mfma_f32_16x16x32_bf16 v[60:63], v[24:27], v[20:23], v[60:63]
    v_mfma_f32_16x16x32_bf16 v[64:67], v[28:31], v[16:19], v[64:67]
    v_mfma_f32_16x16x32_bf16 v[68:71], v[28:31], v[20:23], v[68:71]
    s_waitcnt lgkmcnt(0)
    v_mfma_f32_16x16x32_bf16 v[56:59], v[40:43], v[32:35], v[56:59]
    v_mfma_f32_16x16x32_bf16 v[60:63], v[40:43], v[36:39], v[60:63]
    v_mfma_f32_16x16x32_bf16 v[64:67], v[44:47], v[32:35], v[64:67]
    v_mfma_f32_16x16x32_bf16 v[68:71], v[44:47], v[36:39], v[68:71]
    s_waitcnt vmcnt(16)
    s_barrier
    s_add_u32 m0, s42, 0x18000
    v_add_u32 v10, 0x7000, v3
    global_load_lds_dwordx4 v10, s[8:9]
    s_add_u32 m0, s42, 0x18400
    v_add_u32 v10, 0x15000, v3
    global_load_lds_dwordx4 v10, s[8:9]
    s_add_u32 m0, s42, 0x18800
    v_add_u32 v10, 0x23000, v3
    global_load_lds_dwordx4 v10, s[8:9]
    s_add_u32 m0, s42, 0x18c00
    v_add_u32 v10, 0x31000, v3
    global_load_lds_dwordx4 v10, s[8:9]
    s_add_u32 m0, s42, 0x19000
    v_add_u32 v10, 0x7000, v3
    global_load_lds_dwordx4 v10, s[12:13]
    s_add_u32 m0, s42, 0x19400
    v_add_u32 v10, 0x15000, v3
    global_load_lds_dwordx4 v10, s[12:13]
    s_add_u32 m0, s42, 0x19800
    v_add_u32 v10, 0x23000, v3
    global_load_lds_dwordx4 v10, s[12:13]
    s_add_u32 m0, s42, 0x19c00
    v_add_u32 v10, 0x31000, v3
    global_load_lds_dwordx4 v10, s[12:13]
    ds_read_b128 v[16:19], v11 offset:0
    ds_read_b128 v[20:23], v11 offset:1024
    ds_read_b128 v[24:27], v13 offset:0
    ds_read_b128 v[28:31], v13 offset:1024
    ds_read_b128 v[32:35], v11 offset:8192
    ds_read_b128 v[36:39], v11 offset:9216
    ds_read_b128 v[40:43], v13 offset:8192
    ds_read_b128 v[44:47], v13 offset:9216
    s_waitcnt lgkmcnt(4)
    v_mfma_f32_16x16x32_bf16 v[56:59], v[24:27], v[16:19], v[56:59]
    v_mfma_f32_16x16x32_bf16 v[60:63], v[24:27], v[20:23], v[60:63]
    v_mfma_f32_16x16x32_bf16 v[64:67], v[28:31], v[16:19], v[64:67]
    v_mfma_f32_16x16x32_bf16 v[68:71], v[28:31], v[20:23], v[68:71]
    ds_read_b128 v[16:19], v11 offset:16384
    ds_read_b128 v[20:23], v11 offset:17408
    ds_read_b128 v[24:27], v13 offset:16384
    ds_read_b128 v[28:31], v13 offset:17408
    s_waitcnt lgkmcnt(4)
    v_mfma_f32_16x16x32_bf16 v[56:59], v[40:43], v[32:35], v[56:59]
    v_mfma_f32_16x16x32_bf16 v[60:63], v[40:43], v[36:39], v[60:63]
    v_mfma_f32_16x16x32_bf16 v[64:67], v[44:47], v[32:35], v[64:67]
    v_mfma_f32_16x16x32_bf16 v[68:71], v[44:47], v[36:39], v[68:71]
    ds_read_b128 v[32:35], v11 offset:24576
    ds_read_b128 v[36:39], v11 offset:25600
    ds_read_b128 v[40:43], v13 offset:24576
    ds_read_b128 v[44:47], v13 offset:25600
    s_waitcnt lgkmcnt(4)
    v_mfma_f32_16x16x32_bf16 v[56:59], v[24:27], v[16:19], v[56:59]
    v_mfma_f32_16x16x32_bf16 v[60:63], v[24:27], v[20:23], v[60:63]
    v_mfma_f32_16x16x32_bf16 v[64:67], v[28:31], v[16:19], v[64:67]
    v_mfma_f32_16x16x32_bf16 v[68:71], v[28:31], v[20:23], v[68:71]
    s_waitcnt lgkmcnt(0)
    v_mfma_f32_16x16x32_bf16 v[56:59], v[40:43], v[32:35], v[56:59]
    v_mfma_f32_16x16x32_bf16 v[60:63], v[40:43], v[36:39], v[60:63]
    v_mfma_f32_16x16x32_bf16 v[64:67], v[44:47], v[32:35], v[64:67]
    v_mfma_f32_16x16x32_bf16 v[68:71], v[44:47], v[36:39], v[68:71]
    s_waitcnt vmcnt(16)
    s_barrier
    s_add_u32 m0, s42, 0x0
    v_add_u32 v10, 0x8000, v3
    global_load_lds_dwordx4 v10, s[8:9]
    s_add_u32 m0, s42, 0x400
    v_add_u32 v10, 0x16000, v3
    global_load_lds_dwordx4 v10, s[8:9]
    s_add_u32 m0, s42, 0x800
    v_add_u32 v10, 0x24000, v3
    global_load_lds_dwordx4 v10, s[8:9]
    s_add_u32 m0, s42, 0xc00
    v_add_u32 v10, 0x32000, v3
    global_load_lds_dwordx4 v10, s[8:9]
    s_add_u32 m0, s42, 0x1000
    v_add_u32 v10, 0x8000, v3
    global_load_lds_dwordx4 v10, s[12:13]
    s_add_u32 m0, s42, 0x1400
    v_add_u32 v10, 0x16000, v3
    global_load_lds_dwordx4 v10, s[12:13]
    s_add_u32 m0, s42, 0x1800
    v_add_u32 v10, 0x24000, v3
    global_load_lds_dwordx4 v10, s[12:13]
    s_add_u32 m0, s42, 0x1c00
    v_add_u32 v10, 0x32000, v3
    global_load_lds_dwordx4 v10, s[12:13]
    ds_read_b128 v[16:19], v11 offset:32768
    ds_read_b128 v[20:23], v11 offset:33792
    ds_read_b128 v[24:27], v13 offset:32768
    ds_read_b128 v[28:31], v13 offset:33792
    ds_read_b128 v[32:35], v11 offset:40960
    ds_read_b128 v[36:39], v11 offset:41984
    ds_read_b128 v[40:43], v13 offset:40960
    ds_read_b128 v[44:47], v13 offset:41984
    s_waitcnt lgkmcnt(4)
    v_mfma_f32_16x16x32_bf16 v[56:59], v[24:27], v[16:19], v[56:59]
    v_mfma_f32_16x16x32_bf16 v[60:63], v[24:27], v[20:23], v[60:63]
    v_mfma_f32_16x16x32_bf16 v[64:67], v[28:31], v[16:19], v[64:67]
    v_mfma_f32_16x16x32_bf16 v[68:71], v[28:31], v[20:23], v[68:71]
    ds_read_b128 v[16:19], v11 offset:49152
    ds_read_b128 v[20:23], v11 offset:50176
    ds_read_b128 v[24:27], v13 offset:49152
    ds_read_b128 v[28:31], v13 offset:50176
    s_waitcnt lgkmcnt(4)
    v_mfma_f32_16x16x32_bf16 v[56:59], v[40:43], v[32:35], v[56:59]
    v_mfma_f32_16x16x32_bf16 v[60:63], v[40:43], v[36:39], v[60:63]
    v_mfma_f32_16x16x32_bf16 v[64:67], v[44:47], v[32:35], v[64:67]
    v_mfma_f32_16x16x32_bf16 v[68:71], v[44:47], v[36:39], v[68:71]
    ds_read_b128 v[32:35], v11 offset:57344
    ds_read_b128 v[36:39], v11 offset:58368
    ds_read_b128 v[40:43], v13 offset:57344
    ds_read_b128 v[44:47], v13 offset:58368
    s_waitcnt lgkmcnt(4)
    v_mfma_f32_16x16x32_bf16 v[56:59], v[24:27], v[16:19], v[56:59]
    v_mfma_f32_16x16x32_bf16 v[60:63], v[24:27], v[20:23], v[60:63]
    v_mfma_f32_16x16x32_bf16 v[64:67], v[28:31], v[16:19], v[64:67]
    v_mfma_f32_16x16x32_bf16 v[68:71], v[28:31], v[20:23], v[68:71]
    s_waitcnt lgkmcnt(0)
    v_mfma_f32_16x16x32_bf16 v[56:59], v[40:43], v[32:35], v[56:59]
    v_mfma_f32_16x16x32_bf16 v[60:63], v[40:43], v[36:39], v[60:63]
    v_mfma_f32_16x16x32_bf16 v[64:67], v[44:47], v[32:35], v[64:67]
    v_mfma_f32_16x16x32_bf16 v[68:71], v[44:47], v[36:39], v[68:71]
    s_waitcnt vmcnt(16)
    s_barrier
    s_add_u32 m0, s42, 0x8000
    v_add_u32 v10, 0x9000, v3
    global_load_lds_dwordx4 v10, s[8:9]
    s_add_u32 m0, s42, 0x8400
    v_add_u32 v10, 0x17000, v3
    global_load_lds_dwordx4 v10, s[8:9]
    s_add_u32 m0, s42, 0x8800
    v_add_u32 v10, 0x25000, v3
    global_load_lds_dwordx4 v10, s[8:9]
    s_add_u32 m0, s42, 0x8c00
    v_add_u32 v10, 0x33000, v3
    global_load_lds_dwordx4 v10, s[8:9]
    s_add_u32 m0, s42, 0x9000
    v_add_u32 v10, 0x9000, v3
    global_load_lds_dwordx4 v10, s[12:13]
    s_add_u32 m0, s42, 0x9400
    v_add_u32 v10, 0x17000, v3
    global_load_lds_dwordx4 v10, s[12:13]
    s_add_u32 m0, s42, 0x9800
    v_add_u32 v10, 0x25000, v3
    global_load_lds_dwordx4 v10, s[12:13]
    s_add_u32 m0, s42, 0x9c00
    v_add_u32 v10, 0x33000, v3
    global_load_lds_dwordx4 v10, s[12:13]
    ds_read_b128 v[16:19], v12 offset:0
    ds_read_b128 v[20:23], v12 offset:1024
    ds_read_b128 v[24:27], v14 offset:0
    ds_read_b128 v[28:31], v14 offset:1024
    ds_read_b128 v[32:35], v12 offset:8192
    ds_read_b128 v[36:39], v12 offset:9216
    ds_read_b128 v[40:43], v14 offset:8192
    ds_read_b128 v[44:47], v14 offset:9216
    s_waitcnt lgkmcnt(4)
    v_mfma_f32_16x16x32_bf16 v[56:59], v[24:27], v[16:19], v[56:59]
    v_mfma_f32_16x16x32_bf16 v[60:63], v[24:27], v[20:23], v[60:63]
    v_mfma_f32_16x16x32_bf16 v[64:67], v[28:31], v[16:19], v[64:67]
    v_mfma_f32_16x16x32_bf16 v[68:71], v[28:31], v[20:23], v[68:71]
    ds_read_b128 v[16:19], v12 offset:16384
    ds_read_b128 v[20:23], v12 offset:17408
    ds_read_b128 v[24:27], v14 offset:16384
    ds_read_b128 v[28:31], v14 offset:17408
    s_waitcnt lgkmcnt(4)
    v_mfma_f32_16x16x32_bf16 v[56:59], v[40:43], v[32:35], v[56:59]
    v_mfma_f32_16x16x32_bf16 v[60:63], v[40:43], v[36:39], v[60:63]
    v_mfma_f32_16x16x32_bf16 v[64:67], v[44:47], v[32:35], v[64:67]
    v_mfma_f32_16x16x32_bf16 v[68:71], v[44:47], v[36:39], v[68:71]
    ds_read_b128 v[32:35], v12 offset:24576
    ds_read_b128 v[36:39], v12 offset:25600
    ds_read_b128 v[40:43], v14 offset:24576
    ds_read_b128 v[44:47], v14 offset:25600
    s_waitcnt lgkmcnt(4)
    v_mfma_f32_16x16x32_bf16 v[56:59], v[24:27], v[16:19], v[56:59]
    v_mfma_f32_16x16x32_bf16 v[60:63], v[24:27], v[20:23], v[60:63]
    v_mfma_f32_16x16x32_bf16 v[64:67], v[28:31], v[16:19], v[64:67]
    v_mfma_f32_16x16x32_bf16 v[68:71], v[28:31], v[20:23], v[68:71]
    s_waitcnt lgkmcnt(0)
    v_mfma_f32_16x16x32_bf16 v[56:59], v[40:43], v[32:35], v[56:59]
    v_mfma_f32_16x16x32_bf16 v[60:63], v[40:43], v[36:39], v[60:63]
    v_mfma_f32_16x16x32_bf16 v[64:67], v[44:47], v[32:35], v[64:67]
    v_mfma_f32_16x16x32_bf16 v[68:71], v[44:47], v[36:39], v[68:71]
    s_waitcnt vmcnt(16)
    s_barrier
    s_add_u32 m0, s42, 0x10000
    v_add_u32 v10, 0xa000, v3
    global_load_lds_dwordx4 v10, s[8:9]
    s_add_u32 m0, s42, 0x10400
    v_add_u32 v10, 0x18000, v3
    global_load_lds_dwordx4 v10, s[8:9]
    s_add_u32 m0, s42, 0x10800
    v_add_u32 v10, 0x26000, v3
    global_load_lds_dwordx4 v10, s[8:9]
    s_add_u32 m0, s42, 0x10c00
    v_add_u32 v10, 0x34000, v3
    global_load_lds_dwordx4 v10, s[8:9]
    s_add_u32 m0, s42, 0x11000
    v_add_u32 v10, 0xa000, v3
    global_load_lds_dwordx4 v10, s[12:13]
    s_add_u32 m0, s42, 0x11400
    v_add_u32 v10, 0x18000, v3
    global_load_lds_dwordx4 v10, s[12:13]
    s_add_u32 m0, s42, 0x11800
    v_add_u32 v10, 0x26000, v3
    global_load_lds_dwordx4 v10, s[12:13]
    s_add_u32 m0, s42, 0x11c00
    v_add_u32 v10, 0x34000, v3
    global_load_lds_dwordx4 v10, s[12:13]
    ds_read_b128 v[16:19], v12 offset:32768
    ds_read_b128 v[20:23], v12 offset:33792
    ds_read_b128 v[24:27], v14 offset:32768
    ds_read_b128 v[28:31], v14 offset:33792
    ds_read_b128 v[32:35], v12 offset:40960
    ds_read_b128 v[36:39], v12 offset:41984
    ds_read_b128 v[40:43], v14 offset:40960
    ds_read_b128 v[44:47], v14 offset:41984
    s_waitcnt lgkmcnt(4)
    v_mfma_f32_16x16x32_bf16 v[56:59], v[24:27], v[16:19], v[56:59]
    v_mfma_f32_16x16x32_bf16 v[60:63], v[24:27], v[20:23], v[60:63]
    v_mfma_f32_16x16x32_bf16 v[64:67], v[28:31], v[16:19], v[64:67]
    v_mfma_f32_16x16x32_bf16 v[68:71], v[28:31], v[20:23], v[68:71]
    ds_read_b128 v[16:19], v12 offset:49152
    ds_read_b128 v[20:23], v12 offset:50176
    ds_read_b128 v[24:27], v14 offset:49152
    ds_read_b128 v[28:31], v14 offset:50176
    s_waitcnt lgkmcnt(4)
    v_mfma_f32_16x16x32_bf16 v[56:59], v[40:43], v[32:35], v[56:59]
    v_mfma_f32_16x16x32_bf16 v[60:63], v[40:43], v[36:39], v[60:63]
    v_mfma_f32_16x16x32_bf16 v[64:67], v[44:47], v[32:35], v[64:67]
    v_mfma_f32_16x16x32_bf16 v[68:71], v[44:47], v[36:39], v[68:71]
    ds_read_b128 v[32:35], v12 offset:57344
    ds_read_b128 v[36:39], v12 offset:58368
    ds_read_b128 v[40:43], v14 offset:57344
    ds_read_b128 v[44:47], v14 offset:58368
    s_waitcnt lgkmcnt(4)
    v_mfma_f32_16x16x32_bf16 v[56:59], v[24:27], v[16:19], v[56:59]
    v_mfma_f32_16x16x32_bf16 v[60:63], v[24:27], v[20:23], v[60:63]
    v_mfma_f32_16x16x32_bf16 v[64:67], v[28:31], v[16:19], v[64:67]
    v_mfma_f32_16x16x32_bf16 v[68:71], v[28:31], v[20:23], v[68:71]
    s_waitcnt lgkmcnt(0)
    v_mfma_f32_16x16x32_bf16 v[56:59], v[40:43], v[32:35], v[56:59]
    v_mfma_f32_16x16x32_bf16 v[60:63], v[40:43], v[36:39], v[60:63]
    v_mfma_f32_16x16x32_bf16 v[64:67], v[44:47], v[32:35], v[64:67]
    v_mfma_f32_16x16x32_bf16 v[68:71], v[44:47], v[36:39], v[68:71]
    s_waitcnt vmcnt(16)
    s_barrier
    s_add_u32 m0, s42, 0x18000
    v_add_u32 v10, 0xb000, v3
    global_load_lds_dwordx4 v10, s[8:9]
    s_add_u32 m0, s42, 0x18400
    v_add_u32 v10, 0x19000, v3
    global_load_lds_dwordx4 v10, s[8:9]
    s_add_u32 m0, s42, 0x18800
    v_add_u32 v10, 0x27000, v3
    global_load_lds_dwordx4 v10, s[8:9]
    s_add_u32 m0, s42, 0x18c00
    v_add_u32 v10, 0x35000, v3
    global_load_lds_dwordx4 v10, s[8:9]
    s_add_u32 m0, s42, 0x19000
    v_add_u32 v10, 0xb000, v3
    global_load_lds_dwordx4 v10, s[12:13]
    s_add_u32 m0, s42, 0x19400
    v_add_u32 v10, 0x19000, v3
    global_load_lds_dwordx4 v10, s[12:13]
    s_add_u32 m0, s42, 0x19800
    v_add_u32 v10, 0x27000, v3
    global_load_lds_dwordx4 v10, s[12:13]
    s_add_u32 m0, s42, 0x19c00
    v_add_u32 v10, 0x35000, v3
    global_load_lds_dwordx4 v10, s[12:13]
    ds_read_b128 v[16:19], v11 offset:0
    ds_read_b128 v[20:23], v11 offset:1024
    ds_read_b128 v[24:27], v13 offset:0
    ds_read_b128 v[28:31], v13 offset:1024
    ds_read_b128 v[32:35], v11 offset:8192
    ds_read_b128 v[36:39], v11 offset:9216
    ds_read_b128 v[40:43], v13 offset:8192
    ds_read_b128 v[44:47], v13 offset:9216
    s_waitcnt lgkmcnt(4)
    v_mfma_f32_16x16x32_bf16 v[56:59], v[24:27], v[16:19], v[56:59]
    v_mfma_f32_16x16x32_bf16 v[60:63], v[24:27], v[20:23], v[60:63]
    v_mfma_f32_16x16x32_bf16 v[64:67], v[28:31], v[16:19], v[64:67]
    v_mfma_f32_16x16x32_bf16 v[68:71], v[28:31], v[20:23], v[68:71]
    ds_read_b128 v[16:19], v11 offset:16384
    ds_read_b128 v[20:23], v11 offset:17408
    ds_read_b128 v[24:27], v13 offset:16384
    ds_read_b128 v[28:31], v13 offset:17408
    s_waitcnt lgkmcnt(4)
    v_mfma_f32_16x16x32_bf16 v[56:59], v[40:43], v[32:35], v[56:59]
    v_mfma_f32_16x16x32_bf16 v[60:63], v[40:43], v[36:39], v[60:63]
    v_mfma_f32_16x16x32_bf16 v[64:67], v[44:47], v[32:35], v[64:67]
    v_mfma_f32_16x16x32_bf16 v[68:71], v[44:47], v[36:39], v[68:71]
    ds_read_b128 v[32:35], v11 offset:24576
    ds_read_b128 v[36:39], v11 offset:25600
    ds_read_b128 v[40:43], v13 offset:24576
    ds_read_b128 v[44:47], v13 offset:25600
    s_waitcnt lgkmcnt(4)
    v_mfma_f32_16x16x32_bf16 v[56:59], v[24:27], v[16:19], v[56:59]
    v_mfma_f32_16x16x32_bf16 v[60:63], v[24:27], v[20:23], v[60:63]
    v_mfma_f32_16x16x32_bf16 v[64:67], v[28:31], v[16:19], v[64:67]
    v_mfma_f32_16x16x32_bf16 v[68:71], v[28:31], v[20:23], v[68:71]
    s_waitcnt lgkmcnt(0)
    v_mfma_f32_16x16x32_bf16 v[56:59], v[40:43], v[32:35], v[56:59]
    v_mfma_f32_16x16x32_bf16 v[60:63], v[40:43], v[36:39], v[60:63]
    v_mfma_f32_16x16x32_bf16 v[64:67], v[44:47], v[32:35], v[64:67]
    v_mfma_f32_16x16x32_bf16 v[68:71], v[44:47], v[36:39], v[68:71]
    s_waitcnt vmcnt(16)
    s_barrier
    s_add_u32 m0, s42, 0x0
    v_add_u32 v10, 0xc000, v3
    global_load_lds_dwordx4 v10, s[8:9]
    s_add_u32 m0, s42, 0x400
    v_add_u32 v10, 0x1a000, v3
    global_load_lds_dwordx4 v10, s[8:9]
    s_add_u32 m0, s42, 0x800
    v_add_u32 v10, 0x28000, v3
    global_load_lds_dwordx4 v10, s[8:9]
    s_add_u32 m0, s42, 0xc00
    v_add_u32 v10, 0x36000, v3
    global_load_lds_dwordx4 v10, s[8:9]
    s_add_u32 m0, s42, 0x1000
    v_add_u32 v10, 0xc000, v3
    global_load_lds_dwordx4 v10, s[12:13]
    s_add_u32 m0, s42, 0x1400
    v_add_u32 v10, 0x1a000, v3
    global_load_lds_dwordx4 v10, s[12:13]
    s_add_u32 m0, s42, 0x1800
    v_add_u32 v10, 0x28000, v3
    global_load_lds_dwordx4 v10, s[12:13]
    s_add_u32 m0, s42, 0x1c00
    v_add_u32 v10, 0x36000, v3
    global_load_lds_dwordx4 v10, s[12:13]
    ds_read_b128 v[16:19], v11 offset:32768
    ds_read_b128 v[20:23], v11 offset:33792
    ds_read_b128 v[24:27], v13 offset:32768
    ds_read_b128 v[28:31], v13 offset:33792
    ds_read_b128 v[32:35], v11 offset:40960
    ds_read_b128 v[36:39], v11 offset:41984
    ds_read_b128 v[40:43], v13 offset:40960
    ds_read_b128 v[44:47], v13 offset:41984
    s_waitcnt lgkmcnt(4)
    v_mfma_f32_16x16x32_bf16 v[56:59], v[24:27], v[16:19], v[56:59]
    v_mfma_f32_16x16x32_bf16 v[60:63], v[24:27], v[20:23], v[60:63]
    v_mfma_f32_16x16x32_bf16 v[64:67], v[28:31], v[16:19], v[64:67]
    v_mfma_f32_16x16x32_bf16 v[68:71], v[28:31], v[20:23], v[68:71]
    ds_read_b128 v[16:19], v11 offset:49152
    ds_read_b128 v[20:23], v11 offset:50176
    ds_read_b128 v[24:27], v13 offset:49152
    ds_read_b128 v[28:31], v13 offset:50176
    s_waitcnt lgkmcnt(4)
    v_mfma_f32_16x16x32_bf16 v[56:59], v[40:43], v[32:35], v[56:59]
    v_mfma_f32_16x16x32_bf16 v[60:63], v[40:43], v[36:39], v[60:63]
    v_mfma_f32_16x16x32_bf16 v[64:67], v[44:47], v[32:35], v[64:67]
    v_mfma_f32_16x16x32_bf16 v[68:71], v[44:47], v[36:39], v[68:71]
    ds_read_b128 v[32:35], v11 offset:57344
    ds_read_b128 v[36:39], v11 offset:58368
    ds_read_b128 v[40:43], v13 offset:57344
    ds_read_b128 v[44:47], v13 offset:58368
    s_waitcnt lgkmcnt(4)
    v_mfma_f32_16x16x32_bf16 v[56:59], v[24:27], v[16:19], v[56:59]
    v_mfma_f32_16x16x32_bf16 v[60:63], v[24:27], v[20:23], v[60:63]
    v_mfma_f32_16x16x32_bf16 v[64:67], v[28:31], v[16:19], v[64:67]
    v_mfma_f32_16x16x32_bf16 v[68:71], v[28:31], v[20:23], v[68:71]
    s_waitcnt lgkmcnt(0)
    v_mfma_f32_16x16x32_bf16 v[56:59], v[40:43], v[32:35], v[56:59]
    v_mfma_f32_16x16x32_bf16 v[60:63], v[40:43], v[36:39], v[60:63]
    v_mfma_f32_16x16x32_bf16 v[64:67], v[44:47], v[32:35], v[64:67]
    v_mfma_f32_16x16x32_bf16 v[68:71], v[44:47], v[36:39], v[68:71]
    s_waitcnt vmcnt(16)
    s_barrier
    s_add_u32 m0, s42, 0x8000
    v_add_u32 v10, 0xd000, v3
    global_load_lds_dwordx4 v10, s[8:9]
    s_add_u32 m0, s42, 0x8400
    v_add_u32 v10, 0x1b000, v3
    global_load_lds_dwordx4 v10, s[8:9]
    s_add_u32 m0, s42, 0x8800
    v_add_u32 v10, 0x29000, v3
    global_load_lds_dwordx4 v10, s[8:9]
    s_add_u32 m0, s42, 0x8c00
    v_add_u32 v10, 0x37000, v3
    global_load_lds_dwordx4 v10, s[8:9]
    s_add_u32 m0, s42, 0x9000
    v_add_u32 v10, 0xd000, v3
    global_load_lds_dwordx4 v10, s[12:13]
    s_add_u32 m0, s42, 0x9400
    v_add_u32 v10, 0x1b000, v3
    global_load_lds_dwordx4 v10, s[12:13]
    s_add_u32 m0, s42, 0x9800
    v_add_u32 v10, 0x29000, v3
    global_load_lds_dwordx4 v10, s[12:13]
    s_add_u32 m0, s42, 0x9c00
    v_add_u32 v10, 0x37000, v3
    global_load_lds_dwordx4 v10, s[12:13]
    ds_read_b128 v[16:19], v12 offset:0
    ds_read_b128 v[20:23], v12 offset:1024
    ds_read_b128 v[24:27], v14 offset:0
    ds_read_b128 v[28:31], v14 offset:1024
    ds_read_b128 v[32:35], v12 offset:8192
    ds_read_b128 v[36:39], v12 offset:9216
    ds_read_b128 v[40:43], v14 offset:8192
    ds_read_b128 v[44:47], v14 offset:9216
    s_waitcnt lgkmcnt(4)
    v_mfma_f32_16x16x32_bf16 v[56:59], v[24:27], v[16:19], v[56:59]
    v_mfma_f32_16x16x32_bf16 v[60:63], v[24:27], v[20:23], v[60:63]
    v_mfma_f32_16x16x32_bf16 v[64:67], v[28:31], v[16:19], v[64:67]
    v_mfma_f32_16x16x32_bf16 v[68:71], v[28:31], v[20:23], v[68:71]
    ds_read_b128 v[16:19], v12 offset:16384
    ds_read_b128 v[20:23], v12 offset:17408
    ds_read_b128 v[24:27], v14 offset:16384
    ds_read_b128 v[28:31], v14 offset:17408
    s_waitcnt lgkmcnt(4)
    v_mfma_f32_16x16x32_bf16 v[56:59], v[40:43], v[32:35], v[56:59]
    v_mfma_f32_16x16x32_bf16 v[60:63], v[40:43], v[36:39], v[60:63]
    v_mfma_f32_16x16x32_bf16 v[64:67], v[44:47], v[32:35], v[64:67]
    v_mfma_f32_16x16x32_bf16 v[68:71], v[44:47], v[36:39], v[68:71]
    ds_read_b128 v[32:35], v12 offset:24576
    ds_read_b128 v[36:39], v12 offset:25600
    ds_read_b128 v[40:43], v14 offset:24576
    ds_read_b128 v[44:47], v14 offset:25600
    s_waitcnt lgkmcnt(4)
    v_mfma_f32_16x16x32_bf16 v[56:59], v[24:27], v[16:19], v[56:59]
    v_mfma_f32_16x16x32_bf16 v[60:63], v[24:27], v[20:23], v[60:63]
    v_mfma_f32_16x16x32_bf16 v[64:67], v[28:31], v[16:19], v[64:67]
    v_mfma_f32_16x16x32_bf16 v[68:71], v[28:31], v[20:23], v[68:71]
    s_waitcnt lgkmcnt(0)
    v_mfma_f32_16x16x32_bf16 v[56:59], v[40:43], v[32:35], v[56:59]
    v_mfma_f32_16x16x32_bf16 v[60:63], v[40:43], v[36:39], v[60:63]
    v_mfma_f32_16x16x32_bf16 v[64:67], v[44:47], v[32:35], v[64:67]
    v_mfma_f32_16x16x32_bf16 v[68:71], v[44:47], v[36:39], v[68:71]
    s_waitcnt vmcnt(16)
    s_barrier
    ds_read_b128 v[16:19], v12 offset:32768
    ds_read_b128 v[20:23], v12 offset:33792
    ds_read_b128 v[24:27], v14 offset:32768
    ds_read_b128 v[28:31], v14 offset:33792
    ds_read_b128 v[32:35], v12 offset:40960
    ds_read_b128 v[36:39], v12 offset:41984
    ds_read_b128 v[40:43], v14 offset:40960
    ds_read_b128 v[44:47], v14 offset:41984
    s_waitcnt lgkmcnt(4)
    v_mfma_f32_16x16x32_bf16 v[56:59], v[24:27], v[16:19], v[56:59]
    v_mfma_f32_16x16x32_bf16 v[60:63], v[24:27], v[20:23], v[60:63]
    v_mfma_f32_16x16x32_bf16 v[64:67], v[28:31], v[16:19], v[64:67]
    v_mfma_f32_16x16x32_bf16 v[68:71], v[28:31], v[20:23], v[68:71]
    ds_read_b128 v[16:19], v12 offset:49152
    ds_read_b128 v[20:23], v12 offset:50176
    ds_read_b128 v[24:27], v14 offset:49152
    ds_read_b128 v[28:31], v14 offset:50176
    s_waitcnt lgkmcnt(4)
    v_mfma_f32_16x16x32_bf16 v[56:59], v[40:43], v[32:35], v[56:59]
    v_mfma_f32_16x16x32_bf16 v[60:63], v[40:43], v[36:39], v[60:63]
    v_mfma_f32_16x16x32_bf16 v[64:67], v[44:47], v[32:35], v[64:67]
    v_mfma_f32_16x16x32_bf16 v[68:71], v[44:47], v[36:39], v[68:71]
    ds_read_b128 v[32:35], v12 offset:57344
    ds_read_b128 v[36:39], v12 offset:58368
    ds_read_b128 v[40:43], v14 offset:57344
    ds_read_b128 v[44:47], v14 offset:58368
    s_waitcnt lgkmcnt(4)
    v_mfma_f32_16x16x32_bf16 v[56:59], v[24:27], v[16:19], v[56:59]
    v_mfma_f32_16x16x32_bf16 v[60:63], v[24:27], v[20:23], v[60:63]
    v_mfma_f32_16x16x32_bf16 v[64:67], v[28:31], v[16:19], v[64:67]
    v_mfma_f32_16x16x32_bf16 v[68:71], v[28:31], v[20:23], v[68:71]
    s_waitcnt lgkmcnt(0)
    v_mfma_f32_16x16x32_bf16 v[56:59], v[40:43], v[32:35], v[56:59]
    v_mfma_f32_16x16x32_bf16 v[60:63], v[40:43], v[36:39], v[60:63]
    v_mfma_f32_16x16x32_bf16 v[64:67], v[44:47], v[32:35], v[64:67]
    v_mfma_f32_16x16x32_bf16 v[68:71], v[44:47], v[36:39], v[68:71]
    s_waitcnt vmcnt(8)
    s_barrier
    ds_read_b128 v[16:19], v11 offset:0
    ds_read_b128 v[20:23], v11 offset:1024
    ds_read_b128 v[24:27], v13 offset:0
    ds_read_b128 v[28:31], v13 offset:1024
    ds_read_b128 v[32:35], v11 offset:8192
    ds_read_b128 v[36:39], v11 offset:9216
    ds_read_b128 v[40:43], v13 offset:8192
    ds_read_b128 v[44:47], v13 offset:9216
    s_waitcnt lgkmcnt(4)
    v_mfma_f32_16x16x32_bf16 v[56:59], v[24:27], v[16:19], v[56:59]
    v_mfma_f32_16x16x32_bf16 v[60:63], v[24:27], v[20:23], v[60:63]
    v_mfma_f32_16x16x32_bf16 v[64:67], v[28:31], v[16:19], v[64:67]
    v_mfma_f32_16x16x32_bf16 v[68:71], v[28:31], v[20:23], v[68:71]
    ds_read_b128 v[16:19], v11 offset:16384
    ds_read_b128 v[20:23], v11 offset:17408
    ds_read_b128 v[24:27], v13 offset:16384
    ds_read_b128 v[28:31], v13 offset:17408
    s_waitcnt lgkmcnt(4)
    v_mfma_f32_16x16x32_bf16 v[56:59], v[40:43], v[32:35], v[56:59]
    v_mfma_f32_16x16x32_bf16 v[60:63], v[40:43], v[36:39], v[60:63]
    v_mfma_f32_16x16x32_bf16 v[64:67], v[44:47], v[32:35], v[64:67]
    v_mfma_f32_16x16x32_bf16 v[68:71], v[44:47], v[36:39], v[68:71]
    ds_read_b128 v[32:35], v11 offset:24576
    ds_read_b128 v[36:39], v11 offset:25600
    ds_read_b128 v[40:43], v13 offset:24576
    ds_read_b128 v[44:47], v13 offset:25600
    s_waitcnt lgkmcnt(4)
    v_mfma_f32_16x16x32_bf16 v[56:59], v[24:27], v[16:19], v[56:59]
    v_mfma_f32_16x16x32_bf16 v[60:63], v[24:27], v[20:23], v[60:63]
    v_mfma_f32_16x16x32_bf16 v[64:67], v[28:31], v[16:19], v[64:67]
    v_mfma_f32_16x16x32_bf16 v[68:71], v[28:31], v[20:23], v[68:71]
    s_waitcnt lgkmcnt(0)
    v_mfma_f32_16x16x32_bf16 v[56:59], v[40:43], v[32:35], v[56:59]
    v_mfma_f32_16x16x32_bf16 v[60:63], v[40:43], v[36:39], v[60:63]
    v_mfma_f32_16x16x32_bf16 v[64:67], v[44:47], v[32:35], v[64:67]
    v_mfma_f32_16x16x32_bf16 v[68:71], v[44:47], v[36:39], v[68:71]
    s_waitcnt vmcnt(0)
    s_barrier
    ds_read_b128 v[16:19], v11 offset:32768
    ds_read_b128 v[20:23], v11 offset:33792
    ds_read_b128 v[24:27], v13 offset:32768
    ds_read_b128 v[28:31], v13 offset:33792
    ds_read_b128 v[32:35], v11 offset:40960
    ds_read_b128 v[36:39], v11 offset:41984
    ds_read_b128 v[40:43], v13 offset:40960
    ds_read_b128 v[44:47], v13 offset:41984
    s_waitcnt lgkmcnt(4)
    v_mfma_f32_16x16x32_bf16 v[56:59], v[24:27], v[16:19], v[56:59]
    v_mfma_f32_16x16x32_bf16 v[60:63], v[24:27], v[20:23], v[60:63]
    v_mfma_f32_16x16x32_bf16 v[64:67], v[28:31], v[16:19], v[64:67]
    v_mfma_f32_16x16x32_bf16 v[68:71], v[28:31], v[20:23], v[68:71]
    ds_read_b128 v[16:19], v11 offset:49152
    ds_read_b128 v[20:23], v11 offset:50176
    ds_read_b128 v[24:27], v13 offset:49152
    ds_read_b128 v[28:31], v13 offset:50176
    s_waitcnt lgkmcnt(4)
    v_mfma_f32_16x16x32_bf16 v[56:59], v[40:43], v[32:35], v[56:59]
    v_mfma_f32_16x16x32_bf16 v[60:63], v[40:43], v[36:39], v[60:63]
    v_mfma_f32_16x16x32_bf16 v[64:67], v[44:47], v[32:35], v[64:67]
    v_mfma_f32_16x16x32_bf16 v[68:71], v[44:47], v[36:39], v[68:71]
    ds_read_b128 v[32:35], v11 offset:57344
    ds_read_b128 v[36:39], v11 offset:58368
    ds_read_b128 v[40:43], v13 offset:57344
    ds_read_b128 v[44:47], v13 offset:58368
    s_waitcnt lgkmcnt(4)
    v_mfma_f32_16x16x32_bf16 v[56:59], v[24:27], v[16:19], v[56:59]
    v_mfma_f32_16x16x32_bf16 v[60:63], v[24:27], v[20:23], v[60:63]
    v_mfma_f32_16x16x32_bf16 v[64:67], v[28:31], v[16:19], v[64:67]
    v_mfma_f32_16x16x32_bf16 v[68:71], v[28:31], v[20:23], v[68:71]
    s_waitcnt lgkmcnt(0)
    v_mfma_f32_16x16x32_bf16 v[56:59], v[40:43], v[32:35], v[56:59]
    v_mfma_f32_16x16x32_bf16 v[60:63], v[40:43], v[36:39], v[60:63]
    v_mfma_f32_16x16x32_bf16 v[64:67], v[44:47], v[32:35], v[64:67]
    v_mfma_f32_16x16x32_bf16 v[68:71], v[44:47], v[36:39], v[68:71]
    s_nop 7
    s_nop 1
    v_cvt_pk_bf16_f32 v16, v56, v57
    v_cvt_pk_bf16_f32 v17, v58, v59
    v_cvt_pk_bf16_f32 v18, v64, v65
    v_cvt_pk_bf16_f32 v19, v66, v67
    v_lshlrev_b32 v56, 16, v16
    v_and_b32 v57, 0xffff0000, v16
    v_lshlrev_b32 v58, 16, v17
    v_and_b32 v59, 0xffff0000, v17
    v_lshlrev_b32 v64, 16, v18
    v_and_b32 v65, 0xffff0000, v18
    v_lshlrev_b32 v66, 16, v19
    v_and_b32 v67, 0xffff0000, v19
    v_mul_f32 v56, v56, v80
    v_mul_f32 v57, v57, v81
    v_mul_f32 v58, v58, v82
    v_mul_f32 v59, v59, v83
    v_mul_f32 v64, v64, v84
    v_mul_f32 v65, v65, v85
    v_mul_f32 v66, v66, v86
    v_mul_f32 v67, v67, v87
    v_cvt_pk_bf16_f32 v16, v56, v57
    v_cvt_pk_bf16_f32 v17, v58, v59
    v_cvt_pk_bf16_f32 v18, v64, v65
    v_cvt_pk_bf16_f32 v19, v66, v67
    v_lshlrev_b32 v56, 16, v16
    v_and_b32 v57, 0xffff0000, v16
    v_lshlrev_b32 v58, 16, v17
    v_and_b32 v59, 0xffff0000, v17
    v_lshlrev_b32 v64, 16, v18
    v_and_b32 v65, 0xffff0000, v18
    v_lshlrev_b32 v66, 16, v19
    v_and_b32 v67, 0xffff0000, v19
    v_lshlrev_b32 v20, 16, v72
    v_and_b32 v21, 0xffff0000, v72
    v_lshlrev_b32 v22, 16, v73
    v_and_b32 v23, 0xffff0000, v73
    v_lshlrev_b32 v24, 16, v74
    v_and_b32 v25, 0xffff0000, v74
    v_lshlrev_b32 v26, 16, v75
    v_and_b32 v27, 0xffff0000, v75
    v_add_f32 v56, v56, v20
    v_add_f32 v57, v57, v21
    v_add_f32 v58, v58, v22
    v_add_f32 v59, v59, v23
    v_add_f32 v64, v64, v24
    v_add_f32 v65, v65, v25
    v_add_f32 v66, v66, v26
    v_add_f32 v67, v67, v27
    v_cvt_pk_bf16_f32 v28, v56, v57
    v_cvt_pk_bf16_f32 v29, v58, v59
    v_cvt_pk_bf16_f32 v30, v64, v65
    v_cvt_pk_bf16_f32 v31, v66, v67
    global_store_dwordx4 v7, v[28:31], s[32:33]
    v_cvt_pk_bf16_f32 v16, v60, v61
    v_cvt_pk_bf16_f32 v17, v62, v63
    v_cvt_pk_bf16_f32 v18, v68, v69
    v_cvt_pk_bf16_f32 v19, v70, v71
    v_lshlrev_b32 v60, 16, v16
    v_and_b32 v61, 0xffff0000, v16
    v_lshlrev_b32 v62, 16, v17
    v_and_b32 v63, 0xffff0000, v17
    v_lshlrev_b32 v68, 16, v18
    v_and_b32 v69, 0xffff0000, v18
    v_lshlrev_b32 v70, 16, v19
    v_and_b32 v71, 0xffff0000, v19
    v_mul_f32 v60, v60, v80
    v_mul_f32 v61, v61, v81
    v_mul_f32 v62, v62, v82
    v_mul_f32 v63, v63, v83
    v_mul_f32 v68, v68, v84
    v_mul_f32 v69, v69, v85
    v_mul_f32 v70, v70, v86
    v_mul_f32 v71, v71, v87
    v_cvt_pk_bf16_f32 v16, v60, v61
    v_cvt_pk_bf16_f32 v17, v62, v63
    v_cvt_pk_bf16_f32 v18, v68, v69
    v_cvt_pk_bf16_f32 v19, v70, v71
    v_lshlrev_b32 v60, 16, v16
    v_and_b32 v61, 0xffff0000, v16
    v_lshlrev_b32 v62, 16, v17
    v_and_b32 v63, 0xffff0000, v17
    v_lshlrev_b32 v68, 16, v18
    v_and_b32 v69, 0xffff0000, v18
    v_lshlrev_b32 v70, 16, v19
    v_and_b32 v71, 0xffff0000, v19
    v_lshlrev_b32 v20, 16, v76
    v_and_b32 v21, 0xffff0000, v76
    v_lshlrev_b32 v22, 16, v77
    v_and_b32 v23, 0xffff0000, v77
    v_lshlrev_b32 v24, 16, v78
    v_and_b32 v25, 0xffff0000, v78
    v_lshlrev_b32 v26, 16, v79
    v_and_b32 v27, 0xffff0000, v79
    v_add_f32 v60, v60, v20
    v_add_f32 v61, v61, v21
    v_add_f32 v62, v62, v22
    v_add_f32 v63, v63, v23
    v_add_f32 v68, v68, v24
    v_add_f32 v69, v69, v25
    v_add_f32 v70, v70, v26
    v_add_f32 v71, v71, v27
    v_cvt_pk_bf16_f32 v32, v60, v61
    v_cvt_pk_bf16_f32 v33, v62, v63
    v_cvt_pk_bf16_f32 v34, v68, v69
    v_cvt_pk_bf16_f32 v35, v70, v71
    global_store_dwordx4 v8, v[32:35], s[32:33]
.Lg2_done:
    s_endpgm
.p2align 8
.type tbl_p1,@object
tbl_p1:
.long 0x3c003c00,0x3c003c00,0x3c003c00,0x3c003c00,0x3bd93c00,0x3aa73b64,0x387239a8,0x323e361f
.long 0x3b643c00,0x361f39a8,0xb61f0000,0xbb64b9a8,0x3aa73c00,0xb23e361f,0xbbd9b9a8,0xb872bb64
.long 0x39a83c00,0xb9a80000,0xb9a8bc00,0x39a88000,0x38723c00,0xbbd9b61f,0x323eb9a8,0x3aa73b64
.long 0x361f3c00,0xbb64b9a8,0x3b648000,0xb61f39a8,0x323e3c00,0xb872bb64,0x3aa739a8,0xbbd9b61f
.long 0x3c00,0x8000bc00,0x3c00,0x8000bc00,0xb23e3c00,0x3872bb64,0xbaa739a8,0x3bd9b61f
.long 0xb61f3c00,0x3b64b9a8,0xbb640000,0x361f39a8,0xb8723c00,0x3bd9b61f,0xb23eb9a8,0xbaa73b64
.long 0xb9a83c00,0x39a88000,0x39a8bc00,0xb9a80000,0xbaa73c00,0x323e361f,0x3bd9b9a8,0x3872bb64
.long 0xbb643c00,0xb61f39a8,0x361f8000,0x3b64b9a8,0xbbd93c00,0xbaa73b64,0xb87239a8,0xb23e361f
.long 0x3c003c00,0x3c003c00,0x3c003c00,0x3c003c00,0xb23e0000,0xb872b61f,0xbaa7b9a8,0xbbd9bb64
.long 0xbb64bc00,0xb61fb9a8,0x361f8000,0x3b6439a8,0x38728000,0x3bd93b64,0x323e39a8,0xbaa7b61f
.long 0x39a83c00,0xb9a80000,0xb9a8bc00,0x39a88000,0xbaa70000,0xb23ebb64,0x3bd939a8,0xb872361f
.long 0xb61fbc00,0x3b6439a8,0xbb640000,0x361fb9a8,0x3bd98000,0xbaa7361f,0x3872b9a8,0xb23e3b64
.long 0x3c00,0x8000bc00,0x3c00,0x8000bc00,0xbbd90000,0x3aa7361f,0xb872b9a8,0x323e3b64
.long 0x361fbc00,0xbb6439a8,0x3b648000,0xb61fb9a8,0x3aa78000,0x323ebb64,0xbbd939a8,0x3872361f
.long 0xb9a83c00,0x39a88000,0x39a8bc00,0xb9a80000,0xb8720000,0xbbd93b64,0xb23e39a8,0x3aa7b61f
.long 0x3b64bc00,0x361fb9a8,0xb61f0000,0xbb6439a8,0x323e8000,0x3872b61f,0x3aa7b9a8,0x3bd9bb64
.long 0x3c003c00,0x3c003c00,0x3c003c00,0x3c003c00,0xbbd9bc00,0xbaa7bb64,0xb872b9a8,0xb23eb61f
.long 0x3b643c00,0x361f39a8,0xb61f0000,0xbb64b9a8,0xbaa7bc00,0x323eb61f,0x3bd939a8,0x38723b64
.long 0x39a83c00,0xb9a80000,0xb9a8bc00,0x39a88000,0xb872bc00,0x3bd9361f,0xb23e39a8,0xbaa7bb64
.long 0x361f3c00,0xbb64b9a8,0x3b648000,0xb61f39a8,0xb23ebc00,0x38723b64,0xbaa7b9a8,0x3bd9361f
.long 0x3c00,0x8000bc00,0x3c00,0x8000bc00,0x323ebc00,0xb8723b64,0x3aa7b9a8,0xbbd9361f
.long 0xb61f3c00,0x3b64b9a8,0xbb640000,0x361f39a8,0x3872bc00,0xbbd9361f,0x323e39a8,0x3aa7bb64
.long 0xb9a83c00,0x39a88000,0x39a8bc00,0xb9a80000,0x3aa7bc00,0xb23eb61f,0xbbd939a8,0xb8723b64
.long 0xbb643c00,0xb61f39a8,0x361f8000,0x3b64b9a8,0x3bd9bc00,0x3aa7bb64,0x3872b9a8,0x323eb61f
.long 0x3c003c00,0x3c003c00,0x3c003c00,0x3c003c00,0x323e8000,0x3872361f,0x3aa739a8,0x3bd93b64
.long 0xbb64bc00,0xb61fb9a8,0x361f8000,0x3b6439a8,0xb8720000,0xbbd9bb64,0xb23eb9a8,0x3aa7361f
.long 0x39a83c00,0xb9a80000,0xb9a8bc00,0x39a88000,0x3aa78000,0x323e3b64,0xbbd9b9a8,0x3872b61f
.long 0xb61fbc00,0x3b6439a8,0xbb640000,0x361fb9a8,0xbbd90000,0x3aa7b61f,0xb87239a8,0x323ebb64
.long 0x3c00,0x8000bc00,0x3c00,0x8000bc00,0x3bd98000,0xbaa7b61f,0x387239a8,0xb23ebb64
.long 0x361fbc00,0xbb6439a8,0x3b648000,0xb61fb9a8,0xbaa70000,0xb23e3b64,0x3bd9b9a8,0xb872b61f
.long 0xb9a83c00,0x39a88000,0x39a8bc00,0xb9a80000,0x38728000,0x3bd9bb64,0x323eb9a8,0xbaa7361f
.long 0x3b64bc00,0x361fb9a8,0xb61f0000,0xbb6439a8,0xb23e0000,0xb872361f,0xbaa739a8,0xbbd93b64
.long 0xbc003c00,0xbc003c00,0xbc003c00,0xbc003c00,0xbbd93c00,0xbaa73b64,0xb87239a8,0xb23e361f
.long 0xbb643c00,0xb61f39a8,0x361f0000,0x3b64b9a8,0xbaa73c00,0x323e361f,0x3bd9b9a8,0x3872bb64
.long 0xb9a83c00,0x39a80000,0x39a8bc00,0xb9a88000,0xb8723c00,0x3bd9b61f,0xb23eb9a8,0xbaa73b64
.long 0xb61f3c00,0x3b64b9a8,0xbb648000,0x361f39a8,0xb23e3c00,0x3872bb64,0xbaa739a8,0x3bd9b61f
.long 0x80003c00,0xbc00,0x80003c00,0xbc00,0x323e3c00,0xb872bb64,0x3aa739a8,0xbbd9b61f
.long 0x361f3c00,0xbb64b9a8,0x3b640000,0xb61f39a8,0x38723c00,0xbbd9b61f,0x323eb9a8,0x3aa73b64
.long 0x39a83c00,0xb9a88000,0xb9a8bc00,0x39a80000,0x3aa73c00,0xb23e361f,0xbbd9b9a8,0xb872bb64
.long 0x3b643c00,0x361f39a8,0xb61f8000,0xbb64b9a8,0x3bd93c00,0x3aa73b64,0x387239a8,0x323e361f
.long 0xbc003c00,0xbc003c00,0xbc003c00,0xbc003c00,0x323e0000,0x3872b61f,0x3aa7b9a8,0x3bd9bb64
.long 0x3b64bc00,0x361fb9a8,0xb61f8000,0xbb6439a8,0xb8728000,0xbbd93b64,0xb23e39a8,0x3aa7b61f
.long 0xb9a83c00,0x39a80000,0x39a8bc00,0xb9a88000,0x3aa70000,0x323ebb64,0xbbd939a8,0x3872361f
.long 0x361fbc00,0xbb6439a8,0x3b640000,0xb61fb9a8,0xbbd98000,0x3aa7361f,0xb872b9a8,0x323e3b64
.long 0x80003c00,0xbc00,0x80003c00,0xbc00,0x3bd90000,0xbaa7361f,0x3872b9a8,0xb23e3b64
.long 0xb61fbc00,0x3b6439a8,0xbb648000,0x361fb9a8,0xbaa78000,0xb23ebb64,0x3bd939a8,0xb872361f
.long 0x39a83c00,0xb9a88000,0xb9a8bc00,0x39a80000,0x38720000,0x3bd93b64,0x323e39a8,0xbaa7b61f
.long 0xbb64bc00,0xb61fb9a8,0x361f0000,0x3b6439a8,0xb23e8000,0xb872b61f,0xbaa7b9a8,0xbbd9bb64
.long 0xbc003c00,0xbc003c00,0xbc003c00,0xbc003c00,0x3bd9bc00,0x3aa7bb64,0x3872b9a8,0x323eb61f
.long 0xbb643c00,0xb61f39a8,0x361f0000,0x3b64b9a8,0x3aa7bc00,0xb23eb61f,0xbbd939a8,0xb8723b64
.long 0xb9a83c00,0x39a80000,0x39a8bc00,0xb9a88000,0x3872bc00,0xbbd9361f,0x323e39a8,0x3aa7bb64
.long 0xb61f3c00,0x3b64b9a8,0xbb648000,0x361f39a8,0x323ebc00,0xb8723b64,0x3aa7b9a8,0xbbd9361f
.long 0x80003c00,0xbc00,0x80003c00,0xbc00,0xb23ebc00,0x38723b64,0xbaa7b9a8,0x3bd9361f
.long 0x361f3c00,0xbb64b9a8,0x3b640000,0xb61f39a8,0xb872bc00,0x3bd9361f,0xb23e39a8,0xbaa7bb64
.long 0x39a83c00,0xb9a88000,0xb9a8bc00,0x39a80000,0xbaa7bc00,0x323eb61f,0x3bd939a8,0x38723b64
.long 0x3b643c00,0x361f39a8,0xb61f8000,0xbb64b9a8,0xbbd9bc00,0xbaa7bb64,0xb872b9a8,0xb23eb61f
.long 0xbc003c00,0xbc003c00,0xbc003c00,0xbc003c00,0xb23e8000,0xb872361f,0xbaa739a8,0xbbd93b64
.long 0x3b64bc00,0x361fb9a8,0xb61f8000,0xbb6439a8,0x38720000,0x3bd9bb64,0x323eb9a8,0xbaa7361f
.long 0xb9a83c00,0x39a80000,0x39a8bc00,0xb9a88000,0xbaa78000,0xb23e3b64,0x3bd9b9a8,0xb872b61f
.long 0x361fbc00,0xbb6439a8,0x3b640000,0xb61fb9a8,0x3bd90000,0xbaa7b61f,0x387239a8,0xb23ebb64
.long 0x80003c00,0xbc00,0x80003c00,0xbc00,0xbbd98000,0x3aa7b61f,0xb87239a8,0x323ebb64
.long 0xb61fbc00,0x3b6439a8,0xbb648000,0x361fb9a8,0x3aa70000,0x323e3b64,0xbbd9b9a8,0x3872b61f
.long 0x39a83c00,0xb9a88000,0xb9a8bc00,0x39a80000,0xb8728000,0xbbd9bb64,0xb23eb9a8,0x3aa7361f
.long 0xbb64bc00,0xb61fb9a8,0x361f0000,0x3b6439a8,0x323e0000,0x3872361f,0x3aa739a8,0x3bd93b64
.long 0x80008000,0x80008000,0x80008000,0x80008000,0xb23e8000,0xb872b61f,0xbaa7b9a8,0xbbd9bb64
.long 0xb61f8000,0xbb64b9a8,0xbb64bc00,0xb61fb9a8,0xb8728000,0xbbd9bb64,0xb23eb9a8,0x3aa7361f
.long 0xb9a88000,0xb9a8bc00,0x39a88000,0x39a83c00,0xbaa78000,0xb23ebb64,0x3bd939a8,0xb872361f
.long 0xbb648000,0x361fb9a8,0x361f3c00,0xbb64b9a8,0xbbd98000,0x3aa7b61f,0xb87239a8,0x323ebb64
.long 0xbc008000,0x3c008000,0xbc008000,0x3c008000,0xbbd98000,0x3aa7361f,0xb872b9a8,0x323e3b64
.long 0xbb648000,0x361f39a8,0x361fbc00,0xbb6439a8,0xbaa78000,0xb23e3b64,0x3bd9b9a8,0xb872b61f
.long 0xb9a88000,0xb9a83c00,0x39a88000,0x39a8bc00,0xb8728000,0xbbd93b64,0xb23e39a8,0x3aa7b61f
.long 0xb61f8000,0xbb6439a8,0xbb643c00,0xb61f39a8,0xb23e8000,0xb872361f,0xbaa739a8,0xbbd93b64
.long 0x80008000,0x80008000,0x80008000,0x80008000,0xbbd9bc00,0xbaa7bb64,0xb872b9a8,0xb23eb61f
.long 0x361f8000,0x3b6439a8,0x3b643c00,0x361f39a8,0x3aa73c00,0xb23e361f,0xbbd9b9a8,0xb872bb64
.long 0xb9a88000,0xb9a8bc00,0x39a88000,0x39a83c00,0xb872bc00,0x3bd9361f,0xb23e39a8,0xbaa7bb64
.long 0x3b648000,0xb61f39a8,0xb61fbc00,0x3b6439a8,0x323e3c00,0xb872bb64,0x3aa739a8,0xbbd9b61f
.long 0xbc008000,0x3c008000,0xbc008000,0x3c008000,0x323ebc00,0xb8723b64,0x3aa7b9a8,0xbbd9361f
.long 0x3b648000,0xb61fb9a8,0xb61f3c00,0x3b64b9a8,0xb8723c00,0x3bd9b61f,0xb23eb9a8,0xbaa73b64
.long 0xb9a88000,0xb9a83c00,0x39a88000,0x39a8bc00,0x3aa7bc00,0xb23eb61f,0xbbd939a8,0xb8723b64
.long 0x361f8000,0x3b64b9a8,0x3b64bc00,0x361fb9a8,0xbbd93c00,0xbaa73b64,0xb87239a8,0xb23e361f
.long 0x80008000,0x80008000,0x80008000,0x80008000,0x323e8000,0x3872361f,0x3aa739a8,0x3bd93b64
.long 0xb61f8000,0xbb64b9a8,0xbb64bc00,0xb61fb9a8,0x38728000,0x3bd93b64,0x323e39a8,0xbaa7b61f
.long 0xb9a88000,0xb9a8bc00,0x39a88000,0x39a83c00,0x3aa78000,0x323e3b64,0xbbd9b9a8,0x3872b61f
.long 0xbb648000,0x361fb9a8,0x361f3c00,0xbb64b9a8,0x3bd98000,0xbaa7361f,0x3872b9a8,0xb23e3b64
.long 0xbc008000,0x3c008000,0xbc008000,0x3c008000,0x3bd98000,0xbaa7b61f,0x387239a8,0xb23ebb64
.long 0xbb648000,0x361f39a8,0x361fbc00,0xbb6439a8,0x3aa78000,0x323ebb64,0xbbd939a8,0x3872361f
.long 0xb9a88000,0xb9a83c00,0x39a88000,0x39a8bc00,0x38728000,0x3bd9bb64,0x323eb9a8,0xbaa7361f
.long 0xb61f8000,0xbb6439a8,0xbb643c00,0xb61f39a8,0x323e8000,0x3872b61f,0x3aa7b9a8,0x3bd9bb64
.long 0x80008000,0x80008000,0x80008000,0x80008000,0x3bd93c00,0x3aa73b64,0x387239a8,0x323e361f
.long 0x361f8000,0x3b6439a8,0x3b643c00,0x361f39a8,0xbaa7bc00,0x323eb61f,0x3bd939a8,0x38723b64
.long 0xb9a88000,0xb9a8bc00,0x39a88000,0x39a83c00,0x38723c00,0xbbd9b61f,0x323eb9a8,0x3aa73b64
.long 0x3b648000,0xb61f39a8,0xb61fbc00,0x3b6439a8,0xb23ebc00,0x38723b64,0xbaa7b9a8,0x3bd9361f
.long 0xbc008000,0x3c008000,0xbc008000,0x3c008000,0xb23e3c00,0x3872bb64,0xbaa739a8,0x3bd9b61f
.long 0x3b648000,0xb61fb9a8,0xb61f3c00,0x3b64b9a8,0x3872bc00,0xbbd9361f,0x323e39a8,0x3aa7bb64
.long 0xb9a88000,0xb9a83c00,0x39a88000,0x39a8bc00,0xbaa73c00,0x323e361f,0x3bd9b9a8,0x3872bb64
.long 0x361f8000,0x3b64b9a8,0x3b64bc00,0x361fb9a8,0x3bd9bc00,0x3aa7bb64,0x3872b9a8,0x323eb61f
.long 0x80008000,0x80008000,0x80008000,0x80008000,0x323e8000,0x3872b61f,0x3aa7b9a8,0x3bd9bb64
.long 0x361f8000,0x3b64b9a8,0x3b64bc00,0x361fb9a8,0x38728000,0x3bd9bb64,0x323eb9a8,0xbaa7361f
.long 0x39a88000,0x39a8bc00,0xb9a88000,0xb9a83c00,0x3aa78000,0x323ebb64,0xbbd939a8,0x3872361f
.long 0x3b648000,0xb61fb9a8,0xb61f3c00,0x3b64b9a8,0x3bd98000,0xbaa7b61f,0x387239a8,0xb23ebb64
.long 0x3c008000,0xbc008000,0x3c008000,0xbc008000,0x3bd98000,0xbaa7361f,0x3872b9a8,0xb23e3b64
.long 0x3b648000,0xb61f39a8,0xb61fbc00,0x3b6439a8,0x3aa78000,0x323e3b64,0xbbd9b9a8,0x3872b61f
.long 0x39a88000,0x39a83c00,0xb9a88000,0xb9a8bc00,0x38728000,0x3bd93b64,0x323e39a8,0xbaa7b61f
.long 0x361f8000,0x3b6439a8,0x3b643c00,0x361f39a8,0x323e8000,0x3872361f,0x3aa739a8,0x3bd93b64
.long 0x80008000,0x80008000,0x80008000,0x80008000,0x3bd9bc00,0x3aa7bb64,0x3872b9a8,0x323eb61f
.long 0xb61f8000,0xbb6439a8,0xbb643c00,0xb61f39a8,0xbaa73c00,0x323e361f,0x3bd9b9a8,0x3872bb64
.long 0x39a88000,0x39a8bc00,0xb9a88000,0xb9a83c00,0x3872bc00,0xbbd9361f,0x323e39a8,0x3aa7bb64
.long 0xbb648000,0x361f39a8,0x361fbc00,0xbb6439a8,0xb23e3c00,0x3872bb64,0xbaa739a8,0x3bd9b61f
.long 0x3c008000,0xbc008000,0x3c008000,0xbc008000,0xb23ebc00,0x38723b64,0xbaa7b9a8,0x3bd9361f
.long 0xbb648000,0x361fb9a8,0x361f3c00,0xbb64b9a8,0x38723c00,0xbbd9b61f,0x323eb9a8,0x3aa73b64
.long 0x39a88000,0x39a83c00,0xb9a88000,0xb9a8bc00,0xbaa7bc00,0x323eb61f,0x3bd939a8,0x38723b64
.long 0xb61f8000,0xbb64b9a8,0xbb64bc00,0xb61fb9a8,0x3bd93c00,0x3aa73b64,0x387239a8,0x323e361f
.long 0x80008000,0x80008000,0x80008000,0x80008000,0xb23e8000,0xb872361f,0xbaa739a8,0xbbd93b64
.long 0x361f8000,0x3b64b9a8,0x3b64bc00,0x361fb9a8,0xb8728000,0xbbd93b64,0xb23e39a8,0x3aa7b61f
.long 0x39a88000,0x39a8bc00,0xb9a88000,0xb9a83c00,0xbaa78000,0xb23e3b64,0x3bd9b9a8,0xb872b61f
.long 0x3b648000,0xb61fb9a8,0xb61f3c00,0x3b64b9a8,0xbbd98000,0x3aa7361f,0xb872b9a8,0x323e3b64
.long 0x3c008000,0xbc008000,0x3c008000,0xbc008000,0xbbd98000,0x3aa7b61f,0xb87239a8,0x323ebb64
.long 0x3b648000,0xb61f39a8,0xb61fbc00,0x3b6439a8,0xbaa78000,0xb23ebb64,0x3bd939a8,0xb872361f
.long 0x39a88000,0x39a83c00,0xb9a88000,0xb9a8bc00,0xb8728000,0xbbd9bb64,0xb23eb9a8,0x3aa7361f
.long 0x361f8000,0x3b6439a8,0x3b643c00,0x361f39a8,0xb23e8000,0xb872b61f,0xbaa7b9a8,0xbbd9bb64
.long 0x80008000,0x80008000,0x80008000,0x80008000,0xbbd93c00,0xbaa73b64,0xb87239a8,0xb23e361f
.long 0xb61f8000,0xbb6439a8,0xbb643c00,0xb61f39a8,0x3aa7bc00,0xb23eb61f,0xbbd939a8,0xb8723b64
.long 0x39a88000,0x39a8bc00,0xb9a88000,0xb9a83c00,0xb8723c00,0x3bd9b61f,0xb23eb9a8,0xbaa73b64
.long 0xbb648000,0x361f39a8,0x361fbc00,0xbb6439a8,0x323ebc00,0xb8723b64,0x3aa7b9a8,0xbbd9361f
.long 0x3c008000,0xbc008000,0x3c008000,0xbc008000,0x323e3c00,0xb872bb64,0x3aa739a8,0xbbd9b61f
.long 0xbb648000,0x361fb9a8,0x361f3c00,0xbb64b9a8,0xb872bc00,0x3bd9361f,0xb23e39a8,0xbaa7bb64
.long 0x39a88000,0x39a83c00,0xb9a88000,0xb9a8bc00,0x3aa73c00,0xb23e361f,0xbbd9b9a8,0xb872bb64
.long 0xb61f8000,0xbb64b9a8,0xbb64bc00,0xb61fb9a8,0xbbd9bc00,0xbaa7bb64,0xb872b9a8,0xb23eb61f
.long 0x3400,0x3400,0x3400,0x3400,0x34008000,0x34008000,0x34008000,0x34008000
.long 0x3400,0x2e1f3364,0x31a831a8,0x33642e1f,0x34008000,0x3364ae1f,0x31a8b1a8,0x2e1fb364
.long 0x3400,0x31a831a8,0x34000000,0x31a8b1a8,0x34008000,0x31a8b1a8,0xb400,0xb1a8b1a8
.long 0x3400,0x33642e1f,0x31a8b1a8,0xae1fb364,0x34008000,0x2e1fb364,0xb1a8b1a8,0xb3642e1f
.long 0x3400,0x34000000,0xb400,0xb4008000,0x34008000,0xb400,0xb4008000,0x80003400
.long 0x3400,0x3364ae1f,0xb1a8b1a8,0xae1f3364,0x34008000,0xae1fb364,0xb1a831a8,0x33642e1f
.long 0x3400,0x31a8b1a8,0xb4008000,0x31a831a8,0x34008000,0xb1a8b1a8,0x80003400,0x31a8b1a8
.long 0x3400,0x2e1fb364,0xb1a831a8,0x3364ae1f,0x34008000,0xb364ae1f,0x31a831a8,0xae1fb364
.long 0x3400,0x3400,0x3400,0x3400,0x34008000,0x34008000,0x34008000,0x34008000
.long 0x34000000,0x3364ae1f,0x31a8b1a8,0x2e1fb364,0xb400,0xae1fb364,0xb1a8b1a8,0xb364ae1f
.long 0xb400,0xb1a8b1a8,0xb4008000,0xb1a831a8,0xb4008000,0xb1a831a8,0x80003400,0x31a831a8
.long 0xb4008000,0xae1f3364,0x31a831a8,0x3364ae1f,0x80003400,0x33642e1f,0x31a8b1a8,0xae1fb364
.long 0x3400,0x34000000,0xb400,0xb4008000,0x34008000,0xb400,0xb4008000,0x80003400
.long 0x34000000,0xae1fb364,0xb1a831a8,0x33642e1f,0xb400,0xb3642e1f,0x31a831a8,0x2e1fb364
.long 0xb400,0xb1a831a8,0x34000000,0xb1a8b1a8,0xb4008000,0x31a831a8,0xb400,0xb1a831a8
.long 0xb4008000,0x33642e1f,0xb1a8b1a8,0x2e1f3364,0x80003400,0x2e1fb364,0xb1a831a8,0x3364ae1f
.long 0x3400,0x3400,0x3400,0x3400,0x34008000,0x34008000,0x34008000,0x34008000
.long 0xb400,0xae1fb364,0xb1a8b1a8,0xb364ae1f,0xb4008000,0xb3642e1f,0xb1a831a8,0xae1f3364
.long 0x3400,0x31a831a8,0x34000000,0x31a8b1a8,0x34008000,0x31a8b1a8,0xb400,0xb1a8b1a8
.long 0xb400,0xb364ae1f,0xb1a831a8,0x2e1f3364,0xb4008000,0xae1f3364,0x31a831a8,0x3364ae1f
.long 0x3400,0x34000000,0xb400,0xb4008000,0x34008000,0xb400,0xb4008000,0x80003400
.long 0xb400,0xb3642e1f,0x31a831a8,0x2e1fb364,0xb4008000,0x2e1f3364,0x31a8b1a8,0xb364ae1f
.long 0x3400,0x31a8b1a8,0xb4008000,0x31a831a8,0x34008000,0xb1a8b1a8,0x80003400,0x31a8b1a8
.long 0xb400,0xae1f3364,0x31a8b1a8,0xb3642e1f,0xb4008000,0x33642e1f,0xb1a8b1a8,0x2e1f3364
.long 0x3400,0x3400,0x3400,0x3400,0x34008000,0x34008000,0x34008000,0x34008000
.long 0xb4008000,0xb3642e1f,0xb1a831a8,0xae1f3364,0x80003400,0x2e1f3364,0x31a831a8,0x33642e1f
.long 0xb400,0xb1a8b1a8,0xb4008000,0xb1a831a8,0xb4008000,0xb1a831a8,0x80003400,0x31a831a8
.long 0x34000000,0x2e1fb364,0xb1a8b1a8,0xb3642e1f,0xb400,0xb364ae1f,0xb1a831a8,0x2e1f3364
.long 0x3400,0x34000000,0xb400,0xb4008000,0x34008000,0xb400,0xb4008000,0x80003400
.long 0xb4008000,0x2e1f3364,0x31a8b1a8,0xb364ae1f,0x80003400,0x3364ae1f,0xb1a8b1a8,0xae1f3364
.long 0xb400,0xb1a831a8,0x34000000,0xb1a8b1a8,0xb4008000,0x31a831a8,0xb400,0xb1a831a8
.long 0x34000000,0xb364ae1f,0x31a831a8,0xae1fb364,0xb400,0xae1f3364,0x31a8b1a8,0xb3642e1f
.long 0x3e800000,0x80000000,0x3e800000,0x80000000,0x3e800000,0x80000000,0x3e7ffb11,0xbb490e90
.long 0x3e800000,0x80000000,0x3e7fec43,0xbbc90ab0,0x3e800000,0x80000000,0x3e7fd397,0xbc16c32c
.long 0x3e800000,0x80000000,0x3e7fb10f,0xbc48fb30,0x3e800000,0x80000000,0x3e7f84ab,0xbc7b2b74
.long 0x3e800000,0x80000000,0x3e7f4e6d,0xbc96a905,0x3e800000,0x80000000,0x3e7f0e58,0xbcafb680
.long 0x3e800000,0x80000000,0x3e7ec46d,0xbcc8bd36,0x3e800000,0x80000000,0x3e7e70b0,0xbce1bc2e
.long 0x3e800000,0x80000000,0x3e7e1324,0xbcfab273,0x3e800000,0x80000000,0x3e7dabcc,0xbd09cf86
.long 0x3e800000,0x80000000,0x3e7d3aac,0xbd164083,0x3e800000,0x80000000,0x3e7cbfc9,0xbd22abb6
.long 0x3e800000,0x80000000,0x3e7c3b28,0xbd2f10a2,0x3e800000,0x80000000,0x3e7baccd,0xbd3b6ecf
.long 0x3e800000,0x80000000,0x3e800000,0x80000000,0x3e7fb10f,0xbc48fb30,0x3e7f84ab,0xbc7b2b74
.long 0x3e7ec46d,0xbcc8bd36,0x3e7e1324,0xbcfab273,0x3e7d3aac,0xbd164083,0x3e7baccd,0xbd3b6ecf
.long 0x3e7b14be,0xbd47c5c2,0x3e7853f8,0xbd78cfcc,0x3e7853f8,0xbd78cfcc,0x3e740bdd,0xbd9aa086
.long 0x3e74fa0b,0xbd94a031,0x3e6ed89e,0xbdb8442a,0x3e710908,0xbdac7cd4,0x3e68bf3c,0xbdd53641
.long 0x3e6c835e,0xbdc3ef15,0x3e61c598,0xbdf15aea,0x3e676bd8,0xbddae880,0x3e59f26a,0xbe064b82
.long 0x3e61c598,0xbdf15aea,0x3e514d3d,0xbe13682a,0x3e5b941a,0xbe039c3d,0x3e47de65,0xbe1ff6cb
.long 0x3e54db31,0xbe0e39da,0x3e3daef9,0xbe2beb4a,0x3e4d9f02,0xbe187fc0,0x3e32c8c9,0xbe373a23
.long 0x3e45e403,0xbe226799,0x3e273656,0xbe41d870,0x3e3daef9,0xbe2beb4a,0x3e1b02c6,0xbe4bbbf8
.long 0x3e800000,0x80000000,0x3e800000,0x80000000,0x3e7ec46d,0xbcc8bd36,0x3e7e70b0,0xbce1bc2e
.long 0x3e7b14be,0xbd47c5c2,0x3e79c79d,0xbd605c13,0x3e74fa0b,0xbd94a031,0x3e721352,0xbda68f12
.long 0x3e6c835e,0xbdc3ef15,0x3e676bd8,0xbddae880,0x3e61c598,0xbdf15aea,0x3e59f26a,0xbe064b82
.long 0x3e54db31,0xbe0e39da,0x3e49d112,0xbe1d7fd1,0x3e45e403,0xbe226799,0x3e373a23,0xbe32c8c9
.long 0x3e3504f3,0xbe3504f3,0x3e226799,0xbe45e403,0x3e226799,0xbe45e403,0x3e0b9a6b,0xbe5695e5
.long 0x3e0e39da,0xbe54db31,0x3de63375,0xbe64aa59,0x3df15aea,0xbe61c598,0x3db263ef,0xbe6ff573
.long 0x3dc3ef15,0xbe6c835e,0x3d78cfcc,0xbe7853f8,0x3d94a031,0xbe74fa0b,0x3d09cf86,0xbe7dabcc
.long 0x3d47c5c2,0xbe7b14be,0x3bc90ab0,0xbe7fec43,0x3cc8bd36,0xbe7ec46d,0xbcafb680,0xbe7f0e58
.long 0x3e800000,0x80000000,0x3e800000,0x80000000,0x3e7d3aac,0xbd164083,0x3e7cbfc9,0xbd22abb6
.long 0x3e74fa0b,0xbd94a031,0x3e731447,0xbda09ae5,0x3e676bd8,0xbddae880,0x3e633c5a,0xbdebcbbb
.long 0x3e54db31,0xbe0e39da,0x3e4d9f02,0xbe187fc0,0x3e3daef9,0xbe2beb4a,0x3e32c8c9,0xbe373a23
.long 0x3e226799,0xbe45e403,0x3e13682a,0xbe514d3d,0x3e039c3d,0xbe5b941a,0x3de0924f,0xbe660f88
.long 0x3dc3ef15,0xbe6c835e,0x3d94a031,0xbe74fa0b,0x3d78cfcc,0xbe7853f8,0x3d09cf86,0xbe7dabcc
.long 0x3cc8bd36,0xbe7ec46d,0xbbc90ab0,0xbe7fec43,0xbc48fb30,0xbe7fb10f,0xbd3b6ecf,0xbe7baccd
.long 0xbd47c5c2,0xbe7b14be,0xbdac7cd4,0xbe710908,0xbdac7cd4,0xbe710908,0xbdf6e0cb,0xbe604621
.long 0xbdf15aea,0xbe61c598,0xbe1d7fd1,0xbe49d112,0xbe187fc0,0xbe4d9f02,0xbe3b8f3b,0xbe2e3bde
.long 0x3e800000,0x80000000,0x3e800000,0x80000000,0x3e7fec43,0xbbc90ab0,0x3e7fd397,0xbc16c32c
.long 0x3e7fb10f,0xbc48fb30,0x3e7f4e6d,0xbc96a905,0x3e7f4e6d,0xbc96a905,0x3e7e70b0,0xbce1bc2e
.long 0x3e7ec46d,0xbcc8bd36,0x3e7d3aac,0xbd164083,0x3e7e1324,0xbcfab273,0x3e7baccd,0xbd3b6ecf
.long 0x3e7d3aac,0xbd164083,0x3e79c79d,0xbd605c13,0x3e7c3b28,0xbd2f10a2,0x3e778bc5,0xbd827dc0
.long 0x3e7b14be,0xbd47c5c2,0x3e74fa0b,0xbd94a031,0x3e79c79d,0xbd605c13,0x3e721352,0xbda68f12
.long 0x3e7853f8,0xbd78cfcc,0x3e6ed89e,0xbdb8442a,0x3e76ba07,0xbd888e93,0x3e6b4b0c,0xbdc9b953
.long 0x3e74fa0b,0xbd94a031,0x3e676bd8,0xbddae880,0x3e731447,0xbda09ae5,0x3e633c5a,0xbdebcbbb
.long 0x3e710908,0xbdac7cd4,0x3e5ebe05,0xbdfc5d27,0x3e6ed89e,0xbdb8442a,0x3e59f26a,0xbe064b82
.long 0x3e800000,0x80000000,0x3e800000,0x80000000,0x3e7f4e6d,0xbc96a905,0x3e7f0e58,0xbcafb680
.long 0x3e7d3aac,0xbd164083,0x3e7c3b28,0xbd2f10a2,0x3e79c79d,0xbd605c13,0x3e778bc5,0xbd827dc0
.long 0x3e74fa0b,0xbd94a031,0x3e710908,0xbdac7cd4,0x3e6ed89e,0xbdb8442a,0x3e68bf3c,0xbdd53641
.long 0x3e676bd8,0xbddae880,0x3e5ebe05,0xbdfc5d27,0x3e5ebe05,0xbdfc5d27,0x3e531849,0xbe10d3cd
.long 0x3e54db31,0xbe0e39da,0x3e45e403,0xbe226799,0x3e49d112,0xbe1d7fd1,0x3e373a23,0xbe32c8c9
.long 0x3e3daef9,0xbe2beb4a,0x3e273656,0xbe41d870,0x3e3085bb,0xbe396842,0x3e15f6d9,0xbe4f7a1f
.long 0x3e226799,0xbe45e403,0x3e039c3d,0xbe5b941a,0x3e13682a,0xbe514d3d,0x3de0924f,0xbe660f88
.long 0x3e039c3d,0xbe5b941a,0x3db8442a,0xbe6ed89e,0x3de63375,0xbe64aa59,0x3d8e9a22,0xbe75dec6
.long 0x3e800000,0x80000000,0x3e800000,0x80000000,0x3e7e1324,0xbcfab273,0x3e7dabcc,0xbd09cf86
.long 0x3e7853f8,0xbd78cfcc,0x3e76ba07,0xbd888e93,0x3e6ed89e,0xbdb8442a,0x3e6b4b0c,0xbdc9b953
.long 0x3e61c598,0xbdf15aea,0x3e5b941a,0xbe039c3d,0x3e514d3d,0xbe13682a,0x3e47de65,0xbe1ff6cb
.long 0x3e3daef9,0xbe2beb4a,0x3e3085bb,0xbe396842,0x3e273656,0xbe41d870,0x3e15f6d9,0xbe4f7a1f
.long 0x3e0e39da,0xbe54db31,0x3df15aea,0xbe61c598,0x3de63375,0xbe64aa59,0x3db263ef,0xbe6ff573
.long 0x3dac7cd4,0xbe710908,0x3d605c13,0xbe79c79d,0x3d605c13,0xbe79c79d,0x3cafb680,0xbe7f0e58
.long 0x3cc8bd36,0xbe7ec46d,0xbc48fb30,0xbe7fb10f,0xbbc90ab0,0xbe7fec43,0xbd3b6ecf,0xbe7baccd
.long 0xbd164083,0xbe7d3aac,0xbda09ae5,0xbe731447,0xbd888e93,0xbe76ba07,0xbde0924f,0xbe660f88
.long 0x3e800000,0x80000000,0x3e800000,0x80000000,0x3e7c3b28,0xbd2f10a2,0x3e7baccd,0xbd3b6ecf
.long 0x3e710908,0xbdac7cd4,0x3e6ed89e,0xbdb8442a,0x3e5ebe05,0xbdfc5d27,0x3e59f26a,0xbe064b82
.long 0x3e45e403,0xbe226799,0x3e3daef9,0xbe2beb4a,0x3e273656,0xbe41d870,0x3e1b02c6,0xbe4bbbf8
.long 0x3e039c3d,0xbe5b941a,0x3de63375,0xbe64aa59,0x3db8442a,0xbe6ed89e,0x3d8e9a22,0xbe75dec6
.long 0x3d47c5c2,0xbe7b14be,0x3cc8bd36,0xbe7ec46d,0x3bc90ab0,0xbe7fec43,0xbcafb680,0xbe7f0e58
.long 0xbd164083,0xbe7d3aac,0xbd888e93,0xbe76ba07,0xbda09ae5,0xbe731447,0xbde0924f,0xbe660f88
.long 0xbdf15aea,0xbe61c598,0xbe187fc0,0xbe4d9f02,0xbe1d7fd1,0xbe49d112,0xbe3b8f3b,0xbe2e3bde
.long 0xbe3daef9,0xbe2beb4a,0xbe584853,0xbe08f59b,0xbe584853,0xbe08f59b,0xbe6db293,0xbdbe1d4a
.long 0x3e800000,0x80000000,0x3e7b14be,0xbd47c5c2,0x3e800000,0x80000000,0x3e7a7302,0xbd541501
.long 0x3e800000,0x80000000,0x3e79c79d,0xbd605c13,0x3e800000,0x80000000,0x3e791298,0xbd6c9a7f
.long 0x3e800000,0x80000000,0x3e7853f8,0xbd78cfcc,0x3e800000,0x80000000,0x3e778bc5,0xbd827dc0
.long 0x3e800000,0x80000000,0x3e76ba07,0xbd888e93,0x3e800000,0x80000000,0x3e75dec6,0xbd8e9a22
.long 0x3e800000,0x80000000,0x3e74fa0b,0xbd94a031,0x3e800000,0x80000000,0x3e740bdd,0xbd9aa086
.long 0x3e800000,0x80000000,0x3e731447,0xbda09ae5,0x3e800000,0x80000000,0x3e721352,0xbda68f12
.long 0x3e800000,0x80000000,0x3e710908,0xbdac7cd4,0x3e800000,0x80000000,0x3e6ff573,0xbdb263ef
.long 0x3e800000,0x80000000,0x3e6ed89e,0xbdb8442a,0x3e800000,0x80000000,0x3e6db293,0xbdbe1d4a
.long 0x3e3504f3,0xbe3504f3,0x3e0e39da,0xbe54db31,0x3e2beb4a,0xbe3daef9,0x3e00e7e4,0xbe5d2d53
.long 0x3e226799,0xbe45e403,0x3de63375,0xbe64aa59,0x3e187fc0,0xbe4d9f02,0x3dc9b953,0xbe6b4b0c
.long 0x3e0e39da,0xbe54db31,0x3dac7cd4,0xbe710908,0x3e039c3d,0xbe5b941a,0x3d8e9a22,0xbe75dec6
.long 0x3df15aea,0xbe61c598,0x3d605c13,0xbe79c79d,0x3ddae880,0xbe676bd8,0x3d22abb6,0xbe7cbfc9
.long 0x3dc3ef15,0xbe6c835e,0x3cc8bd36,0xbe7ec46d,0x3dac7cd4,0xbe710908,0x3c16c32c,0xbe7fd397
.long 0x3d94a031,0xbe74fa0b,0xbbc90ab0,0xbe7fec43,0x3d78cfcc,0xbe7853f8,0xbcafb680,0xbe7f0e58
.long 0x3d47c5c2,0xbe7b14be,0xbd164083,0xbe7d3aac,0x3d164083,0xbe7d3aac,0xbd541501,0xbe7a7302
.long 0x3cc8bd36,0xbe7ec46d,0xbd888e93,0xbe76ba07,0x3c48fb30,0xbe7fb10f,0xbda68f12,0xbe721352
.long 0x238d3132,0xbe800000,0xbd47c5c2,0xbe7b14be,0xbcc8bd36,0xbe7ec46d,0xbd9aa086,0xbe740bdd
.long 0xbd47c5c2,0xbe7b14be,0xbdcf7bca,0xbe6a09a7,0xbd94a031,0xbe74fa0b,0xbe00e7e4,0xbe5d2d53
.long 0xbdc3ef15,0xbe6c835e,0xbe187fc0,0xbe4d9f02,0xbdf15aea,0xbe61c598,0xbe2e3bde,0xbe3b8f3b
.long 0xbe0e39da,0xbe54db31,0xbe41d870,0xbe273656,0xbe226799,0xbe45e403,0xbe531849,0xbe10d3cd
.long 0xbe3504f3,0xbe3504f3,0xbe61c598,0xbdf15aea,0xbe45e403,0xbe226799,0xbe6db293,0xbdbe1d4a
.long 0xbe54db31,0xbe0e39da,0xbe76ba07,0xbd888e93,0xbe61c598,0xbdf15aea,0xbe7cbfc9,0xbd22abb6
.long 0xbe6c835e,0xbdc3ef15,0xbe7fb10f,0xbc48fb30,0xbe74fa0b,0xbd94a031,0xbe7f84ab,0x3c7b2b74
.long 0xbe7b14be,0xbd47c5c2,0xbe7c3b28,0x3d2f10a2,0xbe7ec46d,0xbcc8bd36,0xbe75dec6,0x3d8e9a22
.long 0xbe3504f3,0xbe3504f3,0xbe54db31,0xbe0e39da,0xbe4d9f02,0xbe187fc0,0xbe68bf3c,0xbdd53641
.long 0xbe61c598,0xbdf15aea,0xbe76ba07,0xbd888e93,0xbe710908,0xbdac7cd4,0xbe7e70b0,0xbce1bc2e
.long 0xbe7b14be,0xbd47c5c2,0xbe7fb10f,0x3c48fb30,0xbe7fb10f,0xbc48fb30,0xbe7a7302,0x3d541501
.long 0xbe7ec46d,0x3cc8bd36,0xbe6ed89e,0x3db8442a,0xbe7853f8,0x3d78cfcc,0xbe5d2d53,0x3e00e7e4
.long 0xbe6c835e,0x3dc3ef15,0xbe45e403,0x3e226799,0xbe5b941a,0x3e039c3d,0xbe299415,0x3e3fc767
.long 0xbe45e403,0x3e226799,0xbe08f59b,0x3e584853,0xbe2beb4a,0x3e3daef9,0xbdc9b953,0x3e6b4b0c
.long 0xbe0e39da,0x3e54db31,0xbd78cfcc,0x3e7853f8,0xbddae880,0x3e676bd8,0xbcafb680,0x3e7f0e58
.long 0xbd94a031,0x3e74fa0b,0x3c96a905,0x3e7f4e6d,0xbd164083,0x3e7d3aac,0x3d6c9a7f,0x3e791298
.long 0x3e6c835e,0xbdc3ef15,0x3e54db31,0xbe0e39da,0x3e6a09a7,0xbdcf7bca,0x3e4f7a1f,0xbe15f6d9
.long 0x3e676bd8,0xbddae880,0x3e49d112,0xbe1d7fd1,0x3e64aa59,0xbde63375,0x3e43e200,0xbe24d225
.long 0x3e61c598,0xbdf15aea,0x3e3daef9,0xbe2beb4a,0x3e5ebe05,0xbdfc5d27,0x3e373a23,0xbe32c8c9
.long 0x3e5b941a,0xbe039c3d,0x3e3085bb,0xbe396842,0x3e584853,0xbe08f59b,0x3e299415,0xbe3fc767
.long 0x3e54db31,0xbe0e39da,0x3e226799,0xbe45e403,0x3e514d3d,0xbe13682a,0x3e1b02c6,0xbe4bbbf8
.long 0x3e4d9f02,0xbe187fc0,0x3e13682a,0xbe514d3d,0x3e49d112,0xbe1d7fd1,0x3e0b9a6b,0xbe5695e5
.long 0x3e45e403,0xbe226799,0x3e039c3d,0xbe5b941a,0x3e41d870,0xbe273656,0x3df6e0cb,0xbe604621
.long 0x3e3daef9,0xbe2beb4a,0x3de63375,0xbe64aa59,0x3e396842,0xbe3085bb,0x3dd53641,0xbe68bf3c
.long 0x3dc3ef15,0xbe6c835e,0x3d47c5c2,0xbe7b14be,0x3da09ae5,0xbe731447,0x3ce1bc2e,0xbe7e70b0
.long 0x3d78cfcc,0xbe7853f8,0x3bc90ab0,0xbe7fec43,0x3d2f10a2,0xbe7c3b28,0xbc7b2b74,0xbe7f84ab
.long 0x3cc8bd36,0xbe7ec46d,0xbd164083,0xbe7d3aac,0x3bc90ab0,0xbe7fec43,0xbd6c9a7f,0xbe791298
.long 0xbc48fb30,0xbe7fb10f,0xbda09ae5,0xbe731447,0xbcfab273,0xbe7e1324,0xbdc9b953,0xbe6b4b0c
.long 0xbd47c5c2,0xbe7b14be,0xbdf15aea,0xbe61c598,0xbd888e93,0xbe76ba07,0xbe0b9a6b,0xbe5695e5
.long 0xbdac7cd4,0xbe710908,0xbe1d7fd1,0xbe49d112,0xbdcf7bca,0xbe6a09a7,0xbe2e3bde,0xbe3b8f3b
.long 0xbdf15aea,0xbe61c598,0xbe3daef9,0xbe2beb4a,0xbe08f59b,0xbe584853,0xbe4bbbf8,0xbe1b02c6
.long 0xbe187fc0,0xbe4d9f02,0xbe584853,0xbe08f59b,0xbe273656,0xbe41d870,0xbe633c5a,0xbdebcbbb
.long 0xbdc3ef15,0xbe6c835e,0xbe0e39da,0xbe54db31,0xbdfc5d27,0xbe5ebe05,0xbe299415,0xbe3fc767
.long 0xbe187fc0,0xbe4d9f02,0xbe41d870,0xbe273656,0xbe3085bb,0xbe396842,0xbe5695e5,0xbe0b9a6b
.long 0xbe45e403,0xbe226799,0xbe676bd8,0xbddae880,0xbe584853,0xbe08f59b,0xbe740bdd,0xbd9aa086
.long 0xbe676bd8,0xbddae880,0xbe7c3b28,0xbd2f10a2,0xbe731447,0xbda09ae5,0xbe7fd397,0xbc16c32c
.long 0xbe7b14be,0xbd47c5c2,0xbe7ec46d,0x3cc8bd36,0xbe7f4e6d,0xbc96a905,0xbe791298,0x3d6c9a7f
.long 0xbe7fb10f,0x3c48fb30,0xbe6ed89e,0x3db8442a,0xbe7c3b28,0x3d2f10a2,0xbe604621,0x3df6e0cb
.long 0xbe74fa0b,0x3d94a031,0xbe4d9f02,0x3e187fc0,0xbe6a09a7,0x3dcf7bca,0xbe373a23,0x3e32c8c9
.long 0xbe5b941a,0x3e039c3d,0xbe1d7fd1,0x3e49d112,0xbe49d112,0x3e1d7fd1,0xbe00e7e4,0x3e5d2d53
.long 0xbe6c835e,0xbdc3ef15,0xbe7b14be,0xbd47c5c2,0xbe79c79d,0xbd605c13,0xbe7ffb11,0xbb490e90
.long 0xbe7fb10f,0xbc48fb30,0xbe7c3b28,0x3d2f10a2,0xbe7e1324,0x3cfab273,0xbe6ff573,0x3db263ef
.long 0xbe74fa0b,0x3d94a031,0xbe5b941a,0x3e039c3d,0xbe64aa59,0x3de63375,0xbe3fc767,0x3e299415
.long 0xbe4d9f02,0x3e187fc0,0xbe1d7fd1,0x3e49d112,0xbe3085bb,0x3e396842,0xbdebcbbb,0x3e633c5a
.long 0xbe0e39da,0x3e54db31,0xbd94a031,0x3e74fa0b,0xbdcf7bca,0x3e6a09a7,0xbce1bc2e,0x3e7e70b0
.long 0xbd78cfcc,0x3e7853f8,0x3c96a905,0x3e7f4e6d,0xbc96a905,0x3e7f4e6d,0x3d827dc0,0x3e778bc5
.long 0x3cc8bd36,0x3e7ec46d,0x3ddae880,0x3e676bd8,0x3d888e93,0x3e76ba07,0x3e15f6d9,0x3e4f7a1f
.long 0x3ddae880,0x3e676bd8,0x3e396842,0x3e3085bb,0x3e13682a,0x3e514d3d,0x3e5695e5,0x3e0b9a6b
.p2align 8
.type tbl_p2,@object
tbl_p2:
.long 0x3c00,0x3c00,0x3c00,0x3c00,0x3c00,0x2e463bf6,0x323e3bd9,0x34a53ba8
.long 0x3c00,0x323e3bd9,0x361f3b64,0x38723aa7,0x3c00,0x34a53ba8,0x38723aa7,0x3a2f3913
.long 0x3c00,0x361f3b64,0x39a839a8,0x3b64361f,0x3c00,0x378b3b0e,0x3aa73872,0x3bf62e46
.long 0x3c00,0x38723aa7,0x3b64361f,0x3bd9b23e,0x3c00,0x39133a2f,0x3bd9323e,0x3b0eb78b
.long 0x3c00,0x39a839a8,0x3c000000,0x39a8b9a8,0x3c00,0x3a2f3913,0x3bd9b23e,0x378bbb0e
.long 0x3c00,0x3aa73872,0x3b64b61f,0x323ebbd9,0x3c00,0x3b0e378b,0x3aa7b872,0xae46bbf6
.long 0x3c00,0x3b64361f,0x39a8b9a8,0xb61fbb64,0x3c00,0x3ba834a5,0x3872baa7,0xb913ba2f
.long 0x3c00,0x3bd9323e,0x361fbb64,0xbaa7b872,0x3c00,0x3bf62e46,0x323ebbd9,0xbba8b4a5
.long 0x3c00,0x3c00,0x3c00,0x3c00,0x361f3b64,0x378b3b0e,0x38723aa7,0x39133a2f
.long 0x39a839a8,0x3aa73872,0x3b64361f,0x3bd9323e,0x3b64361f,0x3bf62e46,0x3bd9b23e,0x3b0eb78b
.long 0x3c000000,0x3b64b61f,0x39a8b9a8,0x361fbb64,0x3b64b61f,0x3913ba2f,0x323ebbd9,0xb4a5bba8
.long 0x39a8b9a8,0x323ebbd9,0xb61fbb64,0xbaa7b872,0x361fbb64,0xb4a5bba8,0xbaa7b872,0xbbf62e46
.long 0xbc00,0xb9a8b9a8,0xbc008000,0xb9a839a8,0xb61fbb64,0xbba8b4a5,0xbaa73872,0xae463bf6
.long 0xb9a8b9a8,0xbbd9323e,0xb61f3b64,0x38723aa7,0xbb64b61f,0xba2f3913,0x323e3bd9,0x3ba834a5
.long 0xbc008000,0xb61f3b64,0x39a839a8,0x3b64b61f,0xbb64361f,0x2e463bf6,0x3bd9323e,0x378bbb0e
.long 0xb9a839a8,0x38723aa7,0x3b64b61f,0xb23ebbd9,0xb61f3b64,0x3b0e378b,0x3872baa7,0xba2fb913
.long 0x3c00,0x3c00,0x3c00,0x3c00,0x39a839a8,0x3a2f3913,0x3aa73872,0x3b0e378b
.long 0x3c000000,0x3bd9b23e,0x3b64b61f,0x3aa7b872,0x39a8b9a8,0x378bbb0e,0x323ebbd9,0xae46bbf6
.long 0xbc00,0xb61fbb64,0xb9a8b9a8,0xbb64b61f,0xb9a8b9a8,0xbba8b4a5,0xbbd9323e,0xba2f3913
.long 0xbc008000,0xbaa73872,0xb61f3b64,0x323e3bd9,0xb9a839a8,0xae463bf6,0x38723aa7,0x3ba834a5
.long 0x3c00,0x39a839a8,0x3c000000,0x39a8b9a8,0x39a839a8,0x3bf6ae46,0x3872baa7,0xb4a5bba8
.long 0x3c000000,0x3872baa7,0xb61fbb64,0xbbd9b23e,0x39a8b9a8,0xb4a5bba8,0xbbd9b23e,0xb9133a2f
.long 0xbc00,0xbb64b61f,0xb9a839a8,0x361f3b64,0xb9a8b9a8,0xbb0e378b,0x323e3bd9,0x3bf62e46
.long 0xbc008000,0xb23e3bd9,0x3b64361f,0x3872baa7,0xb9a839a8,0x39133a2f,0x3aa7b872,0xb78bbb0e
.long 0x3c00,0x3c00,0x3c00,0x3c00,0x3b64361f,0x3ba834a5,0x3bd9323e,0x3bf62e46
.long 0x39a8b9a8,0x3872baa7,0x361fbb64,0x323ebbd9,0xb61fbb64,0xb913ba2f,0xbaa7b872,0xbba8b4a5
.long 0xbc008000,0xbb64361f,0xb9a839a8,0xb61f3b64,0xb61f3b64,0x2e463bf6,0x38723aa7,0x3b0e378b
.long 0x39a839a8,0x3bd9323e,0x3b64b61f,0x3872baa7,0x3b64b61f,0x378bbb0e,0xb23ebbd9,0xba2fb913
.long 0xbc00,0xb9a8b9a8,0xbc008000,0xb9a839a8,0xbb64b61f,0xbb0e378b,0xb23e3bd9,0x39133a2f
.long 0xb9a839a8,0x323e3bd9,0x3b64361f,0x3aa7b872,0x361f3b64,0x3bf62e46,0x3872baa7,0xb78bbb0e
.long 0x3c000000,0x361fbb64,0xb9a8b9a8,0xbb64361f,0x361fbb64,0xba2fb913,0xbaa73872,0x34a53ba8
.long 0xb9a8b9a8,0xbaa73872,0x361f3b64,0x3bd9b23e,0xbb64361f,0x34a53ba8,0x3bd9b23e,0xae46bbf6
.long 0x3c008000,0x3c008000,0x3c008000,0x3c008000,0x3c008000,0x3bf6ae46,0x3bd9b23e,0x3ba8b4a5
.long 0x3c008000,0x3bd9b23e,0x3b64b61f,0x3aa7b872,0x3c008000,0x3ba8b4a5,0x3aa7b872,0x3913ba2f
.long 0x3c008000,0x3b64b61f,0x39a8b9a8,0x361fbb64,0x3c008000,0x3b0eb78b,0x3872baa7,0x2e46bbf6
.long 0x3c008000,0x3aa7b872,0x361fbb64,0xb23ebbd9,0x3c008000,0x3a2fb913,0x323ebbd9,0xb78bbb0e
.long 0x3c008000,0x39a8b9a8,0xbc00,0xb9a8b9a8,0x3c008000,0x3913ba2f,0xb23ebbd9,0xbb0eb78b
.long 0x3c008000,0x3872baa7,0xb61fbb64,0xbbd9b23e,0x3c008000,0x378bbb0e,0xb872baa7,0xbbf62e46
.long 0x3c008000,0x361fbb64,0xb9a8b9a8,0xbb64361f,0x3c008000,0x34a5bba8,0xbaa7b872,0xba2f3913
.long 0x3c008000,0x323ebbd9,0xbb64b61f,0xb8723aa7,0x3c008000,0x2e46bbf6,0xbbd9b23e,0xb4a53ba8
.long 0x3c008000,0x3c008000,0x3c008000,0x3c008000,0x3b64b61f,0x3b0eb78b,0x3aa7b872,0x3a2fb913
.long 0x39a8b9a8,0x3872baa7,0x361fbb64,0x323ebbd9,0x361fbb64,0x2e46bbf6,0xb23ebbd9,0xb78bbb0e
.long 0xbc00,0xb61fbb64,0xb9a8b9a8,0xbb64b61f,0xb61fbb64,0xba2fb913,0xbbd9b23e,0xbba834a5
.long 0xb9a8b9a8,0xbbd9b23e,0xbb64361f,0xb8723aa7,0xbb64b61f,0xbba834a5,0xb8723aa7,0x2e463bf6
.long 0xbc008000,0xb9a839a8,0x80003c00,0x39a839a8,0xbb64361f,0xb4a53ba8,0x38723aa7,0x3bf62e46
.long 0xb9a839a8,0x323e3bd9,0x3b64361f,0x3aa7b872,0xb61f3b64,0x39133a2f,0x3bd9b23e,0x34a5bba8
.long 0x80003c00,0x3b64361f,0x39a8b9a8,0xb61fbb64,0x361f3b64,0x3bf6ae46,0x323ebbd9,0xbb0eb78b
.long 0x39a839a8,0x3aa7b872,0xb61fbb64,0xbbd9323e,0x3b64361f,0x378bbb0e,0xbaa7b872,0xb9133a2f
.long 0x3c008000,0x3c008000,0x3c008000,0x3c008000,0x39a8b9a8,0x3913ba2f,0x3872baa7,0x378bbb0e
.long 0xbc00,0xb23ebbd9,0xb61fbb64,0xb872baa7,0xb9a8b9a8,0xbb0eb78b,0xbbd9b23e,0xbbf62e46
.long 0xbc008000,0xbb64361f,0xb9a839a8,0xb61f3b64,0xb9a839a8,0xb4a53ba8,0x323e3bd9,0x39133a2f
.long 0x80003c00,0x38723aa7,0x3b64361f,0x3bd9b23e,0x39a839a8,0x3bf62e46,0x3aa7b872,0x34a5bba8
.long 0x3c008000,0x39a8b9a8,0xbc00,0xb9a8b9a8,0x39a8b9a8,0xae46bbf6,0xbaa7b872,0xbba834a5
.long 0xbc00,0xbaa7b872,0xbb64361f,0xb23e3bd9,0xb9a8b9a8,0xbba834a5,0xb23e3bd9,0x3a2f3913
.long 0xbc008000,0xb61f3b64,0x39a839a8,0x3b64b61f,0xb9a839a8,0x378b3b0e,0x3bd9b23e,0x2e46bbf6
.long 0x80003c00,0x3bd9323e,0x361fbb64,0xbaa7b872,0x39a839a8,0x3a2fb913,0xb872baa7,0xbb0e378b
.long 0x3c008000,0x3c008000,0x3c008000,0x3c008000,0x361fbb64,0x34a5bba8,0x323ebbd9,0x2e46bbf6
.long 0xb9a8b9a8,0xbaa7b872,0xbb64b61f,0xbbd9b23e,0xbb64361f,0xba2f3913,0xb8723aa7,0xb4a53ba8
.long 0x80003c00,0x361f3b64,0x39a839a8,0x3b64361f,0x3b64361f,0x3bf6ae46,0x3aa7b872,0x378bbb0e
.long 0x39a8b9a8,0x323ebbd9,0xb61fbb64,0xbaa7b872,0xb61fbb64,0xbb0eb78b,0xbbd9323e,0xb9133a2f
.long 0xbc008000,0xb9a839a8,0x80003c00,0x39a839a8,0xb61f3b64,0x378b3b0e,0x3bd9323e,0x3a2fb913
.long 0x39a839a8,0x3bd9b23e,0x361fbb64,0xb872baa7,0x3b64b61f,0x2e46bbf6,0xbaa7b872,0xbb0e378b
.long 0xbc00,0xbb64b61f,0xb9a839a8,0x361f3b64,0xbb64b61f,0xb9133a2f,0x38723aa7,0x3ba8b4a5
.long 0xb9a839a8,0x38723aa7,0x3b64b61f,0xb23ebbd9,0x361f3b64,0x3ba8b4a5,0xb23ebbd9,0xbbf62e46
.long 0x3c00,0x3c00,0x3c00,0x3c00,0x3c000000,0x3bf6ae46,0x3bd9b23e,0x3ba8b4a5
.long 0xbc00,0xb23ebbd9,0xb61fbb64,0xb872baa7,0xbc008000,0xbba834a5,0xbaa73872,0xb9133a2f
.long 0x3c00,0x361f3b64,0x39a839a8,0x3b64361f,0x3c000000,0x3b0eb78b,0x3872baa7,0x2e46bbf6
.long 0xbc00,0xb872baa7,0xbb64b61f,0xbbd9323e,0xbc008000,0xba2f3913,0xb23e3bd9,0x378b3b0e
.long 0x3c00,0x39a839a8,0x3c000000,0x39a8b9a8,0x3c000000,0x3913ba2f,0xb23ebbd9,0xbb0eb78b
.long 0xbc00,0xbaa7b872,0xbb64361f,0xb23e3bd9,0xbc008000,0xb78b3b0e,0x38723aa7,0x3bf6ae46
.long 0x3c00,0x3b64361f,0x39a8b9a8,0xb61fbb64,0x3c000000,0x34a5bba8,0xbaa7b872,0xba2f3913
.long 0xbc00,0xbbd9b23e,0xb61f3b64,0x3aa73872,0xbc008000,0xae463bf6,0x3bd9323e,0x34a5bba8
.long 0x3c00,0x3c00,0x3c00,0x3c00,0x3b64b61f,0x3b0eb78b,0x3aa7b872,0x3a2fb913
.long 0xb9a8b9a8,0xbaa7b872,0xbb64b61f,0xbbd9b23e,0xb61f3b64,0xae463bf6,0x323e3bd9,0x378b3b0e
.long 0x3c000000,0x3b64b61f,0x39a8b9a8,0x361fbb64,0xb61fbb64,0xba2fb913,0xbbd9b23e,0xbba834a5
.long 0xb9a839a8,0xb23e3bd9,0x361f3b64,0x3aa73872,0x3b64361f,0x3ba8b4a5,0x3872baa7,0xae46bbf6
.long 0xbc00,0xb9a8b9a8,0xbc008000,0xb9a839a8,0xbb64361f,0xb4a53ba8,0x38723aa7,0x3bf62e46
.long 0x39a839a8,0x3bd9b23e,0x361fbb64,0xb872baa7,0x361fbb64,0xb913ba2f,0xbbd9323e,0xb4a53ba8
.long 0xbc008000,0xb61f3b64,0x39a839a8,0x3b64b61f,0x361f3b64,0x3bf6ae46,0x323ebbd9,0xbb0eb78b
.long 0x39a8b9a8,0xb872baa7,0xbb64361f,0x323e3bd9,0xbb64b61f,0xb78b3b0e,0x3aa73872,0x3913ba2f
.long 0x3c00,0x3c00,0x3c00,0x3c00,0x39a8b9a8,0x3913ba2f,0x3872baa7,0x378bbb0e
.long 0xbc008000,0xbbd9323e,0xbb64361f,0xbaa73872,0x39a839a8,0x3b0e378b,0x3bd9323e,0x3bf6ae46
.long 0xbc00,0xb61fbb64,0xb9a8b9a8,0xbb64b61f,0xb9a839a8,0xb4a53ba8,0x323e3bd9,0x39133a2f
.long 0x3c000000,0x3aa7b872,0x361fbb64,0xb23ebbd9,0xb9a8b9a8,0xbbf6ae46,0xbaa73872,0xb4a53ba8
.long 0x3c00,0x39a839a8,0x3c000000,0x39a8b9a8,0x39a8b9a8,0xae46bbf6,0xbaa7b872,0xbba834a5
.long 0xbc008000,0xb8723aa7,0x361f3b64,0x3bd9323e,0x39a839a8,0x3ba8b4a5,0x323ebbd9,0xba2fb913
.long 0xbc00,0xbb64b61f,0xb9a839a8,0x361f3b64,0xb9a839a8,0x378b3b0e,0x3bd9b23e,0x2e46bbf6
.long 0x3c000000,0x323ebbd9,0xbb64b61f,0xb8723aa7,0xb9a8b9a8,0xba2f3913,0x38723aa7,0x3b0eb78b
.long 0x3c00,0x3c00,0x3c00,0x3c00,0x361fbb64,0x34a5bba8,0x323ebbd9,0x2e46bbf6
.long 0xb9a839a8,0xb8723aa7,0xb61f3b64,0xb23e3bd9,0x3b64b61f,0x3a2fb913,0x3872baa7,0x34a5bba8
.long 0xbc008000,0xbb64361f,0xb9a839a8,0xb61f3b64,0x3b64361f,0x3bf6ae46,0x3aa7b872,0x378bbb0e
.long 0xb9a8b9a8,0xbbd9b23e,0xbb64361f,0xb8723aa7,0x361f3b64,0x3b0e378b,0x3bd9b23e,0x3913ba2f
.long 0xbc00,0xb9a8b9a8,0xbc008000,0xb9a839a8,0xb61f3b64,0x378b3b0e,0x3bd9323e,0x3a2fb913
.long 0x39a8b9a8,0xb23ebbd9,0xbb64b61f,0xbaa73872,0xbb64361f,0xae463bf6,0x3aa73872,0x3b0eb78b
.long 0x3c000000,0x361fbb64,0xb9a8b9a8,0xbb64361f,0xbb64b61f,0xb9133a2f,0x38723aa7,0x3ba8b4a5
.long 0x39a839a8,0x3aa7b872,0xb61fbb64,0xbbd9323e,0xb61fbb64,0xbba834a5,0x323e3bd9,0x3bf6ae46
.long 0x3c008000,0x3c008000,0x3c008000,0x3c008000,0xbc00,0xae46bbf6,0xb23ebbd9,0xb4a5bba8
.long 0xbc008000,0xbbd9323e,0xbb64361f,0xbaa73872,0x80003c00,0x34a53ba8,0x38723aa7,0x3a2f3913
.long 0x3c008000,0x3b64b61f,0x39a8b9a8,0x361fbb64,0xbc00,0xb78bbb0e,0xbaa7b872,0xbbf6ae46
.long 0xbc008000,0xbaa73872,0xb61f3b64,0x323e3bd9,0x80003c00,0x39133a2f,0x3bd9323e,0x3b0eb78b
.long 0x3c008000,0x39a8b9a8,0xbc00,0xb9a8b9a8,0xbc00,0xba2fb913,0xbbd9323e,0xb78b3b0e
.long 0xbc008000,0xb8723aa7,0x361f3b64,0x3bd9323e,0x80003c00,0x3b0e378b,0x3aa7b872,0xae46bbf6
.long 0x3c008000,0x361fbb64,0xb9a8b9a8,0xbb64361f,0xbc00,0xbba8b4a5,0xb8723aa7,0x39133a2f
.long 0xbc008000,0xb23e3bd9,0x3b64361f,0x3872baa7,0x80003c00,0x3bf62e46,0x323ebbd9,0xbba8b4a5
.long 0x3c008000,0x3c008000,0x3c008000,0x3c008000,0xb61fbb64,0xb78bbb0e,0xb872baa7,0xb913ba2f
.long 0xb9a839a8,0xb8723aa7,0xb61f3b64,0xb23e3bd9,0x3b64361f,0x3bf62e46,0x3bd9b23e,0x3b0eb78b
.long 0xbc00,0xb61fbb64,0xb9a8b9a8,0xbb64b61f,0xbb64361f,0xb9133a2f,0xb23e3bd9,0x34a53ba8
.long 0x39a839a8,0x3bd9323e,0x3b64b61f,0x3872baa7,0x361fbb64,0xb4a5bba8,0xbaa7b872,0xbbf62e46
.long 0xbc008000,0xb9a839a8,0x80003c00,0x39a839a8,0x361f3b64,0x3ba834a5,0x3aa7b872,0x2e46bbf6
.long 0x39a8b9a8,0xb23ebbd9,0xbb64b61f,0xbaa73872,0xbb64b61f,0xba2f3913,0x323e3bd9,0x3ba834a5
.long 0x80003c00,0x3b64361f,0x39a8b9a8,0xb61fbb64,0x3b64b61f,0xae46bbf6,0xbbd9b23e,0xb78b3b0e
.long 0xb9a8b9a8,0xbaa73872,0x361f3b64,0x3bd9b23e,0xb61f3b64,0x3b0e378b,0x3872baa7,0xba2fb913
.long 0x3c008000,0x3c008000,0x3c008000,0x3c008000,0xb9a8b9a8,0xba2fb913,0xbaa7b872,0xbb0eb78b
.long 0x80003c00,0x323e3bd9,0x361f3b64,0x38723aa7,0x39a8b9a8,0x378bbb0e,0x323ebbd9,0xae46bbf6
.long 0xbc008000,0xbb64361f,0xb9a839a8,0xb61f3b64,0x39a839a8,0x3ba834a5,0x3bd9b23e,0x3a2fb913
.long 0xbc00,0xb872baa7,0xbb64b61f,0xbbd9323e,0xb9a839a8,0xae463bf6,0x38723aa7,0x3ba834a5
.long 0x3c008000,0x39a8b9a8,0xbc00,0xb9a8b9a8,0xb9a8b9a8,0xbbf62e46,0xb8723aa7,0x34a53ba8
.long 0x80003c00,0x3aa73872,0x3b64b61f,0x323ebbd9,0x39a8b9a8,0xb4a5bba8,0xbbd9b23e,0xb9133a2f
.long 0xbc008000,0xb61f3b64,0x39a839a8,0x3b64b61f,0x39a839a8,0x3b0eb78b,0xb23ebbd9,0xbbf6ae46
.long 0xbc00,0xbbd9b23e,0xb61f3b64,0x3aa73872,0xb9a839a8,0x39133a2f,0x3aa7b872,0xb78bbb0e
.long 0x3c008000,0x3c008000,0x3c008000,0x3c008000,0xbb64b61f,0xbba8b4a5,0xbbd9b23e,0xbbf6ae46
.long 0x39a839a8,0x3aa73872,0x3b64361f,0x3bd9323e,0xb61fbb64,0xb913ba2f,0xbaa7b872,0xbba8b4a5
.long 0x80003c00,0x361f3b64,0x39a839a8,0x3b64361f,0x361fbb64,0xae46bbf6,0xb872baa7,0xbb0eb78b
.long 0xb9a839a8,0xb23e3bd9,0x361f3b64,0x3aa73872,0x3b64b61f,0x378bbb0e,0xb23ebbd9,0xba2fb913
.long 0xbc008000,0xb9a839a8,0x80003c00,0x39a839a8,0x3b64361f,0x3b0eb78b,0x323ebbd9,0xb913ba2f
.long 0xb9a8b9a8,0xbbd9323e,0xb61f3b64,0x38723aa7,0x361f3b64,0x3bf62e46,0x3872baa7,0xb78bbb0e
.long 0xbc00,0xbb64b61f,0xb9a839a8,0x361f3b64,0xb61f3b64,0x3a2f3913,0x3aa7b872,0xb4a5bba8
.long 0x39a8b9a8,0xb872baa7,0xbb64361f,0x323e3bd9,0xbb64361f,0x34a53ba8,0x3bd9b23e,0xae46bbf6
.long 0x3c00,0x3c00,0x3c00,0x3c00,0xbc00,0xae46bbf6,0xb23ebbd9,0xb4a5bba8
.long 0x3c00,0x323e3bd9,0x361f3b64,0x38723aa7,0xbc00,0xb4a5bba8,0xb872baa7,0xba2fb913
.long 0x3c00,0x361f3b64,0x39a839a8,0x3b64361f,0xbc00,0xb78bbb0e,0xbaa7b872,0xbbf6ae46
.long 0x3c00,0x38723aa7,0x3b64361f,0x3bd9b23e,0xbc00,0xb913ba2f,0xbbd9b23e,0xbb0e378b
.long 0x3c00,0x39a839a8,0x3c000000,0x39a8b9a8,0xbc00,0xba2fb913,0xbbd9323e,0xb78b3b0e
.long 0x3c00,0x3aa73872,0x3b64b61f,0x323ebbd9,0xbc00,0xbb0eb78b,0xbaa73872,0x2e463bf6
.long 0x3c00,0x3b64361f,0x39a8b9a8,0xb61fbb64,0xbc00,0xbba8b4a5,0xb8723aa7,0x39133a2f
.long 0x3c00,0x3bd9323e,0x361fbb64,0xbaa7b872,0xbc00,0xbbf6ae46,0xb23e3bd9,0x3ba834a5
.long 0x3c00,0x3c00,0x3c00,0x3c00,0xb61fbb64,0xb78bbb0e,0xb872baa7,0xb913ba2f
.long 0x39a839a8,0x3aa73872,0x3b64361f,0x3bd9323e,0xbb64b61f,0xbbf6ae46,0xbbd9323e,0xbb0e378b
.long 0x3c000000,0x3b64b61f,0x39a8b9a8,0x361fbb64,0xbb64361f,0xb9133a2f,0xb23e3bd9,0x34a53ba8
.long 0x39a8b9a8,0x323ebbd9,0xb61fbb64,0xbaa7b872,0xb61f3b64,0x34a53ba8,0x3aa73872,0x3bf6ae46
.long 0xbc00,0xb9a8b9a8,0xbc008000,0xb9a839a8,0x361f3b64,0x3ba834a5,0x3aa7b872,0x2e46bbf6
.long 0xb9a8b9a8,0xbbd9323e,0xb61f3b64,0x38723aa7,0x3b64361f,0x3a2fb913,0xb23ebbd9,0xbba8b4a5
.long 0xbc008000,0xb61f3b64,0x39a839a8,0x3b64b61f,0x3b64b61f,0xae46bbf6,0xbbd9b23e,0xb78b3b0e
.long 0xb9a839a8,0x38723aa7,0x3b64b61f,0xb23ebbd9,0x361fbb64,0xbb0eb78b,0xb8723aa7,0x3a2f3913
.long 0x3c00,0x3c00,0x3c00,0x3c00,0xb9a8b9a8,0xba2fb913,0xbaa7b872,0xbb0eb78b
.long 0x3c000000,0x3bd9b23e,0x3b64b61f,0x3aa7b872,0xb9a839a8,0xb78b3b0e,0xb23e3bd9,0x2e463bf6
.long 0xbc00,0xb61fbb64,0xb9a8b9a8,0xbb64b61f,0x39a839a8,0x3ba834a5,0x3bd9b23e,0x3a2fb913
.long 0xbc008000,0xbaa73872,0xb61f3b64,0x323e3bd9,0x39a8b9a8,0x2e46bbf6,0xb872baa7,0xbba8b4a5
.long 0x3c00,0x39a839a8,0x3c000000,0x39a8b9a8,0xb9a8b9a8,0xbbf62e46,0xb8723aa7,0x34a53ba8
.long 0x3c000000,0x3872baa7,0xb61fbb64,0xbbd9b23e,0xb9a839a8,0x34a53ba8,0x3bd9323e,0x3913ba2f
.long 0xbc00,0xbb64b61f,0xb9a839a8,0x361f3b64,0x39a839a8,0x3b0eb78b,0xb23ebbd9,0xbbf6ae46
.long 0xbc008000,0xb23e3bd9,0x3b64361f,0x3872baa7,0x39a8b9a8,0xb913ba2f,0xbaa73872,0x378b3b0e
.long 0x3c00,0x3c00,0x3c00,0x3c00,0xbb64b61f,0xbba8b4a5,0xbbd9b23e,0xbbf6ae46
.long 0x39a8b9a8,0x3872baa7,0x361fbb64,0x323ebbd9,0x361f3b64,0x39133a2f,0x3aa73872,0x3ba834a5
.long 0xbc008000,0xbb64361f,0xb9a839a8,0xb61f3b64,0x361fbb64,0xae46bbf6,0xb872baa7,0xbb0eb78b
.long 0x39a839a8,0x3bd9323e,0x3b64b61f,0x3872baa7,0xbb64361f,0xb78b3b0e,0x323e3bd9,0x3a2f3913
.long 0xbc00,0xb9a8b9a8,0xbc008000,0xb9a839a8,0x3b64361f,0x3b0eb78b,0x323ebbd9,0xb913ba2f
.long 0xb9a839a8,0x323e3bd9,0x3b64361f,0x3aa7b872,0xb61fbb64,0xbbf6ae46,0xb8723aa7,0x378b3b0e
.long 0x3c000000,0x361fbb64,0xb9a8b9a8,0xbb64361f,0xb61f3b64,0x3a2f3913,0x3aa7b872,0xb4a5bba8
.long 0xb9a8b9a8,0xbaa73872,0x361f3b64,0x3bd9b23e,0x3b64b61f,0xb4a5bba8,0xbbd9323e,0x2e463bf6
.long 0x3c008000,0x3c008000,0x3c008000,0x3c008000,0xbc008000,0xbbf62e46,0xbbd9323e,0xbba834a5
.long 0x3c008000,0x3bd9b23e,0x3b64b61f,0x3aa7b872,0xbc008000,0xbba834a5,0xbaa73872,0xb9133a2f
.long 0x3c008000,0x3b64b61f,0x39a8b9a8,0x361fbb64,0xbc008000,0xbb0e378b,0xb8723aa7,0xae463bf6
.long 0x3c008000,0x3aa7b872,0x361fbb64,0xb23ebbd9,0xbc008000,0xba2f3913,0xb23e3bd9,0x378b3b0e
.long 0x3c008000,0x39a8b9a8,0xbc00,0xb9a8b9a8,0xbc008000,0xb9133a2f,0x323e3bd9,0x3b0e378b
.long 0x3c008000,0x3872baa7,0xb61fbb64,0xbbd9b23e,0xbc008000,0xb78b3b0e,0x38723aa7,0x3bf6ae46
.long 0x3c008000,0x361fbb64,0xb9a8b9a8,0xbb64361f,0xbc008000,0xb4a53ba8,0x3aa73872,0x3a2fb913
.long 0x3c008000,0x323ebbd9,0xbb64b61f,0xb8723aa7,0xbc008000,0xae463bf6,0x3bd9323e,0x34a5bba8
.long 0x3c008000,0x3c008000,0x3c008000,0x3c008000,0xbb64361f,0xbb0e378b,0xbaa73872,0xba2f3913
.long 0x39a8b9a8,0x3872baa7,0x361fbb64,0x323ebbd9,0xb61f3b64,0xae463bf6,0x323e3bd9,0x378b3b0e
.long 0xbc00,0xb61fbb64,0xb9a8b9a8,0xbb64b61f,0x361f3b64,0x3a2f3913,0x3bd9323e,0x3ba8b4a5
.long 0xb9a8b9a8,0xbbd9b23e,0xbb64361f,0xb8723aa7,0x3b64361f,0x3ba8b4a5,0x3872baa7,0xae46bbf6
.long 0xbc008000,0xb9a839a8,0x80003c00,0x39a839a8,0x3b64b61f,0x34a5bba8,0xb872baa7,0xbbf6ae46
.long 0xb9a839a8,0x323e3bd9,0x3b64361f,0x3aa7b872,0x361fbb64,0xb913ba2f,0xbbd9323e,0xb4a53ba8
.long 0x80003c00,0x3b64361f,0x39a8b9a8,0xb61fbb64,0xb61fbb64,0xbbf62e46,0xb23e3bd9,0x3b0e378b
.long 0x39a839a8,0x3aa7b872,0xb61fbb64,0xbbd9323e,0xbb64b61f,0xb78b3b0e,0x3aa73872,0x3913ba2f
.long 0x3c008000,0x3c008000,0x3c008000,0x3c008000,0xb9a839a8,0xb9133a2f,0xb8723aa7,0xb78b3b0e
.long 0xbc00,0xb23ebbd9,0xb61fbb64,0xb872baa7,0x39a839a8,0x3b0e378b,0x3bd9323e,0x3bf6ae46
.long 0xbc008000,0xbb64361f,0xb9a839a8,0xb61f3b64,0x39a8b9a8,0x34a5bba8,0xb23ebbd9,0xb913ba2f
.long 0x80003c00,0x38723aa7,0x3b64361f,0x3bd9b23e,0xb9a8b9a8,0xbbf6ae46,0xbaa73872,0xb4a53ba8
.long 0x3c008000,0x39a8b9a8,0xbc00,0xb9a8b9a8,0xb9a839a8,0x2e463bf6,0x3aa73872,0x3ba8b4a5
.long 0xbc00,0xbaa7b872,0xbb64361f,0xb23e3bd9,0x39a839a8,0x3ba8b4a5,0x323ebbd9,0xba2fb913
.long 0xbc008000,0xb61f3b64,0x39a839a8,0x3b64b61f,0x39a8b9a8,0xb78bbb0e,0xbbd9323e,0xae463bf6
.long 0x80003c00,0x3bd9323e,0x361fbb64,0xbaa7b872,0xb9a8b9a8,0xba2f3913,0x38723aa7,0x3b0eb78b
.long 0x3c008000,0x3c008000,0x3c008000,0x3c008000,0xb61f3b64,0xb4a53ba8,0xb23e3bd9,0xae463bf6
.long 0xb9a8b9a8,0xbaa7b872,0xbb64b61f,0xbbd9b23e,0x3b64b61f,0x3a2fb913,0x3872baa7,0x34a5bba8
.long 0x80003c00,0x361f3b64,0x39a839a8,0x3b64361f,0xbb64b61f,0xbbf62e46,0xbaa73872,0xb78b3b0e
.long 0x39a8b9a8,0x323ebbd9,0xb61fbb64,0xbaa7b872,0x361f3b64,0x3b0e378b,0x3bd9b23e,0x3913ba2f
.long 0xbc008000,0xb9a839a8,0x80003c00,0x39a839a8,0x361fbb64,0xb78bbb0e,0xbbd9b23e,0xba2f3913
.long 0x39a839a8,0x3bd9b23e,0x361fbb64,0xb872baa7,0xbb64361f,0xae463bf6,0x3aa73872,0x3b0eb78b
.long 0xbc00,0xbb64b61f,0xb9a839a8,0x361f3b64,0x3b64361f,0x3913ba2f,0xb872baa7,0xbba834a5
.long 0xb9a839a8,0x38723aa7,0x3b64b61f,0xb23ebbd9,0xb61fbb64,0xbba834a5,0x323e3bd9,0x3bf6ae46
.long 0x3c00,0x3c00,0x3c00,0x3c00,0xbc008000,0xbbf62e46,0xbbd9323e,0xbba834a5
.long 0xbc00,0xb23ebbd9,0xb61fbb64,0xb872baa7,0x3c000000,0x3ba8b4a5,0x3aa7b872,0x3913ba2f
.long 0x3c00,0x361f3b64,0x39a839a8,0x3b64361f,0xbc008000,0xbb0e378b,0xb8723aa7,0xae463bf6
.long 0xbc00,0xb872baa7,0xbb64b61f,0xbbd9323e,0x3c000000,0x3a2fb913,0x323ebbd9,0xb78bbb0e
.long 0x3c00,0x39a839a8,0x3c000000,0x39a8b9a8,0xbc008000,0xb9133a2f,0x323e3bd9,0x3b0e378b
.long 0xbc00,0xbaa7b872,0xbb64361f,0xb23e3bd9,0x3c000000,0x378bbb0e,0xb872baa7,0xbbf62e46
.long 0x3c00,0x3b64361f,0x39a8b9a8,0xb61fbb64,0xbc008000,0xb4a53ba8,0x3aa73872,0x3a2fb913
.long 0xbc00,0xbbd9b23e,0xb61f3b64,0x3aa73872,0x3c000000,0x2e46bbf6,0xbbd9b23e,0xb4a53ba8
.long 0x3c00,0x3c00,0x3c00,0x3c00,0xbb64361f,0xbb0e378b,0xbaa73872,0xba2f3913
.long 0xb9a8b9a8,0xbaa7b872,0xbb64b61f,0xbbd9b23e,0x361fbb64,0x2e46bbf6,0xb23ebbd9,0xb78bbb0e
.long 0x3c000000,0x3b64b61f,0x39a8b9a8,0x361fbb64,0x361f3b64,0x3a2f3913,0x3bd9323e,0x3ba8b4a5
.long 0xb9a839a8,0xb23e3bd9,0x361f3b64,0x3aa73872,0xbb64b61f,0xbba834a5,0xb8723aa7,0x2e463bf6
.long 0xbc00,0xb9a8b9a8,0xbc008000,0xb9a839a8,0x3b64b61f,0x34a5bba8,0xb872baa7,0xbbf6ae46
.long 0x39a839a8,0x3bd9b23e,0x361fbb64,0xb872baa7,0xb61f3b64,0x39133a2f,0x3bd9b23e,0x34a5bba8
.long 0xbc008000,0xb61f3b64,0x39a839a8,0x3b64b61f,0xb61fbb64,0xbbf62e46,0xb23e3bd9,0x3b0e378b
.long 0x39a8b9a8,0xb872baa7,0xbb64361f,0x323e3bd9,0x3b64361f,0x378bbb0e,0xbaa7b872,0xb9133a2f
.long 0x3c00,0x3c00,0x3c00,0x3c00,0xb9a839a8,0xb9133a2f,0xb8723aa7,0xb78b3b0e
.long 0xbc008000,0xbbd9323e,0xbb64361f,0xbaa73872,0xb9a8b9a8,0xbb0eb78b,0xbbd9b23e,0xbbf62e46
.long 0xbc00,0xb61fbb64,0xb9a8b9a8,0xbb64b61f,0x39a8b9a8,0x34a5bba8,0xb23ebbd9,0xb913ba2f
.long 0x3c000000,0x3aa7b872,0x361fbb64,0xb23ebbd9,0x39a839a8,0x3bf62e46,0x3aa7b872,0x34a5bba8
.long 0x3c00,0x39a839a8,0x3c000000,0x39a8b9a8,0xb9a839a8,0x2e463bf6,0x3aa73872,0x3ba8b4a5
.long 0xbc008000,0xb8723aa7,0x361f3b64,0x3bd9323e,0xb9a8b9a8,0xbba834a5,0xb23e3bd9,0x3a2f3913
.long 0xbc00,0xbb64b61f,0xb9a839a8,0x361f3b64,0x39a8b9a8,0xb78bbb0e,0xbbd9323e,0xae463bf6
.long 0x3c000000,0x323ebbd9,0xbb64b61f,0xb8723aa7,0x39a839a8,0x3a2fb913,0xb872baa7,0xbb0e378b
.long 0x3c00,0x3c00,0x3c00,0x3c00,0xb61f3b64,0xb4a53ba8,0xb23e3bd9,0xae463bf6
.long 0xb9a839a8,0xb8723aa7,0xb61f3b64,0xb23e3bd9,0xbb64361f,0xba2f3913,0xb8723aa7,0xb4a53ba8
.long 0xbc008000,0xbb64361f,0xb9a839a8,0xb61f3b64,0xbb64b61f,0xbbf62e46,0xbaa73872,0xb78b3b0e
.long 0xb9a8b9a8,0xbbd9b23e,0xbb64361f,0xb8723aa7,0xb61fbb64,0xbb0eb78b,0xbbd9323e,0xb9133a2f
.long 0xbc00,0xb9a8b9a8,0xbc008000,0xb9a839a8,0x361fbb64,0xb78bbb0e,0xbbd9b23e,0xba2f3913
.long 0x39a8b9a8,0xb23ebbd9,0xbb64b61f,0xbaa73872,0x3b64b61f,0x2e46bbf6,0xbaa7b872,0xbb0e378b
.long 0x3c000000,0x361fbb64,0xb9a8b9a8,0xbb64361f,0x3b64361f,0x3913ba2f,0xb872baa7,0xbba834a5
.long 0x39a839a8,0x3aa7b872,0xb61fbb64,0xbbd9323e,0x361f3b64,0x3ba8b4a5,0xb23ebbd9,0xbbf62e46
.long 0x3c008000,0x3c008000,0x3c008000,0x3c008000,0x80003c00,0x2e463bf6,0x323e3bd9,0x34a53ba8
.long 0xbc008000,0xbbd9323e,0xbb64361f,0xbaa73872,0xbc00,0xb4a5bba8,0xb872baa7,0xba2fb913
.long 0x3c008000,0x3b64b61f,0x39a8b9a8,0x361fbb64,0x80003c00,0x378b3b0e,0x3aa73872,0x3bf62e46
.long 0xbc008000,0xbaa73872,0xb61f3b64,0x323e3bd9,0xbc00,0xb913ba2f,0xbbd9b23e,0xbb0e378b
.long 0x3c008000,0x39a8b9a8,0xbc00,0xb9a8b9a8,0x80003c00,0x3a2f3913,0x3bd9b23e,0x378bbb0e
.long 0xbc008000,0xb8723aa7,0x361f3b64,0x3bd9323e,0xbc00,0xbb0eb78b,0xbaa73872,0x2e463bf6
.long 0x3c008000,0x361fbb64,0xb9a8b9a8,0xbb64361f,0x80003c00,0x3ba834a5,0x3872baa7,0xb913ba2f
.long 0xbc008000,0xb23e3bd9,0x3b64361f,0x3872baa7,0xbc00,0xbbf6ae46,0xb23e3bd9,0x3ba834a5
.long 0x3c008000,0x3c008000,0x3c008000,0x3c008000,0x361f3b64,0x378b3b0e,0x38723aa7,0x39133a2f
.long 0xb9a839a8,0xb8723aa7,0xb61f3b64,0xb23e3bd9,0xbb64b61f,0xbbf6ae46,0xbbd9323e,0xbb0e378b
.long 0xbc00,0xb61fbb64,0xb9a8b9a8,0xbb64b61f,0x3b64b61f,0x3913ba2f,0x323ebbd9,0xb4a5bba8
.long 0x39a839a8,0x3bd9323e,0x3b64b61f,0x3872baa7,0xb61f3b64,0x34a53ba8,0x3aa73872,0x3bf6ae46
.long 0xbc008000,0xb9a839a8,0x80003c00,0x39a839a8,0xb61fbb64,0xbba8b4a5,0xbaa73872,0xae463bf6
.long 0x39a8b9a8,0xb23ebbd9,0xbb64b61f,0xbaa73872,0x3b64361f,0x3a2fb913,0xb23ebbd9,0xbba8b4a5
.long 0x80003c00,0x3b64361f,0x39a8b9a8,0xb61fbb64,0xbb64361f,0x2e463bf6,0x3bd9323e,0x378bbb0e
.long 0xb9a8b9a8,0xbaa73872,0x361f3b64,0x3bd9b23e,0x361fbb64,0xbb0eb78b,0xb8723aa7,0x3a2f3913
.long 0x3c008000,0x3c008000,0x3c008000,0x3c008000,0x39a839a8,0x3a2f3913,0x3aa73872,0x3b0e378b
.long 0x80003c00,0x323e3bd9,0x361f3b64,0x38723aa7,0xb9a839a8,0xb78b3b0e,0xb23e3bd9,0x2e463bf6
.long 0xbc008000,0xbb64361f,0xb9a839a8,0xb61f3b64,0xb9a8b9a8,0xbba8b4a5,0xbbd9323e,0xba2f3913
.long 0xbc00,0xb872baa7,0xbb64b61f,0xbbd9323e,0x39a8b9a8,0x2e46bbf6,0xb872baa7,0xbba8b4a5
.long 0x3c008000,0x39a8b9a8,0xbc00,0xb9a8b9a8,0x39a839a8,0x3bf6ae46,0x3872baa7,0xb4a5bba8
.long 0x80003c00,0x3aa73872,0x3b64b61f,0x323ebbd9,0xb9a839a8,0x34a53ba8,0x3bd9323e,0x3913ba2f
.long 0xbc008000,0xb61f3b64,0x39a839a8,0x3b64b61f,0xb9a8b9a8,0xbb0e378b,0x323e3bd9,0x3bf62e46
.long 0xbc00,0xbbd9b23e,0xb61f3b64,0x3aa73872,0x39a8b9a8,0xb913ba2f,0xbaa73872,0x378b3b0e
.long 0x3c008000,0x3c008000,0x3c008000,0x3c008000,0x3b64361f,0x3ba834a5,0x3bd9323e,0x3bf62e46
.long 0x39a839a8,0x3aa73872,0x3b64361f,0x3bd9323e,0x361f3b64,0x39133a2f,0x3aa73872,0x3ba834a5
.long 0x80003c00,0x361f3b64,0x39a839a8,0x3b64361f,0xb61f3b64,0x2e463bf6,0x38723aa7,0x3b0e378b
.long 0xb9a839a8,0xb23e3bd9,0x361f3b64,0x3aa73872,0xbb64361f,0xb78b3b0e,0x323e3bd9,0x3a2f3913
.long 0xbc008000,0xb9a839a8,0x80003c00,0x39a839a8,0xbb64b61f,0xbb0e378b,0xb23e3bd9,0x39133a2f
.long 0xb9a8b9a8,0xbbd9323e,0xb61f3b64,0x38723aa7,0xb61fbb64,0xbbf6ae46,0xb8723aa7,0x378b3b0e
.long 0xbc00,0xbb64b61f,0xb9a839a8,0x361f3b64,0x361fbb64,0xba2fb913,0xbaa73872,0x34a53ba8
.long 0x39a8b9a8,0xb872baa7,0xbb64361f,0x323e3bd9,0x3b64b61f,0xb4a5bba8,0xbbd9323e,0x2e463bf6
.long 0x3e000000,0x80000000,0x3e000000,0x80000000,0x3e000000,0x80000000,0x3dffffb1,0xb9c90fc6
.long 0x3e000000,0x80000000,0x3dfffec4,0xba490f88,0x3e000000,0x80000000,0x3dfffd39,0xba96cb58
.long 0x3e000000,0x80000000,0x3dfffb11,0xbac90e90,0x3e000000,0x80000000,0x3dfff84a,0xbafb514b
.long 0x3e000000,0x80000000,0x3dfff4e6,0xbb16c9b6,0x3e000000,0x80000000,0x3dfff0e3,0xbb2fea69
.long 0x3e000000,0x80000000,0x3dffec43,0xbb490ab0,0x3e000000,0x80000000,0x3dffe705,0xbb622a7a
.long 0x3e000000,0x80000000,0x3dffe129,0xbb7b49ba,0x3e000000,0x80000000,0x3dffdaaf,0xbb8a342f
.long 0x3e000000,0x80000000,0x3dffd397,0xbb96c32c,0x3e000000,0x80000000,0x3dffcbe2,0xbba351cb
.long 0x3e000000,0x80000000,0x3dffc38f,0xbbafe007,0x3e000000,0x80000000,0x3dffba9e,0xbbbc6dd5
.long 0x3e000000,0x80000000,0x3e000000,0x80000000,0x3dfffb11,0xbac90e90,0x3dfff84a,0xbafb514b
.long 0x3dffec43,0xbb490ab0,0x3dffe129,0xbb7b49ba,0x3dffd397,0xbb96c32c,0x3dffba9e,0xbbbc6dd5
.long 0x3dffb10f,0xbbc8fb30,0x3dff84ab,0xbbfb2b74,0x3dff84ab,0xbbfb2b74,0x3dff3f54,0xbc1cecf9
.long 0x3dff4e6d,0xbc16a905,0x3dfeea9d,0xbc3c3ac3,0x3dff0e58,0xbc2fb680,0x3dfe868b,0xbc5b7d37
.long 0x3dfec46d,0xbc48bd36,0x3dfe1324,0xbc7ab273,0x3dfe70b0,0xbc61bc2e,0x3dfd906e,0xbc8cec4a
.long 0x3dfe1324,0xbc7ab273,0x3dfcfe73,0xbc9c76de,0x3dfdabcc,0xbc89cf86,0x3dfc5d3a,0xbcabf804
.long 0x3dfd3aac,0xbc964083,0x3dfbaccd,0xbcbb6ecf,0x3dfcbfc9,0xbca2abb6,0x3dfaed37,0xbccada4f
.long 0x3dfc3b28,0xbcaf10a2,0x3dfa1e84,0xbcda3997,0x3dfbaccd,0xbcbb6ecf,0x3df940c0,0xbce98bba
.long 0x3e000000,0x80000000,0x3e000000,0x80000000,0x3dffec43,0xbb490ab0,0x3dffe705,0xbb622a7a
.long 0x3dffb10f,0xbbc8fb30,0x3dff9c18,0xbbe21469,0x3dff4e6d,0xbc16a905,0x3dff1f49,0xbc2973ba
.long 0x3dfec46d,0xbc48bd36,0x3dfe70b0,0xbc61bc2e,0x3dfe1324,0xbc7ab273,0x3dfd906e,0xbc8cec4a
.long 0x3dfd3aac,0xbc964083,0x3dfc7eb0,0xbca8defc,0x3dfc3b28,0xbcaf10a2,0x3dfb3bab,0xbcc4b0b9
.long 0x3dfb14be,0xbcc7c5c2,0x3df9c79d,0xbce05c13,0x3df9c79d,0xbce05c13,0x3df822d1,0xbcfbdba4
.long 0x3df853f8,0xbcf8cfcc,0x3df64d97,0xbd0b9507,0x3df6ba07,0xbd088e93,0x3df4484b,0xbd1920fe
.long 0x3df4fa0b,0xbd14a031,0x3df21352,0xbd268f12,0x3df31447,0xbd209ae5,0x3defaf1b,0xbd33dca5
.long 0x3df10908,0xbd2c7cd4,0x3ded1c1d,0xbd41071e,0x3deed89e,0xbd38442a,0x3dea5ad9,0xbd4e0bea
.long 0x3e000000,0x80000000,0x3e000000,0x80000000,0x3dffd397,0xbb96c32c,0x3dffcbe2,0xbba351cb
.long 0x3dff4e6d,0xbc16a905,0x3dff2f9d,0xbc23308c,0x3dfe70b0,0xbc61bc2e,0x3dfe2b72,0xbc7475c0
.long 0x3dfd3aac,0xbc964083,0x3dfcbfc9,0xbca2abb6,0x3dfbaccd,0xbcbb6ecf,0x3dfaed37,0xbccada4f
.long 0x3df9c79d,0xbce05c13,0x3df8b47b,0xbcf2b651,0x3df78bc5,0xbd027dc0,0x3df6167a,0xbd0d17c0
.long 0x3df4fa0b,0xbd14a031,0x3df31447,0xbd209ae5,0x3df21352,0xbd268f12,0x3defaf1b,0xbd33dca5
.long 0x3deed89e,0xbd38442a,0x3debe858,0xbd46d529,0x3deb4b0c,0xbd49b953,0x3de7c187,0xbd597cb9
.long 0x3de76bd8,0xbd5ae880,0x3de33c5a,0xbd6bcbbb,0x3de33c5a,0xbd6bcbbb,0x3dde5aa6,0xbd7dbabb
.long 0x3ddebe05,0xbd7c5d27,0x3dd91e6a,0xbd87a136,0x3dd9f26a,0xbd864b82,0x3dd389c7,0xbd902dd5
.long 0x3e000000,0x80000000,0x3e000000,0x80000000,0x3dfffec4,0xba490f88,0x3dfffd39,0xba96cb58
.long 0x3dfffb11,0xbac90e90,0x3dfff4e6,0xbb16c9b6,0x3dfff4e6,0xbb16c9b6,0x3dffe705,0xbb622a7a
.long 0x3dffec43,0xbb490ab0,0x3dffd397,0xbb96c32c,0x3dffe129,0xbb7b49ba,0x3dffba9e,0xbbbc6dd5
.long 0x3dffd397,0xbb96c32c,0x3dff9c18,0xbbe21469,0x3dffc38f,0xbbafe007,0x3dff7808,0xbc03db0a
.long 0x3dffb10f,0xbbc8fb30,0x3dff4e6d,0xbc16a905,0x3dff9c18,0xbbe21469,0x3dff1f49,0xbc2973ba
.long 0x3dff84ab,0xbbfb2b74,0x3dfeea9d,0xbc3c3ac3,0x3dff6ac7,0xbc0a200a,0x3dfeb069,0xbc4efdb7
.long 0x3dff4e6d,0xbc16a905,0x3dfe70b0,0xbc61bc2e,0x3dff2f9d,0xbc23308c,0x3dfe2b72,0xbc7475c0
.long 0x3dff0e58,0xbc2fb680,0x3dfde0b1,0xbc839502,0x3dfeea9d,0xbc3c3ac3,0x3dfd906e,0xbc8cec4a
.long 0x3e000000,0x80000000,0x3e000000,0x80000000,0x3dfff4e6,0xbb16c9b6,0x3dfff0e3,0xbb2fea69
.long 0x3dffd397,0xbb96c32c,0x3dffc38f,0xbbafe007,0x3dff9c18,0xbbe21469,0x3dff7808,0xbc03db0a
.long 0x3dff4e6d,0xbc16a905,0x3dff0e58,0xbc2fb680,0x3dfeea9d,0xbc3c3ac3,0x3dfe868b,0xbc5b7d37
.long 0x3dfe70b0,0xbc61bc2e,0x3dfde0b1,0xbc839502,0x3dfde0b1,0xbc839502,0x3dfd1cdd,0xbc995be0
.long 0x3dfd3aac,0xbc964083,0x3dfc3b28,0xbcaf10a2,0x3dfc7eb0,0xbca8defc,0x3dfb3bab,0xbcc4b0b9
.long 0x3dfbaccd,0xbcbb6ecf,0x3dfa1e84,0xbcda3997,0x3dfac516,0xbccdee60,0x3df8e3d6,0xbcefa8b2
.long 0x3df9c79d,0xbce05c13,0x3df78bc5,0xbd027dc0,0x3df8b47b,0xbcf2b651,0x3df6167a,0xbd0d17c0
.long 0x3df78bc5,0xbd027dc0,0x3df48422,0xbd17a117,0x3df64d97,0xbd0b9507,0x3df2d4eb,0xbd221887
.long 0x3e000000,0x80000000,0x3e000000,0x80000000,0x3dffe129,0xbb7b49ba,0x3dffdaaf,0xbb8a342f
.long 0x3dff84ab,0xbbfb2b74,0x3dff6ac7,0xbc0a200a,0x3dfeea9d,0xbc3c3ac3,0x3dfeb069,0xbc4efdb7
.long 0x3dfe1324,0xbc7ab273,0x3dfdabcc,0xbc89cf86,0x3dfcfe73,0xbc9c76de,0x3dfc5d3a,0xbcabf804
.long 0x3dfbaccd,0xbcbb6ecf,0x3dfac516,0xbccdee60,0x3dfa1e84,0xbcda3997,0x3df8e3d6,0xbcefa8b2
.long 0x3df853f8,0xbcf8cfcc,0x3df6ba07,0xbd088e93,0x3df64d97,0xbd0b9507,0x3df4484b,0xbd1920fe
.long 0x3df40bdd,0xbd1aa086,0x3df18f57,0xbd2986c4,0x3df18f57,0xbd2986c4,0x3dee8ff8,0xbd39bb1e
.long 0x3deed89e,0xbd38442a,0x3deb4b0c,0xbd49b953,0x3debe858,0xbd46d529,0x3de7c187,0xbd597cb9
.long 0x3de8bf3c,0xbd553641,0x3de3f473,0xbd6900b7,0x3de55e0b,0xbd6363fa,0x3ddfe4e9,0xbd7840c8
.long 0x3e000000,0x80000000,0x3e000000,0x80000000,0x3dffc38f,0xbbafe007,0x3dffba9e,0xbbbc6dd5
.long 0x3dff0e58,0xbc2fb680,0x3dfeea9d,0xbc3c3ac3,0x3dfde0b1,0xbc839502,0x3dfd906e,0xbc8cec4a
.long 0x3dfc3b28,0xbcaf10a2,0x3dfbaccd,0xbcbb6ecf,0x3dfa1e84,0xbcda3997,0x3df940c0,0xbce98bba
.long 0x3df78bc5,0xbd027dc0,0x3df64d97,0xbd0b9507,0x3df48422,0xbd17a117,0x3df2d4eb,0xbd221887
.long 0x3df10908,0xbd2c7cd4,0x3deed89e,0xbd38442a,0x3ded1c1d,0xbd41071e,0x3dea5ad9,0xbd4e0bea
.long 0x3de8bf3c,0xbd553641,0x3de55e0b,0xbd6363fa,0x3de3f473,0xbd6900b7,0x3ddfe4e9,0xbd7840c8
.long 0x3ddebe05,0xbd7c5d27,0x3dd9f26a,0xbd864b82,0x3dd91e6a,0xbd87a136,0x3dd389c7,0xbd902dd5
.long 0x3dd31849,0xbd90d3cd,0x3dccae79,0xbd99c200,0x3dccae79,0xbd99c200,0x3dc56439,0xbda302d3
.long 0x3e000000,0x80000000,0x3e000000,0x80000000,0x3dffb10f,0xbbc8fb30,0x3dffa6e3,0xbbd5880e
.long 0x3dfec46d,0xbc48bd36,0x3dfe9bc9,0xbc553db9,0x3dfd3aac,0xbc964083,0x3dfcdf6c,0xbc9f917b
.long 0x3dfb14be,0xbcc7c5c2,0x3dfa7302,0xbcd41501,0x3df853f8,0xbcf8cfcc,0x3df7583a,0xbd040270
.long 0x3df4fa0b,0xbd14a031,0x3df3913f,0xbd1d9e78,0x3df10908,0xbd2c7cd4,0x3def20b0,0xbd36ccc3
.long 0x3dec835e,0xbd43ef15,0x3dea09a7,0xbd4f7bca,0x3de76bd8,0xbd5ae880,0x3de44fac,0xbd679a5d
.long 0x3de1c598,0xbd715aea,0x3dddf6be,0xbd7f17b2,0x3ddb941a,0xbd839c3d,0x3dd70348,0xbd8af1b7
.long 0x3dd4db31,0xbd8e39da,0x3dcf7a1f,0xbd95f6d9,0x3dcd9f02,0xbd987fc0,0x3dc76085,0xbda09393
.long 0x3dc5e403,0xbda26799,0x3dbebc1b,0xbdaac082,0x3dbdaef9,0xbdabeb4a,0x3db592e7,0xbdb4768f
.long 0x3e000000,0x80000000,0x3e000000,0x80000000,0x3dff84ab,0xbbfb2b74,0x3dff7808,0xbc03db0a
.long 0x3dfe1324,0xbc7ab273,0x3dfde0b1,0xbc839502,0x3dfbaccd,0xbcbb6ecf,0x3dfb3bab,0xbcc4b0b9
.long 0x3df853f8,0xbcf8cfcc,0x3df78bc5,0xbd027dc0,0x3df40bdd,0xbd1aa086,0x3df2d4eb,0xbd221887
.long 0x3deed89e,0xbd38442a,0x3ded1c1d,0xbd41071e,0x3de8bf3c,0xbd553641,0x3de66771,0xbd5f28a9
.long 0x3de1c598,0xbd715aea,0x3ddebe05,0xbd7c5d27,0x3dd9f26a,0xbd864b82,0x3dd627fe,0xbd8c42c9
.long 0x3dd14d3d,0xbd93682a,0x3dccae79,0xbd99c200,0x3dc7de65,0xbd9ff6cb,0x3dc25b89,0xbda69de3
.long 0x3dbdaef9,0xbdabeb4a,0x3db73a23,0xbdb2c8c9,0x3db2c8c9,0xbdb73a23,0x3dab561b,0xbdbe35c5
.long 0x3da73656,0xbdc1d870,0x3d9ebc12,0xbdc8d8b3,0x3d9b02c6,0xbdcbbbf8,0x3d91796b,0xbdd2a649
.long 0x3e000000,0x80000000,0x3e000000,0x80000000,0x3dff4e6d,0xbc16a905,0x3dff3f54,0xbc1cecf9
.long 0x3dfd3aac,0xbc964083,0x3dfcfe73,0xbc9c76de,0x3df9c79d,0xbce05c13,0x3df940c0,0xbce98bba
.long 0x3df4fa0b,0xbd14a031,0x3df40bdd,0xbd1aa086,0x3deed89e,0xbd38442a,0x3ded67a1,0xbd3f926f
.long 0x3de76bd8,0xbd5ae880,0x3de55e0b,0xbd6363fa,0x3ddebe05,0xbd7c5d27,0x3ddbfb34,0xbd82ef9f
.long 0x3dd4db31,0xbd8e39da,0x3dd14d3d,0xbd93682a,0x3dc9d112,0xbd9d7fd1,0x3dc56439,0xbda302d3
.long 0x3dbdaef9,0xbdabeb4a,0x3db85216,0xbdb1a81d,0x3db085bb,0xbdb96842,0x3daa2a80,0xbdbf41fc
.long 0x3da26799,0xbdc5e403,0x3d9b02c6,0xbdcbbbf8,0x3d93682a,0xbdd14d3d,0x3d8af1b7,0xbdd70348
.long 0x3d839c3d,0xbddb941a,0x3d741f07,0xbde106f2,0x3d663375,0xbde4aa59,0x3d50eb2a,0xbde9b7e4
.long 0x3e000000,0x80000000,0x3e000000,0x80000000,0x3dff0e58,0xbc2fb680,0x3dfefcc9,0xbc35f8da
.long 0x3dfc3b28,0xbcaf10a2,0x3dfbf531,0xbcb54098,0x3df78bc5,0xbd027dc0,0x3df6ef5b,0xbd070ada
.long 0x3df10908,0xbd2c7cd4,0x3deff573,0xbd3263ef,0x3de8bf3c,0xbd553641,0x3de71599,0xbd5c53c1
.long 0x3ddebe05,0xbd7c5d27,0x3ddc61c7,0xbd8242b1,0x3dd31849,0xbd90d3cd,0x3dcfefa8,0xbd9553b7
.long 0x3dc5e403,0xbda26799,0x3dc1d870,0xbda73656,0x3db73a23,0xbdb2c8c9,0x3db238aa,0xbdb7c655
.long 0x3da73656,0xbdc1d870,0x3da12ff9,0xbdc6e22a,0x3d95f6d9,0xbdcf7a1f,0x3d8ee0db,0xbdd46b3b
.long 0x3d839c3d,0xbddb941a,0x3d76e0cb,0xbde04621,0x3d60924f,0xbde60f88,0x3d4e0bea,0xbdea5ad9
.long 0x3d38442a,0xbdeed89e,0x3d2395c5,0xbdf294f8,0x3d0e9a22,0xbdf5dec6,0x3cefa8b2,0xbdf8e3d6
.long 0x3e000000,0x80000000,0x3e000000,0x80000000,0x3dff9c18,0xbbe21469,0x3dff90b1,0xbbeea038
.long 0x3dfe70b0,0xbc61bc2e,0x3dfe4323,0xbc6e3876,0x3dfc7eb0,0xbca8defc,0x3dfc187a,0xbcb228d4
.long 0x3df9c79d,0xbce05c13,0x3df91298,0xbcec9a7f,0x3df64d97,0xbd0b9507,0x3df5341d,0xbd131f35
.long 0x3df21352,0xbd268f12,0x3df08066,0xbd2f713a,0x3ded1c1d,0xbd41071e,0x3deafb8c,0xbd4b2aae
.long 0x3de76bd8,0xbd5ae880,0x3de4aa59,0xbd663375,0x3de106f2,0xbd741f07,0x3ddd924d,0xbd803a06
.long 0x3dd9f26a,0xbd864b82,0x3dd5b993,0xbd8cead0,0x3dd233c6,0xbd921eb0,0x3dcd26fd,0xbd99210f
.long 0x3dc9d112,0xbd9d7fd1,0x3dc3e200,0xbda4d225,0x3dc0d0da,0xbda86605,0x3db9f2ac,0xbdaff3e6
.long 0x3db73a23,0xbdb2c8c9,0x3daf61a5,0xbdba7ca4,0x3dad1469,0xbdbca003,0x3da4381a,0xbdc46337
.long 0x3e000000,0x80000000,0x3e000000,0x80000000,0x3dff6ac7,0xbc0a200a,0x3dff5ce9,0xbc1064b4
.long 0x3dfdabcc,0xbc89cf86,0x3dfd7474,0xbc9008b7,0x3dfac516,0xbccdee60,0x3dfa4910,0xbcd7278f
.long 0x3df6ba07,0xbd088e93,0x3df5dec6,0xbd0e9a22,0x3df18f57,0xbd2986c4,0x3df03b37,0xbd30eacb
.long 0x3deb4b0c,0xbd49b953,0x3de96591,0xbd525a09,0x3de3f473,0xbd6900b7,0x3de1668a,0xbd72bd43
.long 0x3ddb941a,0xbd839c3d,0x3dd84853,0xbd88f59b,0x3dd233c6,0xbd921eb0,0x3dce1689,0xbd97de12
.long 0x3dc7de65,0xbd9ff6cb,0x3dc2de29,0xbda6050a,0x3dbca003,0xbdad1469,0x3db6ad7f,0xbdb3587a
.long 0x3db085bb,0xbdb96842,0x3da99415,0xbdbfc767,0x3da39da9,0xbdc4e3f5,0x3d9ba299,0xbdcb41fa
.long 0x3d95f6d9,0xbdcf7a1f,0x3d8cead0,0xbdd5b993,0x3d87a136,0xbdd91e6a,0x3d7afef7,0xbddf20db
.long 0x3e000000,0x80000000,0x3e000000,0x80000000,0x3dff2f9d,0xbc23308c,0x3dff1f49,0xbc2973ba
.long 0x3dfcbfc9,0xbca2abb6,0x3dfc7eb0,0xbca8defc,0x3df8b47b,0xbcf2b651,0x3df822d1,0xbcfbdba4
.long 0x3df31447,0xbd209ae5,0x3df21352,0xbd268f12,0x3debe858,0xbd46d529,0x3dea5ad9,0xbd4e0bea
.long 0x3de33c5a,0xbd6bcbbb,0x3de106f2,0xbd741f07,0x3dd91e6a,0xbd87a136,0x3dd627fe,0xbd8c42c9
.long 0x3dcd9f02,0xbd987fc0,0x3dc9d112,0xbd9d7fd1,0x3dc0d0da,0xbda86605,0x3dbc17d9,0xbdada859
.long 0x3db2c8c9,0xbdb73a23,0x3dad1469,0xbdbca003,0x3da39da9,0xbdc4e3f5,0x3d9ce11f,0xbdca4c87
.long 0x3d93682a,0xbdd14d3d,0x3d8b9a6b,0xbdd695e5,0x3d8242b1,0xbddc61c7,0x3d72bd43,0xbde1668a
.long 0x3d60924f,0xbde60f88,0x3d4c9b8b,0xbdeaab7b,0x3d3b31a0,0xbdee46be,0x3d25129f,0xbdf25470
.long 0x3e000000,0x80000000,0x3e000000,0x80000000,0x3dfeea9d,0xbc3c3ac3,0x3dfed7d4,0xbc427c39
.long 0x3dfbaccd,0xbcbb6ecf,0x3dfb61fc,0xbcc19b37,0x3df64d97,0xbd0b9507,0x3df5a67b,0xbd101c2c
.long 0x3deed89e,0xbd38442a,0x3dedb293,0xbd3e1d4a,0x3de55e0b,0xbd6363fa,0x3de398ac,0xbd6a6681
.long 0x3dd9f26a,0xbd864b82,0x3dd77026,0xbd8a48ad,0x3dccae79,0xbd99c200,0x3dc95521,0xbd9e1e22
.long 0x3dbdaef9,0xbdabeb4a,0x3db96842,0xbdb085bb,0x3dad1469,0xbdbca003,0x3da7ce61,0xbdc154e1
.long 0x3d9b02c6,0xbdcbbbf8,0x3d94b039,0xbdd064af,0x3d87a136,0xbdd91e6a,0x3d803a06,0xbddd924d
.long 0x3d663375,0xbde4aa59,0x3d553641,0xbde8bf3c,0x3d3b31a0,0xbdee46be,0x3d280b1f,0xbdf1d19f
.long 0x3d0e9a22,0xbdf5dec6,0x3cf2b651,0xbdf8b47b,0x3cc19b37,0xbdfb61fc,0x3c9324ca,0xbdfd57de
.long 0x3f000000,0x0,0x3f000000,0x0,0x3f000000,0x0,0x3effffb1,0x3ac90fc6
.long 0x3f000000,0x0,0x3efffec4,0x3b490f88,0x3f000000,0x0,0x3efffd39,0x3b96cb58
.long 0x3f000000,0x0,0x3efffb11,0x3bc90e90,0x3f000000,0x0,0x3efff84a,0x3bfb514b
.long 0x3f000000,0x0,0x3efff4e6,0x3c16c9b6,0x3f000000,0x0,0x3efff0e3,0x3c2fea69
.long 0x3f000000,0x0,0x3effec43,0x3c490ab0,0x3f000000,0x0,0x3effe705,0x3c622a7a
.long 0x3f000000,0x0,0x3effe129,0x3c7b49ba,0x3f000000,0x0,0x3effdaaf,0x3c8a342f
.long 0x3f000000,0x0,0x3effd397,0x3c96c32c,0x3f000000,0x0,0x3effcbe2,0x3ca351cb
.long 0x3f000000,0x0,0x3effc38f,0x3cafe007,0x3f000000,0x0,0x3effba9e,0x3cbc6dd5
.long 0x3f000000,0x0,0x3f000000,0x0,0x3efffb11,0x3bc90e90,0x3efff84a,0x3bfb514b
.long 0x3effec43,0x3c490ab0,0x3effe129,0x3c7b49ba,0x3effd397,0x3c96c32c,0x3effba9e,0x3cbc6dd5
.long 0x3effb10f,0x3cc8fb30,0x3eff84ab,0x3cfb2b74,0x3eff84ab,0x3cfb2b74,0x3eff3f54,0x3d1cecf9
.long 0x3eff4e6d,0x3d16a905,0x3efeea9d,0x3d3c3ac3,0x3eff0e58,0x3d2fb680,0x3efe868b,0x3d5b7d37
.long 0x3efec46d,0x3d48bd36,0x3efe1324,0x3d7ab273,0x3efe70b0,0x3d61bc2e,0x3efd906e,0x3d8cec4a
.long 0x3efe1324,0x3d7ab273,0x3efcfe73,0x3d9c76de,0x3efdabcc,0x3d89cf86,0x3efc5d3a,0x3dabf804
.long 0x3efd3aac,0x3d964083,0x3efbaccd,0x3dbb6ecf,0x3efcbfc9,0x3da2abb6,0x3efaed37,0x3dcada4f
.long 0x3efc3b28,0x3daf10a2,0x3efa1e84,0x3dda3997,0x3efbaccd,0x3dbb6ecf,0x3ef940c0,0x3de98bba
.long 0x3f000000,0x0,0x3f000000,0x0,0x3effec43,0x3c490ab0,0x3effe705,0x3c622a7a
.long 0x3effb10f,0x3cc8fb30,0x3eff9c18,0x3ce21469,0x3eff4e6d,0x3d16a905,0x3eff1f49,0x3d2973ba
.long 0x3efec46d,0x3d48bd36,0x3efe70b0,0x3d61bc2e,0x3efe1324,0x3d7ab273,0x3efd906e,0x3d8cec4a
.long 0x3efd3aac,0x3d964083,0x3efc7eb0,0x3da8defc,0x3efc3b28,0x3daf10a2,0x3efb3bab,0x3dc4b0b9
.long 0x3efb14be,0x3dc7c5c2,0x3ef9c79d,0x3de05c13,0x3ef9c79d,0x3de05c13,0x3ef822d1,0x3dfbdba4
.long 0x3ef853f8,0x3df8cfcc,0x3ef64d97,0x3e0b9507,0x3ef6ba07,0x3e088e93,0x3ef4484b,0x3e1920fe
.long 0x3ef4fa0b,0x3e14a031,0x3ef21352,0x3e268f12,0x3ef31447,0x3e209ae5,0x3eefaf1b,0x3e33dca5
.long 0x3ef10908,0x3e2c7cd4,0x3eed1c1d,0x3e41071e,0x3eeed89e,0x3e38442a,0x3eea5ad9,0x3e4e0bea
.long 0x3f000000,0x0,0x3f000000,0x0,0x3effd397,0x3c96c32c,0x3effcbe2,0x3ca351cb
.long 0x3eff4e6d,0x3d16a905,0x3eff2f9d,0x3d23308c,0x3efe70b0,0x3d61bc2e,0x3efe2b72,0x3d7475c0
.long 0x3efd3aac,0x3d964083,0x3efcbfc9,0x3da2abb6,0x3efbaccd,0x3dbb6ecf,0x3efaed37,0x3dcada4f
.long 0x3ef9c79d,0x3de05c13,0x3ef8b47b,0x3df2b651,0x3ef78bc5,0x3e027dc0,0x3ef6167a,0x3e0d17c0
.long 0x3ef4fa0b,0x3e14a031,0x3ef31447,0x3e209ae5,0x3ef21352,0x3e268f12,0x3eefaf1b,0x3e33dca5
.long 0x3eeed89e,0x3e38442a,0x3eebe858,0x3e46d529,0x3eeb4b0c,0x3e49b953,0x3ee7c187,0x3e597cb9
.long 0x3ee76bd8,0x3e5ae880,0x3ee33c5a,0x3e6bcbbb,0x3ee33c5a,0x3e6bcbbb,0x3ede5aa6,0x3e7dbabb
.long 0x3edebe05,0x3e7c5d27,0x3ed91e6a,0x3e87a136,0x3ed9f26a,0x3e864b82,0x3ed389c7,0x3e902dd5
.long 0x3f000000,0x0,0x3f000000,0x0,0x3efffec4,0x3b490f88,0x3efffd39,0x3b96cb58
.long 0x3efffb11,0x3bc90e90,0x3efff4e6,0x3c16c9b6,0x3efff4e6,0x3c16c9b6,0x3effe705,0x3c622a7a
.long 0x3effec43,0x3c490ab0,0x3effd397,0x3c96c32c,0x3effe129,0x3c7b49ba,0x3effba9e,0x3cbc6dd5
.long 0x3effd397,0x3c96c32c,0x3eff9c18,0x3ce21469,0x3effc38f,0x3cafe007,0x3eff7808,0x3d03db0a
.long 0x3effb10f,0x3cc8fb30,0x3eff4e6d,0x3d16a905,0x3eff9c18,0x3ce21469,0x3eff1f49,0x3d2973ba
.long 0x3eff84ab,0x3cfb2b74,0x3efeea9d,0x3d3c3ac3,0x3eff6ac7,0x3d0a200a,0x3efeb069,0x3d4efdb7
.long 0x3eff4e6d,0x3d16a905,0x3efe70b0,0x3d61bc2e,0x3eff2f9d,0x3d23308c,0x3efe2b72,0x3d7475c0
.long 0x3eff0e58,0x3d2fb680,0x3efde0b1,0x3d839502,0x3efeea9d,0x3d3c3ac3,0x3efd906e,0x3d8cec4a
.long 0x3f000000,0x0,0x3f000000,0x0,0x3efff4e6,0x3c16c9b6,0x3efff0e3,0x3c2fea69
.long 0x3effd397,0x3c96c32c,0x3effc38f,0x3cafe007,0x3eff9c18,0x3ce21469,0x3eff7808,0x3d03db0a
.long 0x3eff4e6d,0x3d16a905,0x3eff0e58,0x3d2fb680,0x3efeea9d,0x3d3c3ac3,0x3efe868b,0x3d5b7d37
.long 0x3efe70b0,0x3d61bc2e,0x3efde0b1,0x3d839502,0x3efde0b1,0x3d839502,0x3efd1cdd,0x3d995be0
.long 0x3efd3aac,0x3d964083,0x3efc3b28,0x3daf10a2,0x3efc7eb0,0x3da8defc,0x3efb3bab,0x3dc4b0b9
.long 0x3efbaccd,0x3dbb6ecf,0x3efa1e84,0x3dda3997,0x3efac516,0x3dcdee60,0x3ef8e3d6,0x3defa8b2
.long 0x3ef9c79d,0x3de05c13,0x3ef78bc5,0x3e027dc0,0x3ef8b47b,0x3df2b651,0x3ef6167a,0x3e0d17c0
.long 0x3ef78bc5,0x3e027dc0,0x3ef48422,0x3e17a117,0x3ef64d97,0x3e0b9507,0x3ef2d4eb,0x3e221887
.long 0x3f000000,0x0,0x3f000000,0x0,0x3effe129,0x3c7b49ba,0x3effdaaf,0x3c8a342f
.long 0x3eff84ab,0x3cfb2b74,0x3eff6ac7,0x3d0a200a,0x3efeea9d,0x3d3c3ac3,0x3efeb069,0x3d4efdb7
.long 0x3efe1324,0x3d7ab273,0x3efdabcc,0x3d89cf86,0x3efcfe73,0x3d9c76de,0x3efc5d3a,0x3dabf804
.long 0x3efbaccd,0x3dbb6ecf,0x3efac516,0x3dcdee60,0x3efa1e84,0x3dda3997,0x3ef8e3d6,0x3defa8b2
.long 0x3ef853f8,0x3df8cfcc,0x3ef6ba07,0x3e088e93,0x3ef64d97,0x3e0b9507,0x3ef4484b,0x3e1920fe
.long 0x3ef40bdd,0x3e1aa086,0x3ef18f57,0x3e2986c4,0x3ef18f57,0x3e2986c4,0x3eee8ff8,0x3e39bb1e
.long 0x3eeed89e,0x3e38442a,0x3eeb4b0c,0x3e49b953,0x3eebe858,0x3e46d529,0x3ee7c187,0x3e597cb9
.long 0x3ee8bf3c,0x3e553641,0x3ee3f473,0x3e6900b7,0x3ee55e0b,0x3e6363fa,0x3edfe4e9,0x3e7840c8
.long 0x3f000000,0x0,0x3f000000,0x0,0x3effc38f,0x3cafe007,0x3effba9e,0x3cbc6dd5
.long 0x3eff0e58,0x3d2fb680,0x3efeea9d,0x3d3c3ac3,0x3efde0b1,0x3d839502,0x3efd906e,0x3d8cec4a
.long 0x3efc3b28,0x3daf10a2,0x3efbaccd,0x3dbb6ecf,0x3efa1e84,0x3dda3997,0x3ef940c0,0x3de98bba
.long 0x3ef78bc5,0x3e027dc0,0x3ef64d97,0x3e0b9507,0x3ef48422,0x3e17a117,0x3ef2d4eb,0x3e221887
.long 0x3ef10908,0x3e2c7cd4,0x3eeed89e,0x3e38442a,0x3eed1c1d,0x3e41071e,0x3eea5ad9,0x3e4e0bea
.long 0x3ee8bf3c,0x3e553641,0x3ee55e0b,0x3e6363fa,0x3ee3f473,0x3e6900b7,0x3edfe4e9,0x3e7840c8
.long 0x3edebe05,0x3e7c5d27,0x3ed9f26a,0x3e864b82,0x3ed91e6a,0x3e87a136,0x3ed389c7,0x3e902dd5
.long 0x3ed31849,0x3e90d3cd,0x3eccae79,0x3e99c200,0x3eccae79,0x3e99c200,0x3ec56439,0x3ea302d3
.long 0x3f000000,0x0,0x3effb10f,0x3cc8fb30,0x3f000000,0x0,0x3effa6e3,0x3cd5880e
.long 0x3f000000,0x0,0x3eff9c18,0x3ce21469,0x3f000000,0x0,0x3eff90b1,0x3ceea038
.long 0x3f000000,0x0,0x3eff84ab,0x3cfb2b74,0x3f000000,0x0,0x3eff7808,0x3d03db0a
.long 0x3f000000,0x0,0x3eff6ac7,0x3d0a200a,0x3f000000,0x0,0x3eff5ce9,0x3d1064b4
.long 0x3f000000,0x0,0x3eff4e6d,0x3d16a905,0x3f000000,0x0,0x3eff3f54,0x3d1cecf9
.long 0x3f000000,0x0,0x3eff2f9d,0x3d23308c,0x3f000000,0x0,0x3eff1f49,0x3d2973ba
.long 0x3f000000,0x0,0x3eff0e58,0x3d2fb680,0x3f000000,0x0,0x3efefcc9,0x3d35f8da
.long 0x3f000000,0x0,0x3efeea9d,0x3d3c3ac3,0x3f000000,0x0,0x3efed7d4,0x3d427c39
.long 0x3efb14be,0x3dc7c5c2,0x3ef853f8,0x3df8cfcc,0x3efa7302,0x3dd41501,0x3ef7583a,0x3e040270
.long 0x3ef9c79d,0x3de05c13,0x3ef64d97,0x3e0b9507,0x3ef91298,0x3dec9a7f,0x3ef5341d,0x3e131f35
.long 0x3ef853f8,0x3df8cfcc,0x3ef40bdd,0x3e1aa086,0x3ef78bc5,0x3e027dc0,0x3ef2d4eb,0x3e221887
.long 0x3ef6ba07,0x3e088e93,0x3ef18f57,0x3e2986c4,0x3ef5dec6,0x3e0e9a22,0x3ef03b37,0x3e30eacb
.long 0x3ef4fa0b,0x3e14a031,0x3eeed89e,0x3e38442a,0x3ef40bdd,0x3e1aa086,0x3eed67a1,0x3e3f926f
.long 0x3ef31447,0x3e209ae5,0x3eebe858,0x3e46d529,0x3ef21352,0x3e268f12,0x3eea5ad9,0x3e4e0bea
.long 0x3ef10908,0x3e2c7cd4,0x3ee8bf3c,0x3e553641,0x3eeff573,0x3e3263ef,0x3ee71599,0x3e5c53c1
.long 0x3eeed89e,0x3e38442a,0x3ee55e0b,0x3e6363fa,0x3eedb293,0x3e3e1d4a,0x3ee398ac,0x3e6a6681
.long 0x3eec835e,0x3e43ef15,0x3ee76bd8,0x3e5ae880,0x3eea09a7,0x3e4f7bca,0x3ee44fac,0x3e679a5d
.long 0x3ee76bd8,0x3e5ae880,0x3ee106f2,0x3e741f07,0x3ee4aa59,0x3e663375,0x3edd924d,0x3e803a06
.long 0x3ee1c598,0x3e715aea,0x3ed9f26a,0x3e864b82,0x3edebe05,0x3e7c5d27,0x3ed627fe,0x3e8c42c9
.long 0x3edb941a,0x3e839c3d,0x3ed233c6,0x3e921eb0,0x3ed84853,0x3e88f59b,0x3ece1689,0x3e97de12
.long 0x3ed4db31,0x3e8e39da,0x3ec9d112,0x3e9d7fd1,0x3ed14d3d,0x3e93682a,0x3ec56439,0x3ea302d3
.long 0x3ecd9f02,0x3e987fc0,0x3ec0d0da,0x3ea86605,0x3ec9d112,0x3e9d7fd1,0x3ebc17d9,0x3eada859
.long 0x3ec5e403,0x3ea26799,0x3eb73a23,0x3eb2c8c9,0x3ec1d870,0x3ea73656,0x3eb238aa,0x3eb7c655
.long 0x3ebdaef9,0x3eabeb4a,0x3ead1469,0x3ebca003,0x3eb96842,0x3eb085bb,0x3ea7ce61,0x3ec154e1
.long 0x3ed4db31,0x3e8e39da,0x3ecd9f02,0x3e987fc0,0x3ecf7a1f,0x3e95f6d9,0x3ec76085,0x3ea09393
.long 0x3ec9d112,0x3e9d7fd1,0x3ec0d0da,0x3ea86605,0x3ec3e200,0x3ea4d225,0x3eb9f2ac,0x3eaff3e6
.long 0x3ebdaef9,0x3eabeb4a,0x3eb2c8c9,0x3eb73a23,0x3eb73a23,0x3eb2c8c9,0x3eab561b,0x3ebe35c5
.long 0x3eb085bb,0x3eb96842,0x3ea39da9,0x3ec4e3f5,0x3ea99415,0x3ebfc767,0x3e9ba299,0x3ecb41fa
.long 0x3ea26799,0x3ec5e403,0x3e93682a,0x3ed14d3d,0x3e9b02c6,0x3ecbbbf8,0x3e8af1b7,0x3ed70348
.long 0x3e93682a,0x3ed14d3d,0x3e8242b1,0x3edc61c7,0x3e8b9a6b,0x3ed695e5,0x3e72bd43,0x3ee1668a
.long 0x3e839c3d,0x3edb941a,0x3e60924f,0x3ee60f88,0x3e76e0cb,0x3ee04621,0x3e4e0bea,0x3eea5ad9
.long 0x3e663375,0x3ee4aa59,0x3e3b31a0,0x3eee46be,0x3e553641,0x3ee8bf3c,0x3e280b1f,0x3ef1d19f
.long 0x3efec46d,0x3d48bd36,0x3efd3aac,0x3d964083,0x3efe9bc9,0x3d553db9,0x3efcdf6c,0x3d9f917b
.long 0x3efe70b0,0x3d61bc2e,0x3efc7eb0,0x3da8defc,0x3efe4323,0x3d6e3876,0x3efc187a,0x3db228d4
.long 0x3efe1324,0x3d7ab273,0x3efbaccd,0x3dbb6ecf,0x3efde0b1,0x3d839502,0x3efb3bab,0x3dc4b0b9
.long 0x3efdabcc,0x3d89cf86,0x3efac516,0x3dcdee60,0x3efd7474,0x3d9008b7,0x3efa4910,0x3dd7278f
.long 0x3efd3aac,0x3d964083,0x3ef9c79d,0x3de05c13,0x3efcfe73,0x3d9c76de,0x3ef940c0,0x3de98bba
.long 0x3efcbfc9,0x3da2abb6,0x3ef8b47b,0x3df2b651,0x3efc7eb0,0x3da8defc,0x3ef822d1,0x3dfbdba4
.long 0x3efc3b28,0x3daf10a2,0x3ef78bc5,0x3e027dc0,0x3efbf531,0x3db54098,0x3ef6ef5b,0x3e070ada
.long 0x3efbaccd,0x3dbb6ecf,0x3ef64d97,0x3e0b9507,0x3efb61fc,0x3dc19b37,0x3ef5a67b,0x3e101c2c
.long 0x3ef4fa0b,0x3e14a031,0x3ef10908,0x3e2c7cd4,0x3ef3913f,0x3e1d9e78,0x3eef20b0,0x3e36ccc3
.long 0x3ef21352,0x3e268f12,0x3eed1c1d,0x3e41071e,0x3ef08066,0x3e2f713a,0x3eeafb8c,0x3e4b2aae
.long 0x3eeed89e,0x3e38442a,0x3ee8bf3c,0x3e553641,0x3eed1c1d,0x3e41071e,0x3ee66771,0x3e5f28a9
.long 0x3eeb4b0c,0x3e49b953,0x3ee3f473,0x3e6900b7,0x3ee96591,0x3e525a09,0x3ee1668a,0x3e72bd43
.long 0x3ee76bd8,0x3e5ae880,0x3edebe05,0x3e7c5d27,0x3ee55e0b,0x3e6363fa,0x3edbfb34,0x3e82ef9f
.long 0x3ee33c5a,0x3e6bcbbb,0x3ed91e6a,0x3e87a136,0x3ee106f2,0x3e741f07,0x3ed627fe,0x3e8c42c9
.long 0x3edebe05,0x3e7c5d27,0x3ed31849,0x3e90d3cd,0x3edc61c7,0x3e8242b1,0x3ecfefa8,0x3e9553b7
.long 0x3ed9f26a,0x3e864b82,0x3eccae79,0x3e99c200,0x3ed77026,0x3e8a48ad,0x3ec95521,0x3e9e1e22
.long 0x3ee1c598,0x3e715aea,0x3edb941a,0x3e839c3d,0x3eddf6be,0x3e7f17b2,0x3ed70348,0x3e8af1b7
.long 0x3ed9f26a,0x3e864b82,0x3ed233c6,0x3e921eb0,0x3ed5b993,0x3e8cead0,0x3ecd26fd,0x3e99210f
.long 0x3ed14d3d,0x3e93682a,0x3ec7de65,0x3e9ff6cb,0x3eccae79,0x3e99c200,0x3ec25b89,0x3ea69de3
.long 0x3ec7de65,0x3e9ff6cb,0x3ebca003,0x3ead1469,0x3ec2de29,0x3ea6050a,0x3eb6ad7f,0x3eb3587a
.long 0x3ebdaef9,0x3eabeb4a,0x3eb085bb,0x3eb96842,0x3eb85216,0x3eb1a81d,0x3eaa2a80,0x3ebf41fc
.long 0x3eb2c8c9,0x3eb73a23,0x3ea39da9,0x3ec4e3f5,0x3ead1469,0x3ebca003,0x3e9ce11f,0x3eca4c87
.long 0x3ea73656,0x3ec1d870,0x3e95f6d9,0x3ecf7a1f,0x3ea12ff9,0x3ec6e22a,0x3e8ee0db,0x3ed46b3b
.long 0x3e9b02c6,0x3ecbbbf8,0x3e87a136,0x3ed91e6a,0x3e94b039,0x3ed064af,0x3e803a06,0x3edd924d
.long 0x3ec5e403,0x3ea26799,0x3ebdaef9,0x3eabeb4a,0x3ebebc1b,0x3eaac082,0x3eb592e7,0x3eb4768f
.long 0x3eb73a23,0x3eb2c8c9,0x3ead1469,0x3ebca003,0x3eaf61a5,0x3eba7ca4,0x3ea4381a,0x3ec46337
.long 0x3ea73656,0x3ec1d870,0x3e9b02c6,0x3ecbbbf8,0x3e9ebc12,0x3ec8d8b3,0x3e91796b,0x3ed2a649
.long 0x3e95f6d9,0x3ecf7a1f,0x3e87a136,0x3ed91e6a,0x3e8cead0,0x3ed5b993,0x3e7afef7,0x3edf20db
.long 0x3e839c3d,0x3edb941a,0x3e663375,0x3ee4aa59,0x3e741f07,0x3ee106f2,0x3e50eb2a,0x3ee9b7e4
.long 0x3e60924f,0x3ee60f88,0x3e3b31a0,0x3eee46be,0x3e4c9b8b,0x3eeaab7b,0x3e25129f,0x3ef25470
.long 0x3e38442a,0x3eeed89e,0x3e0e9a22,0x3ef5dec6,0x3e2395c5,0x3ef294f8,0x3defa8b2,0x3ef8e3d6
.long 0x3e0e9a22,0x3ef5dec6,0x3dc19b37,0x3efb61fc,0x3df2b651,0x3ef8b47b,0x3d9324ca,0x3efd57de
.long 0x3c00,0x3c000000,0xbc00,0xbc008000,0x3c00,0x3bf6ae46,0xb23ebbd9,0xbba834a5
.long 0x3c00,0x3bd9b23e,0xb61fbb64,0xbaa73872,0x3c00,0x3ba8b4a5,0xb872baa7,0xb9133a2f
.long 0x3c00,0x3b64b61f,0xb9a8b9a8,0xb61f3b64,0x3c00,0x3b0eb78b,0xbaa7b872,0xae463bf6
.long 0x3c00,0x3aa7b872,0xbb64b61f,0x323e3bd9,0x3c00,0x3a2fb913,0xbbd9b23e,0x378b3b0e
.long 0x3c00,0x39a8b9a8,0xbc008000,0x39a839a8,0x3c00,0x3913ba2f,0xbbd9323e,0x3b0e378b
.long 0x3c00,0x3872baa7,0xbb64361f,0x3bd9323e,0x3c00,0x378bbb0e,0xbaa73872,0x3bf6ae46
.long 0x3c00,0x361fbb64,0xb9a839a8,0x3b64b61f,0x3c00,0x34a5bba8,0xb8723aa7,0x3a2fb913
.long 0x3c00,0x323ebbd9,0xb61f3b64,0x3872baa7,0x3c00,0x2e46bbf6,0xb23e3bd9,0x34a5bba8
.long 0x3c00,0x3c000000,0xbc00,0xbc008000,0x361f3b64,0x3b0eb78b,0xb872baa7,0xba2f3913
.long 0x39a839a8,0x3872baa7,0xbb64b61f,0xb23e3bd9,0x3b64361f,0x2e46bbf6,0xbbd9323e,0x378b3b0e
.long 0x3c000000,0xb61fbb64,0xb9a839a8,0x3b64361f,0x3b64b61f,0xba2fb913,0xb23e3bd9,0x3ba8b4a5
.long 0x39a8b9a8,0xbbd9b23e,0x361f3b64,0x3872baa7,0x361fbb64,0xbba834a5,0x3aa73872,0xae46bbf6
.long 0xbc00,0xb9a839a8,0x3c000000,0xb9a8b9a8,0xb61fbb64,0xb4a53ba8,0x3aa7b872,0xbbf6ae46
.long 0xb9a8b9a8,0x323e3bd9,0x361fbb64,0xbaa73872,0xbb64b61f,0x39133a2f,0xb23ebbd9,0xb4a53ba8
.long 0xbc008000,0x3b64361f,0xb9a8b9a8,0x361f3b64,0xbb64361f,0x3bf6ae46,0xbbd9b23e,0x3b0e378b
.long 0xb9a839a8,0x3aa7b872,0xbb64361f,0x3bd9b23e,0xb61f3b64,0x378bbb0e,0xb8723aa7,0x3913ba2f
.long 0x3c00,0x3c000000,0xbc00,0xbc008000,0x39a839a8,0x3913ba2f,0xbaa7b872,0xb78b3b0e
.long 0x3c000000,0xb23ebbd9,0xbb64361f,0x38723aa7,0x39a8b9a8,0xbb0eb78b,0xb23e3bd9,0x3bf6ae46
.long 0xbc00,0xbb64361f,0x39a839a8,0x361fbb64,0xb9a8b9a8,0xb4a53ba8,0x3bd9b23e,0xb913ba2f
.long 0xbc008000,0x38723aa7,0x361fbb64,0xbbd9323e,0xb9a839a8,0x3bf62e46,0xb872baa7,0xb4a53ba8
.long 0x3c00,0x39a8b9a8,0xbc008000,0x39a839a8,0x39a839a8,0xae46bbf6,0xb8723aa7,0x3ba8b4a5
.long 0x3c000000,0xbaa7b872,0x361f3b64,0x323ebbd9,0x39a8b9a8,0xbba834a5,0x3bd9323e,0xba2fb913
.long 0xbc00,0xb61f3b64,0x39a8b9a8,0xbb64361f,0xb9a8b9a8,0x378b3b0e,0xb23ebbd9,0xae463bf6
.long 0xbc008000,0x3bd9323e,0xbb64b61f,0x3aa73872,0xb9a839a8,0x3a2fb913,0xbaa73872,0x3b0eb78b
.long 0x3c00,0x3c000000,0xbc00,0xbc008000,0x3b64361f,0x34a5bba8,0xbbd9b23e,0xae463bf6
.long 0x39a8b9a8,0xbaa7b872,0xb61f3b64,0x3bd9323e,0xb61fbb64,0xba2f3913,0x3aa73872,0x34a5bba8
.long 0xbc008000,0x361f3b64,0x39a8b9a8,0xbb64b61f,0xb61f3b64,0x3bf6ae46,0xb872baa7,0xb78b3b0e
.long 0x39a839a8,0x323ebbd9,0xbb64361f,0x3aa73872,0x3b64b61f,0xbb0eb78b,0x323e3bd9,0x3913ba2f
.long 0xbc00,0xb9a839a8,0x3c000000,0xb9a8b9a8,0xbb64b61f,0x378b3b0e,0x323ebbd9,0xba2f3913
.long 0xb9a839a8,0x3bd9b23e,0xbb64b61f,0x38723aa7,0x361f3b64,0x2e46bbf6,0xb8723aa7,0x3b0eb78b
.long 0x3c000000,0xbb64b61f,0x39a839a8,0xb61fbb64,0x361fbb64,0xb9133a2f,0x3aa7b872,0xbba834a5
.long 0xb9a8b9a8,0x38723aa7,0xb61fbb64,0x323e3bd9,0xbb64361f,0x3ba8b4a5,0xbbd9323e,0x3bf6ae46
.long 0x3c008000,0xbc00,0xbc008000,0x80003c00,0x3c008000,0xae46bbf6,0xbbd9323e,0x34a53ba8
.long 0x3c008000,0xb23ebbd9,0xbb64361f,0x38723aa7,0x3c008000,0xb4a5bba8,0xbaa73872,0x3a2f3913
.long 0x3c008000,0xb61fbb64,0xb9a839a8,0x3b64361f,0x3c008000,0xb78bbb0e,0xb8723aa7,0x3bf62e46
.long 0x3c008000,0xb872baa7,0xb61f3b64,0x3bd9b23e,0x3c008000,0xb913ba2f,0xb23e3bd9,0x3b0eb78b
.long 0x3c008000,0xb9a8b9a8,0x80003c00,0x39a8b9a8,0x3c008000,0xba2fb913,0x323e3bd9,0x378bbb0e
.long 0x3c008000,0xbaa7b872,0x361f3b64,0x323ebbd9,0x3c008000,0xbb0eb78b,0x38723aa7,0xae46bbf6
.long 0x3c008000,0xbb64b61f,0x39a839a8,0xb61fbb64,0x3c008000,0xbba8b4a5,0x3aa73872,0xb913ba2f
.long 0x3c008000,0xbbd9b23e,0x3b64361f,0xbaa7b872,0x3c008000,0xbbf6ae46,0x3bd9323e,0xbba8b4a5
.long 0x3c008000,0xbc00,0xbc008000,0x80003c00,0x3b64b61f,0xb78bbb0e,0xbaa73872,0x39133a2f
.long 0x39a8b9a8,0xbaa7b872,0xb61f3b64,0x3bd9323e,0x361fbb64,0xbbf6ae46,0x323e3bd9,0x3b0eb78b
.long 0xbc00,0xbb64361f,0x39a839a8,0x361fbb64,0xb61fbb64,0xb9133a2f,0x3bd9323e,0xb4a5bba8
.long 0xb9a8b9a8,0xb23e3bd9,0x3b64b61f,0xbaa7b872,0xbb64b61f,0x34a53ba8,0x3872baa7,0xbbf62e46
.long 0xbc008000,0x39a839a8,0xbc00,0xb9a839a8,0xbb64361f,0x3ba834a5,0xb872baa7,0xae463bf6
.long 0xb9a839a8,0x3bd9b23e,0xbb64b61f,0x38723aa7,0xb61f3b64,0x3a2fb913,0xbbd9323e,0x3ba834a5
.long 0x80003c00,0x361fbb64,0xb9a839a8,0x3b64b61f,0x361f3b64,0xae46bbf6,0xb23e3bd9,0x378bbb0e
.long 0x39a839a8,0xb872baa7,0x361f3b64,0xb23ebbd9,0x3b64361f,0xbb0eb78b,0x3aa73872,0xba2fb913
.long 0x3c008000,0xbc00,0xbc008000,0x80003c00,0x39a8b9a8,0xba2fb913,0xb8723aa7,0x3b0e378b
.long 0xbc00,0xbbd9323e,0x361f3b64,0x3aa7b872,0xb9a8b9a8,0xb78b3b0e,0x3bd9323e,0xae46bbf6
.long 0xbc008000,0x361f3b64,0x39a8b9a8,0xbb64b61f,0xb9a839a8,0x3ba834a5,0xb23ebbd9,0xba2f3913
.long 0x80003c00,0x3aa7b872,0xbb64b61f,0x323e3bd9,0x39a839a8,0x2e46bbf6,0xbaa73872,0x3ba834a5
.long 0x3c008000,0xb9a8b9a8,0x80003c00,0x39a8b9a8,0x39a8b9a8,0xbbf62e46,0x3aa73872,0xb4a5bba8
.long 0xbc00,0xb8723aa7,0x3b64b61f,0xbbd9b23e,0xb9a8b9a8,0x34a53ba8,0x323ebbd9,0xb9133a2f
.long 0xbc008000,0x3b64361f,0xb9a8b9a8,0x361f3b64,0xb9a839a8,0x3b0eb78b,0xbbd9323e,0x3bf62e46
.long 0x80003c00,0x323ebbd9,0xb61f3b64,0x3872baa7,0x39a839a8,0xb913ba2f,0x38723aa7,0xb78bbb0e
.long 0x3c008000,0xbc00,0xbc008000,0x80003c00,0x361fbb64,0xbba8b4a5,0xb23e3bd9,0x3bf62e46
.long 0xb9a8b9a8,0xb8723aa7,0x3b64361f,0x323ebbd9,0xbb64361f,0x39133a2f,0x3872baa7,0xbba8b4a5
.long 0x80003c00,0x3b64b61f,0xb9a8b9a8,0xb61f3b64,0x3b64361f,0xae46bbf6,0xbaa73872,0x3b0e378b
.long 0x39a8b9a8,0xbbd9b23e,0x361f3b64,0x3872baa7,0xb61fbb64,0xb78b3b0e,0x3bd9b23e,0xba2fb913
.long 0xbc008000,0x39a839a8,0xbc00,0xb9a839a8,0xb61f3b64,0x3b0eb78b,0xbbd9b23e,0x39133a2f
.long 0x39a839a8,0xb23ebbd9,0xb61f3b64,0x3aa7b872,0x3b64b61f,0xbbf6ae46,0x3aa73872,0xb78bbb0e
.long 0xbc00,0xb61f3b64,0x39a8b9a8,0xbb64361f,0xbb64b61f,0x3a2f3913,0xb872baa7,0x34a53ba8
.long 0xb9a839a8,0x3aa7b872,0xbb64361f,0x3bd9b23e,0x361f3b64,0xb4a5bba8,0x323e3bd9,0xae46bbf6
.long 0x3c00,0x3c000000,0xbc00,0xbc008000,0x3c000000,0xae46bbf6,0xbbd9323e,0x34a53ba8
.long 0xbc00,0xbbd9323e,0x361f3b64,0x3aa7b872,0xbc008000,0x34a53ba8,0x3aa7b872,0xba2fb913
.long 0x3c00,0x3b64b61f,0xb9a8b9a8,0xb61f3b64,0x3c000000,0xb78bbb0e,0xb8723aa7,0x3bf62e46
.long 0xbc00,0xbaa73872,0x3b64361f,0xb23ebbd9,0xbc008000,0x39133a2f,0x323ebbd9,0xbb0e378b
.long 0x3c00,0x39a8b9a8,0xbc008000,0x39a839a8,0x3c000000,0xba2fb913,0x323e3bd9,0x378bbb0e
.long 0xbc00,0xb8723aa7,0x3b64b61f,0xbbd9b23e,0xbc008000,0x3b0e378b,0xb872baa7,0x2e463bf6
.long 0x3c00,0x361fbb64,0xb9a839a8,0x3b64b61f,0x3c000000,0xbba8b4a5,0x3aa73872,0xb913ba2f
.long 0xbc00,0xb23e3bd9,0x361fbb64,0xb8723aa7,0xbc008000,0x3bf62e46,0xbbd9b23e,0x3ba834a5
.long 0x3c00,0x3c000000,0xbc00,0xbc008000,0x3b64b61f,0xb78bbb0e,0xbaa73872,0x39133a2f
.long 0xb9a8b9a8,0xb8723aa7,0x3b64361f,0x323ebbd9,0xb61f3b64,0x3bf62e46,0xb23ebbd9,0xbb0e378b
.long 0x3c000000,0xb61fbb64,0xb9a839a8,0x3b64361f,0xb61fbb64,0xb9133a2f,0x3bd9323e,0xb4a5bba8
.long 0xb9a839a8,0x3bd9323e,0xb61fbb64,0xb8723aa7,0x3b64361f,0xb4a5bba8,0xb8723aa7,0x3bf6ae46
.long 0xbc00,0xb9a839a8,0x3c000000,0xb9a8b9a8,0xbb64361f,0x3ba834a5,0xb872baa7,0xae463bf6
.long 0x39a839a8,0xb23ebbd9,0xb61f3b64,0x3aa7b872,0x361fbb64,0xba2f3913,0x3bd9b23e,0xbba8b4a5
.long 0xbc008000,0x3b64361f,0xb9a8b9a8,0x361f3b64,0x361f3b64,0xae46bbf6,0xb23e3bd9,0x378bbb0e
.long 0x39a8b9a8,0xbaa73872,0x3b64b61f,0xbbd9323e,0xbb64b61f,0x3b0e378b,0xbaa7b872,0x3a2f3913
.long 0x3c00,0x3c000000,0xbc00,0xbc008000,0x39a8b9a8,0xba2fb913,0xb8723aa7,0x3b0e378b
.long 0xbc008000,0x323e3bd9,0x3b64b61f,0xb872baa7,0x39a839a8,0x378bbb0e,0xbbd9b23e,0x2e463bf6
.long 0xbc00,0xbb64361f,0x39a839a8,0x361fbb64,0xb9a839a8,0x3ba834a5,0xb23ebbd9,0xba2f3913
.long 0x3c000000,0xb872baa7,0xb61f3b64,0x3bd9b23e,0xb9a8b9a8,0xae463bf6,0x3aa7b872,0xbba8b4a5
.long 0x3c00,0x39a8b9a8,0xbc008000,0x39a839a8,0x39a8b9a8,0xbbf62e46,0x3aa73872,0xb4a5bba8
.long 0xbc008000,0x3aa73872,0xb61fbb64,0xb23e3bd9,0x39a839a8,0xb4a5bba8,0xb23e3bd9,0x3913ba2f
.long 0xbc00,0xb61f3b64,0x39a8b9a8,0xbb64361f,0xb9a839a8,0x3b0eb78b,0xbbd9323e,0x3bf62e46
.long 0x3c000000,0xbbd9b23e,0x3b64361f,0xbaa7b872,0xb9a8b9a8,0x39133a2f,0xb872baa7,0x378b3b0e
.long 0x3c00,0x3c000000,0xbc00,0xbc008000,0x361fbb64,0xbba8b4a5,0xb23e3bd9,0x3bf62e46
.long 0xb9a839a8,0x3aa73872,0x361fbb64,0xbbd9b23e,0x3b64b61f,0xb913ba2f,0xb8723aa7,0x3ba834a5
.long 0xbc008000,0x361f3b64,0x39a8b9a8,0xbb64b61f,0x3b64361f,0xae46bbf6,0xbaa73872,0x3b0e378b
.long 0xb9a8b9a8,0xb23e3bd9,0x3b64b61f,0xbaa7b872,0x361f3b64,0x378bbb0e,0xbbd9323e,0x3a2f3913
.long 0xbc00,0xb9a839a8,0x3c000000,0xb9a8b9a8,0xb61f3b64,0x3b0eb78b,0xbbd9b23e,0x39133a2f
.long 0x39a8b9a8,0xbbd9323e,0x3b64361f,0xb872baa7,0xbb64361f,0x3bf62e46,0xbaa7b872,0x378b3b0e
.long 0x3c000000,0xbb64b61f,0x39a839a8,0xb61fbb64,0xbb64b61f,0x3a2f3913,0xb872baa7,0x34a53ba8
.long 0x39a839a8,0xb872baa7,0x361f3b64,0xb23ebbd9,0xb61fbb64,0x34a53ba8,0xb23ebbd9,0x2e463bf6
.long 0x3c008000,0xbc00,0xbc008000,0x80003c00,0xbc00,0xbbf62e46,0x323e3bd9,0x3ba8b4a5
.long 0xbc008000,0x323e3bd9,0x3b64b61f,0xb872baa7,0x80003c00,0x3ba8b4a5,0xb872baa7,0xb9133a2f
.long 0x3c008000,0xb61fbb64,0xb9a839a8,0x3b64361f,0xbc00,0xbb0e378b,0x3aa73872,0x2e46bbf6
.long 0xbc008000,0x38723aa7,0x361fbb64,0xbbd9323e,0x80003c00,0x3a2fb913,0xbbd9b23e,0x378b3b0e
.long 0x3c008000,0xb9a8b9a8,0x80003c00,0x39a8b9a8,0xbc00,0xb9133a2f,0x3bd9b23e,0xbb0eb78b
.long 0xbc008000,0x3aa73872,0xb61fbb64,0xb23e3bd9,0x80003c00,0x378bbb0e,0xbaa73872,0x3bf6ae46
.long 0x3c008000,0xbb64b61f,0x39a839a8,0xb61fbb64,0xbc00,0xb4a53ba8,0x3872baa7,0xba2f3913
.long 0xbc008000,0x3bd9323e,0xbb64b61f,0x3aa73872,0x80003c00,0x2e46bbf6,0xb23e3bd9,0x34a5bba8
.long 0x3c008000,0xbc00,0xbc008000,0x80003c00,0xb61fbb64,0xbb0e378b,0x38723aa7,0x3a2fb913
.long 0xb9a839a8,0x3aa73872,0x361fbb64,0xbbd9b23e,0x3b64361f,0x2e46bbf6,0xbbd9323e,0x378b3b0e
.long 0xbc00,0xbb64361f,0x39a839a8,0x361fbb64,0xbb64361f,0x3a2f3913,0x323ebbd9,0xbba834a5
.long 0x39a839a8,0x323ebbd9,0xbb64361f,0x3aa73872,0x361fbb64,0xbba834a5,0x3aa73872,0xae46bbf6
.long 0xbc008000,0x39a839a8,0xbc00,0xb9a839a8,0x361f3b64,0x34a5bba8,0xbaa73872,0x3bf62e46
.long 0x39a8b9a8,0xbbd9323e,0x3b64361f,0xb872baa7,0xbb64b61f,0x39133a2f,0xb23ebbd9,0xb4a53ba8
.long 0x80003c00,0x361fbb64,0xb9a839a8,0x3b64b61f,0x3b64b61f,0xbbf62e46,0x3bd9323e,0xbb0eb78b
.long 0xb9a8b9a8,0x38723aa7,0xb61fbb64,0x323e3bd9,0xb61f3b64,0x378bbb0e,0xb8723aa7,0x3913ba2f
.long 0x3c008000,0xbc00,0xbc008000,0x80003c00,0xb9a8b9a8,0xb9133a2f,0x3aa73872,0x378bbb0e
.long 0x80003c00,0x3bd9b23e,0xb61fbb64,0xbaa73872,0x39a8b9a8,0xbb0eb78b,0xb23e3bd9,0x3bf6ae46
.long 0xbc008000,0x361f3b64,0x39a8b9a8,0xbb64b61f,0x39a839a8,0x34a5bba8,0xbbd9323e,0x39133a2f
.long 0xbc00,0xbaa73872,0x3b64361f,0xb23ebbd9,0xb9a839a8,0x3bf62e46,0xb872baa7,0xb4a53ba8
.long 0x3c008000,0xb9a8b9a8,0x80003c00,0x39a8b9a8,0xb9a8b9a8,0x2e463bf6,0x3872baa7,0xbba834a5
.long 0x80003c00,0x3872baa7,0xbb64361f,0x3bd9323e,0x39a8b9a8,0xbba834a5,0x3bd9323e,0xba2fb913
.long 0xbc008000,0x3b64361f,0xb9a8b9a8,0x361f3b64,0x39a839a8,0xb78bbb0e,0x323e3bd9,0x2e46bbf6
.long 0xbc00,0xb23e3bd9,0x361fbb64,0xb8723aa7,0xb9a839a8,0x3a2fb913,0xbaa73872,0x3b0eb78b
.long 0x3c008000,0xbc00,0xbc008000,0x80003c00,0xbb64b61f,0xb4a53ba8,0x3bd9323e,0x2e46bbf6
.long 0x39a839a8,0x3872baa7,0xbb64b61f,0xb23e3bd9,0xb61fbb64,0xba2f3913,0x3aa73872,0x34a5bba8
.long 0x80003c00,0x3b64b61f,0xb9a8b9a8,0xb61f3b64,0x361fbb64,0xbbf62e46,0x38723aa7,0x378bbb0e
.long 0xb9a839a8,0x3bd9323e,0xb61fbb64,0xb8723aa7,0x3b64b61f,0xbb0eb78b,0x323e3bd9,0x3913ba2f
.long 0xbc008000,0x39a839a8,0xbc00,0xb9a839a8,0x3b64361f,0xb78bbb0e,0xb23e3bd9,0x3a2fb913
.long 0xb9a8b9a8,0x323e3bd9,0x361fbb64,0xbaa73872,0x361f3b64,0x2e46bbf6,0xb8723aa7,0x3b0eb78b
.long 0xbc00,0xb61f3b64,0x39a8b9a8,0xbb64361f,0xb61f3b64,0x3913ba2f,0xbaa73872,0x3ba8b4a5
.long 0x39a8b9a8,0xbaa73872,0x3b64b61f,0xbbd9323e,0xbb64361f,0x3ba8b4a5,0xbbd9323e,0x3bf6ae46
.long 0x3c00,0x3c000000,0xbc00,0xbc008000,0xbc00,0xbbf62e46,0x323e3bd9,0x3ba8b4a5
.long 0x3c00,0x3bd9b23e,0xb61fbb64,0xbaa73872,0xbc00,0xbba834a5,0x38723aa7,0x3913ba2f
.long 0x3c00,0x3b64b61f,0xb9a8b9a8,0xb61f3b64,0xbc00,0xbb0e378b,0x3aa73872,0x2e46bbf6
.long 0x3c00,0x3aa7b872,0xbb64b61f,0x323e3bd9,0xbc00,0xba2f3913,0x3bd9323e,0xb78bbb0e
.long 0x3c00,0x39a8b9a8,0xbc008000,0x39a839a8,0xbc00,0xb9133a2f,0x3bd9b23e,0xbb0eb78b
.long 0x3c00,0x3872baa7,0xbb64361f,0x3bd9323e,0xbc00,0xb78b3b0e,0x3aa7b872,0xbbf62e46
.long 0x3c00,0x361fbb64,0xb9a839a8,0x3b64b61f,0xbc00,0xb4a53ba8,0x3872baa7,0xba2f3913
.long 0x3c00,0x323ebbd9,0xb61f3b64,0x3872baa7,0xbc00,0xae463bf6,0x323ebbd9,0xb4a53ba8
.long 0x3c00,0x3c000000,0xbc00,0xbc008000,0xb61fbb64,0xbb0e378b,0x38723aa7,0x3a2fb913
.long 0x39a839a8,0x3872baa7,0xbb64b61f,0xb23e3bd9,0xbb64b61f,0xae463bf6,0x3bd9b23e,0xb78bbb0e
.long 0x3c000000,0xb61fbb64,0xb9a839a8,0x3b64361f,0xbb64361f,0x3a2f3913,0x323ebbd9,0xbba834a5
.long 0x39a8b9a8,0xbbd9b23e,0x361f3b64,0x3872baa7,0xb61f3b64,0x3ba8b4a5,0xbaa7b872,0x2e463bf6
.long 0xbc00,0xb9a839a8,0x3c000000,0xb9a8b9a8,0x361f3b64,0x34a5bba8,0xbaa73872,0x3bf62e46
.long 0xb9a8b9a8,0x323e3bd9,0x361fbb64,0xbaa73872,0x3b64361f,0xb913ba2f,0x323e3bd9,0x34a5bba8
.long 0xbc008000,0x3b64361f,0xb9a8b9a8,0x361f3b64,0x3b64b61f,0xbbf62e46,0x3bd9323e,0xbb0eb78b
.long 0xb9a839a8,0x3aa7b872,0xbb64361f,0x3bd9b23e,0x361fbb64,0xb78b3b0e,0x3872baa7,0xb9133a2f
.long 0x3c00,0x3c000000,0xbc00,0xbc008000,0xb9a8b9a8,0xb9133a2f,0x3aa73872,0x378bbb0e
.long 0x3c000000,0xb23ebbd9,0xbb64361f,0x38723aa7,0xb9a839a8,0x3b0e378b,0x323ebbd9,0xbbf62e46
.long 0xbc00,0xbb64361f,0x39a839a8,0x361fbb64,0x39a839a8,0x34a5bba8,0xbbd9323e,0x39133a2f
.long 0xbc008000,0x38723aa7,0x361fbb64,0xbbd9323e,0x39a8b9a8,0xbbf6ae46,0x38723aa7,0x34a5bba8
.long 0x3c00,0x39a8b9a8,0xbc008000,0x39a839a8,0xb9a8b9a8,0x2e463bf6,0x3872baa7,0xbba834a5
.long 0x3c000000,0xbaa7b872,0x361f3b64,0x323ebbd9,0xb9a839a8,0x3ba8b4a5,0xbbd9b23e,0x3a2f3913
.long 0xbc00,0xb61f3b64,0x39a8b9a8,0xbb64361f,0x39a839a8,0xb78bbb0e,0x323e3bd9,0x2e46bbf6
.long 0xbc008000,0x3bd9323e,0xbb64b61f,0x3aa73872,0x39a8b9a8,0xba2f3913,0x3aa7b872,0xbb0e378b
.long 0x3c00,0x3c000000,0xbc00,0xbc008000,0xbb64b61f,0xb4a53ba8,0x3bd9323e,0x2e46bbf6
.long 0x39a8b9a8,0xbaa7b872,0xb61f3b64,0x3bd9323e,0x361f3b64,0x3a2fb913,0xbaa7b872,0xb4a53ba8
.long 0xbc008000,0x361f3b64,0x39a8b9a8,0xbb64b61f,0x361fbb64,0xbbf62e46,0x38723aa7,0x378bbb0e
.long 0x39a839a8,0x323ebbd9,0xbb64361f,0x3aa73872,0xbb64361f,0x3b0e378b,0xb23ebbd9,0xb9133a2f
.long 0xbc00,0xb9a839a8,0x3c000000,0xb9a8b9a8,0x3b64361f,0xb78bbb0e,0xb23e3bd9,0x3a2fb913
.long 0xb9a839a8,0x3bd9b23e,0xbb64b61f,0x38723aa7,0xb61fbb64,0xae463bf6,0x3872baa7,0xbb0e378b
.long 0x3c000000,0xbb64b61f,0x39a839a8,0xb61fbb64,0xb61f3b64,0x3913ba2f,0xbaa73872,0x3ba8b4a5
.long 0xb9a8b9a8,0x38723aa7,0xb61fbb64,0x323e3bd9,0x3b64b61f,0xbba834a5,0x3bd9b23e,0xbbf62e46
.long 0x3c008000,0xbc00,0xbc008000,0x80003c00,0xbc008000,0x2e463bf6,0x3bd9b23e,0xb4a5bba8
.long 0x3c008000,0xb23ebbd9,0xbb64361f,0x38723aa7,0xbc008000,0x34a53ba8,0x3aa7b872,0xba2fb913
.long 0x3c008000,0xb61fbb64,0xb9a839a8,0x3b64361f,0xbc008000,0x378b3b0e,0x3872baa7,0xbbf6ae46
.long 0x3c008000,0xb872baa7,0xb61f3b64,0x3bd9b23e,0xbc008000,0x39133a2f,0x323ebbd9,0xbb0e378b
.long 0x3c008000,0xb9a8b9a8,0x80003c00,0x39a8b9a8,0xbc008000,0x3a2f3913,0xb23ebbd9,0xb78b3b0e
.long 0x3c008000,0xbaa7b872,0x361f3b64,0x323ebbd9,0xbc008000,0x3b0e378b,0xb872baa7,0x2e463bf6
.long 0x3c008000,0xbb64b61f,0x39a839a8,0xb61fbb64,0xbc008000,0x3ba834a5,0xbaa7b872,0x39133a2f
.long 0x3c008000,0xbbd9b23e,0x3b64361f,0xbaa7b872,0xbc008000,0x3bf62e46,0xbbd9b23e,0x3ba834a5
.long 0x3c008000,0xbc00,0xbc008000,0x80003c00,0xbb64361f,0x378b3b0e,0x3aa7b872,0xb913ba2f
.long 0x39a8b9a8,0xbaa7b872,0xb61f3b64,0x3bd9323e,0xb61f3b64,0x3bf62e46,0xb23ebbd9,0xbb0e378b
.long 0xbc00,0xbb64361f,0x39a839a8,0x361fbb64,0x361f3b64,0x3913ba2f,0xbbd9b23e,0x34a53ba8
.long 0xb9a8b9a8,0xb23e3bd9,0x3b64b61f,0xbaa7b872,0x3b64361f,0xb4a5bba8,0xb8723aa7,0x3bf6ae46
.long 0xbc008000,0x39a839a8,0xbc00,0xb9a839a8,0x3b64b61f,0xbba8b4a5,0x38723aa7,0x2e46bbf6
.long 0xb9a839a8,0x3bd9b23e,0xbb64b61f,0x38723aa7,0x361fbb64,0xba2f3913,0x3bd9b23e,0xbba8b4a5
.long 0x80003c00,0x361fbb64,0xb9a839a8,0x3b64b61f,0xb61fbb64,0x2e463bf6,0x323ebbd9,0xb78b3b0e
.long 0x39a839a8,0xb872baa7,0x361f3b64,0xb23ebbd9,0xbb64b61f,0x3b0e378b,0xbaa7b872,0x3a2f3913
.long 0x3c008000,0xbc00,0xbc008000,0x80003c00,0xb9a839a8,0x3a2f3913,0x3872baa7,0xbb0eb78b
.long 0xbc00,0xbbd9323e,0x361f3b64,0x3aa7b872,0x39a839a8,0x378bbb0e,0xbbd9b23e,0x2e463bf6
.long 0xbc008000,0x361f3b64,0x39a8b9a8,0xbb64b61f,0x39a8b9a8,0xbba8b4a5,0x323e3bd9,0x3a2fb913
.long 0x80003c00,0x3aa7b872,0xbb64b61f,0x323e3bd9,0xb9a8b9a8,0xae463bf6,0x3aa7b872,0xbba8b4a5
.long 0x3c008000,0xb9a8b9a8,0x80003c00,0x39a8b9a8,0xb9a839a8,0x3bf6ae46,0xbaa7b872,0x34a53ba8
.long 0xbc00,0xb8723aa7,0x3b64b61f,0xbbd9b23e,0x39a839a8,0xb4a5bba8,0xb23e3bd9,0x3913ba2f
.long 0xbc008000,0x3b64361f,0xb9a8b9a8,0x361f3b64,0x39a8b9a8,0xbb0e378b,0x3bd9b23e,0xbbf6ae46
.long 0x80003c00,0x323ebbd9,0xb61f3b64,0x3872baa7,0xb9a8b9a8,0x39133a2f,0xb872baa7,0x378b3b0e
.long 0x3c008000,0xbc00,0xbc008000,0x80003c00,0xb61f3b64,0x3ba834a5,0x323ebbd9,0xbbf6ae46
.long 0xb9a8b9a8,0xb8723aa7,0x3b64361f,0x323ebbd9,0x3b64b61f,0xb913ba2f,0xb8723aa7,0x3ba834a5
.long 0x80003c00,0x3b64b61f,0xb9a8b9a8,0xb61f3b64,0xbb64b61f,0x2e463bf6,0x3aa7b872,0xbb0eb78b
.long 0x39a8b9a8,0xbbd9b23e,0x361f3b64,0x3872baa7,0x361f3b64,0x378bbb0e,0xbbd9323e,0x3a2f3913
.long 0xbc008000,0x39a839a8,0xbc00,0xb9a839a8,0x361fbb64,0xbb0e378b,0x3bd9323e,0xb913ba2f
.long 0x39a839a8,0xb23ebbd9,0xb61f3b64,0x3aa7b872,0xbb64361f,0x3bf62e46,0xbaa7b872,0x378b3b0e
.long 0xbc00,0xb61f3b64,0x39a8b9a8,0xbb64361f,0x3b64361f,0xba2fb913,0x38723aa7,0xb4a5bba8
.long 0xb9a839a8,0x3aa7b872,0xbb64361f,0x3bd9b23e,0xb61fbb64,0x34a53ba8,0xb23ebbd9,0x2e463bf6
.long 0x3c00,0x3c000000,0xbc00,0xbc008000,0xbc008000,0x2e463bf6,0x3bd9b23e,0xb4a5bba8
.long 0xbc00,0xbbd9323e,0x361f3b64,0x3aa7b872,0x3c000000,0xb4a5bba8,0xbaa73872,0x3a2f3913
.long 0x3c00,0x3b64b61f,0xb9a8b9a8,0xb61f3b64,0xbc008000,0x378b3b0e,0x3872baa7,0xbbf6ae46
.long 0xbc00,0xbaa73872,0x3b64361f,0xb23ebbd9,0x3c000000,0xb913ba2f,0xb23e3bd9,0x3b0eb78b
.long 0x3c00,0x39a8b9a8,0xbc008000,0x39a839a8,0xbc008000,0x3a2f3913,0xb23ebbd9,0xb78b3b0e
.long 0xbc00,0xb8723aa7,0x3b64b61f,0xbbd9b23e,0x3c000000,0xbb0eb78b,0x38723aa7,0xae46bbf6
.long 0x3c00,0x361fbb64,0xb9a839a8,0x3b64b61f,0xbc008000,0x3ba834a5,0xbaa7b872,0x39133a2f
.long 0xbc00,0xb23e3bd9,0x361fbb64,0xb8723aa7,0x3c000000,0xbbf6ae46,0x3bd9323e,0xbba8b4a5
.long 0x3c00,0x3c000000,0xbc00,0xbc008000,0xbb64361f,0x378b3b0e,0x3aa7b872,0xb913ba2f
.long 0xb9a8b9a8,0xb8723aa7,0x3b64361f,0x323ebbd9,0x361fbb64,0xbbf6ae46,0x323e3bd9,0x3b0eb78b
.long 0x3c000000,0xb61fbb64,0xb9a839a8,0x3b64361f,0x361f3b64,0x3913ba2f,0xbbd9b23e,0x34a53ba8
.long 0xb9a839a8,0x3bd9323e,0xb61fbb64,0xb8723aa7,0xbb64b61f,0x34a53ba8,0x3872baa7,0xbbf62e46
.long 0xbc00,0xb9a839a8,0x3c000000,0xb9a8b9a8,0x3b64b61f,0xbba8b4a5,0x38723aa7,0x2e46bbf6
.long 0x39a839a8,0xb23ebbd9,0xb61f3b64,0x3aa7b872,0xb61f3b64,0x3a2fb913,0xbbd9323e,0x3ba834a5
.long 0xbc008000,0x3b64361f,0xb9a8b9a8,0x361f3b64,0xb61fbb64,0x2e463bf6,0x323ebbd9,0xb78b3b0e
.long 0x39a8b9a8,0xbaa73872,0x3b64b61f,0xbbd9323e,0x3b64361f,0xbb0eb78b,0x3aa73872,0xba2fb913
.long 0x3c00,0x3c000000,0xbc00,0xbc008000,0xb9a839a8,0x3a2f3913,0x3872baa7,0xbb0eb78b
.long 0xbc008000,0x323e3bd9,0x3b64b61f,0xb872baa7,0xb9a8b9a8,0xb78b3b0e,0x3bd9323e,0xae46bbf6
.long 0xbc00,0xbb64361f,0x39a839a8,0x361fbb64,0x39a8b9a8,0xbba8b4a5,0x323e3bd9,0x3a2fb913
.long 0x3c000000,0xb872baa7,0xb61f3b64,0x3bd9b23e,0x39a839a8,0x2e46bbf6,0xbaa73872,0x3ba834a5
.long 0x3c00,0x39a8b9a8,0xbc008000,0x39a839a8,0xb9a839a8,0x3bf6ae46,0xbaa7b872,0x34a53ba8
.long 0xbc008000,0x3aa73872,0xb61fbb64,0xb23e3bd9,0xb9a8b9a8,0x34a53ba8,0x323ebbd9,0xb9133a2f
.long 0xbc00,0xb61f3b64,0x39a8b9a8,0xbb64361f,0x39a8b9a8,0xbb0e378b,0x3bd9b23e,0xbbf6ae46
.long 0x3c000000,0xbbd9b23e,0x3b64361f,0xbaa7b872,0x39a839a8,0xb913ba2f,0x38723aa7,0xb78bbb0e
.long 0x3c00,0x3c000000,0xbc00,0xbc008000,0xb61f3b64,0x3ba834a5,0x323ebbd9,0xbbf6ae46
.long 0xb9a839a8,0x3aa73872,0x361fbb64,0xbbd9b23e,0xbb64361f,0x39133a2f,0x3872baa7,0xbba8b4a5
.long 0xbc008000,0x361f3b64,0x39a8b9a8,0xbb64b61f,0xbb64b61f,0x2e463bf6,0x3aa7b872,0xbb0eb78b
.long 0xb9a8b9a8,0xb23e3bd9,0x3b64b61f,0xbaa7b872,0xb61fbb64,0xb78b3b0e,0x3bd9b23e,0xba2fb913
.long 0xbc00,0xb9a839a8,0x3c000000,0xb9a8b9a8,0x361fbb64,0xbb0e378b,0x3bd9323e,0xb913ba2f
.long 0x39a8b9a8,0xbbd9323e,0x3b64361f,0xb872baa7,0x3b64b61f,0xbbf6ae46,0x3aa73872,0xb78bbb0e
.long 0x3c000000,0xbb64b61f,0x39a839a8,0xb61fbb64,0x3b64361f,0xba2fb913,0x38723aa7,0xb4a5bba8
.long 0x39a839a8,0xb872baa7,0x361f3b64,0xb23ebbd9,0x361f3b64,0xb4a5bba8,0x323e3bd9,0xae46bbf6
.long 0x3c008000,0xbc00,0xbc008000,0x80003c00,0x80003c00,0x3bf6ae46,0xb23ebbd9,0xbba834a5
.long 0xbc008000,0x323e3bd9,0x3b64b61f,0xb872baa7,0xbc00,0xbba834a5,0x38723aa7,0x3913ba2f
.long 0x3c008000,0xb61fbb64,0xb9a839a8,0x3b64361f,0x80003c00,0x3b0eb78b,0xbaa7b872,0xae463bf6
.long 0xbc008000,0x38723aa7,0x361fbb64,0xbbd9323e,0xbc00,0xba2f3913,0x3bd9323e,0xb78bbb0e
.long 0x3c008000,0xb9a8b9a8,0x80003c00,0x39a8b9a8,0x80003c00,0x3913ba2f,0xbbd9323e,0x3b0e378b
.long 0xbc008000,0x3aa73872,0xb61fbb64,0xb23e3bd9,0xbc00,0xb78b3b0e,0x3aa7b872,0xbbf62e46
.long 0x3c008000,0xbb64b61f,0x39a839a8,0xb61fbb64,0x80003c00,0x34a5bba8,0xb8723aa7,0x3a2fb913
.long 0xbc008000,0x3bd9323e,0xbb64b61f,0x3aa73872,0xbc00,0xae463bf6,0x323ebbd9,0xb4a53ba8
.long 0x3c008000,0xbc00,0xbc008000,0x80003c00,0x361f3b64,0x3b0eb78b,0xb872baa7,0xba2f3913
.long 0xb9a839a8,0x3aa73872,0x361fbb64,0xbbd9b23e,0xbb64b61f,0xae463bf6,0x3bd9b23e,0xb78bbb0e
.long 0xbc00,0xbb64361f,0x39a839a8,0x361fbb64,0x3b64b61f,0xba2fb913,0xb23e3bd9,0x3ba8b4a5
.long 0x39a839a8,0x323ebbd9,0xbb64361f,0x3aa73872,0xb61f3b64,0x3ba8b4a5,0xbaa7b872,0x2e463bf6
.long 0xbc008000,0x39a839a8,0xbc00,0xb9a839a8,0xb61fbb64,0xb4a53ba8,0x3aa7b872,0xbbf6ae46
.long 0x39a8b9a8,0xbbd9323e,0x3b64361f,0xb872baa7,0x3b64361f,0xb913ba2f,0x323e3bd9,0x34a5bba8
.long 0x80003c00,0x361fbb64,0xb9a839a8,0x3b64b61f,0xbb64361f,0x3bf6ae46,0xbbd9b23e,0x3b0e378b
.long 0xb9a8b9a8,0x38723aa7,0xb61fbb64,0x323e3bd9,0x361fbb64,0xb78b3b0e,0x3872baa7,0xb9133a2f
.long 0x3c008000,0xbc00,0xbc008000,0x80003c00,0x39a839a8,0x3913ba2f,0xbaa7b872,0xb78b3b0e
.long 0x80003c00,0x3bd9b23e,0xb61fbb64,0xbaa73872,0xb9a839a8,0x3b0e378b,0x323ebbd9,0xbbf62e46
.long 0xbc008000,0x361f3b64,0x39a8b9a8,0xbb64b61f,0xb9a8b9a8,0xb4a53ba8,0x3bd9b23e,0xb913ba2f
.long 0xbc00,0xbaa73872,0x3b64361f,0xb23ebbd9,0x39a8b9a8,0xbbf6ae46,0x38723aa7,0x34a5bba8
.long 0x3c008000,0xb9a8b9a8,0x80003c00,0x39a8b9a8,0x39a839a8,0xae46bbf6,0xb8723aa7,0x3ba8b4a5
.long 0x80003c00,0x3872baa7,0xbb64361f,0x3bd9323e,0xb9a839a8,0x3ba8b4a5,0xbbd9b23e,0x3a2f3913
.long 0xbc008000,0x3b64361f,0xb9a8b9a8,0x361f3b64,0xb9a8b9a8,0x378b3b0e,0xb23ebbd9,0xae463bf6
.long 0xbc00,0xb23e3bd9,0x361fbb64,0xb8723aa7,0x39a8b9a8,0xba2f3913,0x3aa7b872,0xbb0e378b
.long 0x3c008000,0xbc00,0xbc008000,0x80003c00,0x3b64361f,0x34a5bba8,0xbbd9b23e,0xae463bf6
.long 0x39a839a8,0x3872baa7,0xbb64b61f,0xb23e3bd9,0x361f3b64,0x3a2fb913,0xbaa7b872,0xb4a53ba8
.long 0x80003c00,0x3b64b61f,0xb9a8b9a8,0xb61f3b64,0xb61f3b64,0x3bf6ae46,0xb872baa7,0xb78b3b0e
.long 0xb9a839a8,0x3bd9323e,0xb61fbb64,0xb8723aa7,0xbb64361f,0x3b0e378b,0xb23ebbd9,0xb9133a2f
.long 0xbc008000,0x39a839a8,0xbc00,0xb9a839a8,0xbb64b61f,0x378b3b0e,0x323ebbd9,0xba2f3913
.long 0xb9a8b9a8,0x323e3bd9,0x361fbb64,0xbaa73872,0xb61fbb64,0xae463bf6,0x3872baa7,0xbb0e378b
.long 0xbc00,0xb61f3b64,0x39a8b9a8,0xbb64361f,0x361fbb64,0xb9133a2f,0x3aa7b872,0xbba834a5
.long 0x39a8b9a8,0xbaa73872,0x3b64b61f,0xbbd9323e,0x3b64b61f,0xbba834a5,0x3bd9b23e,0xbbf62e46
.long 0x3e000000,0x80000000,0x3dffb10f,0xbbc8fb30,0x3e000000,0x80000000,0x3dffa6e3,0xbbd5880e
.long 0x3e000000,0x80000000,0x3dff9c18,0xbbe21469,0x3e000000,0x80000000,0x3dff90b1,0xbbeea038
.long 0x3e000000,0x80000000,0x3dff84ab,0xbbfb2b74,0x3e000000,0x80000000,0x3dff7808,0xbc03db0a
.long 0x3e000000,0x80000000,0x3dff6ac7,0xbc0a200a,0x3e000000,0x80000000,0x3dff5ce9,0xbc1064b4
.long 0x3e000000,0x80000000,0x3dff4e6d,0xbc16a905,0x3e000000,0x80000000,0x3dff3f54,0xbc1cecf9
.long 0x3e000000,0x80000000,0x3dff2f9d,0xbc23308c,0x3e000000,0x80000000,0x3dff1f49,0xbc2973ba
.long 0x3e000000,0x80000000,0x3dff0e58,0xbc2fb680,0x3e000000,0x80000000,0x3dfefcc9,0xbc35f8da
.long 0x3e000000,0x80000000,0x3dfeea9d,0xbc3c3ac3,0x3e000000,0x80000000,0x3dfed7d4,0xbc427c39
.long 0x3dfb14be,0xbcc7c5c2,0x3df853f8,0xbcf8cfcc,0x3dfa7302,0xbcd41501,0x3df7583a,0xbd040270
.long 0x3df9c79d,0xbce05c13,0x3df64d97,0xbd0b9507,0x3df91298,0xbcec9a7f,0x3df5341d,0xbd131f35
.long 0x3df853f8,0xbcf8cfcc,0x3df40bdd,0xbd1aa086,0x3df78bc5,0xbd027dc0,0x3df2d4eb,0xbd221887
.long 0x3df6ba07,0xbd088e93,0x3df18f57,0xbd2986c4,0x3df5dec6,0xbd0e9a22,0x3df03b37,0xbd30eacb
.long 0x3df4fa0b,0xbd14a031,0x3deed89e,0xbd38442a,0x3df40bdd,0xbd1aa086,0x3ded67a1,0xbd3f926f
.long 0x3df31447,0xbd209ae5,0x3debe858,0xbd46d529,0x3df21352,0xbd268f12,0x3dea5ad9,0xbd4e0bea
.long 0x3df10908,0xbd2c7cd4,0x3de8bf3c,0xbd553641,0x3deff573,0xbd3263ef,0x3de71599,0xbd5c53c1
.long 0x3deed89e,0xbd38442a,0x3de55e0b,0xbd6363fa,0x3dedb293,0xbd3e1d4a,0x3de398ac,0xbd6a6681
.long 0x3dec835e,0xbd43ef15,0x3de76bd8,0xbd5ae880,0x3dea09a7,0xbd4f7bca,0x3de44fac,0xbd679a5d
.long 0x3de76bd8,0xbd5ae880,0x3de106f2,0xbd741f07,0x3de4aa59,0xbd663375,0x3ddd924d,0xbd803a06
.long 0x3de1c598,0xbd715aea,0x3dd9f26a,0xbd864b82,0x3ddebe05,0xbd7c5d27,0x3dd627fe,0xbd8c42c9
.long 0x3ddb941a,0xbd839c3d,0x3dd233c6,0xbd921eb0,0x3dd84853,0xbd88f59b,0x3dce1689,0xbd97de12
.long 0x3dd4db31,0xbd8e39da,0x3dc9d112,0xbd9d7fd1,0x3dd14d3d,0xbd93682a,0x3dc56439,0xbda302d3
.long 0x3dcd9f02,0xbd987fc0,0x3dc0d0da,0xbda86605,0x3dc9d112,0xbd9d7fd1,0x3dbc17d9,0xbdada859
.long 0x3dc5e403,0xbda26799,0x3db73a23,0xbdb2c8c9,0x3dc1d870,0xbda73656,0x3db238aa,0xbdb7c655
.long 0x3dbdaef9,0xbdabeb4a,0x3dad1469,0xbdbca003,0x3db96842,0xbdb085bb,0x3da7ce61,0xbdc154e1
.long 0x3dd4db31,0xbd8e39da,0x3dcd9f02,0xbd987fc0,0x3dcf7a1f,0xbd95f6d9,0x3dc76085,0xbda09393
.long 0x3dc9d112,0xbd9d7fd1,0x3dc0d0da,0xbda86605,0x3dc3e200,0xbda4d225,0x3db9f2ac,0xbdaff3e6
.long 0x3dbdaef9,0xbdabeb4a,0x3db2c8c9,0xbdb73a23,0x3db73a23,0xbdb2c8c9,0x3dab561b,0xbdbe35c5
.long 0x3db085bb,0xbdb96842,0x3da39da9,0xbdc4e3f5,0x3da99415,0xbdbfc767,0x3d9ba299,0xbdcb41fa
.long 0x3da26799,0xbdc5e403,0x3d93682a,0xbdd14d3d,0x3d9b02c6,0xbdcbbbf8,0x3d8af1b7,0xbdd70348
.long 0x3d93682a,0xbdd14d3d,0x3d8242b1,0xbddc61c7,0x3d8b9a6b,0xbdd695e5,0x3d72bd43,0xbde1668a
.long 0x3d839c3d,0xbddb941a,0x3d60924f,0xbde60f88,0x3d76e0cb,0xbde04621,0x3d4e0bea,0xbdea5ad9
.long 0x3d663375,0xbde4aa59,0x3d3b31a0,0xbdee46be,0x3d553641,0xbde8bf3c,0x3d280b1f,0xbdf1d19f
.long 0x3dfec46d,0xbc48bd36,0x3dfd3aac,0xbc964083,0x3dfe9bc9,0xbc553db9,0x3dfcdf6c,0xbc9f917b
.long 0x3dfe70b0,0xbc61bc2e,0x3dfc7eb0,0xbca8defc,0x3dfe4323,0xbc6e3876,0x3dfc187a,0xbcb228d4
.long 0x3dfe1324,0xbc7ab273,0x3dfbaccd,0xbcbb6ecf,0x3dfde0b1,0xbc839502,0x3dfb3bab,0xbcc4b0b9
.long 0x3dfdabcc,0xbc89cf86,0x3dfac516,0xbccdee60,0x3dfd7474,0xbc9008b7,0x3dfa4910,0xbcd7278f
.long 0x3dfd3aac,0xbc964083,0x3df9c79d,0xbce05c13,0x3dfcfe73,0xbc9c76de,0x3df940c0,0xbce98bba
.long 0x3dfcbfc9,0xbca2abb6,0x3df8b47b,0xbcf2b651,0x3dfc7eb0,0xbca8defc,0x3df822d1,0xbcfbdba4
.long 0x3dfc3b28,0xbcaf10a2,0x3df78bc5,0xbd027dc0,0x3dfbf531,0xbcb54098,0x3df6ef5b,0xbd070ada
.long 0x3dfbaccd,0xbcbb6ecf,0x3df64d97,0xbd0b9507,0x3dfb61fc,0xbcc19b37,0x3df5a67b,0xbd101c2c
.long 0x3df4fa0b,0xbd14a031,0x3df10908,0xbd2c7cd4,0x3df3913f,0xbd1d9e78,0x3def20b0,0xbd36ccc3
.long 0x3df21352,0xbd268f12,0x3ded1c1d,0xbd41071e,0x3df08066,0xbd2f713a,0x3deafb8c,0xbd4b2aae
.long 0x3deed89e,0xbd38442a,0x3de8bf3c,0xbd553641,0x3ded1c1d,0xbd41071e,0x3de66771,0xbd5f28a9
.long 0x3deb4b0c,0xbd49b953,0x3de3f473,0xbd6900b7,0x3de96591,0xbd525a09,0x3de1668a,0xbd72bd43
.long 0x3de76bd8,0xbd5ae880,0x3ddebe05,0xbd7c5d27,0x3de55e0b,0xbd6363fa,0x3ddbfb34,0xbd82ef9f
.long 0x3de33c5a,0xbd6bcbbb,0x3dd91e6a,0xbd87a136,0x3de106f2,0xbd741f07,0x3dd627fe,0xbd8c42c9
.long 0x3ddebe05,0xbd7c5d27,0x3dd31849,0xbd90d3cd,0x3ddc61c7,0xbd8242b1,0x3dcfefa8,0xbd9553b7
.long 0x3dd9f26a,0xbd864b82,0x3dccae79,0xbd99c200,0x3dd77026,0xbd8a48ad,0x3dc95521,0xbd9e1e22
.long 0x3de1c598,0xbd715aea,0x3ddb941a,0xbd839c3d,0x3dddf6be,0xbd7f17b2,0x3dd70348,0xbd8af1b7
.long 0x3dd9f26a,0xbd864b82,0x3dd233c6,0xbd921eb0,0x3dd5b993,0xbd8cead0,0x3dcd26fd,0xbd99210f
.long 0x3dd14d3d,0xbd93682a,0x3dc7de65,0xbd9ff6cb,0x3dccae79,0xbd99c200,0x3dc25b89,0xbda69de3
.long 0x3dc7de65,0xbd9ff6cb,0x3dbca003,0xbdad1469,0x3dc2de29,0xbda6050a,0x3db6ad7f,0xbdb3587a
.long 0x3dbdaef9,0xbdabeb4a,0x3db085bb,0xbdb96842,0x3db85216,0xbdb1a81d,0x3daa2a80,0xbdbf41fc
.long 0x3db2c8c9,0xbdb73a23,0x3da39da9,0xbdc4e3f5,0x3dad1469,0xbdbca003,0x3d9ce11f,0xbdca4c87
.long 0x3da73656,0xbdc1d870,0x3d95f6d9,0xbdcf7a1f,0x3da12ff9,0xbdc6e22a,0x3d8ee0db,0xbdd46b3b
.long 0x3d9b02c6,0xbdcbbbf8,0x3d87a136,0xbdd91e6a,0x3d94b039,0xbdd064af,0x3d803a06,0xbddd924d
.long 0x3dc5e403,0xbda26799,0x3dbdaef9,0xbdabeb4a,0x3dbebc1b,0xbdaac082,0x3db592e7,0xbdb4768f
.long 0x3db73a23,0xbdb2c8c9,0x3dad1469,0xbdbca003,0x3daf61a5,0xbdba7ca4,0x3da4381a,0xbdc46337
.long 0x3da73656,0xbdc1d870,0x3d9b02c6,0xbdcbbbf8,0x3d9ebc12,0xbdc8d8b3,0x3d91796b,0xbdd2a649
.long 0x3d95f6d9,0xbdcf7a1f,0x3d87a136,0xbdd91e6a,0x3d8cead0,0xbdd5b993,0x3d7afef7,0xbddf20db
.long 0x3d839c3d,0xbddb941a,0x3d663375,0xbde4aa59,0x3d741f07,0xbde106f2,0x3d50eb2a,0xbde9b7e4
.long 0x3d60924f,0xbde60f88,0x3d3b31a0,0xbdee46be,0x3d4c9b8b,0xbdeaab7b,0x3d25129f,0xbdf25470
.long 0x3d38442a,0xbdeed89e,0x3d0e9a22,0xbdf5dec6,0x3d2395c5,0xbdf294f8,0x3cefa8b2,0xbdf8e3d6
.long 0x3d0e9a22,0xbdf5dec6,0x3cc19b37,0xbdfb61fc,0x3cf2b651,0xbdf8b47b,0x3c9324ca,0xbdfd57de
.long 0x3db504f3,0xbdb504f3,0x3dabeb4a,0xbdbdaef9,0x3dabeb4a,0xbdbdaef9,0x3da1cbfb,0xbdc66354
.long 0x3da26799,0xbdc5e403,0x3d973c07,0xbdce8d90,0x3d987fc0,0xbdcd9f02,0x3d8c42c9,0xbdd627fe
.long 0x3d8e39da,0xbdd4db31,0x3d80e7e4,0xbddd2d53,0x3d839c3d,0xbddb941a,0x3d6a6681,0xbde398ac
.long 0x3d715aea,0xbde1c598,0x3d525a09,0xbde96591,0x3d5ae880,0xbde76bd8,0x3d39bb1e,0xbdee8ff8
.long 0x3d43ef15,0xbdec835e,0x3d209ae5,0xbdf31447,0x3d2c7cd4,0xbdf10908,0x3d070ada,0xbdf6ef5b
.long 0x3d14a031,0xbdf4fa0b,0x3cda3997,0xbdfa1e84,0x3cf8cfcc,0xbdf853f8,0x3ca5c58c,0xbdfc9f8a
.long 0x3cc7c5c2,0xbdfb14be,0x3c61bc2e,0xbdfe70b0,0x3c964083,0xbdfd3aac,0x3beea038,0xbdff90b1
.long 0x3c48bd36,0xbdfec46d,0x3a490f88,0xbdfffec4,0x3bc8fb30,0xbdffb10f,0xbbbc6dd5,0xbdffba9e
.long 0x3d8e39da,0xbdd4db31,0x3d839c3d,0xbddb941a,0x3d80e7e4,0xbddd2d53,0x3d6a6681,0xbde398ac
.long 0x3d663375,0xbde4aa59,0x3d4c9b8b,0xbdeaab7b,0x3d49b953,0xbdeb4b0c,0x3d2df73c,0xbdf0c501
.long 0x3d2c7cd4,0xbdf10908,0x3d0e9a22,0xbdf5dec6,0x3d0e9a22,0xbdf5dec6,0x3cdd4b1a,0xbdf9f35e
.long 0x3ce05c13,0xbdf9c79d,0x3c9c76de,0xbdfcfe73,0x3ca2abb6,0xbdfcbfc9,0x3c35f8da,0xbdfefcc9
.long 0x3c48bd36,0xbdfec46d,0x3b490ab0,0xbdffec43,0x3b96c32c,0xbdffd397,0xbba351cb,0xbdffcbe2
.long 0xbb490ab0,0xbdffec43,0xbc553db9,0xbdfe9bc9,0xbc2fb680,0xbdff0e58,0xbcabf804,0xbdfc5d3a
.long 0xbc964083,0xbdfd3aac,0xbcec9a7f,0xbdf91298,0xbcd41501,0xbdfa7302,0xbd1620d2,0xbdf4bf62
.long 0xbd088e93,0xbdf6ba07,0xbd3554ec,0xbdef6830,0xbd268f12,0xbdf21352,0xbd53c867,0xbde912ae
.long 0x3d43ef15,0xbdec835e,0x3d2c7cd4,0xbdf10908,0x3d209ae5,0xbdf31447,0x3d070ada,0xbdf6ef5b
.long 0x3cf8cfcc,0xbdf853f8,0x3cc19b37,0xbdfb61fc,0x3caf10a2,0xbdfc3b28,0x3c67fa9a,0xbdfe5a38
.long 0x3c48bd36,0xbdfec46d,0x3b96c32c,0xbdffd397,0x3b490ab0,0xbdffec43,0xbba351cb,0xbdffcbe2
.long 0xbbc8fb30,0xbdffb10f,0xbc6e3876,0xbdfe4323,0xbc7ab273,0xbdfe1324,0xbcc4b0b9,0xbdfb3bab
.long 0xbcc7c5c2,0xbdfb14be,0xbd088e93,0xbdf6ba07,0xbd088e93,0xbdf6ba07,0xbd2df73c,0xbdf0c501
.long 0xbd2c7cd4,0xbdf10908,0xbd525a09,0xbde96591,0xbd4f7bca,0xbdea09a7,0xbd758035,0xbde0a6cf
.long 0xbd715aea,0xbde1c598,0xbd8b9a6b,0xbdd695e5,0xbd88f59b,0xbdd84853,0xbd9ba299,0xbdcb41fa
.long 0xbd987fc0,0xbdcd9f02,0xbdaac082,0xbdbebc1b,0xbda73656,0xbdc1d870,0xbdb8dd65,0xbdb11722
.long 0x3cc7c5c2,0xbdfb14be,0x3c964083,0xbdfd3aac,0x3c61bc2e,0xbdfe70b0,0x3beea038,0xbdff90b1
.long 0x3b490ab0,0xbdffec43,0xbb7b49ba,0xbdffe129,0xbbfb2b74,0xbdff84ab,0xbc7475c0,0xbdfe2b72
.long 0xbc964083,0xbdfd3aac,0xbcd41501,0xbdfa7302,0xbcec9a7f,0xbdf91298,0xbd1620d2,0xbdf4bf62
.long 0xbd209ae5,0xbdf31447,0xbd41071e,0xbded1c1d,0xbd49b953,0xbdeb4b0c,0xbd6a6681,0xbde398ac
.long 0xbd715aea,0xbde1c598,0xbd88f59b,0xbdd84853,0xbd8b9a6b,0xbdd695e5,0xbd9ba299,0xbdcb41fa
.long 0xbd9d7fd1,0xbdc9d112,0xbdad1469,0xbdbca003,0xbdae3bde,0xbdbb8f3b,0xbdbd27b8,0xbdac800f
.long 0xbdbdaef9,0xbdabeb4a,0xbdcbbbf8,0xbd9b02c6,0xbdcbbbf8,0xbd9b02c6,0xbdd8b3a1,0xbd884b92
.long 0xbdd84853,0xbd88f59b,0xbde3f473,0xbd6900b7,0xbde33c5a,0xbd6bcbbb,0xbded67a1,0xbd3f926f
.long 0x3da26799,0xbdc5e403,0x3d987fc0,0xbdcd9f02,0x3d973c07,0xbdce8d90,0x3d8c42c9,0xbdd627fe
.long 0x3d8b9a6b,0xbdd695e5,0x3d7f17b2,0xbdddf6be,0x3d7f17b2,0xbdddf6be,0x3d64cbfe,0xbde50479
.long 0x3d663375,0xbde4aa59,0x3d49b953,0xbdeb4b0c,0x3d4c9b8b,0xbdeaab7b,0x3d2df73c,0xbdf0c501
.long 0x3d3263ef,0xbdeff573,0x3d119ddd,0xbdf56d97,0x3d17a117,0xbdf48422,0x3ce98bba,0xbdf940c0
.long 0x3cf8cfcc,0xbdf853f8,0x3caf10a2,0xbdfc3b28,0x3cc19b37,0xbdfb61fc,0x3c67fa9a,0xbdfe5a38
.long 0x3c89cf86,0xbdfdabcc,0x3be21469,0xbdff9c18,0x3c23308c,0xbdff2f9d,0xb9c90fc6,0xbdffffb1
.long 0x3b490ab0,0xbdffec43,0xbbfb2b74,0xbdff84ab,0xbb7b49ba,0xbdffe129,0xbc7475c0,0xbdfe2b72
.long 0xbc2fb680,0xbdff0e58,0xbcb54098,0xbdfbf531,0xbc9008b7,0xbdfd7474,0xbcefa8b2,0xbdf8e3d6
.long 0x3d715aea,0xbde1c598,0x3d5ae880,0xbde76bd8,0x3d525a09,0xbde96591,0x3d39bb1e,0xbdee8ff8
.long 0x3d3263ef,0xbdeff573,0x3d17a117,0xbdf48422,0x3d119ddd,0xbdf56d97,0x3ce98bba,0xbdf940c0
.long 0x3ce05c13,0xbdf9c79d,0x3ca2abb6,0xbdfcbfc9,0x3c9c76de,0xbdfcfe73,0x3c35f8da,0xbdfefcc9
.long 0x3c2fb680,0xbdff0e58,0x3b16c9b6,0xbdfff4e6,0x3b16c9b6,0xbdfff4e6,0xbbd5880e,0xbdffa6e3
.long 0xbbc8fb30,0xbdffb10f,0xbc7ab273,0xbdfe1324,0xbc6e3876,0xbdfe4323,0xbcc4b0b9,0xbdfb3bab
.long 0xbcbb6ecf,0xbdfbaccd,0xbd0586ce,0xbdf72417,0xbcfee6e1,0xbdf7f110,0xbd280b1f,0xbdf1d19f
.long 0xbd209ae5,0xbdf31447,0xbd49b953,0xbdeb4b0c,0xbd41071e,0xbded1c1d,0xbd6a6681,0xbde398ac
.long 0xbd60924f,0xbde60f88,0xbd84f484,0xbddac450,0xbd7f17b2,0xbdddf6be,0xbd940c5f,0xbdd0d937
.long 0x3d14a031,0xbdf4fa0b,0x3cf8cfcc,0xbdf853f8,0x3cda3997,0xbdfa1e84,0x3ca5c58c,0xbdfc9f8a
.long 0x3c89cf86,0xbdfdabcc,0x3c23308c,0xbdff2f9d,0x3be21469,0xbdff9c18,0xb9c90fc6,0xbdffffb1
.long 0xbb490ab0,0xbdffec43,0xbc2fb680,0xbdff0e58,0xbc553db9,0xbdfe9bc9,0xbcabf804,0xbdfc5d3a
.long 0xbcbb6ecf,0xbdfbaccd,0xbcfee6e1,0xbdf7f110,0xbd0586ce,0xbdf72417,0xbd280b1f,0xbdf1d19f
.long 0xbd2c7cd4,0xbdf10908,0xbd4f7bca,0xbdea09a7,0xbd525a09,0xbde96591,0xbd758035,0xbde0a6cf
.long 0xbd76e0cb,0xbde04621,0xbd8cead0,0xbdd5b993,0xbd8cead0,0xbdd5b993,0xbd9e1e22,0xbdc95521
.long 0xbd9d7fd1,0xbdc9d112,0xbdae3bde,0xbdbb8f3b,0xbdad1469,0xbdbca003,0xbdbd27b8,0xbdac800f
.long 0xbdbb8f3b,0xbdae3bde,0xbdcac77f,0xbd9c420c,0xbdc8d8b3,0xbd9ebc12,0xbdd70348,0xbd8af1b7
.long 0x3c48bd36,0xbdfec46d,0x3bc8fb30,0xbdffb10f,0x3a490f88,0xbdfffec4,0xbbbc6dd5,0xbdffba9e
.long 0xbc2fb680,0xbdff0e58,0xbc9008b7,0xbdfd7474,0xbcb54098,0xbdfbf531,0xbcefa8b2,0xbdf8e3d6
.long 0xbd088e93,0xbdf6ba07,0xbd268f12,0xbdf21352,0xbd3554ec,0xbdef6830,0xbd53c867,0xbde912ae
.long 0xbd60924f,0xbde60f88,0xbd7f17b2,0xbdddf6be,0xbd84f484,0xbddac450,0xbd940c5f,0xbdd0d937
.long 0xbd987fc0,0xbdcd9f02,0xbda73656,0xbdc1d870,0xbdaac082,0xbdbebc1b,0xbdb8dd65,0xbdb11722
.long 0xbdbb8f3b,0xbdae3bde,0xbdc8d8b3,0xbd9ebc12,0xbdcac77f,0xbd9c420c,0xbdd70348,0xbd8af1b7
.long 0xbdd84853,0xbd88f59b,0xbde33c5a,0xbd6bcbbb,0xbde3f473,0xbd6900b7,0xbded67a1,0xbd3f926f
.long 0xbdedb293,0xbd3e1d4a,0xbdf56d97,0xbd119ddd,0xbdf56d97,0xbd119ddd,0xbdfb3bab,0xbcc4b0b9
.long 0x3f000000,0x0,0x3f000000,0x0,0x3effb10f,0x3cc8fb30,0x3effa6e3,0x3cd5880e
.long 0x3efec46d,0x3d48bd36,0x3efe9bc9,0x3d553db9,0x3efd3aac,0x3d964083,0x3efcdf6c,0x3d9f917b
.long 0x3efb14be,0x3dc7c5c2,0x3efa7302,0x3dd41501,0x3ef853f8,0x3df8cfcc,0x3ef7583a,0x3e040270
.long 0x3ef4fa0b,0x3e14a031,0x3ef3913f,0x3e1d9e78,0x3ef10908,0x3e2c7cd4,0x3eef20b0,0x3e36ccc3
.long 0x3eec835e,0x3e43ef15,0x3eea09a7,0x3e4f7bca,0x3ee76bd8,0x3e5ae880,0x3ee44fac,0x3e679a5d
.long 0x3ee1c598,0x3e715aea,0x3eddf6be,0x3e7f17b2,0x3edb941a,0x3e839c3d,0x3ed70348,0x3e8af1b7
.long 0x3ed4db31,0x3e8e39da,0x3ecf7a1f,0x3e95f6d9,0x3ecd9f02,0x3e987fc0,0x3ec76085,0x3ea09393
.long 0x3ec5e403,0x3ea26799,0x3ebebc1b,0x3eaac082,0x3ebdaef9,0x3eabeb4a,0x3eb592e7,0x3eb4768f
.long 0x3f000000,0x0,0x3f000000,0x0,0x3eff84ab,0x3cfb2b74,0x3eff7808,0x3d03db0a
.long 0x3efe1324,0x3d7ab273,0x3efde0b1,0x3d839502,0x3efbaccd,0x3dbb6ecf,0x3efb3bab,0x3dc4b0b9
.long 0x3ef853f8,0x3df8cfcc,0x3ef78bc5,0x3e027dc0,0x3ef40bdd,0x3e1aa086,0x3ef2d4eb,0x3e221887
.long 0x3eeed89e,0x3e38442a,0x3eed1c1d,0x3e41071e,0x3ee8bf3c,0x3e553641,0x3ee66771,0x3e5f28a9
.long 0x3ee1c598,0x3e715aea,0x3edebe05,0x3e7c5d27,0x3ed9f26a,0x3e864b82,0x3ed627fe,0x3e8c42c9
.long 0x3ed14d3d,0x3e93682a,0x3eccae79,0x3e99c200,0x3ec7de65,0x3e9ff6cb,0x3ec25b89,0x3ea69de3
.long 0x3ebdaef9,0x3eabeb4a,0x3eb73a23,0x3eb2c8c9,0x3eb2c8c9,0x3eb73a23,0x3eab561b,0x3ebe35c5
.long 0x3ea73656,0x3ec1d870,0x3e9ebc12,0x3ec8d8b3,0x3e9b02c6,0x3ecbbbf8,0x3e91796b,0x3ed2a649
.long 0x3f000000,0x0,0x3f000000,0x0,0x3eff4e6d,0x3d16a905,0x3eff3f54,0x3d1cecf9
.long 0x3efd3aac,0x3d964083,0x3efcfe73,0x3d9c76de,0x3ef9c79d,0x3de05c13,0x3ef940c0,0x3de98bba
.long 0x3ef4fa0b,0x3e14a031,0x3ef40bdd,0x3e1aa086,0x3eeed89e,0x3e38442a,0x3eed67a1,0x3e3f926f
.long 0x3ee76bd8,0x3e5ae880,0x3ee55e0b,0x3e6363fa,0x3edebe05,0x3e7c5d27,0x3edbfb34,0x3e82ef9f
.long 0x3ed4db31,0x3e8e39da,0x3ed14d3d,0x3e93682a,0x3ec9d112,0x3e9d7fd1,0x3ec56439,0x3ea302d3
.long 0x3ebdaef9,0x3eabeb4a,0x3eb85216,0x3eb1a81d,0x3eb085bb,0x3eb96842,0x3eaa2a80,0x3ebf41fc
.long 0x3ea26799,0x3ec5e403,0x3e9b02c6,0x3ecbbbf8,0x3e93682a,0x3ed14d3d,0x3e8af1b7,0x3ed70348
.long 0x3e839c3d,0x3edb941a,0x3e741f07,0x3ee106f2,0x3e663375,0x3ee4aa59,0x3e50eb2a,0x3ee9b7e4
.long 0x3f000000,0x0,0x3f000000,0x0,0x3eff0e58,0x3d2fb680,0x3efefcc9,0x3d35f8da
.long 0x3efc3b28,0x3daf10a2,0x3efbf531,0x3db54098,0x3ef78bc5,0x3e027dc0,0x3ef6ef5b,0x3e070ada
.long 0x3ef10908,0x3e2c7cd4,0x3eeff573,0x3e3263ef,0x3ee8bf3c,0x3e553641,0x3ee71599,0x3e5c53c1
.long 0x3edebe05,0x3e7c5d27,0x3edc61c7,0x3e8242b1,0x3ed31849,0x3e90d3cd,0x3ecfefa8,0x3e9553b7
.long 0x3ec5e403,0x3ea26799,0x3ec1d870,0x3ea73656,0x3eb73a23,0x3eb2c8c9,0x3eb238aa,0x3eb7c655
.long 0x3ea73656,0x3ec1d870,0x3ea12ff9,0x3ec6e22a,0x3e95f6d9,0x3ecf7a1f,0x3e8ee0db,0x3ed46b3b
.long 0x3e839c3d,0x3edb941a,0x3e76e0cb,0x3ee04621,0x3e60924f,0x3ee60f88,0x3e4e0bea,0x3eea5ad9
.long 0x3e38442a,0x3eeed89e,0x3e2395c5,0x3ef294f8,0x3e0e9a22,0x3ef5dec6,0x3defa8b2,0x3ef8e3d6
.long 0x3f000000,0x0,0x3f000000,0x0,0x3eff9c18,0x3ce21469,0x3eff90b1,0x3ceea038
.long 0x3efe70b0,0x3d61bc2e,0x3efe4323,0x3d6e3876,0x3efc7eb0,0x3da8defc,0x3efc187a,0x3db228d4
.long 0x3ef9c79d,0x3de05c13,0x3ef91298,0x3dec9a7f,0x3ef64d97,0x3e0b9507,0x3ef5341d,0x3e131f35
.long 0x3ef21352,0x3e268f12,0x3ef08066,0x3e2f713a,0x3eed1c1d,0x3e41071e,0x3eeafb8c,0x3e4b2aae
.long 0x3ee76bd8,0x3e5ae880,0x3ee4aa59,0x3e663375,0x3ee106f2,0x3e741f07,0x3edd924d,0x3e803a06
.long 0x3ed9f26a,0x3e864b82,0x3ed5b993,0x3e8cead0,0x3ed233c6,0x3e921eb0,0x3ecd26fd,0x3e99210f
.long 0x3ec9d112,0x3e9d7fd1,0x3ec3e200,0x3ea4d225,0x3ec0d0da,0x3ea86605,0x3eb9f2ac,0x3eaff3e6
.long 0x3eb73a23,0x3eb2c8c9,0x3eaf61a5,0x3eba7ca4,0x3ead1469,0x3ebca003,0x3ea4381a,0x3ec46337
.long 0x3f000000,0x0,0x3f000000,0x0,0x3eff6ac7,0x3d0a200a,0x3eff5ce9,0x3d1064b4
.long 0x3efdabcc,0x3d89cf86,0x3efd7474,0x3d9008b7,0x3efac516,0x3dcdee60,0x3efa4910,0x3dd7278f
.long 0x3ef6ba07,0x3e088e93,0x3ef5dec6,0x3e0e9a22,0x3ef18f57,0x3e2986c4,0x3ef03b37,0x3e30eacb
.long 0x3eeb4b0c,0x3e49b953,0x3ee96591,0x3e525a09,0x3ee3f473,0x3e6900b7,0x3ee1668a,0x3e72bd43
.long 0x3edb941a,0x3e839c3d,0x3ed84853,0x3e88f59b,0x3ed233c6,0x3e921eb0,0x3ece1689,0x3e97de12
.long 0x3ec7de65,0x3e9ff6cb,0x3ec2de29,0x3ea6050a,0x3ebca003,0x3ead1469,0x3eb6ad7f,0x3eb3587a
.long 0x3eb085bb,0x3eb96842,0x3ea99415,0x3ebfc767,0x3ea39da9,0x3ec4e3f5,0x3e9ba299,0x3ecb41fa
.long 0x3e95f6d9,0x3ecf7a1f,0x3e8cead0,0x3ed5b993,0x3e87a136,0x3ed91e6a,0x3e7afef7,0x3edf20db
.long 0x3f000000,0x0,0x3f000000,0x0,0x3eff2f9d,0x3d23308c,0x3eff1f49,0x3d2973ba
.long 0x3efcbfc9,0x3da2abb6,0x3efc7eb0,0x3da8defc,0x3ef8b47b,0x3df2b651,0x3ef822d1,0x3dfbdba4
.long 0x3ef31447,0x3e209ae5,0x3ef21352,0x3e268f12,0x3eebe858,0x3e46d529,0x3eea5ad9,0x3e4e0bea
.long 0x3ee33c5a,0x3e6bcbbb,0x3ee106f2,0x3e741f07,0x3ed91e6a,0x3e87a136,0x3ed627fe,0x3e8c42c9
.long 0x3ecd9f02,0x3e987fc0,0x3ec9d112,0x3e9d7fd1,0x3ec0d0da,0x3ea86605,0x3ebc17d9,0x3eada859
.long 0x3eb2c8c9,0x3eb73a23,0x3ead1469,0x3ebca003,0x3ea39da9,0x3ec4e3f5,0x3e9ce11f,0x3eca4c87
.long 0x3e93682a,0x3ed14d3d,0x3e8b9a6b,0x3ed695e5,0x3e8242b1,0x3edc61c7,0x3e72bd43,0x3ee1668a
.long 0x3e60924f,0x3ee60f88,0x3e4c9b8b,0x3eeaab7b,0x3e3b31a0,0x3eee46be,0x3e25129f,0x3ef25470
.long 0x3f000000,0x0,0x3f000000,0x0,0x3efeea9d,0x3d3c3ac3,0x3efed7d4,0x3d427c39
.long 0x3efbaccd,0x3dbb6ecf,0x3efb61fc,0x3dc19b37,0x3ef64d97,0x3e0b9507,0x3ef5a67b,0x3e101c2c
.long 0x3eeed89e,0x3e38442a,0x3eedb293,0x3e3e1d4a,0x3ee55e0b,0x3e6363fa,0x3ee398ac,0x3e6a6681
.long 0x3ed9f26a,0x3e864b82,0x3ed77026,0x3e8a48ad,0x3eccae79,0x3e99c200,0x3ec95521,0x3e9e1e22
.long 0x3ebdaef9,0x3eabeb4a,0x3eb96842,0x3eb085bb,0x3ead1469,0x3ebca003,0x3ea7ce61,0x3ec154e1
.long 0x3e9b02c6,0x3ecbbbf8,0x3e94b039,0x3ed064af,0x3e87a136,0x3ed91e6a,0x3e803a06,0x3edd924d
.long 0x3e663375,0x3ee4aa59,0x3e553641,0x3ee8bf3c,0x3e3b31a0,0x3eee46be,0x3e280b1f,0x3ef1d19f
.long 0x3e0e9a22,0x3ef5dec6,0x3df2b651,0x3ef8b47b,0x3dc19b37,0x3efb61fc,0x3d9324ca,0x3efd57de
.long 0x3eb504f3,0x3eb504f3,0x3eabeb4a,0x3ebdaef9,0x3eabeb4a,0x3ebdaef9,0x3ea1cbfb,0x3ec66354
.long 0x3ea26799,0x3ec5e403,0x3e973c07,0x3ece8d90,0x3e987fc0,0x3ecd9f02,0x3e8c42c9,0x3ed627fe
.long 0x3e8e39da,0x3ed4db31,0x3e80e7e4,0x3edd2d53,0x3e839c3d,0x3edb941a,0x3e6a6681,0x3ee398ac
.long 0x3e715aea,0x3ee1c598,0x3e525a09,0x3ee96591,0x3e5ae880,0x3ee76bd8,0x3e39bb1e,0x3eee8ff8
.long 0x3e43ef15,0x3eec835e,0x3e209ae5,0x3ef31447,0x3e2c7cd4,0x3ef10908,0x3e070ada,0x3ef6ef5b
.long 0x3e14a031,0x3ef4fa0b,0x3dda3997,0x3efa1e84,0x3df8cfcc,0x3ef853f8,0x3da5c58c,0x3efc9f8a
.long 0x3dc7c5c2,0x3efb14be,0x3d61bc2e,0x3efe70b0,0x3d964083,0x3efd3aac,0x3ceea038,0x3eff90b1
.long 0x3d48bd36,0x3efec46d,0x3b490f88,0x3efffec4,0x3cc8fb30,0x3effb10f,0xbcbc6dd5,0x3effba9e
.long 0x3e8e39da,0x3ed4db31,0x3e839c3d,0x3edb941a,0x3e80e7e4,0x3edd2d53,0x3e6a6681,0x3ee398ac
.long 0x3e663375,0x3ee4aa59,0x3e4c9b8b,0x3eeaab7b,0x3e49b953,0x3eeb4b0c,0x3e2df73c,0x3ef0c501
.long 0x3e2c7cd4,0x3ef10908,0x3e0e9a22,0x3ef5dec6,0x3e0e9a22,0x3ef5dec6,0x3ddd4b1a,0x3ef9f35e
.long 0x3de05c13,0x3ef9c79d,0x3d9c76de,0x3efcfe73,0x3da2abb6,0x3efcbfc9,0x3d35f8da,0x3efefcc9
.long 0x3d48bd36,0x3efec46d,0x3c490ab0,0x3effec43,0x3c96c32c,0x3effd397,0xbca351cb,0x3effcbe2
.long 0xbc490ab0,0x3effec43,0xbd553db9,0x3efe9bc9,0xbd2fb680,0x3eff0e58,0xbdabf804,0x3efc5d3a
.long 0xbd964083,0x3efd3aac,0xbdec9a7f,0x3ef91298,0xbdd41501,0x3efa7302,0xbe1620d2,0x3ef4bf62
.long 0xbe088e93,0x3ef6ba07,0xbe3554ec,0x3eef6830,0xbe268f12,0x3ef21352,0xbe53c867,0x3ee912ae
.long 0x3e43ef15,0x3eec835e,0x3e2c7cd4,0x3ef10908,0x3e209ae5,0x3ef31447,0x3e070ada,0x3ef6ef5b
.long 0x3df8cfcc,0x3ef853f8,0x3dc19b37,0x3efb61fc,0x3daf10a2,0x3efc3b28,0x3d67fa9a,0x3efe5a38
.long 0x3d48bd36,0x3efec46d,0x3c96c32c,0x3effd397,0x3c490ab0,0x3effec43,0xbca351cb,0x3effcbe2
.long 0xbcc8fb30,0x3effb10f,0xbd6e3876,0x3efe4323,0xbd7ab273,0x3efe1324,0xbdc4b0b9,0x3efb3bab
.long 0xbdc7c5c2,0x3efb14be,0xbe088e93,0x3ef6ba07,0xbe088e93,0x3ef6ba07,0xbe2df73c,0x3ef0c501
.long 0xbe2c7cd4,0x3ef10908,0xbe525a09,0x3ee96591,0xbe4f7bca,0x3eea09a7,0xbe758035,0x3ee0a6cf
.long 0xbe715aea,0x3ee1c598,0xbe8b9a6b,0x3ed695e5,0xbe88f59b,0x3ed84853,0xbe9ba299,0x3ecb41fa
.long 0xbe987fc0,0x3ecd9f02,0xbeaac082,0x3ebebc1b,0xbea73656,0x3ec1d870,0xbeb8dd65,0x3eb11722
.long 0x3dc7c5c2,0x3efb14be,0x3d964083,0x3efd3aac,0x3d61bc2e,0x3efe70b0,0x3ceea038,0x3eff90b1
.long 0x3c490ab0,0x3effec43,0xbc7b49ba,0x3effe129,0xbcfb2b74,0x3eff84ab,0xbd7475c0,0x3efe2b72
.long 0xbd964083,0x3efd3aac,0xbdd41501,0x3efa7302,0xbdec9a7f,0x3ef91298,0xbe1620d2,0x3ef4bf62
.long 0xbe209ae5,0x3ef31447,0xbe41071e,0x3eed1c1d,0xbe49b953,0x3eeb4b0c,0xbe6a6681,0x3ee398ac
.long 0xbe715aea,0x3ee1c598,0xbe88f59b,0x3ed84853,0xbe8b9a6b,0x3ed695e5,0xbe9ba299,0x3ecb41fa
.long 0xbe9d7fd1,0x3ec9d112,0xbead1469,0x3ebca003,0xbeae3bde,0x3ebb8f3b,0xbebd27b8,0x3eac800f
.long 0xbebdaef9,0x3eabeb4a,0xbecbbbf8,0x3e9b02c6,0xbecbbbf8,0x3e9b02c6,0xbed8b3a1,0x3e884b92
.long 0xbed84853,0x3e88f59b,0xbee3f473,0x3e6900b7,0xbee33c5a,0x3e6bcbbb,0xbeed67a1,0x3e3f926f
.long 0x3ea26799,0x3ec5e403,0x3e987fc0,0x3ecd9f02,0x3e973c07,0x3ece8d90,0x3e8c42c9,0x3ed627fe
.long 0x3e8b9a6b,0x3ed695e5,0x3e7f17b2,0x3eddf6be,0x3e7f17b2,0x3eddf6be,0x3e64cbfe,0x3ee50479
.long 0x3e663375,0x3ee4aa59,0x3e49b953,0x3eeb4b0c,0x3e4c9b8b,0x3eeaab7b,0x3e2df73c,0x3ef0c501
.long 0x3e3263ef,0x3eeff573,0x3e119ddd,0x3ef56d97,0x3e17a117,0x3ef48422,0x3de98bba,0x3ef940c0
.long 0x3df8cfcc,0x3ef853f8,0x3daf10a2,0x3efc3b28,0x3dc19b37,0x3efb61fc,0x3d67fa9a,0x3efe5a38
.long 0x3d89cf86,0x3efdabcc,0x3ce21469,0x3eff9c18,0x3d23308c,0x3eff2f9d,0xbac90fc6,0x3effffb1
.long 0x3c490ab0,0x3effec43,0xbcfb2b74,0x3eff84ab,0xbc7b49ba,0x3effe129,0xbd7475c0,0x3efe2b72
.long 0xbd2fb680,0x3eff0e58,0xbdb54098,0x3efbf531,0xbd9008b7,0x3efd7474,0xbdefa8b2,0x3ef8e3d6
.long 0x3e715aea,0x3ee1c598,0x3e5ae880,0x3ee76bd8,0x3e525a09,0x3ee96591,0x3e39bb1e,0x3eee8ff8
.long 0x3e3263ef,0x3eeff573,0x3e17a117,0x3ef48422,0x3e119ddd,0x3ef56d97,0x3de98bba,0x3ef940c0
.long 0x3de05c13,0x3ef9c79d,0x3da2abb6,0x3efcbfc9,0x3d9c76de,0x3efcfe73,0x3d35f8da,0x3efefcc9
.long 0x3d2fb680,0x3eff0e58,0x3c16c9b6,0x3efff4e6,0x3c16c9b6,0x3efff4e6,0xbcd5880e,0x3effa6e3
.long 0xbcc8fb30,0x3effb10f,0xbd7ab273,0x3efe1324,0xbd6e3876,0x3efe4323,0xbdc4b0b9,0x3efb3bab
.long 0xbdbb6ecf,0x3efbaccd,0xbe0586ce,0x3ef72417,0xbdfee6e1,0x3ef7f110,0xbe280b1f,0x3ef1d19f
.long 0xbe209ae5,0x3ef31447,0xbe49b953,0x3eeb4b0c,0xbe41071e,0x3eed1c1d,0xbe6a6681,0x3ee398ac
.long 0xbe60924f,0x3ee60f88,0xbe84f484,0x3edac450,0xbe7f17b2,0x3eddf6be,0xbe940c5f,0x3ed0d937
.long 0x3e14a031,0x3ef4fa0b,0x3df8cfcc,0x3ef853f8,0x3dda3997,0x3efa1e84,0x3da5c58c,0x3efc9f8a
.long 0x3d89cf86,0x3efdabcc,0x3d23308c,0x3eff2f9d,0x3ce21469,0x3eff9c18,0xbac90fc6,0x3effffb1
.long 0xbc490ab0,0x3effec43,0xbd2fb680,0x3eff0e58,0xbd553db9,0x3efe9bc9,0xbdabf804,0x3efc5d3a
.long 0xbdbb6ecf,0x3efbaccd,0xbdfee6e1,0x3ef7f110,0xbe0586ce,0x3ef72417,0xbe280b1f,0x3ef1d19f
.long 0xbe2c7cd4,0x3ef10908,0xbe4f7bca,0x3eea09a7,0xbe525a09,0x3ee96591,0xbe758035,0x3ee0a6cf
.long 0xbe76e0cb,0x3ee04621,0xbe8cead0,0x3ed5b993,0xbe8cead0,0x3ed5b993,0xbe9e1e22,0x3ec95521
.long 0xbe9d7fd1,0x3ec9d112,0xbeae3bde,0x3ebb8f3b,0xbead1469,0x3ebca003,0xbebd27b8,0x3eac800f
.long 0xbebb8f3b,0x3eae3bde,0xbecac77f,0x3e9c420c,0xbec8d8b3,0x3e9ebc12,0xbed70348,0x3e8af1b7
.long 0x3d48bd36,0x3efec46d,0x3cc8fb30,0x3effb10f,0x3b490f88,0x3efffec4,0xbcbc6dd5,0x3effba9e
.long 0xbd2fb680,0x3eff0e58,0xbd9008b7,0x3efd7474,0xbdb54098,0x3efbf531,0xbdefa8b2,0x3ef8e3d6
.long 0xbe088e93,0x3ef6ba07,0xbe268f12,0x3ef21352,0xbe3554ec,0x3eef6830,0xbe53c867,0x3ee912ae
.long 0xbe60924f,0x3ee60f88,0xbe7f17b2,0x3eddf6be,0xbe84f484,0x3edac450,0xbe940c5f,0x3ed0d937
.long 0xbe987fc0,0x3ecd9f02,0xbea73656,0x3ec1d870,0xbeaac082,0x3ebebc1b,0xbeb8dd65,0x3eb11722
.long 0xbebb8f3b,0x3eae3bde,0xbec8d8b3,0x3e9ebc12,0xbecac77f,0x3e9c420c,0xbed70348,0x3e8af1b7
.long 0xbed84853,0x3e88f59b,0xbee33c5a,0x3e6bcbbb,0xbee3f473,0x3e6900b7,0xbeed67a1,0x3e3f926f
.long 0xbeedb293,0x3e3e1d4a,0xbef56d97,0x3e119ddd,0xbef56d97,0x3e119ddd,0xbefb3bab,0x3dc4b0b9
.long 0x3c00,0xbc00,0x3c00,0xbc00,0x3c00,0xae46bbf6,0x323e3bd9,0xb4a5bba8
.long 0x3c00,0xb23ebbd9,0x361f3b64,0xb872baa7,0x3c00,0xb4a5bba8,0x38723aa7,0xba2fb913
.long 0x3c00,0xb61fbb64,0x39a839a8,0xbb64b61f,0x3c00,0xb78bbb0e,0x3aa73872,0xbbf6ae46
.long 0x3c00,0xb872baa7,0x3b64361f,0xbbd9323e,0x3c00,0xb913ba2f,0x3bd9323e,0xbb0e378b
.long 0x3c00,0xb9a8b9a8,0x3c000000,0xb9a839a8,0x3c00,0xba2fb913,0x3bd9b23e,0xb78b3b0e
.long 0x3c00,0xbaa7b872,0x3b64b61f,0xb23e3bd9,0x3c00,0xbb0eb78b,0x3aa7b872,0x2e463bf6
.long 0x3c00,0xbb64b61f,0x39a8b9a8,0x361f3b64,0x3c00,0xbba8b4a5,0x3872baa7,0x39133a2f
.long 0x3c00,0xbbd9b23e,0x361fbb64,0x3aa73872,0x3c00,0xbbf6ae46,0x323ebbd9,0x3ba834a5
.long 0x3c00,0xbc00,0x3c00,0xbc00,0x361f3b64,0xb78bbb0e,0x38723aa7,0xb913ba2f
.long 0x39a839a8,0xbaa7b872,0x3b64361f,0xbbd9b23e,0x3b64361f,0xbbf6ae46,0x3bd9b23e,0xbb0e378b
.long 0x3c000000,0xbb64361f,0x39a8b9a8,0xb61f3b64,0x3b64b61f,0xb9133a2f,0x323ebbd9,0x34a53ba8
.long 0x39a8b9a8,0xb23e3bd9,0xb61fbb64,0x3aa73872,0x361fbb64,0x34a53ba8,0xbaa7b872,0x3bf6ae46
.long 0xbc00,0x39a839a8,0xbc008000,0x39a8b9a8,0xb61fbb64,0x3ba834a5,0xbaa73872,0x2e46bbf6
.long 0xb9a8b9a8,0x3bd9b23e,0xb61f3b64,0xb872baa7,0xbb64b61f,0x3a2fb913,0x323e3bd9,0xbba8b4a5
.long 0xbc008000,0x361fbb64,0x39a839a8,0xbb64361f,0xbb64361f,0xae46bbf6,0x3bd9323e,0xb78b3b0e
.long 0xb9a839a8,0xb872baa7,0x3b64b61f,0x323e3bd9,0xb61f3b64,0xbb0eb78b,0x3872baa7,0x3a2f3913
.long 0x3c00,0xbc00,0x3c00,0xbc00,0x39a839a8,0xba2fb913,0x3aa73872,0xbb0eb78b
.long 0x3c000000,0xbbd9323e,0x3b64b61f,0xbaa73872,0x39a8b9a8,0xb78b3b0e,0x323ebbd9,0x2e463bf6
.long 0xbc00,0x361f3b64,0xb9a8b9a8,0x3b64361f,0xb9a8b9a8,0x3ba834a5,0xbbd9323e,0x3a2fb913
.long 0xbc008000,0x3aa7b872,0xb61f3b64,0xb23ebbd9,0xb9a839a8,0x2e46bbf6,0x38723aa7,0xbba8b4a5
.long 0x3c00,0xb9a8b9a8,0x3c000000,0xb9a839a8,0x39a839a8,0xbbf62e46,0x3872baa7,0x34a53ba8
.long 0x3c000000,0xb8723aa7,0xb61fbb64,0x3bd9323e,0x39a8b9a8,0x34a53ba8,0xbbd9b23e,0x3913ba2f
.long 0xbc00,0x3b64361f,0xb9a839a8,0xb61fbb64,0xb9a8b9a8,0x3b0eb78b,0x323e3bd9,0xbbf6ae46
.long 0xbc008000,0x323ebbd9,0x3b64361f,0xb8723aa7,0xb9a839a8,0xb913ba2f,0x3aa7b872,0x378b3b0e
.long 0x3c00,0xbc00,0x3c00,0xbc00,0x3b64361f,0xbba8b4a5,0x3bd9323e,0xbbf6ae46
.long 0x39a8b9a8,0xb8723aa7,0x361fbb64,0xb23e3bd9,0xb61fbb64,0x39133a2f,0xbaa7b872,0x3ba834a5
.long 0xbc008000,0x3b64b61f,0xb9a839a8,0x361fbb64,0xb61f3b64,0xae46bbf6,0x38723aa7,0xbb0eb78b
.long 0x39a839a8,0xbbd9b23e,0x3b64b61f,0xb8723aa7,0x3b64b61f,0xb78b3b0e,0xb23ebbd9,0x3a2f3913
.long 0xbc00,0x39a839a8,0xbc008000,0x39a8b9a8,0xbb64b61f,0x3b0eb78b,0xb23e3bd9,0xb913ba2f
.long 0xb9a839a8,0xb23ebbd9,0x3b64361f,0xbaa73872,0x361f3b64,0xbbf6ae46,0x3872baa7,0x378b3b0e
.long 0x3c000000,0xb61f3b64,0xb9a8b9a8,0x3b64b61f,0x361fbb64,0x3a2f3913,0xbaa73872,0xb4a5bba8
.long 0xb9a8b9a8,0x3aa7b872,0x361f3b64,0xbbd9323e,0xbb64361f,0xb4a5bba8,0x3bd9b23e,0x2e463bf6
.long 0x3c008000,0xbc008000,0x3c008000,0xbc008000,0x3c008000,0xbbf62e46,0x3bd9b23e,0xbba834a5
.long 0x3c008000,0xbbd9323e,0x3b64b61f,0xbaa73872,0x3c008000,0xbba834a5,0x3aa7b872,0xb9133a2f
.long 0x3c008000,0xbb64361f,0x39a8b9a8,0xb61f3b64,0x3c008000,0xbb0e378b,0x3872baa7,0xae463bf6
.long 0x3c008000,0xbaa73872,0x361fbb64,0x323e3bd9,0x3c008000,0xba2f3913,0x323ebbd9,0x378b3b0e
.long 0x3c008000,0xb9a839a8,0xbc00,0x39a839a8,0x3c008000,0xb9133a2f,0xb23ebbd9,0x3b0e378b
.long 0x3c008000,0xb8723aa7,0xb61fbb64,0x3bd9323e,0x3c008000,0xb78b3b0e,0xb872baa7,0x3bf6ae46
.long 0x3c008000,0xb61f3b64,0xb9a8b9a8,0x3b64b61f,0x3c008000,0xb4a53ba8,0xbaa7b872,0x3a2fb913
.long 0x3c008000,0xb23e3bd9,0xbb64b61f,0x3872baa7,0x3c008000,0xae463bf6,0xbbd9b23e,0x34a5bba8
.long 0x3c008000,0xbc008000,0x3c008000,0xbc008000,0x3b64b61f,0xbb0e378b,0x3aa7b872,0xba2f3913
.long 0x39a8b9a8,0xb8723aa7,0x361fbb64,0xb23e3bd9,0x361fbb64,0xae463bf6,0xb23ebbd9,0x378b3b0e
.long 0xbc00,0x361f3b64,0xb9a8b9a8,0x3b64361f,0xb61fbb64,0x3a2f3913,0xbbd9b23e,0x3ba8b4a5
.long 0xb9a8b9a8,0x3bd9323e,0xbb64361f,0x3872baa7,0xbb64b61f,0x3ba8b4a5,0xb8723aa7,0xae46bbf6
.long 0xbc008000,0x39a8b9a8,0x80003c00,0xb9a8b9a8,0xbb64361f,0x34a5bba8,0x38723aa7,0xbbf6ae46
.long 0xb9a839a8,0xb23ebbd9,0x3b64361f,0xbaa73872,0xb61f3b64,0xb913ba2f,0x3bd9b23e,0xb4a53ba8
.long 0x80003c00,0xbb64b61f,0x39a8b9a8,0x361f3b64,0x361f3b64,0xbbf62e46,0x323ebbd9,0x3b0e378b
.long 0x39a839a8,0xbaa73872,0xb61fbb64,0x3bd9b23e,0x3b64361f,0xb78b3b0e,0xbaa7b872,0x3913ba2f
.long 0x3c008000,0xbc008000,0x3c008000,0xbc008000,0x39a8b9a8,0xb9133a2f,0x3872baa7,0xb78b3b0e
.long 0xbc00,0x323e3bd9,0xb61fbb64,0x38723aa7,0xb9a8b9a8,0x3b0e378b,0xbbd9b23e,0x3bf6ae46
.long 0xbc008000,0x3b64b61f,0xb9a839a8,0x361fbb64,0xb9a839a8,0x34a5bba8,0x323e3bd9,0xb913ba2f
.long 0x80003c00,0xb872baa7,0x3b64361f,0xbbd9323e,0x39a839a8,0xbbf6ae46,0x3aa7b872,0xb4a53ba8
.long 0x3c008000,0xb9a839a8,0xbc00,0x39a839a8,0x39a8b9a8,0x2e463bf6,0xbaa7b872,0x3ba8b4a5
.long 0xbc00,0x3aa73872,0xbb64361f,0x323ebbd9,0xb9a8b9a8,0x3ba8b4a5,0xb23e3bd9,0xba2fb913
.long 0xbc008000,0x361fbb64,0x39a839a8,0xbb64361f,0xb9a839a8,0xb78bbb0e,0x3bd9b23e,0xae463bf6
.long 0x80003c00,0xbbd9b23e,0x361fbb64,0x3aa73872,0x39a839a8,0xba2f3913,0xb872baa7,0x3b0eb78b
.long 0x3c008000,0xbc008000,0x3c008000,0xbc008000,0x361fbb64,0xb4a53ba8,0x323ebbd9,0xae463bf6
.long 0xb9a8b9a8,0x3aa73872,0xbb64b61f,0x3bd9323e,0xbb64361f,0x3a2fb913,0xb8723aa7,0x34a5bba8
.long 0x80003c00,0xb61fbb64,0x39a839a8,0xbb64b61f,0x3b64361f,0xbbf62e46,0x3aa7b872,0xb78b3b0e
.long 0x39a8b9a8,0xb23e3bd9,0xb61fbb64,0x3aa73872,0xb61fbb64,0x3b0e378b,0xbbd9323e,0x3913ba2f
.long 0xbc008000,0x39a8b9a8,0x80003c00,0xb9a8b9a8,0xb61f3b64,0xb78bbb0e,0x3bd9323e,0xba2f3913
.long 0x39a839a8,0xbbd9323e,0x361fbb64,0x38723aa7,0x3b64b61f,0xae463bf6,0xbaa7b872,0x3b0eb78b
.long 0xbc00,0x3b64361f,0xb9a839a8,0xb61fbb64,0xbb64b61f,0x3913ba2f,0x38723aa7,0xbba834a5
.long 0xb9a839a8,0xb872baa7,0x3b64b61f,0x323e3bd9,0x361f3b64,0xbba834a5,0xb23ebbd9,0x3bf6ae46
.long 0x3c00,0xbc00,0x3c00,0xbc00,0x3c000000,0xbbf62e46,0x3bd9b23e,0xbba834a5
.long 0xbc00,0x323e3bd9,0xb61fbb64,0x38723aa7,0xbc008000,0x3ba8b4a5,0xbaa73872,0x3913ba2f
.long 0x3c00,0xb61fbb64,0x39a839a8,0xbb64b61f,0x3c000000,0xbb0e378b,0x3872baa7,0xae463bf6
.long 0xbc00,0x38723aa7,0xbb64b61f,0x3bd9b23e,0xbc008000,0x3a2fb913,0xb23e3bd9,0xb78bbb0e
.long 0x3c00,0xb9a8b9a8,0x3c000000,0xb9a839a8,0x3c000000,0xb9133a2f,0xb23ebbd9,0x3b0e378b
.long 0xbc00,0x3aa73872,0xbb64361f,0x323ebbd9,0xbc008000,0x378bbb0e,0x38723aa7,0xbbf62e46
.long 0x3c00,0xbb64b61f,0x39a8b9a8,0x361f3b64,0x3c000000,0xb4a53ba8,0xbaa7b872,0x3a2fb913
.long 0xbc00,0x3bd9323e,0xb61f3b64,0xbaa7b872,0xbc008000,0x2e46bbf6,0x3bd9323e,0xb4a53ba8
.long 0x3c00,0xbc00,0x3c00,0xbc00,0x3b64b61f,0xbb0e378b,0x3aa7b872,0xba2f3913
.long 0xb9a8b9a8,0x3aa73872,0xbb64b61f,0x3bd9323e,0xb61f3b64,0x2e46bbf6,0x323e3bd9,0xb78bbb0e
.long 0x3c000000,0xbb64361f,0x39a8b9a8,0xb61f3b64,0xb61fbb64,0x3a2f3913,0xbbd9b23e,0x3ba8b4a5
.long 0xb9a839a8,0x323ebbd9,0x361f3b64,0xbaa7b872,0x3b64361f,0xbba834a5,0x3872baa7,0x2e463bf6
.long 0xbc00,0x39a839a8,0xbc008000,0x39a8b9a8,0xbb64361f,0x34a5bba8,0x38723aa7,0xbbf6ae46
.long 0x39a839a8,0xbbd9323e,0x361fbb64,0x38723aa7,0x361fbb64,0x39133a2f,0xbbd9323e,0x34a5bba8
.long 0xbc008000,0x361fbb64,0x39a839a8,0xbb64361f,0x361f3b64,0xbbf62e46,0x323ebbd9,0x3b0e378b
.long 0x39a8b9a8,0x38723aa7,0xbb64361f,0xb23ebbd9,0xbb64b61f,0x378bbb0e,0x3aa73872,0xb9133a2f
.long 0x3c00,0xbc00,0x3c00,0xbc00,0x39a8b9a8,0xb9133a2f,0x3872baa7,0xb78b3b0e
.long 0xbc008000,0x3bd9b23e,0xbb64361f,0x3aa7b872,0x39a839a8,0xbb0eb78b,0x3bd9323e,0xbbf62e46
.long 0xbc00,0x361f3b64,0xb9a8b9a8,0x3b64361f,0xb9a839a8,0x34a5bba8,0x323e3bd9,0xb913ba2f
.long 0x3c000000,0xbaa73872,0x361fbb64,0x323e3bd9,0xb9a8b9a8,0x3bf62e46,0xbaa73872,0x34a5bba8
.long 0x3c00,0xb9a8b9a8,0x3c000000,0xb9a839a8,0x39a8b9a8,0x2e463bf6,0xbaa7b872,0x3ba8b4a5
.long 0xbc008000,0x3872baa7,0x361f3b64,0xbbd9b23e,0x39a839a8,0xbba834a5,0x323ebbd9,0x3a2f3913
.long 0xbc00,0x3b64361f,0xb9a839a8,0xb61fbb64,0xb9a839a8,0xb78bbb0e,0x3bd9b23e,0xae463bf6
.long 0x3c000000,0xb23e3bd9,0xbb64b61f,0x3872baa7,0xb9a8b9a8,0x3a2fb913,0x38723aa7,0xbb0e378b
.long 0x3c00,0xbc00,0x3c00,0xbc00,0x361fbb64,0xb4a53ba8,0x323ebbd9,0xae463bf6
.long 0xb9a839a8,0x3872baa7,0xb61f3b64,0x323ebbd9,0x3b64b61f,0xba2f3913,0x3872baa7,0xb4a53ba8
.long 0xbc008000,0x3b64b61f,0xb9a839a8,0x361fbb64,0x3b64361f,0xbbf62e46,0x3aa7b872,0xb78b3b0e
.long 0xb9a8b9a8,0x3bd9323e,0xbb64361f,0x3872baa7,0x361f3b64,0xbb0eb78b,0x3bd9b23e,0xb9133a2f
.long 0xbc00,0x39a839a8,0xbc008000,0x39a8b9a8,0xb61f3b64,0xb78bbb0e,0x3bd9323e,0xba2f3913
.long 0x39a8b9a8,0x323e3bd9,0xbb64b61f,0x3aa7b872,0xbb64361f,0x2e46bbf6,0x3aa73872,0xbb0e378b
.long 0x3c000000,0xb61f3b64,0xb9a8b9a8,0x3b64b61f,0xbb64b61f,0x3913ba2f,0x38723aa7,0xbba834a5
.long 0x39a839a8,0xbaa73872,0xb61fbb64,0x3bd9b23e,0xb61fbb64,0x3ba8b4a5,0x323e3bd9,0xbbf62e46
.long 0x3c008000,0xbc008000,0x3c008000,0xbc008000,0xbc00,0x2e463bf6,0xb23ebbd9,0x34a53ba8
.long 0xbc008000,0x3bd9b23e,0xbb64361f,0x3aa7b872,0x80003c00,0xb4a5bba8,0x38723aa7,0xba2fb913
.long 0x3c008000,0xbb64361f,0x39a8b9a8,0xb61f3b64,0xbc00,0x378b3b0e,0xbaa7b872,0x3bf62e46
.long 0xbc008000,0x3aa7b872,0xb61f3b64,0xb23ebbd9,0x80003c00,0xb913ba2f,0x3bd9323e,0xbb0e378b
.long 0x3c008000,0xb9a839a8,0xbc00,0x39a839a8,0xbc00,0x3a2f3913,0xbbd9323e,0x378bbb0e
.long 0xbc008000,0x3872baa7,0x361f3b64,0xbbd9b23e,0x80003c00,0xbb0eb78b,0x3aa7b872,0x2e463bf6
.long 0x3c008000,0xb61f3b64,0xb9a8b9a8,0x3b64b61f,0xbc00,0x3ba834a5,0xb8723aa7,0xb913ba2f
.long 0xbc008000,0x323ebbd9,0x3b64361f,0xb8723aa7,0x80003c00,0xbbf6ae46,0x323ebbd9,0x3ba834a5
.long 0x3c008000,0xbc008000,0x3c008000,0xbc008000,0xb61fbb64,0x378b3b0e,0xb872baa7,0x39133a2f
.long 0xb9a839a8,0x3872baa7,0xb61f3b64,0x323ebbd9,0x3b64361f,0xbbf6ae46,0x3bd9b23e,0xbb0e378b
.long 0xbc00,0x361f3b64,0xb9a8b9a8,0x3b64361f,0xbb64361f,0x3913ba2f,0xb23e3bd9,0xb4a5bba8
.long 0x39a839a8,0xbbd9b23e,0x3b64b61f,0xb8723aa7,0x361fbb64,0x34a53ba8,0xbaa7b872,0x3bf6ae46
.long 0xbc008000,0x39a8b9a8,0x80003c00,0xb9a8b9a8,0x361f3b64,0xbba8b4a5,0x3aa7b872,0xae463bf6
.long 0x39a8b9a8,0x323e3bd9,0xbb64b61f,0x3aa7b872,0xbb64b61f,0x3a2fb913,0x323e3bd9,0xbba8b4a5
.long 0x80003c00,0xbb64b61f,0x39a8b9a8,0x361f3b64,0x3b64b61f,0x2e463bf6,0xbbd9b23e,0x378bbb0e
.long 0xb9a8b9a8,0x3aa7b872,0x361f3b64,0xbbd9323e,0xb61f3b64,0xbb0eb78b,0x3872baa7,0x3a2f3913
.long 0x3c008000,0xbc008000,0x3c008000,0xbc008000,0xb9a8b9a8,0x3a2f3913,0xbaa7b872,0x3b0e378b
.long 0x80003c00,0xb23ebbd9,0x361f3b64,0xb872baa7,0x39a8b9a8,0xb78b3b0e,0x323ebbd9,0x2e463bf6
.long 0xbc008000,0x3b64b61f,0xb9a839a8,0x361fbb64,0x39a839a8,0xbba8b4a5,0x3bd9b23e,0xba2f3913
.long 0xbc00,0x38723aa7,0xbb64b61f,0x3bd9b23e,0xb9a839a8,0x2e46bbf6,0x38723aa7,0xbba8b4a5
.long 0x3c008000,0xb9a839a8,0xbc00,0x39a839a8,0xb9a8b9a8,0x3bf6ae46,0xb8723aa7,0xb4a5bba8
.long 0x80003c00,0xbaa7b872,0x3b64b61f,0xb23e3bd9,0x39a8b9a8,0x34a53ba8,0xbbd9b23e,0x3913ba2f
.long 0xbc008000,0x361fbb64,0x39a839a8,0xbb64361f,0x39a839a8,0xbb0e378b,0xb23ebbd9,0x3bf62e46
.long 0xbc00,0x3bd9323e,0xb61f3b64,0xbaa7b872,0xb9a839a8,0xb913ba2f,0x3aa7b872,0x378b3b0e
.long 0x3c008000,0xbc008000,0x3c008000,0xbc008000,0xbb64b61f,0x3ba834a5,0xbbd9b23e,0x3bf62e46
.long 0x39a839a8,0xbaa7b872,0x3b64361f,0xbbd9b23e,0xb61fbb64,0x39133a2f,0xbaa7b872,0x3ba834a5
.long 0x80003c00,0xb61fbb64,0x39a839a8,0xbb64b61f,0x361fbb64,0x2e463bf6,0xb872baa7,0x3b0e378b
.long 0xb9a839a8,0x323ebbd9,0x361f3b64,0xbaa7b872,0x3b64b61f,0xb78b3b0e,0xb23ebbd9,0x3a2f3913
.long 0xbc008000,0x39a8b9a8,0x80003c00,0xb9a8b9a8,0x3b64361f,0xbb0e378b,0x323ebbd9,0x39133a2f
.long 0xb9a8b9a8,0x3bd9b23e,0xb61f3b64,0xb872baa7,0x361f3b64,0xbbf6ae46,0x3872baa7,0x378b3b0e
.long 0xbc00,0x3b64361f,0xb9a839a8,0xb61fbb64,0xb61f3b64,0xba2fb913,0x3aa7b872,0x34a53ba8
.long 0x39a8b9a8,0x38723aa7,0xbb64361f,0xb23ebbd9,0xbb64361f,0xb4a5bba8,0x3bd9b23e,0x2e463bf6
.long 0x3c00,0xbc00,0x3c00,0xbc00,0xbc00,0x2e463bf6,0xb23ebbd9,0x34a53ba8
.long 0x3c00,0xb23ebbd9,0x361f3b64,0xb872baa7,0xbc00,0x34a53ba8,0xb872baa7,0x3a2f3913
.long 0x3c00,0xb61fbb64,0x39a839a8,0xbb64b61f,0xbc00,0x378b3b0e,0xbaa7b872,0x3bf62e46
.long 0x3c00,0xb872baa7,0x3b64361f,0xbbd9323e,0xbc00,0x39133a2f,0xbbd9b23e,0x3b0eb78b
.long 0x3c00,0xb9a8b9a8,0x3c000000,0xb9a839a8,0xbc00,0x3a2f3913,0xbbd9323e,0x378bbb0e
.long 0x3c00,0xbaa7b872,0x3b64b61f,0xb23e3bd9,0xbc00,0x3b0e378b,0xbaa73872,0xae46bbf6
.long 0x3c00,0xbb64b61f,0x39a8b9a8,0x361f3b64,0xbc00,0x3ba834a5,0xb8723aa7,0xb913ba2f
.long 0x3c00,0xbbd9b23e,0x361fbb64,0x3aa73872,0xbc00,0x3bf62e46,0xb23e3bd9,0xbba8b4a5
.long 0x3c00,0xbc00,0x3c00,0xbc00,0xb61fbb64,0x378b3b0e,0xb872baa7,0x39133a2f
.long 0x39a839a8,0xbaa7b872,0x3b64361f,0xbbd9b23e,0xbb64b61f,0x3bf62e46,0xbbd9323e,0x3b0eb78b
.long 0x3c000000,0xbb64361f,0x39a8b9a8,0xb61f3b64,0xbb64361f,0x3913ba2f,0xb23e3bd9,0xb4a5bba8
.long 0x39a8b9a8,0xb23e3bd9,0xb61fbb64,0x3aa73872,0xb61f3b64,0xb4a5bba8,0x3aa73872,0xbbf62e46
.long 0xbc00,0x39a839a8,0xbc008000,0x39a8b9a8,0x361f3b64,0xbba8b4a5,0x3aa7b872,0xae463bf6
.long 0xb9a8b9a8,0x3bd9b23e,0xb61f3b64,0xb872baa7,0x3b64361f,0xba2f3913,0xb23ebbd9,0x3ba834a5
.long 0xbc008000,0x361fbb64,0x39a839a8,0xbb64361f,0x3b64b61f,0x2e463bf6,0xbbd9b23e,0x378bbb0e
.long 0xb9a839a8,0xb872baa7,0x3b64b61f,0x323e3bd9,0x361fbb64,0x3b0e378b,0xb8723aa7,0xba2fb913
.long 0x3c00,0xbc00,0x3c00,0xbc00,0xb9a8b9a8,0x3a2f3913,0xbaa7b872,0x3b0e378b
.long 0x3c000000,0xbbd9323e,0x3b64b61f,0xbaa73872,0xb9a839a8,0x378bbb0e,0xb23e3bd9,0xae46bbf6
.long 0xbc00,0x361f3b64,0xb9a8b9a8,0x3b64361f,0x39a839a8,0xbba8b4a5,0x3bd9b23e,0xba2f3913
.long 0xbc008000,0x3aa7b872,0xb61f3b64,0xb23ebbd9,0x39a8b9a8,0xae463bf6,0xb872baa7,0x3ba834a5
.long 0x3c00,0xb9a8b9a8,0x3c000000,0xb9a839a8,0xb9a8b9a8,0x3bf6ae46,0xb8723aa7,0xb4a5bba8
.long 0x3c000000,0xb8723aa7,0xb61fbb64,0x3bd9323e,0xb9a839a8,0xb4a5bba8,0x3bd9323e,0xb9133a2f
.long 0xbc00,0x3b64361f,0xb9a839a8,0xb61fbb64,0x39a839a8,0xbb0e378b,0xb23ebbd9,0x3bf62e46
.long 0xbc008000,0x323ebbd9,0x3b64361f,0xb8723aa7,0x39a8b9a8,0x39133a2f,0xbaa73872,0xb78bbb0e
.long 0x3c00,0xbc00,0x3c00,0xbc00,0xbb64b61f,0x3ba834a5,0xbbd9b23e,0x3bf62e46
.long 0x39a8b9a8,0xb8723aa7,0x361fbb64,0xb23e3bd9,0x361f3b64,0xb913ba2f,0x3aa73872,0xbba8b4a5
.long 0xbc008000,0x3b64b61f,0xb9a839a8,0x361fbb64,0x361fbb64,0x2e463bf6,0xb872baa7,0x3b0e378b
.long 0x39a839a8,0xbbd9b23e,0x3b64b61f,0xb8723aa7,0xbb64361f,0x378bbb0e,0x323e3bd9,0xba2fb913
.long 0xbc00,0x39a839a8,0xbc008000,0x39a8b9a8,0x3b64361f,0xbb0e378b,0x323ebbd9,0x39133a2f
.long 0xb9a839a8,0xb23ebbd9,0x3b64361f,0xbaa73872,0xb61fbb64,0x3bf62e46,0xb8723aa7,0xb78bbb0e
.long 0x3c000000,0xb61f3b64,0xb9a8b9a8,0x3b64b61f,0xb61f3b64,0xba2fb913,0x3aa7b872,0x34a53ba8
.long 0xb9a8b9a8,0x3aa7b872,0x361f3b64,0xbbd9323e,0x3b64b61f,0x34a53ba8,0xbbd9323e,0xae46bbf6
.long 0x3c008000,0xbc008000,0x3c008000,0xbc008000,0xbc008000,0x3bf6ae46,0xbbd9323e,0x3ba8b4a5
.long 0x3c008000,0xbbd9323e,0x3b64b61f,0xbaa73872,0xbc008000,0x3ba8b4a5,0xbaa73872,0x3913ba2f
.long 0x3c008000,0xbb64361f,0x39a8b9a8,0xb61f3b64,0xbc008000,0x3b0eb78b,0xb8723aa7,0x2e46bbf6
.long 0x3c008000,0xbaa73872,0x361fbb64,0x323e3bd9,0xbc008000,0x3a2fb913,0xb23e3bd9,0xb78bbb0e
.long 0x3c008000,0xb9a839a8,0xbc00,0x39a839a8,0xbc008000,0x3913ba2f,0x323e3bd9,0xbb0eb78b
.long 0x3c008000,0xb8723aa7,0xb61fbb64,0x3bd9323e,0xbc008000,0x378bbb0e,0x38723aa7,0xbbf62e46
.long 0x3c008000,0xb61f3b64,0xb9a8b9a8,0x3b64b61f,0xbc008000,0x34a5bba8,0x3aa73872,0xba2f3913
.long 0x3c008000,0xb23e3bd9,0xbb64b61f,0x3872baa7,0xbc008000,0x2e46bbf6,0x3bd9323e,0xb4a53ba8
.long 0x3c008000,0xbc008000,0x3c008000,0xbc008000,0xbb64361f,0x3b0eb78b,0xbaa73872,0x3a2fb913
.long 0x39a8b9a8,0xb8723aa7,0x361fbb64,0xb23e3bd9,0xb61f3b64,0x2e46bbf6,0x323e3bd9,0xb78bbb0e
.long 0xbc00,0x361f3b64,0xb9a8b9a8,0x3b64361f,0x361f3b64,0xba2fb913,0x3bd9323e,0xbba834a5
.long 0xb9a8b9a8,0x3bd9323e,0xbb64361f,0x3872baa7,0x3b64361f,0xbba834a5,0x3872baa7,0x2e463bf6
.long 0xbc008000,0x39a8b9a8,0x80003c00,0xb9a8b9a8,0x3b64b61f,0xb4a53ba8,0xb872baa7,0x3bf62e46
.long 0xb9a839a8,0xb23ebbd9,0x3b64361f,0xbaa73872,0x361fbb64,0x39133a2f,0xbbd9323e,0x34a5bba8
.long 0x80003c00,0xbb64b61f,0x39a8b9a8,0x361f3b64,0xb61fbb64,0x3bf6ae46,0xb23e3bd9,0xbb0eb78b
.long 0x39a839a8,0xbaa73872,0xb61fbb64,0x3bd9b23e,0xbb64b61f,0x378bbb0e,0x3aa73872,0xb9133a2f
.long 0x3c008000,0xbc008000,0x3c008000,0xbc008000,0xb9a839a8,0x3913ba2f,0xb8723aa7,0x378bbb0e
.long 0xbc00,0x323e3bd9,0xb61fbb64,0x38723aa7,0x39a839a8,0xbb0eb78b,0x3bd9323e,0xbbf62e46
.long 0xbc008000,0x3b64b61f,0xb9a839a8,0x361fbb64,0x39a8b9a8,0xb4a53ba8,0xb23ebbd9,0x39133a2f
.long 0x80003c00,0xb872baa7,0x3b64361f,0xbbd9323e,0xb9a8b9a8,0x3bf62e46,0xbaa73872,0x34a5bba8
.long 0x3c008000,0xb9a839a8,0xbc00,0x39a839a8,0xb9a839a8,0xae46bbf6,0x3aa73872,0xbba834a5
.long 0xbc00,0x3aa73872,0xbb64361f,0x323ebbd9,0x39a839a8,0xbba834a5,0x323ebbd9,0x3a2f3913
.long 0xbc008000,0x361fbb64,0x39a839a8,0xbb64361f,0x39a8b9a8,0x378b3b0e,0xbbd9323e,0x2e46bbf6
.long 0x80003c00,0xbbd9b23e,0x361fbb64,0x3aa73872,0xb9a8b9a8,0x3a2fb913,0x38723aa7,0xbb0e378b
.long 0x3c008000,0xbc008000,0x3c008000,0xbc008000,0xb61f3b64,0x34a5bba8,0xb23e3bd9,0x2e46bbf6
.long 0xb9a8b9a8,0x3aa73872,0xbb64b61f,0x3bd9323e,0x3b64b61f,0xba2f3913,0x3872baa7,0xb4a53ba8
.long 0x80003c00,0xb61fbb64,0x39a839a8,0xbb64b61f,0xbb64b61f,0x3bf6ae46,0xbaa73872,0x378bbb0e
.long 0x39a8b9a8,0xb23e3bd9,0xb61fbb64,0x3aa73872,0x361f3b64,0xbb0eb78b,0x3bd9b23e,0xb9133a2f
.long 0xbc008000,0x39a8b9a8,0x80003c00,0xb9a8b9a8,0x361fbb64,0x378b3b0e,0xbbd9b23e,0x3a2fb913
.long 0x39a839a8,0xbbd9323e,0x361fbb64,0x38723aa7,0xbb64361f,0x2e46bbf6,0x3aa73872,0xbb0e378b
.long 0xbc00,0x3b64361f,0xb9a839a8,0xb61fbb64,0x3b64361f,0xb9133a2f,0xb872baa7,0x3ba8b4a5
.long 0xb9a839a8,0xb872baa7,0x3b64b61f,0x323e3bd9,0xb61fbb64,0x3ba8b4a5,0x323e3bd9,0xbbf62e46
.long 0x3c00,0xbc00,0x3c00,0xbc00,0xbc008000,0x3bf6ae46,0xbbd9323e,0x3ba8b4a5
.long 0xbc00,0x323e3bd9,0xb61fbb64,0x38723aa7,0x3c000000,0xbba834a5,0x3aa7b872,0xb9133a2f
.long 0x3c00,0xb61fbb64,0x39a839a8,0xbb64b61f,0xbc008000,0x3b0eb78b,0xb8723aa7,0x2e46bbf6
.long 0xbc00,0x38723aa7,0xbb64b61f,0x3bd9b23e,0x3c000000,0xba2f3913,0x323ebbd9,0x378b3b0e
.long 0x3c00,0xb9a8b9a8,0x3c000000,0xb9a839a8,0xbc008000,0x3913ba2f,0x323e3bd9,0xbb0eb78b
.long 0xbc00,0x3aa73872,0xbb64361f,0x323ebbd9,0x3c000000,0xb78b3b0e,0xb872baa7,0x3bf6ae46
.long 0x3c00,0xbb64b61f,0x39a8b9a8,0x361f3b64,0xbc008000,0x34a5bba8,0x3aa73872,0xba2f3913
.long 0xbc00,0x3bd9323e,0xb61f3b64,0xbaa7b872,0x3c000000,0xae463bf6,0xbbd9b23e,0x34a5bba8
.long 0x3c00,0xbc00,0x3c00,0xbc00,0xbb64361f,0x3b0eb78b,0xbaa73872,0x3a2fb913
.long 0xb9a8b9a8,0x3aa73872,0xbb64b61f,0x3bd9323e,0x361fbb64,0xae463bf6,0xb23ebbd9,0x378b3b0e
.long 0x3c000000,0xbb64361f,0x39a8b9a8,0xb61f3b64,0x361f3b64,0xba2fb913,0x3bd9323e,0xbba834a5
.long 0xb9a839a8,0x323ebbd9,0x361f3b64,0xbaa7b872,0xbb64b61f,0x3ba8b4a5,0xb8723aa7,0xae46bbf6
.long 0xbc00,0x39a839a8,0xbc008000,0x39a8b9a8,0x3b64b61f,0xb4a53ba8,0xb872baa7,0x3bf62e46
.long 0x39a839a8,0xbbd9323e,0x361fbb64,0x38723aa7,0xb61f3b64,0xb913ba2f,0x3bd9b23e,0xb4a53ba8
.long 0xbc008000,0x361fbb64,0x39a839a8,0xbb64361f,0xb61fbb64,0x3bf6ae46,0xb23e3bd9,0xbb0eb78b
.long 0x39a8b9a8,0x38723aa7,0xbb64361f,0xb23ebbd9,0x3b64361f,0xb78b3b0e,0xbaa7b872,0x3913ba2f
.long 0x3c00,0xbc00,0x3c00,0xbc00,0xb9a839a8,0x3913ba2f,0xb8723aa7,0x378bbb0e
.long 0xbc008000,0x3bd9b23e,0xbb64361f,0x3aa7b872,0xb9a8b9a8,0x3b0e378b,0xbbd9b23e,0x3bf6ae46
.long 0xbc00,0x361f3b64,0xb9a8b9a8,0x3b64361f,0x39a8b9a8,0xb4a53ba8,0xb23ebbd9,0x39133a2f
.long 0x3c000000,0xbaa73872,0x361fbb64,0x323e3bd9,0x39a839a8,0xbbf6ae46,0x3aa7b872,0xb4a53ba8
.long 0x3c00,0xb9a8b9a8,0x3c000000,0xb9a839a8,0xb9a839a8,0xae46bbf6,0x3aa73872,0xbba834a5
.long 0xbc008000,0x3872baa7,0x361f3b64,0xbbd9b23e,0xb9a8b9a8,0x3ba8b4a5,0xb23e3bd9,0xba2fb913
.long 0xbc00,0x3b64361f,0xb9a839a8,0xb61fbb64,0x39a8b9a8,0x378b3b0e,0xbbd9323e,0x2e46bbf6
.long 0x3c000000,0xb23e3bd9,0xbb64b61f,0x3872baa7,0x39a839a8,0xba2f3913,0xb872baa7,0x3b0eb78b
.long 0x3c00,0xbc00,0x3c00,0xbc00,0xb61f3b64,0x34a5bba8,0xb23e3bd9,0x2e46bbf6
.long 0xb9a839a8,0x3872baa7,0xb61f3b64,0x323ebbd9,0xbb64361f,0x3a2fb913,0xb8723aa7,0x34a5bba8
.long 0xbc008000,0x3b64b61f,0xb9a839a8,0x361fbb64,0xbb64b61f,0x3bf6ae46,0xbaa73872,0x378bbb0e
.long 0xb9a8b9a8,0x3bd9323e,0xbb64361f,0x3872baa7,0xb61fbb64,0x3b0e378b,0xbbd9323e,0x3913ba2f
.long 0xbc00,0x39a839a8,0xbc008000,0x39a8b9a8,0x361fbb64,0x378b3b0e,0xbbd9b23e,0x3a2fb913
.long 0x39a8b9a8,0x323e3bd9,0xbb64b61f,0x3aa7b872,0x3b64b61f,0xae463bf6,0xbaa7b872,0x3b0eb78b
.long 0x3c000000,0xb61f3b64,0xb9a8b9a8,0x3b64b61f,0x3b64361f,0xb9133a2f,0xb872baa7,0x3ba8b4a5
.long 0x39a839a8,0xbaa73872,0xb61fbb64,0x3bd9b23e,0x361f3b64,0xbba834a5,0xb23ebbd9,0x3bf6ae46
.long 0x3c008000,0xbc008000,0x3c008000,0xbc008000,0x80003c00,0xae46bbf6,0x323e3bd9,0xb4a5bba8
.long 0xbc008000,0x3bd9b23e,0xbb64361f,0x3aa7b872,0xbc00,0x34a53ba8,0xb872baa7,0x3a2f3913
.long 0x3c008000,0xbb64361f,0x39a8b9a8,0xb61f3b64,0x80003c00,0xb78bbb0e,0x3aa73872,0xbbf6ae46
.long 0xbc008000,0x3aa7b872,0xb61f3b64,0xb23ebbd9,0xbc00,0x39133a2f,0xbbd9b23e,0x3b0eb78b
.long 0x3c008000,0xb9a839a8,0xbc00,0x39a839a8,0x80003c00,0xba2fb913,0x3bd9b23e,0xb78b3b0e
.long 0xbc008000,0x3872baa7,0x361f3b64,0xbbd9b23e,0xbc00,0x3b0e378b,0xbaa73872,0xae46bbf6
.long 0x3c008000,0xb61f3b64,0xb9a8b9a8,0x3b64b61f,0x80003c00,0xbba8b4a5,0x3872baa7,0x39133a2f
.long 0xbc008000,0x323ebbd9,0x3b64361f,0xb8723aa7,0xbc00,0x3bf62e46,0xb23e3bd9,0xbba8b4a5
.long 0x3c008000,0xbc008000,0x3c008000,0xbc008000,0x361f3b64,0xb78bbb0e,0x38723aa7,0xb913ba2f
.long 0xb9a839a8,0x3872baa7,0xb61f3b64,0x323ebbd9,0xbb64b61f,0x3bf62e46,0xbbd9323e,0x3b0eb78b
.long 0xbc00,0x361f3b64,0xb9a8b9a8,0x3b64361f,0x3b64b61f,0xb9133a2f,0x323ebbd9,0x34a53ba8
.long 0x39a839a8,0xbbd9b23e,0x3b64b61f,0xb8723aa7,0xb61f3b64,0xb4a5bba8,0x3aa73872,0xbbf62e46
.long 0xbc008000,0x39a8b9a8,0x80003c00,0xb9a8b9a8,0xb61fbb64,0x3ba834a5,0xbaa73872,0x2e46bbf6
.long 0x39a8b9a8,0x323e3bd9,0xbb64b61f,0x3aa7b872,0x3b64361f,0xba2f3913,0xb23ebbd9,0x3ba834a5
.long 0x80003c00,0xbb64b61f,0x39a8b9a8,0x361f3b64,0xbb64361f,0xae46bbf6,0x3bd9323e,0xb78b3b0e
.long 0xb9a8b9a8,0x3aa7b872,0x361f3b64,0xbbd9323e,0x361fbb64,0x3b0e378b,0xb8723aa7,0xba2fb913
.long 0x3c008000,0xbc008000,0x3c008000,0xbc008000,0x39a839a8,0xba2fb913,0x3aa73872,0xbb0eb78b
.long 0x80003c00,0xb23ebbd9,0x361f3b64,0xb872baa7,0xb9a839a8,0x378bbb0e,0xb23e3bd9,0xae46bbf6
.long 0xbc008000,0x3b64b61f,0xb9a839a8,0x361fbb64,0xb9a8b9a8,0x3ba834a5,0xbbd9323e,0x3a2fb913
.long 0xbc00,0x38723aa7,0xbb64b61f,0x3bd9b23e,0x39a8b9a8,0xae463bf6,0xb872baa7,0x3ba834a5
.long 0x3c008000,0xb9a839a8,0xbc00,0x39a839a8,0x39a839a8,0xbbf62e46,0x3872baa7,0x34a53ba8
.long 0x80003c00,0xbaa7b872,0x3b64b61f,0xb23e3bd9,0xb9a839a8,0xb4a5bba8,0x3bd9323e,0xb9133a2f
.long 0xbc008000,0x361fbb64,0x39a839a8,0xbb64361f,0xb9a8b9a8,0x3b0eb78b,0x323e3bd9,0xbbf6ae46
.long 0xbc00,0x3bd9323e,0xb61f3b64,0xbaa7b872,0x39a8b9a8,0x39133a2f,0xbaa73872,0xb78bbb0e
.long 0x3c008000,0xbc008000,0x3c008000,0xbc008000,0x3b64361f,0xbba8b4a5,0x3bd9323e,0xbbf6ae46
.long 0x39a839a8,0xbaa7b872,0x3b64361f,0xbbd9b23e,0x361f3b64,0xb913ba2f,0x3aa73872,0xbba8b4a5
.long 0x80003c00,0xb61fbb64,0x39a839a8,0xbb64b61f,0xb61f3b64,0xae46bbf6,0x38723aa7,0xbb0eb78b
.long 0xb9a839a8,0x323ebbd9,0x361f3b64,0xbaa7b872,0xbb64361f,0x378bbb0e,0x323e3bd9,0xba2fb913
.long 0xbc008000,0x39a8b9a8,0x80003c00,0xb9a8b9a8,0xbb64b61f,0x3b0eb78b,0xb23e3bd9,0xb913ba2f
.long 0xb9a8b9a8,0x3bd9b23e,0xb61f3b64,0xb872baa7,0xb61fbb64,0x3bf62e46,0xb8723aa7,0xb78bbb0e
.long 0xbc00,0x3b64361f,0xb9a839a8,0xb61fbb64,0x361fbb64,0x3a2f3913,0xbaa73872,0xb4a5bba8
.long 0x39a8b9a8,0x38723aa7,0xbb64361f,0xb23ebbd9,0x3b64b61f,0x34a53ba8,0xbbd9323e,0xae46bbf6
.long 0x3e000000,0x80000000,0x3dfec46d,0xbc48bd36,0x3e000000,0x80000000,0x3dfeb069,0xbc4efdb7
.long 0x3e000000,0x80000000,0x3dfe9bc9,0xbc553db9,0x3e000000,0x80000000,0x3dfe868b,0xbc5b7d37
.long 0x3e000000,0x80000000,0x3dfe70b0,0xbc61bc2e,0x3e000000,0x80000000,0x3dfe5a38,0xbc67fa9a
.long 0x3e000000,0x80000000,0x3dfe4323,0xbc6e3876,0x3e000000,0x80000000,0x3dfe2b72,0xbc7475c0
.long 0x3e000000,0x80000000,0x3dfe1324,0xbc7ab273,0x3e000000,0x80000000,0x3dfdfa38,0xbc807745
.long 0x3e000000,0x80000000,0x3dfde0b1,0xbc839502,0x3e000000,0x80000000,0x3dfdc68c,0xbc86b26e
.long 0x3e000000,0x80000000,0x3dfdabcc,0xbc89cf86,0x3e000000,0x80000000,0x3dfd906e,0xbc8cec4a
.long 0x3e000000,0x80000000,0x3dfd7474,0xbc9008b7,0x3e000000,0x80000000,0x3dfd57de,0xbc9324ca
.long 0x3dec835e,0xbd43ef15,0x3de1c598,0xbd715aea,0x3deb4b0c,0xbd49b953,0x3ddfe4e9,0xbd7840c8
.long 0x3dea09a7,0xbd4f7bca,0x3dddf6be,0xbd7f17b2,0x3de8bf3c,0xbd553641,0x3ddbfb34,0xbd82ef9f
.long 0x3de76bd8,0xbd5ae880,0x3dd9f26a,0xbd864b82,0x3de60f88,0xbd60924f,0x3dd7dc7f,0xbd899f4e
.long 0x3de4aa59,0xbd663375,0x3dd5b993,0xbd8cead0,0x3de33c5a,0xbd6bcbbb,0x3dd389c7,0xbd902dd5
.long 0x3de1c598,0xbd715aea,0x3dd14d3d,0xbd93682a,0x3de04621,0xbd76e0cb,0x3dcf0417,0xbd96999f
.long 0x3ddebe05,0xbd7c5d27,0x3dccae79,0xbd99c200,0x3ddd2d53,0xbd80e7e4,0x3dca4c87,0xbd9ce11f
.long 0x3ddb941a,0xbd839c3d,0x3dc7de65,0xbd9ff6cb,0x3dd9f26a,0xbd864b82,0x3dc56439,0xbda302d3
.long 0x3dd84853,0xbd88f59b,0x3dc2de29,0xbda6050a,0x3dd695e5,0xbd8b9a6b,0x3dc04c5c,0xbda8fd41
.long 0x3db504f3,0xbdb504f3,0x3da26799,0xbdc5e403,0x3db085bb,0xbdb96842,0x3d9ce11f,0xbdca4c87
.long 0x3dabeb4a,0xbdbdaef9,0x3d973c07,0xbdce8d90,0x3da73656,0xbdc1d870,0x3d91796b,0xbdd2a649
.long 0x3da26799,0xbdc5e403,0x3d8b9a6b,0xbdd695e5,0x3d9d7fd1,0xbdc9d112,0x3d85a02c,0xbdda5ba0
.long 0x3d987fc0,0xbdcd9f02,0x3d7f17b2,0xbdddf6be,0x3d93682a,0xbdd14d3d,0x3d72bd43,0xbde1668a
.long 0x3d8e39da,0xbdd4db31,0x3d663375,0xbde4aa59,0x3d88f59b,0xbdd84853,0x3d597cb9,0xbde7c187
.long 0x3d839c3d,0xbddb941a,0x3d4c9b8b,0xbdeaab7b,0x3d7c5d27,0xbddebe05,0x3d3f926f,0xbded67a1
.long 0x3d715aea,0xbde1c598,0x3d3263ef,0xbdeff573,0x3d663375,0xbde4aa59,0x3d25129f,0xbdf25470
.long 0x3d5ae880,0xbde76bd8,0x3d17a117,0xbdf48422,0x3d4f7bca,0xbdea09a7,0x3d0a11f7,0xbdf6841b
.long 0x3d43ef15,0xbdec835e,0x3d14a031,0xbdf4fa0b,0x3d3263ef,0xbdeff573,0x3d00f8c0,0xbdf7beb7
.long 0x3d209ae5,0xbdf31447,0x3cda3997,0xbdfa1e84,0x3d0e9a22,0xbdf5dec6,0x3cb228d4,0xbdfc187a
.long 0x3cf8cfcc,0xbdf853f8,0x3c89cf86,0xbdfdabcc,0x3cd41501,0xbdfa7302,0x3c427c39,0xbdfed7d4
.long 0x3caf10a2,0xbdfc3b28,0x3be21469,0xbdff9c18,0x3c89cf86,0xbdfdabcc,0x3afb514b,0xbdfff84a
.long 0x3c48bd36,0xbdfec46d,0xbb490ab0,0xbdffec43,0x3bfb2b74,0xbdff84ab,0xbc03db0a,0xbdff7808
.long 0x3b490ab0,0xbdffec43,0xbc553db9,0xbdfe9bc9,0xbac90e90,0xbdfffb11,0xbc9324ca,0xbdfd57de
.long 0xbbc8fb30,0xbdffb10f,0xbcbb6ecf,0xbdfbaccd,0xbc2fb680,0xbdff0e58,0xbce36c83,0xbdf99b43
.long 0xbc7ab273,0xbdfe1324,0xbd0586ce,0xbdf72417,0xbca2abb6,0xbdfcbfc9,0xbd1920fe,0xbdf4484b
.long 0x3dfb14be,0xbcc7c5c2,0x3df4fa0b,0xbd14a031,0x3dfac516,0xbccdee60,0x3df4484b,0xbd1920fe
.long 0x3dfa7302,0xbcd41501,0x3df3913f,0xbd1d9e78,0x3dfa1e84,0xbcda3997,0x3df2d4eb,0xbd221887
.long 0x3df9c79d,0xbce05c13,0x3df21352,0xbd268f12,0x3df96e4e,0xbce67c66,0x3df14c7a,0xbd2b0201
.long 0x3df91298,0xbcec9a7f,0x3df08066,0xbd2f713a,0x3df8b47b,0xbcf2b651,0x3defaf1b,0xbd33dca5
.long 0x3df853f8,0xbcf8cfcc,0x3deed89e,0xbd38442a,0x3df7f110,0xbcfee6e1,0x3dedfcf2,0xbd3ca7af
.long 0x3df78bc5,0xbd027dc0,0x3ded1c1d,0xbd41071e,0x3df72417,0xbd0586ce,0x3dec3624,0xbd45625c
.long 0x3df6ba07,0xbd088e93,0x3deb4b0c,0xbd49b953,0x3df64d97,0xbd0b9507,0x3dea5ad9,0xbd4e0bea
.long 0x3df5dec6,0xbd0e9a22,0x3de96591,0xbd525a09,0x3df56d97,0xbd119ddd,0x3de86b39,0xbd56a399
.long 0x3dd4db31,0xbd8e39da,0x3dc5e403,0xbda26799,0x3dd233c6,0xbd921eb0,0x3dc25b89,0xbda69de3
.long 0x3dcf7a1f,0xbd95f6d9,0x3dbebc1b,0xbdaac082,0x3dccae79,0xbd99c200,0x3dbb0629,0xbdaecef7
.long 0x3dc9d112,0xbd9d7fd1,0x3db73a23,0xbdb2c8c9,0x3dc6e22a,0xbda12ff9,0x3db3587a,0xbdb6ad7f
.long 0x3dc3e200,0xbda4d225,0x3daf61a5,0xbdba7ca4,0x3dc0d0da,0xbda86605,0x3dab561b,0xbdbe35c5
.long 0x3dbdaef9,0xbdabeb4a,0x3da73656,0xbdc1d870,0x3dba7ca4,0xbdaf61a5,0x3da302d3,0xbdc56439
.long 0x3db73a23,0xbdb2c8c9,0x3d9ebc12,0xbdc8d8b3,0x3db3e7bc,0xbdb6206c,0x3d9a6293,0xbdcc3578
.long 0x3db085bb,0xbdb96842,0x3d95f6d9,0xbdcf7a1f,0x3dad1469,0xbdbca003,0x3d91796b,0xbdd2a649
.long 0x3da99415,0xbdbfc767,0x3d8cead0,0xbdd5b993,0x3da6050a,0xbdc2de29,0x3d884b92,0xbdd8b3a1
.long 0x3d8e39da,0xbdd4db31,0x3d715aea,0xbde1c598,0x3d87a136,0xbdd91e6a,0x3d61fb6a,0xbde5b710
.long 0x3d80e7e4,0xbddd2d53,0x3d525a09,0xbde96591,0x3d741f07,0xbde106f2,0x3d427b55,0xbdecd007
.long 0x3d663375,0xbde4aa59,0x3d3263ef,0xbdeff573,0x3d58106b,0xbde816a8,0x3d221887,0xbdf2d4eb
.long 0x3d49b953,0xbdeb4b0c,0x3d119ddd,0xbdf56d97,0x3d3b31a0,0xbdee46be,0x3d00f8c0,0xbdf7beb7
.long 0x3d2c7cd4,0xbdf10908,0x3ce05c13,0xbdf9c79d,0x3d1d9e78,0xbdf3913f,0x3cbe853e,0xbdfb87b2
.long 0x3d0e9a22,0xbdf5dec6,0x3c9c76de,0xbdfcfe73,0x3cfee6e1,0xbdf7f110,0x3c7475c0,0xbdfe2b72
.long 0x3ce05c13,0xbdf9c79d,0x3c2fb680,0xbdff0e58,0x3cc19b37,0xbdfb61fc,0x3bd5880e,0xbdffa6e3
.long 0x3ca2abb6,0xbdfcbfc9,0x3b16c9b6,0xbdfff4e6,0x3c839502,0xbdfde0b1,0xbafb514b,0xbdfff84a
.long 0x3cc7c5c2,0xbdfb14be,0x3c48bd36,0xbdfec46d,0x3c9c76de,0xbdfcfe73,0x3bd5880e,0xbdffa6e3
.long 0x3c61bc2e,0xbdfe70b0,0x3a490f88,0xbdfffec4,0x3c0a200a,0xbdff6ac7,0xbba351cb,0xbdffcbe2
.long 0x3b490ab0,0xbdffec43,0xbc2fb680,0xbdff0e58,0xbb16c9b6,0xbdfff4e6,0xbc86b26e,0xbdfdc68c
.long 0xbbfb2b74,0xbdff84ab,0xbcb54098,0xbdfbf531,0xbc553db9,0xbdfe9bc9,0xbce36c83,0xbdf99b43
.long 0xbc964083,0xbdfd3aac,0xbd088e93,0xbdf6ba07,0xbcc19b37,0xbdfb61fc,0xbd1f1cdf,0xbdf3530e
.long 0xbcec9a7f,0xbdf91298,0xbd3554ec,0xbdef6830,0xbd0b9507,0xbdf64d97,0xbd4b2aae,0xbdeafb8c
.long 0xbd209ae5,0xbdf31447,0xbd60924f,0xbde60f88,0xbd3554ec,0xbdef6830,0xbd758035,0xbde0a6cf
.long 0xbd49b953,0xbdeb4b0c,0xbd84f484,0xbddac450,0xbd5dbe79,0xbde6becc,0xbd8ee0db,0xbdd46b3b
.long 0x230d3132,0xbe000000,0xbc48bd36,0xbdfec46d,0xbbc8fb30,0xbdffb10f,0xbc995be0,0xbdfd1cdd
.long 0xbc48bd36,0xbdfec46d,0xbccdee60,0xbdfac516,0xbc964083,0xbdfd3aac,0xbd00f8c0,0xbdf7beb7
.long 0xbcc7c5c2,0xbdfb14be,0xbd1aa086,0xbdf40bdd,0xbcf8cfcc,0xbdf853f8,0xbd33dca5,0xbdefaf1b
.long 0xbd14a031,0xbdf4fa0b,0xbd4c9b8b,0xbdeaab7b,0xbd2c7cd4,0xbdf10908,0xbd64cbfe,0xbde50479
.long 0xbd43ef15,0xbdec835e,0xbd7c5d27,0xbddebe05,0xbd5ae880,0xbde76bd8,0xbd899f4e,0xbdd7dc7f
.long 0xbd715aea,0xbde1c598,0xbd94b039,0xbdd064af,0xbd839c3d,0xbddb941a,0xbd9f599f,0xbdc85bca
.long 0xbd8e39da,0xbdd4db31,0xbda99415,0xbdbfc767,0xbd987fc0,0xbdcd9f02,0xbdb3587a,0xbdb6ad7f
.long 0xbda26799,0xbdc5e403,0xbdbca003,0xbdad1469,0xbdabeb4a,0xbdbdaef9,0xbdc56439,0xbda302d3
.long 0xbd43ef15,0xbdec835e,0xbd715aea,0xbde1c598,0xbd60924f,0xbde60f88,0xbd86f686,0xbdd988ad
.long 0xbd7c5d27,0xbddebe05,0xbd94b039,0xbdd064af,0xbd8b9a6b,0xbdd695e5,0xbda1cbfb,0xbdc66354
.long 0xbd987fc0,0xbdcd9f02,0xbdae3bde,0xbdbb8f3b,0xbda4d225,0xbdc3e200,0xbdb9f2ac,0xbdaff3e6
.long 0xbdb085bb,0xbdb96842,0xbdc4e3f5,0xbda39da9,0xbdbb8f3b,0xbdae3bde,0xbdcf0417,0xbd96999f
.long 0xbdc5e403,0xbda26799,0xbdd84853,0xbd88f59b,0xbdcf7a1f,0xbd95f6d9,0xbde0a6cf,0xbd758035
.long 0xbdd84853,0xbd88f59b,0xbde816a8,0xbd58106b,0xbde04621,0xbd76e0cb,0xbdee8ff8,0xbd39bb1e
.long 0xbde76bd8,0xbd5ae880,0xbdf40bdd,0xbd1aa086,0xbdedb293,0xbd3e1d4a,0xbdf88486,0xbcf5c35a
.long 0xbdf31447,0xbd209ae5,0xbdfbf531,0xbcb54098,0xbdf78bc5,0xbd027dc0,0xbdfe5a38,0xbc67fa9a
.long 0xbdb504f3,0xbdb504f3,0xbdc5e403,0xbda26799,0xbdc1d870,0xbda73656,0xbdd1c0c2,0xbd92c39a
.long 0xbdcd9f02,0xbd987fc0,0xbddc61c7,0xbd8242b1,0xbdd84853,0xbd88f59b,0xbde5b710,0xbd61fb6a
.long 0xbde1c598,0xbd715aea,0xbdedb293,0xbd3e1d4a,0xbdea09a7,0xbd4f7bca,0xbdf4484b,0xbd1920fe
.long 0xbdf10908,0xbd2c7cd4,0xbdf96e4e,0xbce67c66,0xbdf6ba07,0xbd088e93,0xbdfd1cdd,0xbc995be0
.long 0xbdfb14be,0xbcc7c5c2,0xbdff4e6d,0xbc16a905,0xbdfe1324,0xbc7ab273,0xbdffffb1,0x39c90fc6
.long 0xbdffb10f,0xbbc8fb30,0xbdff2f9d,0x3c23308c,0xbdffec43,0x3b490ab0,0xbdfcdf6c,0x3c9f917b
.long 0xbdfec46d,0x3c48bd36,0xbdf91298,0x3cec9a7f,0xbdfc3b28,0x3caf10a2,0xbdf3ced9,0x3d1c1faf
.long 0xbdf853f8,0x3cf8cfcc,0xbded1c1d,0x3d41071e,0xbdf31447,0x3d209ae5,0xbde50479,0x3d64cbfe
.long 0xbdec835e,0xbd43ef15,0xbdf4fa0b,0xbd14a031,0xbdf40bdd,0xbd1aa086,0xbdfa9c59,0xbcd101f1
.long 0xbdf9c79d,0xbce05c13,0xbdfe4323,0xbc6e3876,0xbdfdabcc,0xbc89cf86,0xbdffe705,0xbb622a7a
.long 0xbdffb10f,0xbbc8fb30,0xbdff84ab,0x3bfb2b74,0xbdffd397,0x3b96c32c,0xbdfd1cdd,0x3c995be0
.long 0xbdfe1324,0x3c7ab273,0xbdf8b47b,0x3cf2b651,0xbdfa7302,0x3cd41501,0xbdf25470,0x3d25129f
.long 0xbdf4fa0b,0x3d14a031,0xbdea09a7,0x3d4f7bca,0xbdedb293,0x3d3e1d4a,0xbddfe4e9,0x3d7840c8
.long 0xbde4aa59,0x3d663375,0xbdd3fac3,0x3d8f8784,0xbdd9f26a,0x3d864b82,0xbdc66354,0x3da1cbfb
.long 0xbdcd9f02,0x3d987fc0,0xbdb73a23,0x3db2c8c9,0xbdbfc767,0x3da99415,0xbda69de3,0x3dc25b89
.long 0xbdb085bb,0x3db96842,0xbd94b039,0x3dd064af,0xbd9ff6cb,0x3dc7de65,0xbd819573,0x3ddcc7d1
.long 0xbcc7c5c2,0xbdfb14be,0xbd14a031,0xbdf4fa0b,0xbcfee6e1,0xbdf7f110,0xbd30eacb,0xbdf03b37
.long 0xbd1aa086,0xbdf40bdd,0xbd4c9b8b,0xbdeaab7b,0xbd3554ec,0xbdef6830,0xbd679a5d,0xbde44fac
.long 0xbd4f7bca,0xbdea09a7,0xbd80e7e4,0xbddd2d53,0xbd6900b7,0xbde3f473,0xbd8d9281,0xbdd54aa4
.long 0xbd80e7e4,0xbddd2d53,0xbd99c200,0xbdccae79,0xbd8cead0,0xbdd5b993,0xbda56bcb,0xbdc36051
.long 0xbd987fc0,0xbdcd9f02,0xbdb085bb,0xbdb96842,0xbda39da9,0xbdc4e3f5,0xbdbb0629,0xbdaecef7
.long 0xbdae3bde,0xbdbb8f3b,0xbdc4e3f5,0xbda39da9,0xbdb85216,0xbdb1a81d,0xbdce1689,0xbd97de12
.long 0xbdc1d870,0xbda73656,0xbdd695e5,0xbd8b9a6b,0xbdcac77f,0xbd9c420c,0xbdde5aa6,0xbd7dbabb
.long 0xbdd31849,0xbd90d3cd,0xbde55e0b,0xbd6363fa,0xbddac450,0xbd84f484,0xbdeb99fb,0xbd48477c
.long 0xbd8e39da,0xbdd4db31,0xbda26799,0xbdc5e403,0xbd9c420c,0xbdcac77f,0xbdaff3e6,0xbdb9f2ac
.long 0xbda99415,0xbdbfc767,0xbdbca003,0xbdad1469,0xbdb6206c,0xbdb3e7bc,0xbdc85bca,0xbd9f599f
.long 0xbdc1d870,0xbda73656,0xbdd31849,0xbd90d3cd,0xbdccae79,0xbd99c200,0xbddcc7d1,0xbd819573
.long 0xbdd695e5,0xbd8b9a6b,0xbde55e0b,0xbd6363fa,0xbddf8327,0xbd79a02d,0xbdecd007,0xbd427b55
.long 0xbde76bd8,0xbd5ae880,0xbdf31447,0xbd209ae5,0xbdee46be,0xbd3b31a0,0xbdf822d1,0xbcfbdba4
.long 0xbdf40bdd,0xbd1aa086,0xbdfbf531,0xbcb54098,0xbdf8b47b,0xbcf2b651,0xbdfe868b,0xbc5b7d37
.long 0xbdfc3b28,0xbcaf10a2,0xbdffd397,0xbb96c32c,0xbdfe9bc9,0xbc553db9,0xbdffdaaf,0x3b8a342f
.long 0xbdffd397,0xbb96c32c,0xbdfe9bc9,0x3c553db9,0xbdffe129,0x3b7b49ba,0xbdfc187a,0x3cb228d4
.long 0xbdd4db31,0xbd8e39da,0xbde1c598,0xbd715aea,0xbddf8327,0xbd79a02d,0xbdeafb8c,0xbd4b2aae
.long 0xbde8bf3c,0xbd553641,0xbdf294f8,0xbd2395c5,0xbdf08066,0xbd2f713a,0xbdf88486,0xbcf5c35a
.long 0xbdf6ba07,0xbd088e93,0xbdfcbfc9,0xbca2abb6,0xbdfb61fc,0xbcc19b37,0xbdff3f54,0xbc1cecf9
.long 0xbdfe70b0,0xbc61bc2e,0xbdfffec4,0x3a490f88,0xbdffe129,0xbb7b49ba,0xbdfefcc9,0x3c35f8da
.long 0xbdffb10f,0x3bc8fb30,0xbdfc3b28,0x3caf10a2,0xbdfde0b1,0x3c839502,0xbdf7beb7,0x3d00f8c0
.long 0xbdfa7302,0x3cd41501,0xbdf18f57,0x3d2986c4,0xbdf56d97,0x3d119ddd,0xbde9b7e4,0x3d50eb2a
.long 0xbdeed89e,0x3d38442a,0xbde04621,0x3d76e0cb,0xbde6becc,0x3d5dbe79,0xbdd54aa4,0x3d8d9281
.long 0xbddd2d53,0x3d80e7e4,0xbdc8d8b3,0x3d9ebc12,0xbdd233c6,0x3d921eb0,0xbdbb0629,0x3daecef7
.long 0xbdfb14be,0xbcc7c5c2,0xbdfec46d,0xbc48bd36,0xbdfe9bc9,0xbc553db9,0xbdffffb1,0xb9c90fc6
.long 0xbdfffb11,0xbac90e90,0xbdfeea9d,0x3c3c3ac3,0xbdff2f9d,0x3c23308c,0xbdfb87b2,0x3cbe853e
.long 0xbdfc3b28,0x3caf10a2,0xbdf5dec6,0x3d0e9a22,0xbdf72417,0x3d0586ce,0xbdedfcf2,0x3d3ca7af
.long 0xbdeff573,0x3d3263ef,0xbde3f473,0x3d6900b7,0xbde6becc,0x3d5dbe79,0xbdd7dc7f,0x3d899f4e
.long 0xbddb941a,0x3d839c3d,0xbdc9d112,0x3d9d7fd1,0xbdce8d90,0x3d973c07,0xbdb9f2ac,0x3daff3e6
.long 0xbdbfc767,0x3da99415,0xbda86605,0x3dc0d0da,0xbdaf61a5,0x3dba7ca4,0xbd9553b7,0x3dcfefa8
.long 0xbd9d7fd1,0x3dc9d112,0xbd80e7e4,0x3ddd2d53,0xbd8a48ad,0x3dd77026,0xbd56a399,0x3de86b39
.long 0xbd6bcbbb,0x3de33c5a,0xbd2986c4,0x3df18f57,0xbd41071e,0x3ded1c1d,0xbcf5c35a,0x3df88486
.long 0x3f000000,0x0,0x3f000000,0x0,0x3efec46d,0x3d48bd36,0x3efeb069,0x3d4efdb7
.long 0x3efb14be,0x3dc7c5c2,0x3efac516,0x3dcdee60,0x3ef4fa0b,0x3e14a031,0x3ef4484b,0x3e1920fe
.long 0x3eec835e,0x3e43ef15,0x3eeb4b0c,0x3e49b953,0x3ee1c598,0x3e715aea,0x3edfe4e9,0x3e7840c8
.long 0x3ed4db31,0x3e8e39da,0x3ed233c6,0x3e921eb0,0x3ec5e403,0x3ea26799,0x3ec25b89,0x3ea69de3
.long 0x3eb504f3,0x3eb504f3,0x3eb085bb,0x3eb96842,0x3ea26799,0x3ec5e403,0x3e9ce11f,0x3eca4c87
.long 0x3e8e39da,0x3ed4db31,0x3e87a136,0x3ed91e6a,0x3e715aea,0x3ee1c598,0x3e61fb6a,0x3ee5b710
.long 0x3e43ef15,0x3eec835e,0x3e3263ef,0x3eeff573,0x3e14a031,0x3ef4fa0b,0x3e00f8c0,0x3ef7beb7
.long 0x3dc7c5c2,0x3efb14be,0x3d9c76de,0x3efcfe73,0x3d48bd36,0x3efec46d,0x3cd5880e,0x3effa6e3
.long 0x3f000000,0x0,0x3f000000,0x0,0x3efe70b0,0x3d61bc2e,0x3efe5a38,0x3d67fa9a
.long 0x3ef9c79d,0x3de05c13,0x3ef96e4e,0x3de67c66,0x3ef21352,0x3e268f12,0x3ef14c7a,0x3e2b0201
.long 0x3ee76bd8,0x3e5ae880,0x3ee60f88,0x3e60924f,0x3ed9f26a,0x3e864b82,0x3ed7dc7f,0x3e899f4e
.long 0x3ec9d112,0x3e9d7fd1,0x3ec6e22a,0x3ea12ff9,0x3eb73a23,0x3eb2c8c9,0x3eb3587a,0x3eb6ad7f
.long 0x3ea26799,0x3ec5e403,0x3e9d7fd1,0x3ec9d112,0x3e8b9a6b,0x3ed695e5,0x3e85a02c,0x3eda5ba0
.long 0x3e663375,0x3ee4aa59,0x3e58106b,0x3ee816a8,0x3e3263ef,0x3eeff573,0x3e221887,0x3ef2d4eb
.long 0x3df8cfcc,0x3ef853f8,0x3dd41501,0x3efa7302,0x3d89cf86,0x3efdabcc,0x3d427c39,0x3efed7d4
.long 0x3c490ab0,0x3effec43,0xbc16c9b6,0x3efff4e6,0xbd2fb680,0x3eff0e58,0xbd86b26e,0x3efdc68c
.long 0x3f000000,0x0,0x3f000000,0x0,0x3efe1324,0x3d7ab273,0x3efdfa38,0x3d807745
.long 0x3ef853f8,0x3df8cfcc,0x3ef7f110,0x3dfee6e1,0x3eeed89e,0x3e38442a,0x3eedfcf2,0x3e3ca7af
.long 0x3ee1c598,0x3e715aea,0x3ee04621,0x3e76e0cb,0x3ed14d3d,0x3e93682a,0x3ecf0417,0x3e96999f
.long 0x3ebdaef9,0x3eabeb4a,0x3eba7ca4,0x3eaf61a5,0x3ea73656,0x3ec1d870,0x3ea302d3,0x3ec56439
.long 0x3e8e39da,0x3ed4db31,0x3e88f59b,0x3ed84853,0x3e663375,0x3ee4aa59,0x3e597cb9,0x3ee7c187
.long 0x3e2c7cd4,0x3ef10908,0x3e1d9e78,0x3ef3913f,0x3de05c13,0x3ef9c79d,0x3dbe853e,0x3efb87b2
.long 0x3d48bd36,0x3efec46d,0x3cfb2b74,0x3eff84ab,0xbc490ab0,0x3effec43,0xbd03db0a,0x3eff7808
.long 0xbd964083,0x3efd3aac,0xbdc19b37,0x3efb61fc,0xbe088e93,0x3ef6ba07,0xbe1f1cdf,0x3ef3530e
.long 0x3f000000,0x0,0x3f000000,0x0,0x3efdabcc,0x3d89cf86,0x3efd906e,0x3d8cec4a
.long 0x3ef6ba07,0x3e088e93,0x3ef64d97,0x3e0b9507,0x3eeb4b0c,0x3e49b953,0x3eea5ad9,0x3e4e0bea
.long 0x3edb941a,0x3e839c3d,0x3ed9f26a,0x3e864b82,0x3ec7de65,0x3e9ff6cb,0x3ec56439,0x3ea302d3
.long 0x3eb085bb,0x3eb96842,0x3ead1469,0x3ebca003,0x3e95f6d9,0x3ecf7a1f,0x3e91796b,0x3ed2a649
.long 0x3e715aea,0x3ee1c598,0x3e663375,0x3ee4aa59,0x3e3263ef,0x3eeff573,0x3e25129f,0x3ef25470
.long 0x3de05c13,0x3ef9c79d,0x3dc19b37,0x3efb61fc,0x3d2fb680,0x3eff0e58,0x3cd5880e,0x3effa6e3
.long 0xbcc8fb30,0x3effb10f,0xbd2fb680,0x3eff0e58,0xbdbb6ecf,0x3efbaccd,0xbde36c83,0x3ef99b43
.long 0xbe209ae5,0x3ef31447,0xbe3554ec,0x3eef6830,0xbe60924f,0x3ee60f88,0xbe758035,0x3ee0a6cf
.long 0x3f000000,0x0,0x3f000000,0x0,0x3efe9bc9,0x3d553db9,0x3efe868b,0x3d5b7d37
.long 0x3efa7302,0x3dd41501,0x3efa1e84,0x3dda3997,0x3ef3913f,0x3e1d9e78,0x3ef2d4eb,0x3e221887
.long 0x3eea09a7,0x3e4f7bca,0x3ee8bf3c,0x3e553641,0x3eddf6be,0x3e7f17b2,0x3edbfb34,0x3e82ef9f
.long 0x3ecf7a1f,0x3e95f6d9,0x3eccae79,0x3e99c200,0x3ebebc1b,0x3eaac082,0x3ebb0629,0x3eaecef7
.long 0x3eabeb4a,0x3ebdaef9,0x3ea73656,0x3ec1d870,0x3e973c07,0x3ece8d90,0x3e91796b,0x3ed2a649
.long 0x3e80e7e4,0x3edd2d53,0x3e741f07,0x3ee106f2,0x3e525a09,0x3ee96591,0x3e427b55,0x3eecd007
.long 0x3e209ae5,0x3ef31447,0x3e0e9a22,0x3ef5dec6,0x3dda3997,0x3efa1e84,0x3db228d4,0x3efc187a
.long 0x3d61bc2e,0x3efe70b0,0x3d0a200a,0x3eff6ac7,0x3b490f88,0x3efffec4,0xbca351cb,0x3effcbe2
.long 0x3f000000,0x0,0x3f000000,0x0,0x3efe4323,0x3d6e3876,0x3efe2b72,0x3d7475c0
.long 0x3ef91298,0x3dec9a7f,0x3ef8b47b,0x3df2b651,0x3ef08066,0x3e2f713a,0x3eefaf1b,0x3e33dca5
.long 0x3ee4aa59,0x3e663375,0x3ee33c5a,0x3e6bcbbb,0x3ed5b993,0x3e8cead0,0x3ed389c7,0x3e902dd5
.long 0x3ec3e200,0x3ea4d225,0x3ec0d0da,0x3ea86605,0x3eaf61a5,0x3eba7ca4,0x3eab561b,0x3ebe35c5
.long 0x3e987fc0,0x3ecd9f02,0x3e93682a,0x3ed14d3d,0x3e7f17b2,0x3eddf6be,0x3e72bd43,0x3ee1668a
.long 0x3e49b953,0x3eeb4b0c,0x3e3b31a0,0x3eee46be,0x3e119ddd,0x3ef56d97,0x3e00f8c0,0x3ef7beb7
.long 0x3daf10a2,0x3efc3b28,0x3d89cf86,0x3efdabcc,0x3ce21469,0x3eff9c18,0x3bfb514b,0x3efff84a
.long 0xbcfb2b74,0x3eff84ab,0xbd553db9,0x3efe9bc9,0xbdb54098,0x3efbf531,0xbde36c83,0x3ef99b43
.long 0x3f000000,0x0,0x3f000000,0x0,0x3efde0b1,0x3d839502,0x3efdc68c,0x3d86b26e
.long 0x3ef78bc5,0x3e027dc0,0x3ef72417,0x3e0586ce,0x3eed1c1d,0x3e41071e,0x3eec3624,0x3e45625c
.long 0x3edebe05,0x3e7c5d27,0x3edd2d53,0x3e80e7e4,0x3eccae79,0x3e99c200,0x3eca4c87,0x3e9ce11f
.long 0x3eb73a23,0x3eb2c8c9,0x3eb3e7bc,0x3eb6206c,0x3e9ebc12,0x3ec8d8b3,0x3e9a6293,0x3ecc3578
.long 0x3e839c3d,0x3edb941a,0x3e7c5d27,0x3edebe05,0x3e4c9b8b,0x3eeaab7b,0x3e3f926f,0x3eed67a1
.long 0x3e0e9a22,0x3ef5dec6,0x3dfee6e1,0x3ef7f110,0x3d9c76de,0x3efcfe73,0x3d7475c0,0x3efe2b72
.long 0x3c490ab0,0x3effec43,0xbbc90e90,0x3efffb11,0xbd553db9,0x3efe9bc9,0xbd9324ca,0x3efd57de
.long 0xbdec9a7f,0x3ef91298,0xbe0b9507,0x3ef64d97,0xbe3554ec,0x3eef6830,0xbe4b2aae,0x3eeafb8c
.long 0x3f000000,0x0,0x3f000000,0x0,0x3efd7474,0x3d9008b7,0x3efd57de,0x3d9324ca
.long 0x3ef5dec6,0x3e0e9a22,0x3ef56d97,0x3e119ddd,0x3ee96591,0x3e525a09,0x3ee86b39,0x3e56a399
.long 0x3ed84853,0x3e88f59b,0x3ed695e5,0x3e8b9a6b,0x3ec2de29,0x3ea6050a,0x3ec04c5c,0x3ea8fd41
.long 0x3ea99415,0x3ebfc767,0x3ea6050a,0x3ec2de29,0x3e8cead0,0x3ed5b993,0x3e884b92,0x3ed8b3a1
.long 0x3e5ae880,0x3ee76bd8,0x3e4f7bca,0x3eea09a7,0x3e17a117,0x3ef48422,0x3e0a11f7,0x3ef6841b
.long 0x3da2abb6,0x3efcbfc9,0x3d839502,0x3efde0b1,0x3c16c9b6,0x3efff4e6,0xbbfb514b,0x3efff84a
.long 0xbd7ab273,0x3efe1324,0xbda2abb6,0x3efcbfc9,0xbe0586ce,0x3ef72417,0xbe1920fe,0x3ef4484b
.long 0xbe49b953,0x3eeb4b0c,0xbe5dbe79,0x3ee6becc,0xbe84f484,0x3edac450,0xbe8ee0db,0x3ed46b3b
.long 0x240d3132,0x3f000000,0xbcc8fb30,0x3effb10f,0xbd48bd36,0x3efec46d,0xbd995be0,0x3efd1cdd
.long 0xbdc7c5c2,0x3efb14be,0xbdfee6e1,0x3ef7f110,0xbe14a031,0x3ef4fa0b,0xbe30eacb,0x3ef03b37
.long 0xbe43ef15,0x3eec835e,0xbe60924f,0x3ee60f88,0xbe715aea,0x3ee1c598,0xbe86f686,0x3ed988ad
.long 0xbe8e39da,0x3ed4db31,0xbe9c420c,0x3ecac77f,0xbea26799,0x3ec5e403,0xbeaff3e6,0x3eb9f2ac
.long 0xbeb504f3,0x3eb504f3,0xbec1d870,0x3ea73656,0xbec5e403,0x3ea26799,0xbed1c0c2,0x3e92c39a
.long 0xbed4db31,0x3e8e39da,0xbedf8327,0x3e79a02d,0xbee1c598,0x3e715aea,0xbeeafb8c,0x3e4b2aae
.long 0xbeec835e,0x3e43ef15,0xbef40bdd,0x3e1aa086,0xbef4fa0b,0x3e14a031,0xbefa9c59,0x3dd101f1
.long 0xbefb14be,0x3dc7c5c2,0xbefe9bc9,0x3d553db9,0xbefec46d,0x3d48bd36,0xbeffffb1,0x3ac90fc6
.long 0xbdc7c5c2,0x3efb14be,0xbdf8cfcc,0x3ef853f8,0xbe1aa086,0x3ef40bdd,0xbe33dca5,0x3eefaf1b
.long 0xbe4f7bca,0x3eea09a7,0xbe6900b7,0x3ee3f473,0xbe80e7e4,0x3edd2d53,0xbe8d9281,0x3ed54aa4
.long 0xbe987fc0,0x3ecd9f02,0xbea4d225,0x3ec3e200,0xbeae3bde,0x3ebb8f3b,0xbeb9f2ac,0x3eaff3e6
.long 0xbec1d870,0x3ea73656,0xbeccae79,0x3e99c200,0xbed31849,0x3e90d3cd,0xbedcc7d1,0x3e819573
.long 0xbee1c598,0x3e715aea,0xbeea09a7,0x3e4f7bca,0xbeedb293,0x3e3e1d4a,0xbef4484b,0x3e1920fe
.long 0xbef6ba07,0x3e088e93,0xbefb61fc,0x3dc19b37,0xbefcbfc9,0x3da2abb6,0xbeff3f54,0x3d1cecf9
.long 0xbeffb10f,0x3cc8fb30,0xbeffd397,0xbc96c32c,0xbeff84ab,0xbcfb2b74,0xbefd1cdd,0xbd995be0
.long 0xbefc3b28,0xbdaf10a2,0xbef72417,0xbe0586ce,0xbef5dec6,0xbe0e9a22,0xbeedfcf2,0xbe3ca7af
.long 0xbe43ef15,0x3eec835e,0xbe5ae880,0x3ee76bd8,0xbe7c5d27,0x3edebe05,0xbe899f4e,0x3ed7dc7f
.long 0xbe987fc0,0x3ecd9f02,0xbea39da9,0x3ec4e3f5,0xbeb085bb,0x3eb96842,0xbebb0629,0x3eaecef7
.long 0xbec5e403,0x3ea26799,0xbecf7a1f,0x3e95f6d9,0xbed84853,0x3e88f59b,0xbee0a6cf,0x3e758035
.long 0xbee76bd8,0x3e5ae880,0xbeee46be,0x3e3b31a0,0xbef31447,0x3e209ae5,0xbef822d1,0x3dfbdba4
.long 0xbefb14be,0x3dc7c5c2,0xbefe1324,0x3d7ab273,0xbeff4e6d,0x3d16a905,0xbeffffb1,0xbac90fc6
.long 0xbeffb10f,0xbcc8fb30,0xbefde0b1,0xbd839502,0xbefc3b28,0xbdaf10a2,0xbef7beb7,0xbe00f8c0
.long 0xbef4fa0b,0xbe14a031,0xbeedb293,0xbe3e1d4a,0xbeea09a7,0xbe4f7bca,0xbedfe4e9,0xbe7840c8
.long 0xbedb941a,0xbe839c3d,0xbece8d90,0xbe973c07,0xbec9d112,0xbe9d7fd1,0xbeb9f2ac,0xbeaff3e6
.long 0xbe8e39da,0x3ed4db31,0xbe987fc0,0x3ecd9f02,0xbea99415,0x3ebfc767,0xbeb3587a,0x3eb6ad7f
.long 0xbec1d870,0x3ea73656,0xbecac77f,0x3e9c420c,0xbed695e5,0x3e8b9a6b,0xbede5aa6,0x3e7dbabb
.long 0xbee76bd8,0x3e5ae880,0xbeedb293,0x3e3e1d4a,0xbef40bdd,0x3e1aa086,0xbef88486,0x3df5c35a
.long 0xbefc3b28,0x3daf10a2,0xbefe9bc9,0x3d553db9,0xbeffd397,0x3c96c32c,0xbeffdaaf,0xbc8a342f
.long 0xbefec46d,0xbd48bd36,0xbefc3b28,0xbdaf10a2,0xbef91298,0xbdec9a7f,0xbef3ced9,0xbe1c1faf
.long 0xbeeed89e,0xbe38442a,0xbee6becc,0xbe5dbe79,0xbee04621,0xbe76e0cb,0xbed54aa4,0xbe8d9281
.long 0xbecd9f02,0xbe987fc0,0xbebfc767,0xbea99415,0xbeb73a23,0xbeb2c8c9,0xbea69de3,0xbec25b89
.long 0xbe9d7fd1,0xbec9d112,0xbe8a48ad,0xbed77026,0xbe80e7e4,0xbedd2d53,0xbe56a399,0xbee86b39
.long 0xbd48bd36,0x3efec46d,0xbd964083,0x3efd3aac,0xbdcdee60,0x3efac516,0xbe00f8c0,0x3ef7beb7
.long 0xbe1aa086,0x3ef40bdd,0xbe3554ec,0x3eef6830,0xbe4c9b8b,0x3eeaab7b,0xbe679a5d,0x3ee44fac
.long 0xbe7c5d27,0x3edebe05,0xbe8b9a6b,0x3ed695e5,0xbe94b039,0x3ed064af,0xbea1cbfb,0x3ec66354
.long 0xbea99415,0x3ebfc767,0xbeb6206c,0x3eb3e7bc,0xbebca003,0x3ead1469,0xbec85bca,0x3e9f599f
.long 0xbecd9f02,0x3e987fc0,0xbed84853,0x3e88f59b,0xbedc61c7,0x3e8242b1,0xbee5b710,0x3e61fb6a
.long 0xbee8bf3c,0x3e553641,0xbef08066,0x3e2f713a,0xbef294f8,0x3e2395c5,0xbef88486,0x3df5c35a
.long 0xbef9c79d,0x3de05c13,0xbefdabcc,0x3d89cf86,0xbefe4323,0x3d6e3876,0xbeffe705,0x3c622a7a
.long 0xbefffb11,0x3bc90e90,0xbeff2f9d,0xbd23308c,0xbefeea9d,0xbd3c3ac3,0xbefb87b2,0xbdbe853e
.long 0xbe14a031,0x3ef4fa0b,0xbe2c7cd4,0x3ef10908,0xbe4c9b8b,0x3eeaab7b,0xbe64cbfe,0x3ee50479
.long 0xbe80e7e4,0x3edd2d53,0xbe8cead0,0x3ed5b993,0xbe99c200,0x3eccae79,0xbea56bcb,0x3ec36051
.long 0xbeb085bb,0x3eb96842,0xbebb8f3b,0x3eae3bde,0xbec4e3f5,0x3ea39da9,0xbecf0417,0x3e96999f
.long 0xbed695e5,0x3e8b9a6b,0xbedf8327,0x3e79a02d,0xbee55e0b,0x3e6363fa,0xbeecd007,0x3e427b55
.long 0xbef10908,0x3e2c7cd4,0xbef6ba07,0x3e088e93,0xbef96e4e,0x3de67c66,0xbefd1cdd,0x3d995be0
.long 0xbefe70b0,0x3d61bc2e,0xbeffe129,0x3c7b49ba,0xbefffec4,0xbb490f88,0xbefefcc9,0xbd35f8da
.long 0xbefe1324,0xbd7ab273,0xbefa7302,0xbdd41501,0xbef8b47b,0xbdf2b651,0xbef25470,0xbe25129f
.long 0xbeeff573,0xbe3263ef,0xbee6becc,0xbe5dbe79,0xbee3f473,0xbe6900b7,0xbed7dc7f,0xbe899f4e
.long 0xbe715aea,0x3ee1c598,0xbe839c3d,0x3edb941a,0xbe94b039,0x3ed064af,0xbe9f599f,0x3ec85bca
.long 0xbeae3bde,0x3ebb8f3b,0xbeb85216,0x3eb1a81d,0xbec4e3f5,0x3ea39da9,0xbece1689,0x3e97de12
.long 0xbed84853,0x3e88f59b,0xbee04621,0x3e76e0cb,0xbee816a8,0x3e58106b,0xbeee8ff8,0x3e39bb1e
.long 0xbef40bdd,0x3e1aa086,0xbef8b47b,0x3df2b651,0xbefbf531,0x3db54098,0xbefe868b,0x3d5b7d37
.long 0xbeffb10f,0x3cc8fb30,0xbeffec43,0xbc490ab0,0xbeff2f9d,0xbd23308c,0xbefcdf6c,0xbd9f917b
.long 0xbefa7302,0xbdd41501,0xbef56d97,0xbe119ddd,0xbef18f57,0xbe2986c4,0xbee9b7e4,0xbe50eb2a
.long 0xbee4aa59,0xbe663375,0xbed9f26a,0xbe864b82,0xbed3fac3,0xbe8f8784,0xbec66354,0xbea1cbfb
.long 0xbebfc767,0xbea99415,0xbeaf61a5,0xbeba7ca4,0xbea86605,0xbec0d0da,0xbe9553b7,0xbecfefa8
.long 0xbea26799,0x3ec5e403,0xbeabeb4a,0x3ebdaef9,0xbebca003,0x3ead1469,0xbec56439,0x3ea302d3
.long 0xbed31849,0x3e90d3cd,0xbedac450,0x3e84f484,0xbee55e0b,0x3e6363fa,0xbeeb99fb,0x3e48477c
.long 0xbef31447,0x3e209ae5,0xbef78bc5,0x3e027dc0,0xbefbf531,0x3db54098,0xbefe5a38,0x3d67fa9a
.long 0xbeffd397,0x3c96c32c,0xbeffe129,0xbc7b49ba,0xbefe9bc9,0xbd553db9,0xbefc187a,0xbdb228d4
.long 0xbef853f8,0xbdf8cfcc,0xbef31447,0xbe209ae5,0xbeed1c1d,0xbe41071e,0xbee50479,0xbe64cbfe
.long 0xbedd2d53,0xbe80e7e4,0xbed233c6,0xbe921eb0,0xbec8d8b3,0xbe9ebc12,0xbebb0629,0xbeaecef7
.long 0xbeb085bb,0xbeb96842,0xbe9ff6cb,0xbec7de65,0xbe94b039,0xbed064af,0xbe819573,0xbedcc7d1
.long 0xbe6bcbbb,0xbee33c5a,0xbe41071e,0xbeed1c1d,0xbe2986c4,0xbef18f57,0xbdf5c35a,0xbef88486
.long 0x3c00,0xbc008000,0xbc00,0x3c000000,0x3c00,0xbbf62e46,0xb23ebbd9,0x3ba8b4a5
.long 0x3c00,0xbbd9323e,0xb61fbb64,0x3aa7b872,0x3c00,0xbba834a5,0xb872baa7,0x3913ba2f
.long 0x3c00,0xbb64361f,0xb9a8b9a8,0x361fbb64,0x3c00,0xbb0e378b,0xbaa7b872,0x2e46bbf6
.long 0x3c00,0xbaa73872,0xbb64b61f,0xb23ebbd9,0x3c00,0xba2f3913,0xbbd9b23e,0xb78bbb0e
.long 0x3c00,0xb9a839a8,0xbc008000,0xb9a8b9a8,0x3c00,0xb9133a2f,0xbbd9323e,0xbb0eb78b
.long 0x3c00,0xb8723aa7,0xbb64361f,0xbbd9b23e,0x3c00,0xb78b3b0e,0xbaa73872,0xbbf62e46
.long 0x3c00,0xb61f3b64,0xb9a839a8,0xbb64361f,0x3c00,0xb4a53ba8,0xb8723aa7,0xba2f3913
.long 0x3c00,0xb23e3bd9,0xb61f3b64,0xb8723aa7,0x3c00,0xae463bf6,0xb23e3bd9,0xb4a53ba8
.long 0x3c00,0xbc008000,0xbc00,0x3c000000,0x361f3b64,0xbb0e378b,0xb872baa7,0x3a2fb913
.long 0x39a839a8,0xb8723aa7,0xbb64b61f,0x323ebbd9,0x3b64361f,0xae463bf6,0xbbd9323e,0xb78bbb0e
.long 0x3c000000,0x361f3b64,0xb9a839a8,0xbb64b61f,0x3b64b61f,0x3a2f3913,0xb23e3bd9,0xbba834a5
.long 0x39a8b9a8,0x3bd9323e,0x361f3b64,0xb8723aa7,0x361fbb64,0x3ba8b4a5,0x3aa73872,0x2e463bf6
.long 0xbc00,0x39a8b9a8,0x3c000000,0x39a839a8,0xb61fbb64,0x34a5bba8,0x3aa7b872,0x3bf62e46
.long 0xb9a8b9a8,0xb23ebbd9,0x361fbb64,0x3aa7b872,0xbb64b61f,0xb913ba2f,0xb23ebbd9,0x34a5bba8
.long 0xbc008000,0xbb64b61f,0xb9a8b9a8,0xb61fbb64,0xbb64361f,0xbbf62e46,0xbbd9b23e,0xbb0eb78b
.long 0xb9a839a8,0xbaa73872,0xbb64361f,0xbbd9323e,0xb61f3b64,0xb78b3b0e,0xb8723aa7,0xb9133a2f
.long 0x3c00,0xbc008000,0xbc00,0x3c000000,0x39a839a8,0xb9133a2f,0xbaa7b872,0x378bbb0e
.long 0x3c000000,0x323e3bd9,0xbb64361f,0xb872baa7,0x39a8b9a8,0x3b0e378b,0xb23e3bd9,0xbbf62e46
.long 0xbc00,0x3b64b61f,0x39a839a8,0xb61f3b64,0xb9a8b9a8,0x34a5bba8,0x3bd9b23e,0x39133a2f
.long 0xbc008000,0xb872baa7,0x361fbb64,0x3bd9b23e,0xb9a839a8,0xbbf6ae46,0xb872baa7,0x34a5bba8
.long 0x3c00,0xb9a839a8,0xbc008000,0xb9a8b9a8,0x39a839a8,0x2e463bf6,0xb8723aa7,0xbba834a5
.long 0x3c000000,0x3aa73872,0x361f3b64,0xb23e3bd9,0x39a8b9a8,0x3ba8b4a5,0x3bd9323e,0x3a2f3913
.long 0xbc00,0x361fbb64,0x39a8b9a8,0x3b64b61f,0xb9a8b9a8,0xb78bbb0e,0xb23ebbd9,0x2e46bbf6
.long 0xbc008000,0xbbd9b23e,0xbb64b61f,0xbaa7b872,0xb9a839a8,0xba2f3913,0xbaa73872,0xbb0e378b
.long 0x3c00,0xbc008000,0xbc00,0x3c000000,0x3b64361f,0xb4a53ba8,0xbbd9b23e,0x2e46bbf6
.long 0x39a8b9a8,0x3aa73872,0xb61f3b64,0xbbd9b23e,0xb61fbb64,0x3a2fb913,0x3aa73872,0xb4a53ba8
.long 0xbc008000,0xb61fbb64,0x39a8b9a8,0x3b64361f,0xb61f3b64,0xbbf62e46,0xb872baa7,0x378bbb0e
.long 0x39a839a8,0xb23e3bd9,0xbb64361f,0xbaa7b872,0x3b64b61f,0x3b0e378b,0x323e3bd9,0xb9133a2f
.long 0xbc00,0x39a8b9a8,0x3c000000,0x39a839a8,0xbb64b61f,0xb78bbb0e,0x323ebbd9,0x3a2fb913
.long 0xb9a839a8,0xbbd9323e,0xbb64b61f,0xb872baa7,0x361f3b64,0xae463bf6,0xb8723aa7,0xbb0e378b
.long 0x3c000000,0x3b64361f,0x39a839a8,0x361f3b64,0x361fbb64,0x3913ba2f,0x3aa7b872,0x3ba8b4a5
.long 0xb9a8b9a8,0xb872baa7,0xb61fbb64,0xb23ebbd9,0xbb64361f,0xbba834a5,0xbbd9323e,0xbbf62e46
.long 0x3c008000,0x80003c00,0xbc008000,0xbc00,0x3c008000,0x2e463bf6,0xbbd9323e,0xb4a5bba8
.long 0x3c008000,0x323e3bd9,0xbb64361f,0xb872baa7,0x3c008000,0x34a53ba8,0xbaa73872,0xba2fb913
.long 0x3c008000,0x361f3b64,0xb9a839a8,0xbb64b61f,0x3c008000,0x378b3b0e,0xb8723aa7,0xbbf6ae46
.long 0x3c008000,0x38723aa7,0xb61f3b64,0xbbd9323e,0x3c008000,0x39133a2f,0xb23e3bd9,0xbb0e378b
.long 0x3c008000,0x39a839a8,0x80003c00,0xb9a839a8,0x3c008000,0x3a2f3913,0x323e3bd9,0xb78b3b0e
.long 0x3c008000,0x3aa73872,0x361f3b64,0xb23e3bd9,0x3c008000,0x3b0e378b,0x38723aa7,0x2e463bf6
.long 0x3c008000,0x3b64361f,0x39a839a8,0x361f3b64,0x3c008000,0x3ba834a5,0x3aa73872,0x39133a2f
.long 0x3c008000,0x3bd9323e,0x3b64361f,0x3aa73872,0x3c008000,0x3bf62e46,0x3bd9323e,0x3ba834a5
.long 0x3c008000,0x80003c00,0xbc008000,0xbc00,0x3b64b61f,0x378b3b0e,0xbaa73872,0xb913ba2f
.long 0x39a8b9a8,0x3aa73872,0xb61f3b64,0xbbd9b23e,0x361fbb64,0x3bf62e46,0x323e3bd9,0xbb0e378b
.long 0xbc00,0x3b64b61f,0x39a839a8,0xb61f3b64,0xb61fbb64,0x3913ba2f,0x3bd9323e,0x34a53ba8
.long 0xb9a8b9a8,0x323ebbd9,0x3b64b61f,0x3aa73872,0xbb64b61f,0xb4a5bba8,0x3872baa7,0x3bf6ae46
.long 0xbc008000,0xb9a8b9a8,0xbc00,0x39a8b9a8,0xbb64361f,0xbba8b4a5,0xb872baa7,0x2e46bbf6
.long 0xb9a839a8,0xbbd9323e,0xbb64b61f,0xb872baa7,0xb61f3b64,0xba2f3913,0xbbd9323e,0xbba8b4a5
.long 0x80003c00,0xb61f3b64,0xb9a839a8,0xbb64361f,0x361f3b64,0x2e463bf6,0xb23e3bd9,0xb78b3b0e
.long 0x39a839a8,0x38723aa7,0x361f3b64,0x323e3bd9,0x3b64361f,0x3b0e378b,0x3aa73872,0x3a2f3913
.long 0x3c008000,0x80003c00,0xbc008000,0xbc00,0x39a8b9a8,0x3a2f3913,0xb8723aa7,0xbb0eb78b
.long 0xbc00,0x3bd9b23e,0x361f3b64,0xbaa73872,0xb9a8b9a8,0x378bbb0e,0x3bd9323e,0x2e463bf6
.long 0xbc008000,0xb61fbb64,0x39a8b9a8,0x3b64361f,0xb9a839a8,0xbba8b4a5,0xb23ebbd9,0x3a2fb913
.long 0x80003c00,0xbaa73872,0xbb64b61f,0xb23ebbd9,0x39a839a8,0xae463bf6,0xbaa73872,0xbba8b4a5
.long 0x3c008000,0x39a839a8,0x80003c00,0xb9a839a8,0x39a8b9a8,0x3bf6ae46,0x3aa73872,0x34a53ba8
.long 0xbc00,0x3872baa7,0x3b64b61f,0x3bd9323e,0xb9a8b9a8,0xb4a5bba8,0x323ebbd9,0x3913ba2f
.long 0xbc008000,0xbb64b61f,0xb9a8b9a8,0xb61fbb64,0xb9a839a8,0xbb0e378b,0xbbd9323e,0xbbf6ae46
.long 0x80003c00,0xb23e3bd9,0xb61f3b64,0xb8723aa7,0x39a839a8,0x39133a2f,0x38723aa7,0x378b3b0e
.long 0x3c008000,0x80003c00,0xbc008000,0xbc00,0x361fbb64,0x3ba834a5,0xb23e3bd9,0xbbf6ae46
.long 0xb9a8b9a8,0x3872baa7,0x3b64361f,0xb23e3bd9,0xbb64361f,0xb913ba2f,0x3872baa7,0x3ba834a5
.long 0x80003c00,0xbb64361f,0xb9a8b9a8,0x361fbb64,0x3b64361f,0x2e463bf6,0xbaa73872,0xbb0eb78b
.long 0x39a8b9a8,0x3bd9323e,0x361f3b64,0xb8723aa7,0xb61fbb64,0x378bbb0e,0x3bd9b23e,0x3a2f3913
.long 0xbc008000,0xb9a8b9a8,0xbc00,0x39a8b9a8,0xb61f3b64,0xbb0e378b,0xbbd9b23e,0xb913ba2f
.long 0x39a839a8,0x323e3bd9,0xb61f3b64,0xbaa73872,0x3b64b61f,0x3bf62e46,0x3aa73872,0x378b3b0e
.long 0xbc00,0x361fbb64,0x39a8b9a8,0x3b64b61f,0xbb64b61f,0xba2fb913,0xb872baa7,0xb4a5bba8
.long 0xb9a839a8,0xbaa73872,0xbb64361f,0xbbd9323e,0x361f3b64,0x34a53ba8,0x323e3bd9,0x2e463bf6
.long 0x3c00,0xbc008000,0xbc00,0x3c000000,0x3c000000,0x2e463bf6,0xbbd9323e,0xb4a5bba8
.long 0xbc00,0x3bd9b23e,0x361f3b64,0xbaa73872,0xbc008000,0xb4a5bba8,0x3aa7b872,0x3a2f3913
.long 0x3c00,0xbb64361f,0xb9a8b9a8,0x361fbb64,0x3c000000,0x378b3b0e,0xb8723aa7,0xbbf6ae46
.long 0xbc00,0x3aa7b872,0x3b64361f,0x323e3bd9,0xbc008000,0xb913ba2f,0x323ebbd9,0x3b0eb78b
.long 0x3c00,0xb9a839a8,0xbc008000,0xb9a8b9a8,0x3c000000,0x3a2f3913,0x323e3bd9,0xb78b3b0e
.long 0xbc00,0x3872baa7,0x3b64b61f,0x3bd9323e,0xbc008000,0xbb0eb78b,0xb872baa7,0xae46bbf6
.long 0x3c00,0xb61f3b64,0xb9a839a8,0xbb64361f,0x3c000000,0x3ba834a5,0x3aa73872,0x39133a2f
.long 0xbc00,0x323ebbd9,0x361fbb64,0x3872baa7,0xbc008000,0xbbf6ae46,0xbbd9b23e,0xbba8b4a5
.long 0x3c00,0xbc008000,0xbc00,0x3c000000,0x3b64b61f,0x378b3b0e,0xbaa73872,0xb913ba2f
.long 0xb9a8b9a8,0x3872baa7,0x3b64361f,0xb23e3bd9,0xb61f3b64,0xbbf6ae46,0xb23ebbd9,0x3b0eb78b
.long 0x3c000000,0x361f3b64,0xb9a839a8,0xbb64b61f,0xb61fbb64,0x3913ba2f,0x3bd9323e,0x34a53ba8
.long 0xb9a839a8,0xbbd9b23e,0xb61fbb64,0x3872baa7,0x3b64361f,0x34a53ba8,0xb8723aa7,0xbbf62e46
.long 0xbc00,0x39a8b9a8,0x3c000000,0x39a839a8,0xbb64361f,0xbba8b4a5,0xb872baa7,0x2e46bbf6
.long 0x39a839a8,0x323e3bd9,0xb61f3b64,0xbaa73872,0x361fbb64,0x3a2fb913,0x3bd9b23e,0x3ba834a5
.long 0xbc008000,0xbb64b61f,0xb9a8b9a8,0xb61fbb64,0x361f3b64,0x2e463bf6,0xb23e3bd9,0xb78b3b0e
.long 0x39a8b9a8,0x3aa7b872,0x3b64b61f,0x3bd9b23e,0xbb64b61f,0xbb0eb78b,0xbaa7b872,0xba2fb913
.long 0x3c00,0xbc008000,0xbc00,0x3c000000,0x39a8b9a8,0x3a2f3913,0xb8723aa7,0xbb0eb78b
.long 0xbc008000,0xb23ebbd9,0x3b64b61f,0x38723aa7,0x39a839a8,0xb78b3b0e,0xbbd9b23e,0xae46bbf6
.long 0xbc00,0x3b64b61f,0x39a839a8,0xb61f3b64,0xb9a839a8,0xbba8b4a5,0xb23ebbd9,0x3a2fb913
.long 0x3c000000,0x38723aa7,0xb61f3b64,0xbbd9323e,0xb9a8b9a8,0x2e46bbf6,0x3aa7b872,0x3ba834a5
.long 0x3c00,0xb9a839a8,0xbc008000,0xb9a8b9a8,0x39a8b9a8,0x3bf6ae46,0x3aa73872,0x34a53ba8
.long 0xbc008000,0xbaa7b872,0xb61fbb64,0x323ebbd9,0x39a839a8,0x34a53ba8,0xb23e3bd9,0xb9133a2f
.long 0xbc00,0x361fbb64,0x39a8b9a8,0x3b64b61f,0xb9a839a8,0xbb0e378b,0xbbd9323e,0xbbf6ae46
.long 0x3c000000,0x3bd9323e,0x3b64361f,0x3aa73872,0xb9a8b9a8,0xb913ba2f,0xb872baa7,0xb78bbb0e
.long 0x3c00,0xbc008000,0xbc00,0x3c000000,0x361fbb64,0x3ba834a5,0xb23e3bd9,0xbbf6ae46
.long 0xb9a839a8,0xbaa7b872,0x361fbb64,0x3bd9323e,0x3b64b61f,0x39133a2f,0xb8723aa7,0xbba8b4a5
.long 0xbc008000,0xb61fbb64,0x39a8b9a8,0x3b64361f,0x3b64361f,0x2e463bf6,0xbaa73872,0xbb0eb78b
.long 0xb9a8b9a8,0x323ebbd9,0x3b64b61f,0x3aa73872,0x361f3b64,0xb78b3b0e,0xbbd9323e,0xba2fb913
.long 0xbc00,0x39a8b9a8,0x3c000000,0x39a839a8,0xb61f3b64,0xbb0e378b,0xbbd9b23e,0xb913ba2f
.long 0x39a8b9a8,0x3bd9b23e,0x3b64361f,0x38723aa7,0xbb64361f,0xbbf6ae46,0xbaa7b872,0xb78bbb0e
.long 0x3c000000,0x3b64361f,0x39a839a8,0x361f3b64,0xbb64b61f,0xba2fb913,0xb872baa7,0xb4a5bba8
.long 0x39a839a8,0x38723aa7,0x361f3b64,0x323e3bd9,0xb61fbb64,0xb4a5bba8,0xb23ebbd9,0xae46bbf6
.long 0x3c008000,0x80003c00,0xbc008000,0xbc00,0xbc00,0x3bf6ae46,0x323e3bd9,0xbba834a5
.long 0xbc008000,0xb23ebbd9,0x3b64b61f,0x38723aa7,0x80003c00,0xbba834a5,0xb872baa7,0x3913ba2f
.long 0x3c008000,0x361f3b64,0xb9a839a8,0xbb64b61f,0xbc00,0x3b0eb78b,0x3aa73872,0xae463bf6
.long 0xbc008000,0xb872baa7,0x361fbb64,0x3bd9b23e,0x80003c00,0xba2f3913,0xbbd9b23e,0xb78bbb0e
.long 0x3c008000,0x39a839a8,0x80003c00,0xb9a839a8,0xbc00,0x3913ba2f,0x3bd9b23e,0x3b0e378b
.long 0xbc008000,0xbaa7b872,0xb61fbb64,0x323ebbd9,0x80003c00,0xb78b3b0e,0xbaa73872,0xbbf62e46
.long 0x3c008000,0x3b64361f,0x39a839a8,0x361f3b64,0xbc00,0x34a5bba8,0x3872baa7,0x3a2fb913
.long 0xbc008000,0xbbd9b23e,0xbb64b61f,0xbaa7b872,0x80003c00,0xae463bf6,0xb23e3bd9,0xb4a53ba8
.long 0x3c008000,0x80003c00,0xbc008000,0xbc00,0xb61fbb64,0x3b0eb78b,0x38723aa7,0xba2f3913
.long 0xb9a839a8,0xbaa7b872,0x361fbb64,0x3bd9323e,0x3b64361f,0xae463bf6,0xbbd9323e,0xb78bbb0e
.long 0xbc00,0x3b64b61f,0x39a839a8,0xb61f3b64,0xbb64361f,0xba2fb913,0x323ebbd9,0x3ba8b4a5
.long 0x39a839a8,0xb23e3bd9,0xbb64361f,0xbaa7b872,0x361fbb64,0x3ba8b4a5,0x3aa73872,0x2e463bf6
.long 0xbc008000,0xb9a8b9a8,0xbc00,0x39a8b9a8,0x361f3b64,0xb4a53ba8,0xbaa73872,0xbbf6ae46
.long 0x39a8b9a8,0x3bd9b23e,0x3b64361f,0x38723aa7,0xbb64b61f,0xb913ba2f,0xb23ebbd9,0x34a5bba8
.long 0x80003c00,0xb61f3b64,0xb9a839a8,0xbb64361f,0x3b64b61f,0x3bf6ae46,0x3bd9323e,0x3b0e378b
.long 0xb9a8b9a8,0xb872baa7,0xb61fbb64,0xb23ebbd9,0xb61f3b64,0xb78b3b0e,0xb8723aa7,0xb9133a2f
.long 0x3c008000,0x80003c00,0xbc008000,0xbc00,0xb9a8b9a8,0x3913ba2f,0x3aa73872,0xb78b3b0e
.long 0x80003c00,0xbbd9323e,0xb61fbb64,0x3aa7b872,0x39a8b9a8,0x3b0e378b,0xb23e3bd9,0xbbf62e46
.long 0xbc008000,0xb61fbb64,0x39a8b9a8,0x3b64361f,0x39a839a8,0xb4a53ba8,0xbbd9323e,0xb913ba2f
.long 0xbc00,0x3aa7b872,0x3b64361f,0x323e3bd9,0xb9a839a8,0xbbf6ae46,0xb872baa7,0x34a5bba8
.long 0x3c008000,0x39a839a8,0x80003c00,0xb9a839a8,0xb9a8b9a8,0xae46bbf6,0x3872baa7,0x3ba8b4a5
.long 0x80003c00,0xb8723aa7,0xbb64361f,0xbbd9b23e,0x39a8b9a8,0x3ba8b4a5,0x3bd9323e,0x3a2f3913
.long 0xbc008000,0xbb64b61f,0xb9a8b9a8,0xb61fbb64,0x39a839a8,0x378b3b0e,0x323e3bd9,0xae463bf6
.long 0xbc00,0x323ebbd9,0x361fbb64,0x3872baa7,0xb9a839a8,0xba2f3913,0xbaa73872,0xbb0e378b
.long 0x3c008000,0x80003c00,0xbc008000,0xbc00,0xbb64b61f,0x34a5bba8,0x3bd9323e,0xae463bf6
.long 0x39a839a8,0xb8723aa7,0xbb64b61f,0x323ebbd9,0xb61fbb64,0x3a2fb913,0x3aa73872,0xb4a53ba8
.long 0x80003c00,0xbb64361f,0xb9a8b9a8,0x361fbb64,0x361fbb64,0x3bf6ae46,0x38723aa7,0xb78b3b0e
.long 0xb9a839a8,0xbbd9b23e,0xb61fbb64,0x3872baa7,0x3b64b61f,0x3b0e378b,0x323e3bd9,0xb9133a2f
.long 0xbc008000,0xb9a8b9a8,0xbc00,0x39a8b9a8,0x3b64361f,0x378b3b0e,0xb23e3bd9,0xba2f3913
.long 0xb9a8b9a8,0xb23ebbd9,0x361fbb64,0x3aa7b872,0x361f3b64,0xae463bf6,0xb8723aa7,0xbb0e378b
.long 0xbc00,0x361fbb64,0x39a8b9a8,0x3b64b61f,0xb61f3b64,0xb9133a2f,0xbaa73872,0xbba834a5
.long 0x39a8b9a8,0x3aa7b872,0x3b64b61f,0x3bd9b23e,0xbb64361f,0xbba834a5,0xbbd9323e,0xbbf62e46
.long 0x3c00,0xbc008000,0xbc00,0x3c000000,0xbc00,0x3bf6ae46,0x323e3bd9,0xbba834a5
.long 0x3c00,0xbbd9323e,0xb61fbb64,0x3aa7b872,0xbc00,0x3ba8b4a5,0x38723aa7,0xb9133a2f
.long 0x3c00,0xbb64361f,0xb9a8b9a8,0x361fbb64,0xbc00,0x3b0eb78b,0x3aa73872,0xae463bf6
.long 0x3c00,0xbaa73872,0xbb64b61f,0xb23ebbd9,0xbc00,0x3a2fb913,0x3bd9323e,0x378b3b0e
.long 0x3c00,0xb9a839a8,0xbc008000,0xb9a8b9a8,0xbc00,0x3913ba2f,0x3bd9b23e,0x3b0e378b
.long 0x3c00,0xb8723aa7,0xbb64361f,0xbbd9b23e,0xbc00,0x378bbb0e,0x3aa7b872,0x3bf6ae46
.long 0x3c00,0xb61f3b64,0xb9a839a8,0xbb64361f,0xbc00,0x34a5bba8,0x3872baa7,0x3a2fb913
.long 0x3c00,0xb23e3bd9,0xb61f3b64,0xb8723aa7,0xbc00,0x2e46bbf6,0x323ebbd9,0x34a5bba8
.long 0x3c00,0xbc008000,0xbc00,0x3c000000,0xb61fbb64,0x3b0eb78b,0x38723aa7,0xba2f3913
.long 0x39a839a8,0xb8723aa7,0xbb64b61f,0x323ebbd9,0xbb64b61f,0x2e46bbf6,0x3bd9b23e,0x378b3b0e
.long 0x3c000000,0x361f3b64,0xb9a839a8,0xbb64b61f,0xbb64361f,0xba2fb913,0x323ebbd9,0x3ba8b4a5
.long 0x39a8b9a8,0x3bd9323e,0x361f3b64,0xb8723aa7,0xb61f3b64,0xbba834a5,0xbaa7b872,0xae46bbf6
.long 0xbc00,0x39a8b9a8,0x3c000000,0x39a839a8,0x361f3b64,0xb4a53ba8,0xbaa73872,0xbbf6ae46
.long 0xb9a8b9a8,0xb23ebbd9,0x361fbb64,0x3aa7b872,0x3b64361f,0x39133a2f,0x323e3bd9,0xb4a53ba8
.long 0xbc008000,0xbb64b61f,0xb9a8b9a8,0xb61fbb64,0x3b64b61f,0x3bf6ae46,0x3bd9323e,0x3b0e378b
.long 0xb9a839a8,0xbaa73872,0xbb64361f,0xbbd9323e,0x361fbb64,0x378bbb0e,0x3872baa7,0x3913ba2f
.long 0x3c00,0xbc008000,0xbc00,0x3c000000,0xb9a8b9a8,0x3913ba2f,0x3aa73872,0xb78b3b0e
.long 0x3c000000,0x323e3bd9,0xbb64361f,0xb872baa7,0xb9a839a8,0xbb0eb78b,0x323ebbd9,0x3bf6ae46
.long 0xbc00,0x3b64b61f,0x39a839a8,0xb61f3b64,0x39a839a8,0xb4a53ba8,0xbbd9323e,0xb913ba2f
.long 0xbc008000,0xb872baa7,0x361fbb64,0x3bd9b23e,0x39a8b9a8,0x3bf62e46,0x38723aa7,0xb4a53ba8
.long 0x3c00,0xb9a839a8,0xbc008000,0xb9a8b9a8,0xb9a8b9a8,0xae46bbf6,0x3872baa7,0x3ba8b4a5
.long 0x3c000000,0x3aa73872,0x361f3b64,0xb23e3bd9,0xb9a839a8,0xbba834a5,0xbbd9b23e,0xba2fb913
.long 0xbc00,0x361fbb64,0x39a8b9a8,0x3b64b61f,0x39a839a8,0x378b3b0e,0x323e3bd9,0xae463bf6
.long 0xbc008000,0xbbd9b23e,0xbb64b61f,0xbaa7b872,0x39a8b9a8,0x3a2fb913,0x3aa7b872,0x3b0eb78b
.long 0x3c00,0xbc008000,0xbc00,0x3c000000,0xbb64b61f,0x34a5bba8,0x3bd9323e,0xae463bf6
.long 0x39a8b9a8,0x3aa73872,0xb61f3b64,0xbbd9b23e,0x361f3b64,0xba2f3913,0xbaa7b872,0x34a5bba8
.long 0xbc008000,0xb61fbb64,0x39a8b9a8,0x3b64361f,0x361fbb64,0x3bf6ae46,0x38723aa7,0xb78b3b0e
.long 0x39a839a8,0xb23e3bd9,0xbb64361f,0xbaa7b872,0xbb64361f,0xbb0eb78b,0xb23ebbd9,0x3913ba2f
.long 0xbc00,0x39a8b9a8,0x3c000000,0x39a839a8,0x3b64361f,0x378b3b0e,0xb23e3bd9,0xba2f3913
.long 0xb9a839a8,0xbbd9323e,0xbb64b61f,0xb872baa7,0xb61fbb64,0x2e46bbf6,0x3872baa7,0x3b0eb78b
.long 0x3c000000,0x3b64361f,0x39a839a8,0x361f3b64,0xb61f3b64,0xb9133a2f,0xbaa73872,0xbba834a5
.long 0xb9a8b9a8,0xb872baa7,0xb61fbb64,0xb23ebbd9,0x3b64b61f,0x3ba8b4a5,0x3bd9b23e,0x3bf6ae46
.long 0x3c008000,0x80003c00,0xbc008000,0xbc00,0xbc008000,0xae46bbf6,0x3bd9b23e,0x34a53ba8
.long 0x3c008000,0x323e3bd9,0xbb64361f,0xb872baa7,0xbc008000,0xb4a5bba8,0x3aa7b872,0x3a2f3913
.long 0x3c008000,0x361f3b64,0xb9a839a8,0xbb64b61f,0xbc008000,0xb78bbb0e,0x3872baa7,0x3bf62e46
.long 0x3c008000,0x38723aa7,0xb61f3b64,0xbbd9323e,0xbc008000,0xb913ba2f,0x323ebbd9,0x3b0eb78b
.long 0x3c008000,0x39a839a8,0x80003c00,0xb9a839a8,0xbc008000,0xba2fb913,0xb23ebbd9,0x378bbb0e
.long 0x3c008000,0x3aa73872,0x361f3b64,0xb23e3bd9,0xbc008000,0xbb0eb78b,0xb872baa7,0xae46bbf6
.long 0x3c008000,0x3b64361f,0x39a839a8,0x361f3b64,0xbc008000,0xbba8b4a5,0xbaa7b872,0xb913ba2f
.long 0x3c008000,0x3bd9323e,0x3b64361f,0x3aa73872,0xbc008000,0xbbf6ae46,0xbbd9b23e,0xbba8b4a5
.long 0x3c008000,0x80003c00,0xbc008000,0xbc00,0xbb64361f,0xb78bbb0e,0x3aa7b872,0x39133a2f
.long 0x39a8b9a8,0x3aa73872,0xb61f3b64,0xbbd9b23e,0xb61f3b64,0xbbf6ae46,0xb23ebbd9,0x3b0eb78b
.long 0xbc00,0x3b64b61f,0x39a839a8,0xb61f3b64,0x361f3b64,0xb9133a2f,0xbbd9b23e,0xb4a5bba8
.long 0xb9a8b9a8,0x323ebbd9,0x3b64b61f,0x3aa73872,0x3b64361f,0x34a53ba8,0xb8723aa7,0xbbf62e46
.long 0xbc008000,0xb9a8b9a8,0xbc00,0x39a8b9a8,0x3b64b61f,0x3ba834a5,0x38723aa7,0xae463bf6
.long 0xb9a839a8,0xbbd9323e,0xbb64b61f,0xb872baa7,0x361fbb64,0x3a2fb913,0x3bd9b23e,0x3ba834a5
.long 0x80003c00,0xb61f3b64,0xb9a839a8,0xbb64361f,0xb61fbb64,0xae46bbf6,0x323ebbd9,0x378bbb0e
.long 0x39a839a8,0x38723aa7,0x361f3b64,0x323e3bd9,0xbb64b61f,0xbb0eb78b,0xbaa7b872,0xba2fb913
.long 0x3c008000,0x80003c00,0xbc008000,0xbc00,0xb9a839a8,0xba2fb913,0x3872baa7,0x3b0e378b
.long 0xbc00,0x3bd9b23e,0x361f3b64,0xbaa73872,0x39a839a8,0xb78b3b0e,0xbbd9b23e,0xae46bbf6
.long 0xbc008000,0xb61fbb64,0x39a8b9a8,0x3b64361f,0x39a8b9a8,0x3ba834a5,0x323e3bd9,0xba2f3913
.long 0x80003c00,0xbaa73872,0xbb64b61f,0xb23ebbd9,0xb9a8b9a8,0x2e46bbf6,0x3aa7b872,0x3ba834a5
.long 0x3c008000,0x39a839a8,0x80003c00,0xb9a839a8,0xb9a839a8,0xbbf62e46,0xbaa7b872,0xb4a5bba8
.long 0xbc00,0x3872baa7,0x3b64b61f,0x3bd9323e,0x39a839a8,0x34a53ba8,0xb23e3bd9,0xb9133a2f
.long 0xbc008000,0xbb64b61f,0xb9a8b9a8,0xb61fbb64,0x39a8b9a8,0x3b0eb78b,0x3bd9b23e,0x3bf62e46
.long 0x80003c00,0xb23e3bd9,0xb61f3b64,0xb8723aa7,0xb9a8b9a8,0xb913ba2f,0xb872baa7,0xb78bbb0e
.long 0x3c008000,0x80003c00,0xbc008000,0xbc00,0xb61f3b64,0xbba8b4a5,0x323ebbd9,0x3bf62e46
.long 0xb9a8b9a8,0x3872baa7,0x3b64361f,0xb23e3bd9,0x3b64b61f,0x39133a2f,0xb8723aa7,0xbba8b4a5
.long 0x80003c00,0xbb64361f,0xb9a8b9a8,0x361fbb64,0xbb64b61f,0xae46bbf6,0x3aa7b872,0x3b0e378b
.long 0x39a8b9a8,0x3bd9323e,0x361f3b64,0xb8723aa7,0x361f3b64,0xb78b3b0e,0xbbd9323e,0xba2fb913
.long 0xbc008000,0xb9a8b9a8,0xbc00,0x39a8b9a8,0x361fbb64,0x3b0eb78b,0x3bd9323e,0x39133a2f
.long 0x39a839a8,0x323e3bd9,0xb61f3b64,0xbaa73872,0xbb64361f,0xbbf6ae46,0xbaa7b872,0xb78bbb0e
.long 0xbc00,0x361fbb64,0x39a8b9a8,0x3b64b61f,0x3b64361f,0x3a2f3913,0x38723aa7,0x34a53ba8
.long 0xb9a839a8,0xbaa73872,0xbb64361f,0xbbd9323e,0xb61fbb64,0xb4a5bba8,0xb23ebbd9,0xae46bbf6
.long 0x3c00,0xbc008000,0xbc00,0x3c000000,0xbc008000,0xae46bbf6,0x3bd9b23e,0x34a53ba8
.long 0xbc00,0x3bd9b23e,0x361f3b64,0xbaa73872,0x3c000000,0x34a53ba8,0xbaa73872,0xba2fb913
.long 0x3c00,0xbb64361f,0xb9a8b9a8,0x361fbb64,0xbc008000,0xb78bbb0e,0x3872baa7,0x3bf62e46
.long 0xbc00,0x3aa7b872,0x3b64361f,0x323e3bd9,0x3c000000,0x39133a2f,0xb23e3bd9,0xbb0e378b
.long 0x3c00,0xb9a839a8,0xbc008000,0xb9a8b9a8,0xbc008000,0xba2fb913,0xb23ebbd9,0x378bbb0e
.long 0xbc00,0x3872baa7,0x3b64b61f,0x3bd9323e,0x3c000000,0x3b0e378b,0x38723aa7,0x2e463bf6
.long 0x3c00,0xb61f3b64,0xb9a839a8,0xbb64361f,0xbc008000,0xbba8b4a5,0xbaa7b872,0xb913ba2f
.long 0xbc00,0x323ebbd9,0x361fbb64,0x3872baa7,0x3c000000,0x3bf62e46,0x3bd9323e,0x3ba834a5
.long 0x3c00,0xbc008000,0xbc00,0x3c000000,0xbb64361f,0xb78bbb0e,0x3aa7b872,0x39133a2f
.long 0xb9a8b9a8,0x3872baa7,0x3b64361f,0xb23e3bd9,0x361fbb64,0x3bf62e46,0x323e3bd9,0xbb0e378b
.long 0x3c000000,0x361f3b64,0xb9a839a8,0xbb64b61f,0x361f3b64,0xb9133a2f,0xbbd9b23e,0xb4a5bba8
.long 0xb9a839a8,0xbbd9b23e,0xb61fbb64,0x3872baa7,0xbb64b61f,0xb4a5bba8,0x3872baa7,0x3bf6ae46
.long 0xbc00,0x39a8b9a8,0x3c000000,0x39a839a8,0x3b64b61f,0x3ba834a5,0x38723aa7,0xae463bf6
.long 0x39a839a8,0x323e3bd9,0xb61f3b64,0xbaa73872,0xb61f3b64,0xba2f3913,0xbbd9323e,0xbba8b4a5
.long 0xbc008000,0xbb64b61f,0xb9a8b9a8,0xb61fbb64,0xb61fbb64,0xae46bbf6,0x323ebbd9,0x378bbb0e
.long 0x39a8b9a8,0x3aa7b872,0x3b64b61f,0x3bd9b23e,0x3b64361f,0x3b0e378b,0x3aa73872,0x3a2f3913
.long 0x3c00,0xbc008000,0xbc00,0x3c000000,0xb9a839a8,0xba2fb913,0x3872baa7,0x3b0e378b
.long 0xbc008000,0xb23ebbd9,0x3b64b61f,0x38723aa7,0xb9a8b9a8,0x378bbb0e,0x3bd9323e,0x2e463bf6
.long 0xbc00,0x3b64b61f,0x39a839a8,0xb61f3b64,0x39a8b9a8,0x3ba834a5,0x323e3bd9,0xba2f3913
.long 0x3c000000,0x38723aa7,0xb61f3b64,0xbbd9323e,0x39a839a8,0xae463bf6,0xbaa73872,0xbba8b4a5
.long 0x3c00,0xb9a839a8,0xbc008000,0xb9a8b9a8,0xb9a839a8,0xbbf62e46,0xbaa7b872,0xb4a5bba8
.long 0xbc008000,0xbaa7b872,0xb61fbb64,0x323ebbd9,0xb9a8b9a8,0xb4a5bba8,0x323ebbd9,0x3913ba2f
.long 0xbc00,0x361fbb64,0x39a8b9a8,0x3b64b61f,0x39a8b9a8,0x3b0eb78b,0x3bd9b23e,0x3bf62e46
.long 0x3c000000,0x3bd9323e,0x3b64361f,0x3aa73872,0x39a839a8,0x39133a2f,0x38723aa7,0x378b3b0e
.long 0x3c00,0xbc008000,0xbc00,0x3c000000,0xb61f3b64,0xbba8b4a5,0x323ebbd9,0x3bf62e46
.long 0xb9a839a8,0xbaa7b872,0x361fbb64,0x3bd9323e,0xbb64361f,0xb913ba2f,0x3872baa7,0x3ba834a5
.long 0xbc008000,0xb61fbb64,0x39a8b9a8,0x3b64361f,0xbb64b61f,0xae46bbf6,0x3aa7b872,0x3b0e378b
.long 0xb9a8b9a8,0x323ebbd9,0x3b64b61f,0x3aa73872,0xb61fbb64,0x378bbb0e,0x3bd9b23e,0x3a2f3913
.long 0xbc00,0x39a8b9a8,0x3c000000,0x39a839a8,0x361fbb64,0x3b0eb78b,0x3bd9323e,0x39133a2f
.long 0x39a8b9a8,0x3bd9b23e,0x3b64361f,0x38723aa7,0x3b64b61f,0x3bf62e46,0x3aa73872,0x378b3b0e
.long 0x3c000000,0x3b64361f,0x39a839a8,0x361f3b64,0x3b64361f,0x3a2f3913,0x38723aa7,0x34a53ba8
.long 0x39a839a8,0x38723aa7,0x361f3b64,0x323e3bd9,0x361f3b64,0x34a53ba8,0x323e3bd9,0x2e463bf6
.long 0x3c008000,0x80003c00,0xbc008000,0xbc00,0x80003c00,0xbbf62e46,0xb23ebbd9,0x3ba8b4a5
.long 0xbc008000,0xb23ebbd9,0x3b64b61f,0x38723aa7,0xbc00,0x3ba8b4a5,0x38723aa7,0xb9133a2f
.long 0x3c008000,0x361f3b64,0xb9a839a8,0xbb64b61f,0x80003c00,0xbb0e378b,0xbaa7b872,0x2e46bbf6
.long 0xbc008000,0xb872baa7,0x361fbb64,0x3bd9b23e,0xbc00,0x3a2fb913,0x3bd9323e,0x378b3b0e
.long 0x3c008000,0x39a839a8,0x80003c00,0xb9a839a8,0x80003c00,0xb9133a2f,0xbbd9323e,0xbb0eb78b
.long 0xbc008000,0xbaa7b872,0xb61fbb64,0x323ebbd9,0xbc00,0x378bbb0e,0x3aa7b872,0x3bf6ae46
.long 0x3c008000,0x3b64361f,0x39a839a8,0x361f3b64,0x80003c00,0xb4a53ba8,0xb8723aa7,0xba2f3913
.long 0xbc008000,0xbbd9b23e,0xbb64b61f,0xbaa7b872,0xbc00,0x2e46bbf6,0x323ebbd9,0x34a5bba8
.long 0x3c008000,0x80003c00,0xbc008000,0xbc00,0x361f3b64,0xbb0e378b,0xb872baa7,0x3a2fb913
.long 0xb9a839a8,0xbaa7b872,0x361fbb64,0x3bd9323e,0xbb64b61f,0x2e46bbf6,0x3bd9b23e,0x378b3b0e
.long 0xbc00,0x3b64b61f,0x39a839a8,0xb61f3b64,0x3b64b61f,0x3a2f3913,0xb23e3bd9,0xbba834a5
.long 0x39a839a8,0xb23e3bd9,0xbb64361f,0xbaa7b872,0xb61f3b64,0xbba834a5,0xbaa7b872,0xae46bbf6
.long 0xbc008000,0xb9a8b9a8,0xbc00,0x39a8b9a8,0xb61fbb64,0x34a5bba8,0x3aa7b872,0x3bf62e46
.long 0x39a8b9a8,0x3bd9b23e,0x3b64361f,0x38723aa7,0x3b64361f,0x39133a2f,0x323e3bd9,0xb4a53ba8
.long 0x80003c00,0xb61f3b64,0xb9a839a8,0xbb64361f,0xbb64361f,0xbbf62e46,0xbbd9b23e,0xbb0eb78b
.long 0xb9a8b9a8,0xb872baa7,0xb61fbb64,0xb23ebbd9,0x361fbb64,0x378bbb0e,0x3872baa7,0x3913ba2f
.long 0x3c008000,0x80003c00,0xbc008000,0xbc00,0x39a839a8,0xb9133a2f,0xbaa7b872,0x378bbb0e
.long 0x80003c00,0xbbd9323e,0xb61fbb64,0x3aa7b872,0xb9a839a8,0xbb0eb78b,0x323ebbd9,0x3bf6ae46
.long 0xbc008000,0xb61fbb64,0x39a8b9a8,0x3b64361f,0xb9a8b9a8,0x34a5bba8,0x3bd9b23e,0x39133a2f
.long 0xbc00,0x3aa7b872,0x3b64361f,0x323e3bd9,0x39a8b9a8,0x3bf62e46,0x38723aa7,0xb4a53ba8
.long 0x3c008000,0x39a839a8,0x80003c00,0xb9a839a8,0x39a839a8,0x2e463bf6,0xb8723aa7,0xbba834a5
.long 0x80003c00,0xb8723aa7,0xbb64361f,0xbbd9b23e,0xb9a839a8,0xbba834a5,0xbbd9b23e,0xba2fb913
.long 0xbc008000,0xbb64b61f,0xb9a8b9a8,0xb61fbb64,0xb9a8b9a8,0xb78bbb0e,0xb23ebbd9,0x2e46bbf6
.long 0xbc00,0x323ebbd9,0x361fbb64,0x3872baa7,0x39a8b9a8,0x3a2fb913,0x3aa7b872,0x3b0eb78b
.long 0x3c008000,0x80003c00,0xbc008000,0xbc00,0x3b64361f,0xb4a53ba8,0xbbd9b23e,0x2e46bbf6
.long 0x39a839a8,0xb8723aa7,0xbb64b61f,0x323ebbd9,0x361f3b64,0xba2f3913,0xbaa7b872,0x34a5bba8
.long 0x80003c00,0xbb64361f,0xb9a8b9a8,0x361fbb64,0xb61f3b64,0xbbf62e46,0xb872baa7,0x378bbb0e
.long 0xb9a839a8,0xbbd9b23e,0xb61fbb64,0x3872baa7,0xbb64361f,0xbb0eb78b,0xb23ebbd9,0x3913ba2f
.long 0xbc008000,0xb9a8b9a8,0xbc00,0x39a8b9a8,0xbb64b61f,0xb78bbb0e,0x323ebbd9,0x3a2fb913
.long 0xb9a8b9a8,0xb23ebbd9,0x361fbb64,0x3aa7b872,0xb61fbb64,0x2e46bbf6,0x3872baa7,0x3b0eb78b
.long 0xbc00,0x361fbb64,0x39a8b9a8,0x3b64b61f,0x361fbb64,0x3913ba2f,0x3aa7b872,0x3ba8b4a5
.long 0x39a8b9a8,0x3aa7b872,0x3b64b61f,0x3bd9b23e,0x3b64b61f,0x3ba8b4a5,0x3bd9b23e,0x3bf6ae46
.long 0x3e000000,0x80000000,0x3dfd3aac,0xbc964083,0x3e000000,0x80000000,0x3dfd1cdd,0xbc995be0
.long 0x3e000000,0x80000000,0x3dfcfe73,0xbc9c76de,0x3e000000,0x80000000,0x3dfcdf6c,0xbc9f917b
.long 0x3e000000,0x80000000,0x3dfcbfc9,0xbca2abb6,0x3e000000,0x80000000,0x3dfc9f8a,0xbca5c58c
.long 0x3e000000,0x80000000,0x3dfc7eb0,0xbca8defc,0x3e000000,0x80000000,0x3dfc5d3a,0xbcabf804
.long 0x3e000000,0x80000000,0x3dfc3b28,0xbcaf10a2,0x3e000000,0x80000000,0x3dfc187a,0xbcb228d4
.long 0x3e000000,0x80000000,0x3dfbf531,0xbcb54098,0x3e000000,0x80000000,0x3dfbd14d,0xbcb857ec
.long 0x3e000000,0x80000000,0x3dfbaccd,0xbcbb6ecf,0x3e000000,0x80000000,0x3dfb87b2,0xbcbe853e
.long 0x3e000000,0x80000000,0x3dfb61fc,0xbcc19b37,0x3e000000,0x80000000,0x3dfb3bab,0xbcc4b0b9
.long 0x3dd4db31,0xbd8e39da,0x3dbdaef9,0xbdabeb4a,0x3dd31849,0xbd90d3cd,0x3dbb0629,0xbdaecef7
.long 0x3dd14d3d,0xbd93682a,0x3db85216,0xbdb1a81d,0x3dcf7a1f,0xbd95f6d9,0x3db592e7,0xbdb4768f
.long 0x3dcd9f02,0xbd987fc0,0x3db2c8c9,0xbdb73a23,0x3dcbbbf8,0xbd9b02c6,0x3daff3e6,0xbdb9f2ac
.long 0x3dc9d112,0xbd9d7fd1,0x3dad1469,0xbdbca003,0x3dc7de65,0xbd9ff6cb,0x3daa2a80,0xbdbf41fc
.long 0x3dc5e403,0xbda26799,0x3da73656,0xbdc1d870,0x3dc3e200,0xbda4d225,0x3da4381a,0xbdc46337
.long 0x3dc1d870,0xbda73656,0x3da12ff9,0xbdc6e22a,0x3dbfc767,0xbda99415,0x3d9e1e22,0xbdc95521
.long 0x3dbdaef9,0xbdabeb4a,0x3d9b02c6,0xbdcbbbf8,0x3dbb8f3b,0xbdae3bde,0x3d97de12,0xbdce1689
.long 0x3db96842,0xbdb085bb,0x3d94b039,0xbdd064af,0x3db73a23,0xbdb2c8c9,0x3d91796b,0xbdd2a649
.long 0x3d43ef15,0xbdec835e,0x3cf8cfcc,0xbdf853f8,0x3d38442a,0xbdeed89e,0x3cdd4b1a,0xbdf9f35e
.long 0x3d2c7cd4,0xbdf10908,0x3cc19b37,0xbdfb61fc,0x3d209ae5,0xbdf31447,0x3ca5c58c,0xbdfc9f8a
.long 0x3d14a031,0xbdf4fa0b,0x3c89cf86,0xbdfdabcc,0x3d088e93,0xbdf6ba07,0x3c5b7d37,0xbdfe868b
.long 0x3cf8cfcc,0xbdf853f8,0x3c23308c,0xbdff2f9d,0x3ce05c13,0xbdf9c79d,0x3bd5880e,0xbdffa6e3
.long 0x3cc7c5c2,0xbdfb14be,0x3b490ab0,0xbdffec43,0x3caf10a2,0xbdfc3b28,0xb9c90fc6,0xbdffffb1
.long 0x3c964083,0xbdfd3aac,0xbb7b49ba,0xbdffe129,0x3c7ab273,0xbdfe1324,0xbbeea038,0xbdff90b1
.long 0x3c48bd36,0xbdfec46d,0xbc2fb680,0xbdff0e58,0x3c16a905,0xbdff4e6d,0xbc67fa9a,0xbdfe5a38
.long 0x3bc8fb30,0xbdffb10f,0xbc9008b7,0xbdfd7474,0x3b490ab0,0xbdffec43,0xbcabf804,0xbdfc5d3a
.long 0xbcc7c5c2,0xbdfb14be,0xbd2c7cd4,0xbdf10908,0xbcec9a7f,0xbdf91298,0xbd3f926f,0xbded67a1
.long 0xbd088e93,0xbdf6ba07,0xbd525a09,0xbde96591,0xbd1aa086,0xbdf40bdd,0xbd64cbfe,0xbde50479
.long 0xbd2c7cd4,0xbdf10908,0xbd76e0cb,0xbde04621,0xbd3e1d4a,0xbdedb293,0xbd844889,0xbddb2c79
.long 0xbd4f7bca,0xbdea09a7,0xbd8cead0,0xbdd5b993,0xbd60924f,0xbde60f88,0xbd9553b7,0xbdcfefa8
.long 0xbd715aea,0xbde1c598,0xbd9d7fd1,0xbdc9d112,0xbd80e7e4,0xbddd2d53,0xbda56bcb,0xbdc36051
.long 0xbd88f59b,0xbdd84853,0xbdad1469,0xbdbca003,0xbd90d3cd,0xbdd31849,0xbdb4768f,0xbdb592e7
.long 0xbd987fc0,0xbdcd9f02,0xbdbb8f3b,0xbdae3bde,0xbd9ff6cb,0xbdc7de65,0xbdc25b89,0xbda69de3
.long 0xbda73656,0xbdc1d870,0xbdc8d8b3,0xbd9ebc12,0xbdae3bde,0xbdbb8f3b,0xbdcf0417,0xbd96999f
.long 0x3df4fa0b,0xbd14a031,0x3de76bd8,0xbd5ae880,0x3df48422,0xbd17a117,0x3de66771,0xbd5f28a9
.long 0x3df40bdd,0xbd1aa086,0x3de55e0b,0xbd6363fa,0x3df3913f,0xbd1d9e78,0x3de44fac,0xbd679a5d
.long 0x3df31447,0xbd209ae5,0x3de33c5a,0xbd6bcbbb,0x3df294f8,0xbd2395c5,0x3de2241a,0xbd6ff7fb
.long 0x3df21352,0xbd268f12,0x3de106f2,0xbd741f07,0x3df18f57,0xbd2986c4,0x3ddfe4e9,0xbd7840c8
.long 0x3df10908,0xbd2c7cd4,0x3ddebe05,0xbd7c5d27,0x3df08066,0xbd2f713a,0x3ddd924d,0xbd803a06
.long 0x3deff573,0xbd3263ef,0x3ddc61c7,0xbd8242b1,0x3def6830,0xbd3554ec,0x3ddb2c79,0xbd844889
.long 0x3deed89e,0xbd38442a,0x3dd9f26a,0xbd864b82,0x3dee46be,0xbd3b31a0,0x3dd8b3a1,0xbd884b92
.long 0x3dedb293,0xbd3e1d4a,0x3dd77026,0xbd8a48ad,0x3ded1c1d,0xbd41071e,0x3dd627fe,0xbd8c42c9
.long 0x3da26799,0xbdc5e403,0x3d839c3d,0xbddb941a,0x3d9ebc12,0xbdc8d8b3,0x3d7dbabb,0xbdde5aa6
.long 0x3d9b02c6,0xbdcbbbf8,0x3d741f07,0xbde106f2,0x3d973c07,0xbdce8d90,0x3d6a6681,0xbde398ac
.long 0x3d93682a,0xbdd14d3d,0x3d60924f,0xbde60f88,0x3d8f8784,0xbdd3fac3,0x3d56a399,0xbde86b39
.long 0x3d8b9a6b,0xbdd695e5,0x3d4c9b8b,0xbdeaab7b,0x3d87a136,0xbdd91e6a,0x3d427b55,0xbdecd007
.long 0x3d839c3d,0xbddb941a,0x3d38442a,0xbdeed89e,0x3d7f17b2,0xbdddf6be,0x3d2df73c,0xbdf0c501
.long 0x3d76e0cb,0xbde04621,0x3d2395c5,0xbdf294f8,0x3d6e9479,0xbde28210,0x3d1920fe,0xbdf4484b
.long 0x3d663375,0xbde4aa59,0x3d0e9a22,0xbdf5dec6,0x3d5dbe79,0xbde6becc,0x3d040270,0xbdf7583a
.long 0x3d553641,0xbde8bf3c,0x3cf2b651,0xbdf8b47b,0x3d4c9b8b,0xbdeaab7b,0x3cdd4b1a,0xbdf9f35e
.long 0x3c48bd36,0xbdfec46d,0xbbc8fb30,0xbdffb10f,0x3c0a200a,0xbdff6ac7,0xbc2973ba,0xbdff1f49
.long 0x3b96c32c,0xbdffd397,0xbc6e3876,0xbdfe4323,0x3a490f88,0xbdfffec4,0xbc995be0,0xbdfd1cdd
.long 0xbb490ab0,0xbdffec43,0xbcbb6ecf,0xbdfbaccd,0xbbe21469,0xbdff9c18,0xbcdd4b1a,0xbdf9f35e
.long 0xbc2fb680,0xbdff0e58,0xbcfee6e1,0xbdf7f110,0xbc6e3876,0xbdfe4323,0xbd101c2c,0xbdf5a67b
.long 0xbc964083,0xbdfd3aac,0xbd209ae5,0xbdf31447,0xbcb54098,0xbdfbf531,0xbd30eacb,0xbdf03b37
.long 0xbcd41501,0xbdfa7302,0xbd41071e,0xbded1c1d,0xbcf2b651,0xbdf8b47b,0xbd50eb2a,0xbde9b7e4
.long 0xbd088e93,0xbdf6ba07,0xbd60924f,0xbde60f88,0xbd17a117,0xbdf48422,0xbd6ff7fb,0xbde2241a
.long 0xbd268f12,0xbdf21352,0xbd7f17b2,0xbdddf6be,0xbd3554ec,0xbdef6830,0xbd86f686,0xbdd988ad
.long 0xbd715aea,0xbde1c598,0xbd987fc0,0xbdcd9f02,0xbd8242b1,0xbddc61c7,0xbda1cbfb,0xbdc66354
.long 0xbd8b9a6b,0xbdd695e5,0xbdaac082,0xbdbebc1b,0xbd94b039,0xbdd064af,0xbdb3587a,0xbdb6ad7f
.long 0xbd9d7fd1,0xbdc9d112,0xbdbb8f3b,0xbdae3bde,0xbda6050a,0xbdc2de29,0xbdc36051,0xbda56bcb
.long 0xbdae3bde,0xbdbb8f3b,0xbdcac77f,0xbd9c420c,0xbdb6206c,0xbdb3e7bc,0xbdd1c0c2,0xbd92c39a
.long 0xbdbdaef9,0xbdabeb4a,0xbdd84853,0xbd88f59b,0xbdc4e3f5,0xbda39da9,0xbdde5aa6,0xbd7dbabb
.long 0xbdcbbbf8,0xbd9b02c6,0xbde3f473,0xbd6900b7,0xbdd233c6,0xbd921eb0,0xbde912ae,0xbd53c867
.long 0xbdd84853,0xbd88f59b,0xbdedb293,0xbd3e1d4a,0xbdddf6be,0xbd7f17b2,0xbdf1d19f,0xbd280b1f
.long 0xbde33c5a,0xbd6bcbbb,0xbdf56d97,0xbd119ddd,0xbde816a8,0xbd58106b,0xbdf88486,0xbcf5c35a
.long 0xbdb504f3,0xbdb504f3,0xbdcd9f02,0xbd987fc0,0xbdbdaef9,0xbdabeb4a,0xbdd54aa4,0xbd8d9281
.long 0xbdc5e403,0xbda26799,0xbddc61c7,0xbd8242b1,0xbdcd9f02,0xbd987fc0,0xbde2df7b,0xbd6d3063
.long 0xbdd4db31,0xbd8e39da,0xbde8bf3c,0xbd553641,0xbddb941a,0xbd839c3d,0xbdedfcf2,0xbd3ca7af
.long 0xbde1c598,0xbd715aea,0xbdf294f8,0xbd2395c5,0xbde76bd8,0xbd5ae880,0xbdf6841b,0xbd0a11f7
.long 0xbdec835e,0xbd43ef15,0xbdf9c79d,0xbce05c13,0xbdf10908,0xbd2c7cd4,0xbdfc5d3a,0xbcabf804
.long 0xbdf4fa0b,0xbd14a031,0xbdfe4323,0xbc6e3876,0xbdf853f8,0xbcf8cfcc,0xbdff7808,0xbc03db0a
.long 0xbdfb14be,0xbcc7c5c2,0xbdfffb11,0xbac90e90,0xbdfd3aac,0xbc964083,0xbdffcbe2,0x3ba351cb
.long 0xbdfec46d,0xbc48bd36,0xbdfeea9d,0x3c3c3ac3,0xbdffb10f,0xbbc8fb30,0xbdfd57de,0x3c9324ca
.long 0xbdfb14be,0xbcc7c5c2,0xbdffb10f,0xbbc8fb30,0xbdfdabcc,0xbc89cf86,0xbdfff84a,0x3afb514b
.long 0xbdff4e6d,0xbc16a905,0xbdff2f9d,0x3c23308c,0xbdfffb11,0xbac90e90,0xbdfd57de,0x3c9324ca
.long 0xbdffb10f,0x3bc8fb30,0xbdfa7302,0x3cd41501,0xbdfe70b0,0x3c61bc2e,0xbdf6841b,0x3d0a11f7
.long 0xbdfc3b28,0x3caf10a2,0xbdf18f57,0x3d2986c4,0xbdf91298,0x3cec9a7f,0xbdeb99fb,0x3d48477c
.long 0xbdf4fa0b,0x3d14a031,0xbde4aa59,0x3d663375,0xbdeff573,0x3d3263ef,0xbddcc7d1,0x3d819573
.long 0xbdea09a7,0x3d4f7bca,0xbdd3fac3,0x3d8f8784,0xbde33c5a,0x3d6bcbbb,0xbdca4c87,0x3d9ce11f
.long 0xbddb941a,0x3d839c3d,0xbdbfc767,0x3da99415,0xbdd31849,0x3d90d3cd,0xbdb4768f,0x3db592e7
.long 0xbdc9d112,0x3d9d7fd1,0xbda86605,0x3dc0d0da,0xbdbfc767,0x3da99415,0xbd9ba299,0x3dcb41fa
.long 0xbdec835e,0x3d43ef15,0xbddb941a,0x3d839c3d,0xbde4aa59,0x3d663375,0xbdd0d937,0x3d940c5f
.long 0xbddb941a,0x3d839c3d,0xbdc4e3f5,0x3da39da9,0xbdd14d3d,0x3d93682a,0xbdb7c655,0x3db238aa
.long 0xbdc5e403,0x3da26799,0xbda99415,0x3dbfc767,0xbdb96842,0x3db085bb,0xbd9a6293,0x3dcc3578
.long 0xbdabeb4a,0x3dbdaef9,0xbd8a48ad,0x3dd77026,0xbd9d7fd1,0x3dc9d112,0xbd72bd43,0x3de1668a
.long 0xbd8e39da,0x3dd4db31,0xbd4f7bca,0x3dea09a7,0xbd7c5d27,0x3ddebe05,0xbd2b0201,0x3df14c7a
.long 0xbd5ae880,0x3de76bd8,0xbd0586ce,0x3df72417,0xbd38442a,0x3deed89e,0xbcbe853e,0x3dfb87b2
.long 0xbd14a031,0x3df4fa0b,0xbc61bc2e,0x3dfe70b0,0xbce05c13,0x3df9c79d,0xbb8a342f,0x3dffdaaf
.long 0xbc964083,0x3dfd3aac,0x3bafe007,0x3dffc38f,0xbc16a905,0x3dff4e6d,0x3c7475c0,0x3dfe2b72
.long 0xbd8e39da,0x3dd4db31,0xbd5ae880,0x3de76bd8,0xbd76e0cb,0x3de04621,0xbd30eacb,0x3df03b37
.long 0xbd4f7bca,0x3dea09a7,0xbd0586ce,0x3df72417,0xbd268f12,0x3df21352,0xbcb228d4,0x3dfc187a
.long 0xbcf8cfcc,0x3df853f8,0xbc2fb680,0x3dff0e58,0xbca2abb6,0x3dfcbfc9,0x39c90fc6,0x3dffffb1
.long 0xbc16a905,0x3dff4e6d,0x3c3c3ac3,0x3dfeea9d,0x3ac90e90,0x3dfffb11,0x3cb857ec,0x3dfbd14d
.long 0x3c48bd36,0x3dfec46d,0x3d088e93,0x3df6ba07,0x3cbb6ecf,0x3dfbaccd,0x3d33dca5,0x3defaf1b
.long 0x3d088e93,0x3df6ba07,0x3d5dbe79,0x3de6becc,0x3d3263ef,0x3deff573,0x3d82ef9f,0x3ddbfb34
.long 0x3d5ae880,0x3de76bd8,0x3d95f6d9,0x3dcf7a1f,0x3d80e7e4,0x3ddd2d53,0x3da7ce61,0x3dc154e1
.long 0x3d93682a,0x3dd14d3d,0x3db85216,0x3db1a81d,0x3da4d225,0x3dc3e200,0x3dc76085,0x3da09393
.long 0xbde1c598,0xbd715aea,0xbdf10908,0xbd2c7cd4,0xbde816a8,0xbd58106b,0xbdf5a67b,0xbd101c2c
.long 0xbdedb293,0xbd3e1d4a,0xbdf96e4e,0xbce67c66,0xbdf294f8,0xbd2395c5,0xbdfc5d3a,0xbcabf804
.long 0xbdf6ba07,0xbd088e93,0xbdfe70b0,0xbc61bc2e,0xbdfa1e84,0xbcda3997,0xbdffa6e3,0xbbd5880e
.long 0xbdfcbfc9,0xbca2abb6,0xbdfffec4,0x3a490f88,0xbdfe9bc9,0xbc553db9,0xbdff7808,0x3c03db0a
.long 0xbdffb10f,0xbbc8fb30,0xbdfe1324,0x3c7ab273,0xbdfffec4,0x3a490f88,0xbdfbd14d,0x3cb857ec
.long 0xbdff84ab,0x3bfb2b74,0xbdf8b47b,0x3cf2b651,0xbdfe4323,0x3c6e3876,0xbdf4bf62,0x3d1620d2
.long 0xbdfc3b28,0x3caf10a2,0xbdeff573,0x3d3263ef,0xbdf96e4e,0x3ce67c66,0xbdea5ad9,0x3d4e0bea
.long 0xbdf5dec6,0x3d0e9a22,0xbde3f473,0x3d6900b7,0xbdf18f57,0x3d2986c4,0xbddcc7d1,0x3d819573
.long 0xbdfec46d,0x3c48bd36,0xbdf853f8,0x3cf8cfcc,0xbdfc7eb0,0x3ca8defc,0xbdf3530e,0x3d1f1cdf
.long 0xbdf91298,0x3cec9a7f,0xbded1c1d,0x3d41071e,0xbdf48422,0x3d17a117,0xbde5b710,0x3d61fb6a
.long 0xbdeed89e,0x3d38442a,0xbddd2d53,0x3d80e7e4,0xbde816a8,0x3d58106b,0xbdd389c7,0x3d902dd5
.long 0xbde04621,0x3d76e0cb,0xbdc8d8b3,0x3d9ebc12,0xbdd77026,0x3d8a48ad,0xbdbd27b8,0x3dac800f
.long 0xbdcd9f02,0x3d987fc0,0xbdb085bb,0x3db96842,0xbdc2de29,0x3da6050a,0xbda302d3,0x3dc56439
.long 0xbdb73a23,0x3db2c8c9,0xbd94b039,0x3dd064af,0xbdaac082,0x3dbebc1b,0xbd85a02c,0x3dda5ba0
.long 0xbd9d7fd1,0x3dc9d112,0xbd6bcbbb,0x3de33c5a,0xbd8f8784,0x3dd3fac3,0xbd4b2aae,0x3deafb8c
.long 0xbd80e7e4,0x3ddd2d53,0xbd2986c4,0x3df18f57,0xbd6363fa,0x3de55e0b,0xbd070ada,0x3df6ef5b
.long 0xbdc5e403,0x3da26799,0xbdabeb4a,0x3dbdaef9,0xbdb85216,0x3db1a81d,0xbd9ba299,0x3dcb41fa
.long 0xbda99415,0x3dbfc767,0xbd8a48ad,0x3dd77026,0xbd99c200,0x3dccae79,0xbd6ff7fb,0x3de2241a
.long 0xbd88f59b,0x3dd84853,0xbd49b953,0x3deb4b0c,0xbd6e9479,0x3de28210,0xbd221887,0x3df2d4eb
.long 0xbd49b953,0x3deb4b0c,0xbcf2b651,0x3df8b47b,0xbd2395c5,0x3df294f8,0xbc9f917b,0x3dfcdf6c
.long 0xbcf8cfcc,0x3df853f8,0xbc16a905,0x3dff4e6d,0xbca8defc,0x3dfc7eb0,0x3a96cb58,0x3dfffd39
.long 0xbc2fb680,0x3dff0e58,0x3c3c3ac3,0x3dfeea9d,0xba490f88,0x3dfffec4,0x3cb228d4,0x3dfc187a
.long 0x3c16a905,0x3dff4e6d,0x3d027dc0,0x3df78bc5,0x3c9c76de,0x3dfcfe73,0x3d2b0201,0x3df14c7a
.long 0x3cec9a7f,0x3df91298,0x3d525a09,0x3de96591,0x3d1d9e78,0x3df3913f,0x3d7840c8,0x3ddfe4e9
.long 0xbd14a031,0x3df4fa0b,0xbc964083,0x3dfd3aac,0xbccdee60,0x3dfac516,0xbbd5880e,0x3dffa6e3
.long 0xbc61bc2e,0x3dfe70b0,0x3bafe007,0x3dffc38f,0xbb16c9b6,0x3dfff4e6,0x3c8cec4a,0x3dfd906e
.long 0x3c16a905,0x3dff4e6d,0x3cec9a7f,0x3df91298,0x3ca8defc,0x3dfc7eb0,0x3d25129f,0x3df25470
.long 0x3d027dc0,0x3df78bc5,0x3d525a09,0x3de96591,0x3d2f713a,0x3df08066,0x3d7dbabb,0x3dde5aa6
.long 0x3d5ae880,0x3de76bd8,0x3d93682a,0x3dd14d3d,0x3d8242b1,0x3ddc61c7,0x3da69de3,0x3dc25b89
.long 0x3d95f6d9,0x3dcf7a1f,0x3db85216,0x3db1a81d,0x3da86605,0x3dc0d0da,0x3dc85bca,0x3d9f599f
.long 0x3db96842,0x3db085bb,0x3dd695e5,0x3d8b9a6b,0x3dc8d8b3,0x3d9ebc12,0x3de2df7b,0x3d6d3063
.long 0x3dd695e5,0x3d8b9a6b,0x3ded1c1d,0x3d41071e,0x3de28210,0x3d6e9479,0x3df5341d,0x3d131f35
.long 0x3f000000,0x0,0x3f000000,0x0,0x3efd3aac,0x3d964083,0x3efd1cdd,0x3d995be0
.long 0x3ef4fa0b,0x3e14a031,0x3ef48422,0x3e17a117,0x3ee76bd8,0x3e5ae880,0x3ee66771,0x3e5f28a9
.long 0x3ed4db31,0x3e8e39da,0x3ed31849,0x3e90d3cd,0x3ebdaef9,0x3eabeb4a,0x3ebb0629,0x3eaecef7
.long 0x3ea26799,0x3ec5e403,0x3e9ebc12,0x3ec8d8b3,0x3e839c3d,0x3edb941a,0x3e7dbabb,0x3ede5aa6
.long 0x3e43ef15,0x3eec835e,0x3e38442a,0x3eeed89e,0x3df8cfcc,0x3ef853f8,0x3ddd4b1a,0x3ef9f35e
.long 0x3d48bd36,0x3efec46d,0x3d0a200a,0x3eff6ac7,0xbcc8fb30,0x3effb10f,0xbd2973ba,0x3eff1f49
.long 0xbdc7c5c2,0x3efb14be,0xbdec9a7f,0x3ef91298,0xbe2c7cd4,0x3ef10908,0xbe3f926f,0x3eed67a1
.long 0xbe715aea,0x3ee1c598,0xbe8242b1,0x3edc61c7,0xbe987fc0,0x3ecd9f02,0xbea1cbfb,0x3ec66354
.long 0x3f000000,0x0,0x3f000000,0x0,0x3efcbfc9,0x3da2abb6,0x3efc9f8a,0x3da5c58c
.long 0x3ef31447,0x3e209ae5,0x3ef294f8,0x3e2395c5,0x3ee33c5a,0x3e6bcbbb,0x3ee2241a,0x3e6ff7fb
.long 0x3ecd9f02,0x3e987fc0,0x3ecbbbf8,0x3e9b02c6,0x3eb2c8c9,0x3eb73a23,0x3eaff3e6,0x3eb9f2ac
.long 0x3e93682a,0x3ed14d3d,0x3e8f8784,0x3ed3fac3,0x3e60924f,0x3ee60f88,0x3e56a399,0x3ee86b39
.long 0x3e14a031,0x3ef4fa0b,0x3e088e93,0x3ef6ba07,0x3d89cf86,0x3efdabcc,0x3d5b7d37,0x3efe868b
.long 0xbc490ab0,0x3effec43,0xbce21469,0x3eff9c18,0xbdbb6ecf,0x3efbaccd,0xbddd4b1a,0x3ef9f35e
.long 0xbe2c7cd4,0x3ef10908,0xbe3e1d4a,0x3eedb293,0xbe76e0cb,0x3ee04621,0xbe844889,0x3edb2c79
.long 0xbe9d7fd1,0x3ec9d112,0xbea6050a,0x3ec2de29,0xbebb8f3b,0x3eae3bde,0xbec36051,0x3ea56bcb
.long 0x3f000000,0x0,0x3f000000,0x0,0x3efc3b28,0x3daf10a2,0x3efc187a,0x3db228d4
.long 0x3ef10908,0x3e2c7cd4,0x3ef08066,0x3e2f713a,0x3edebe05,0x3e7c5d27,0x3edd924d,0x3e803a06
.long 0x3ec5e403,0x3ea26799,0x3ec3e200,0x3ea4d225,0x3ea73656,0x3ec1d870,0x3ea4381a,0x3ec46337
.long 0x3e839c3d,0x3edb941a,0x3e7f17b2,0x3eddf6be,0x3e38442a,0x3eeed89e,0x3e2df73c,0x3ef0c501
.long 0x3dc7c5c2,0x3efb14be,0x3daf10a2,0x3efc3b28,0x3c490ab0,0x3effec43,0xbac90fc6,0x3effffb1
.long 0xbd964083,0x3efd3aac,0xbdb54098,0x3efbf531,0xbe209ae5,0x3ef31447,0xbe30eacb,0x3ef03b37
.long 0xbe715aea,0x3ee1c598,0xbe80e7e4,0x3edd2d53,0xbe9d7fd1,0x3ec9d112,0xbea56bcb,0x3ec36051
.long 0xbebdaef9,0x3eabeb4a,0xbec4e3f5,0x3ea39da9,0xbed84853,0x3e88f59b,0xbede5aa6,0x3e7dbabb
.long 0x3f000000,0x0,0x3f000000,0x0,0x3efbaccd,0x3dbb6ecf,0x3efb87b2,0x3dbe853e
.long 0x3eeed89e,0x3e38442a,0x3eee46be,0x3e3b31a0,0x3ed9f26a,0x3e864b82,0x3ed8b3a1,0x3e884b92
.long 0x3ebdaef9,0x3eabeb4a,0x3ebb8f3b,0x3eae3bde,0x3e9b02c6,0x3ecbbbf8,0x3e97de12,0x3ece1689
.long 0x3e663375,0x3ee4aa59,0x3e5dbe79,0x3ee6becc,0x3e0e9a22,0x3ef5dec6,0x3e040270,0x3ef7583a
.long 0x3d48bd36,0x3efec46d,0x3d16a905,0x3eff4e6d,0xbd2fb680,0x3eff0e58,0xbd67fa9a,0x3efe5a38
.long 0xbe088e93,0x3ef6ba07,0xbe17a117,0x3ef48422,0xbe60924f,0x3ee60f88,0xbe6ff7fb,0x3ee2241a
.long 0xbe987fc0,0x3ecd9f02,0xbe9ff6cb,0x3ec7de65,0xbebb8f3b,0x3eae3bde,0xbec25b89,0x3ea69de3
.long 0xbed84853,0x3e88f59b,0xbeddf6be,0x3e7f17b2,0xbeedb293,0x3e3e1d4a,0xbef1d19f,0x3e280b1f
.long 0x3f000000,0x0,0x3f000000,0x0,0x3efcfe73,0x3d9c76de,0x3efcdf6c,0x3d9f917b
.long 0x3ef40bdd,0x3e1aa086,0x3ef3913f,0x3e1d9e78,0x3ee55e0b,0x3e6363fa,0x3ee44fac,0x3e679a5d
.long 0x3ed14d3d,0x3e93682a,0x3ecf7a1f,0x3e95f6d9,0x3eb85216,0x3eb1a81d,0x3eb592e7,0x3eb4768f
.long 0x3e9b02c6,0x3ecbbbf8,0x3e973c07,0x3ece8d90,0x3e741f07,0x3ee106f2,0x3e6a6681,0x3ee398ac
.long 0x3e2c7cd4,0x3ef10908,0x3e209ae5,0x3ef31447,0x3dc19b37,0x3efb61fc,0x3da5c58c,0x3efc9f8a
.long 0x3c96c32c,0x3effd397,0x3b490f88,0x3efffec4,0xbd6e3876,0x3efe4323,0xbd995be0,0x3efd1cdd
.long 0xbe088e93,0x3ef6ba07,0xbe1aa086,0x3ef40bdd,0xbe525a09,0x3ee96591,0xbe64cbfe,0x3ee50479
.long 0xbe8b9a6b,0x3ed695e5,0xbe94b039,0x3ed064af,0xbeaac082,0x3ebebc1b,0xbeb3587a,0x3eb6ad7f
.long 0x3f000000,0x0,0x3f000000,0x0,0x3efc7eb0,0x3da8defc,0x3efc5d3a,0x3dabf804
.long 0x3ef21352,0x3e268f12,0x3ef18f57,0x3e2986c4,0x3ee106f2,0x3e741f07,0x3edfe4e9,0x3e7840c8
.long 0x3ec9d112,0x3e9d7fd1,0x3ec7de65,0x3e9ff6cb,0x3ead1469,0x3ebca003,0x3eaa2a80,0x3ebf41fc
.long 0x3e8b9a6b,0x3ed695e5,0x3e87a136,0x3ed91e6a,0x3e4c9b8b,0x3eeaab7b,0x3e427b55,0x3eecd007
.long 0x3df8cfcc,0x3ef853f8,0x3de05c13,0x3ef9c79d,0x3d23308c,0x3eff2f9d,0x3cd5880e,0x3effa6e3
.long 0xbd2fb680,0x3eff0e58,0xbd6e3876,0x3efe4323,0xbdfee6e1,0x3ef7f110,0xbe101c2c,0x3ef5a67b
.long 0xbe4f7bca,0x3eea09a7,0xbe60924f,0x3ee60f88,0xbe8cead0,0x3ed5b993,0xbe9553b7,0x3ecfefa8
.long 0xbeae3bde,0x3ebb8f3b,0xbeb6206c,0x3eb3e7bc,0xbecac77f,0x3e9c420c,0xbed1c0c2,0x3e92c39a
.long 0x3f000000,0x0,0x3f000000,0x0,0x3efbf531,0x3db54098,0x3efbd14d,0x3db857ec
.long 0x3eeff573,0x3e3263ef,0x3eef6830,0x3e3554ec,0x3edc61c7,0x3e8242b1,0x3edb2c79,0x3e844889
.long 0x3ec1d870,0x3ea73656,0x3ebfc767,0x3ea99415,0x3ea12ff9,0x3ec6e22a,0x3e9e1e22,0x3ec95521
.long 0x3e76e0cb,0x3ee04621,0x3e6e9479,0x3ee28210,0x3e2395c5,0x3ef294f8,0x3e1920fe,0x3ef4484b
.long 0x3d964083,0x3efd3aac,0x3d7ab273,0x3efe1324,0xbc7b49ba,0x3effe129,0xbceea038,0x3eff90b1
.long 0xbdd41501,0x3efa7302,0xbdf2b651,0x3ef8b47b,0xbe41071e,0x3eed1c1d,0xbe50eb2a,0x3ee9b7e4
.long 0xbe88f59b,0x3ed84853,0xbe90d3cd,0x3ed31849,0xbead1469,0x3ebca003,0xbeb4768f,0x3eb592e7
.long 0xbecbbbf8,0x3e9b02c6,0xbed233c6,0x3e921eb0,0xbee3f473,0x3e6900b7,0xbee912ae,0x3e53c867
.long 0x3f000000,0x0,0x3f000000,0x0,0x3efb61fc,0x3dc19b37,0x3efb3bab,0x3dc4b0b9
.long 0x3eedb293,0x3e3e1d4a,0x3eed1c1d,0x3e41071e,0x3ed77026,0x3e8a48ad,0x3ed627fe,0x3e8c42c9
.long 0x3eb96842,0x3eb085bb,0x3eb73a23,0x3eb2c8c9,0x3e94b039,0x3ed064af,0x3e91796b,0x3ed2a649
.long 0x3e553641,0x3ee8bf3c,0x3e4c9b8b,0x3eeaab7b,0x3df2b651,0x3ef8b47b,0x3ddd4b1a,0x3ef9f35e
.long 0x3cc8fb30,0x3effb10f,0x3c490ab0,0x3effec43,0xbd9008b7,0x3efd7474,0xbdabf804,0x3efc5d3a
.long 0xbe268f12,0x3ef21352,0xbe3554ec,0x3eef6830,0xbe7f17b2,0x3eddf6be,0xbe86f686,0x3ed988ad
.long 0xbea73656,0x3ec1d870,0xbeae3bde,0x3ebb8f3b,0xbec8d8b3,0x3e9ebc12,0xbecf0417,0x3e96999f
.long 0xbee33c5a,0x3e6bcbbb,0xbee816a8,0x3e58106b,0xbef56d97,0x3e119ddd,0xbef88486,0x3df5c35a
.long 0xbeb504f3,0x3eb504f3,0xbebdaef9,0x3eabeb4a,0xbecd9f02,0x3e987fc0,0xbed54aa4,0x3e8d9281
.long 0xbee1c598,0x3e715aea,0xbee816a8,0x3e58106b,0xbef10908,0x3e2c7cd4,0xbef5a67b,0x3e101c2c
.long 0xbefb14be,0x3dc7c5c2,0xbefdabcc,0x3d89cf86,0xbeffb10f,0x3cc8fb30,0xbefff84a,0xbbfb514b
.long 0xbefec46d,0xbd48bd36,0xbefc7eb0,0xbda8defc,0xbef853f8,0xbdf8cfcc,0xbef3530e,0xbe1f1cdf
.long 0xbeec835e,0xbe43ef15,0xbee4aa59,0xbe663375,0xbedb941a,0xbe839c3d,0xbed0d937,0xbe940c5f
.long 0xbec5e403,0xbea26799,0xbeb85216,0xbeb1a81d,0xbeabeb4a,0xbebdaef9,0xbe9ba299,0xbecb41fa
.long 0xbe8e39da,0xbed4db31,0xbe76e0cb,0xbee04621,0xbe5ae880,0xbee76bd8,0xbe30eacb,0xbef03b37
.long 0xbe14a031,0xbef4fa0b,0xbdcdee60,0xbefac516,0xbd964083,0xbefd3aac,0xbcd5880e,0xbeffa6e3
.long 0xbed4db31,0x3e8e39da,0xbedb941a,0x3e839c3d,0xbee8bf3c,0x3e553641,0xbeedfcf2,0x3e3ca7af
.long 0xbef6ba07,0x3e088e93,0xbefa1e84,0x3dda3997,0xbefe70b0,0x3d61bc2e,0xbeffa6e3,0x3cd5880e
.long 0xbeffb10f,0xbcc8fb30,0xbefe70b0,0xbd61bc2e,0xbefa7302,0xbdd41501,0xbef6841b,0xbe0a11f7
.long 0xbeeed89e,0xbe38442a,0xbee816a8,0xbe58106b,0xbedd2d53,0xbe80e7e4,0xbed389c7,0xbe902dd5
.long 0xbec5e403,0xbea26799,0xbeb96842,0xbeb085bb,0xbea99415,0xbebfc767,0xbe9a6293,0xbecc3578
.long 0xbe88f59b,0xbed84853,0xbe6e9479,0xbee28210,0xbe49b953,0xbeeb4b0c,0xbe221887,0xbef2d4eb
.long 0xbdf8cfcc,0xbef853f8,0xbda2abb6,0xbefcbfc9,0xbd2fb680,0xbeff0e58,0x3ac90fc6,0xbeffffb1
.long 0x3d16a905,0xbeff4e6d,0x3da8defc,0xbefc7eb0,0x3dec9a7f,0xbef91298,0x3e25129f,0xbef25470
.long 0xbeec835e,0x3e43ef15,0xbef10908,0x3e2c7cd4,0xbef9c79d,0x3de05c13,0xbefc5d3a,0x3dabf804
.long 0xbeffb10f,0x3cc8fb30,0xbefffec4,0xbb490f88,0xbefe1324,0xbd7ab273,0xbefbd14d,0xbdb857ec
.long 0xbef4fa0b,0xbe14a031,0xbeeff573,0xbe3263ef,0xbee4aa59,0xbe663375,0xbedcc7d1,0xbe819573
.long 0xbecd9f02,0xbe987fc0,0xbec2de29,0xbea6050a,0xbeb085bb,0xbeb96842,0xbea302d3,0xbec56439
.long 0xbe8e39da,0xbed4db31,0xbe7c5d27,0xbedebe05,0xbe4f7bca,0xbeea09a7,0xbe2b0201,0xbef14c7a
.long 0xbdf8cfcc,0xbef853f8,0xbda8defc,0xbefc7eb0,0xbd16a905,0xbeff4e6d,0x3b96cb58,0xbefffd39
.long 0x3d48bd36,0xbefec46d,0x3dbb6ecf,0xbefbaccd,0x3e088e93,0xbef6ba07,0x3e33dca5,0xbeefaf1b
.long 0x3e5ae880,0xbee76bd8,0x3e8242b1,0xbedc61c7,0x3e93682a,0xbed14d3d,0x3ea69de3,0xbec25b89
.long 0xbefb14be,0x3dc7c5c2,0xbefd3aac,0x3d964083,0xbefffb11,0x3bc90e90,0xbeffcbe2,0xbca351cb
.long 0xbefc3b28,0xbdaf10a2,0xbef96e4e,0xbde67c66,0xbeeff573,0xbe3263ef,0xbeea5ad9,0xbe4e0bea
.long 0xbedb941a,0xbe839c3d,0xbed31849,0xbe90d3cd,0xbebfc767,0xbea99415,0xbeb4768f,0xbeb592e7
.long 0xbe9d7fd1,0xbec9d112,0xbe8f8784,0xbed3fac3,0xbe6bcbbb,0xbee33c5a,0xbe4b2aae,0xbeeafb8c
.long 0xbe14a031,0xbef4fa0b,0xbde05c13,0xbef9c79d,0xbd61bc2e,0xbefe70b0,0xbc8a342f,0xbeffdaaf
.long 0x3d16a905,0xbeff4e6d,0x3d9c76de,0xbefcfe73,0x3e027dc0,0xbef78bc5,0x3e2b0201,0xbef14c7a
.long 0x3e5ae880,0xbee76bd8,0x3e80e7e4,0xbedd2d53,0x3e95f6d9,0xbecf7a1f,0x3ea7ce61,0xbec154e1
.long 0x3eb96842,0xbeb085bb,0x3ec8d8b3,0xbe9ebc12,0x3ed695e5,0xbe8b9a6b,0x3ee2df7b,0xbe6d3063
.long 0xbec5e403,0x3ea26799,0xbecd9f02,0x3e987fc0,0xbedc61c7,0x3e8242b1,0xbee2df7b,0x3e6d3063
.long 0xbeedb293,0x3e3e1d4a,0xbef294f8,0x3e2395c5,0xbef96e4e,0x3de67c66,0xbefc5d3a,0x3dabf804
.long 0xbeff4e6d,0x3d16a905,0xbefffb11,0x3bc90e90,0xbeff2f9d,0xbd23308c,0xbefd57de,0xbd9324ca
.long 0xbef91298,0xbdec9a7f,0xbef48422,0xbe17a117,0xbeed1c1d,0xbe41071e,0xbee5b710,0xbe61fb6a
.long 0xbedb941a,0xbe839c3d,0xbed14d3d,0xbe93682a,0xbec4e3f5,0xbea39da9,0xbeb7c655,0xbeb238aa
.long 0xbea99415,0xbebfc767,0xbe99c200,0xbeccae79,0xbe8a48ad,0xbed77026,0xbe6ff7fb,0xbee2241a
.long 0xbe4f7bca,0xbeea09a7,0xbe268f12,0xbef21352,0xbe0586ce,0xbef72417,0xbdb228d4,0xbefc187a
.long 0xbd61bc2e,0xbefe70b0,0xbc16c9b6,0xbefff4e6,0x3cafe007,0xbeffc38f,0x3d8cec4a,0xbefd906e
.long 0xbee1c598,0x3e715aea,0xbee76bd8,0x3e5ae880,0xbef294f8,0x3e2395c5,0xbef6841b,0x3e0a11f7
.long 0xbefcbfc9,0x3da2abb6,0xbefe9bc9,0x3d553db9,0xbefffec4,0xbb490f88,0xbeff7808,0xbd03db0a
.long 0xbefc3b28,0xbdaf10a2,0xbef91298,0xbdec9a7f,0xbef18f57,0xbe2986c4,0xbeeb99fb,0xbe48477c
.long 0xbee04621,0xbe76e0cb,0xbed77026,0xbe8a48ad,0xbec8d8b3,0xbe9ebc12,0xbebd27b8,0xbeac800f
.long 0xbeabeb4a,0xbebdaef9,0xbe9d7fd1,0xbec9d112,0xbe8a48ad,0xbed77026,0xbe72bd43,0xbee1668a
.long 0xbe49b953,0xbeeb4b0c,0xbe2395c5,0xbef294f8,0xbdf2b651,0xbef8b47b,0xbd9f917b,0xbefcdf6c
.long 0xbd16a905,0xbeff4e6d,0x3bc90e90,0xbefffb11,0x3d3c3ac3,0xbefeea9d,0x3db857ec,0xbefbd14d
.long 0x3e027dc0,0xbef78bc5,0x3e2f713a,0xbef08066,0x3e525a09,0xbee96591,0x3e7dbabb,0xbede5aa6
.long 0xbef4fa0b,0x3e14a031,0xbef853f8,0x3df8cfcc,0xbefe4323,0x3d6e3876,0xbeff7808,0x3d03db0a
.long 0xbeff84ab,0xbcfb2b74,0xbefe4323,0xbd6e3876,0xbef8b47b,0xbdf2b651,0xbef4bf62,0xbe1620d2
.long 0xbeea09a7,0xbe4f7bca,0xbee33c5a,0xbe6bcbbb,0xbed3fac3,0xbe8f8784,0xbeca4c87,0xbe9ce11f
.long 0xbeb73a23,0xbeb2c8c9,0xbeaac082,0xbebebc1b,0xbe94b039,0xbed064af,0xbe85a02c,0xbeda5ba0
.long 0xbe5ae880,0xbee76bd8,0xbe38442a,0xbeeed89e,0xbe0586ce,0xbef72417,0xbdbe853e,0xbefb87b2
.long 0xbd2fb680,0xbeff0e58,0xbb490f88,0xbefffec4,0x3d3c3ac3,0xbefeea9d,0x3db228d4,0xbefc187a
.long 0x3e088e93,0xbef6ba07,0x3e3263ef,0xbeeff573,0x3e5dbe79,0xbee6becc,0x3e82ef9f,0xbedbfb34
.long 0x3e95f6d9,0xbecf7a1f,0x3ea86605,0xbec0d0da,0x3eb85216,0xbeb1a81d,0x3ec85bca,0xbe9f599f
.long 0xbefec46d,0x3d48bd36,0xbeffb10f,0x3cc8fb30,0xbefeea9d,0xbd3c3ac3,0xbefd57de,0xbd9324ca
.long 0xbef5dec6,0xbe0e9a22,0xbef18f57,0xbe2986c4,0xbee3f473,0xbe6900b7,0xbedcc7d1,0xbe819573
.long 0xbec9d112,0xbe9d7fd1,0xbebfc767,0xbea99415,0xbea86605,0xbec0d0da,0xbe9ba299,0xbecb41fa
.long 0xbe80e7e4,0xbedd2d53,0xbe6363fa,0xbee55e0b,0xbe2986c4,0xbef18f57,0xbe070ada,0xbef6ef5b
.long 0xbd964083,0xbefd3aac,0xbd16a905,0xbeff4e6d,0x3cafe007,0xbeffc38f,0x3d7475c0,0xbefe2b72
.long 0x3dec9a7f,0xbef91298,0x3e1d9e78,0xbef3913f,0x3e525a09,0xbee96591,0x3e7840c8,0xbedfe4e9
.long 0x3e93682a,0xbed14d3d,0x3ea4d225,0xbec3e200,0x3eb85216,0xbeb1a81d,0x3ec76085,0xbea09393
.long 0x3ed695e5,0xbe8b9a6b,0x3ee28210,0xbe6e9479,0x3eed1c1d,0xbe41071e,0x3ef5341d,0xbe131f35
.long 0x3c003c00,0x3c003c00,0x3c003c00,0x3c003c00,0x3bd93c00,0x3aa73b64,0xbbd9bc00,0xbaa7bb64
.long 0x3b643c00,0x361f39a8,0x3b643c00,0x361f39a8,0x3aa73c00,0xb23e361f,0xbaa7bc00,0x323eb61f
.long 0x39a83c00,0xb9a80000,0x39a83c00,0xb9a80000,0x38723c00,0xbbd9b61f,0xb872bc00,0x3bd9361f
.long 0x361f3c00,0xbb64b9a8,0x361f3c00,0xbb64b9a8,0x323e3c00,0xb872bb64,0xb23ebc00,0x38723b64
.long 0x3c00,0x8000bc00,0x3c00,0x8000bc00,0xb23e3c00,0x3872bb64,0x323ebc00,0xb8723b64
.long 0xb61f3c00,0x3b64b9a8,0xb61f3c00,0x3b64b9a8,0xb8723c00,0x3bd9b61f,0x3872bc00,0xbbd9361f
.long 0xb9a83c00,0x39a88000,0xb9a83c00,0x39a88000,0xbaa73c00,0x323e361f,0x3aa7bc00,0xb23eb61f
.long 0xbb643c00,0xb61f39a8,0xbb643c00,0xb61f39a8,0xbbd93c00,0xbaa73b64,0x3bd9bc00,0x3aa7bb64
.long 0x3c003c00,0x3c003c00,0x3c003c00,0x3c003c00,0x387239a8,0x323e361f,0xb872b9a8,0xb23eb61f
.long 0xb61f0000,0xbb64b9a8,0xb61f0000,0xbb64b9a8,0xbbd9b9a8,0xb872bb64,0x3bd939a8,0x38723b64
.long 0xb9a8bc00,0x39a88000,0xb9a8bc00,0x39a88000,0x323eb9a8,0x3aa73b64,0xb23e39a8,0xbaa7bb64
.long 0x3b648000,0xb61f39a8,0x3b648000,0xb61f39a8,0x3aa739a8,0xbbd9b61f,0xbaa7b9a8,0x3bd9361f
.long 0x3c00,0x8000bc00,0x3c00,0x8000bc00,0xbaa739a8,0x3bd9b61f,0x3aa7b9a8,0xbbd9361f
.long 0xbb640000,0x361f39a8,0xbb640000,0x361f39a8,0xb23eb9a8,0xbaa73b64,0x323e39a8,0x3aa7bb64
.long 0x39a8bc00,0xb9a80000,0x39a8bc00,0xb9a80000,0x3bd9b9a8,0x3872bb64,0xbbd939a8,0xb8723b64
.long 0x361f8000,0x3b64b9a8,0x361f8000,0x3b64b9a8,0xb87239a8,0xb23e361f,0x3872b9a8,0x323eb61f
.long 0x3c003c00,0x3c003c00,0x3c003c00,0x3c003c00,0xb23e0000,0xb872b61f,0x323e8000,0x3872361f
.long 0xbb64bc00,0xb61fb9a8,0xbb64bc00,0xb61fb9a8,0x38728000,0x3bd93b64,0xb8720000,0xbbd9bb64
.long 0x39a83c00,0xb9a80000,0x39a83c00,0xb9a80000,0xbaa70000,0xb23ebb64,0x3aa78000,0x323e3b64
.long 0xb61fbc00,0x3b6439a8,0xb61fbc00,0x3b6439a8,0x3bd98000,0xbaa7361f,0xbbd90000,0x3aa7b61f
.long 0x3c00,0x8000bc00,0x3c00,0x8000bc00,0xbbd90000,0x3aa7361f,0x3bd98000,0xbaa7b61f
.long 0x361fbc00,0xbb6439a8,0x361fbc00,0xbb6439a8,0x3aa78000,0x323ebb64,0xbaa70000,0xb23e3b64
.long 0xb9a83c00,0x39a88000,0xb9a83c00,0x39a88000,0xb8720000,0xbbd93b64,0x38728000,0x3bd9bb64
.long 0x3b64bc00,0x361fb9a8,0x3b64bc00,0x361fb9a8,0x323e8000,0x3872b61f,0xb23e0000,0xb872361f
.long 0x3c003c00,0x3c003c00,0x3c003c00,0x3c003c00,0xbaa7b9a8,0xbbd9bb64,0x3aa739a8,0x3bd93b64
.long 0x361f8000,0x3b6439a8,0x361f8000,0x3b6439a8,0x323e39a8,0xbaa7b61f,0xb23eb9a8,0x3aa7361f
.long 0xb9a8bc00,0x39a88000,0xb9a8bc00,0x39a88000,0x3bd939a8,0xb872361f,0xbbd9b9a8,0x3872b61f
.long 0xbb640000,0x361fb9a8,0xbb640000,0x361fb9a8,0x3872b9a8,0xb23e3b64,0xb87239a8,0x323ebb64
.long 0x3c00,0x8000bc00,0x3c00,0x8000bc00,0xb872b9a8,0x323e3b64,0x387239a8,0xb23ebb64
.long 0x3b648000,0xb61fb9a8,0x3b648000,0xb61fb9a8,0xbbd939a8,0x3872361f,0x3bd9b9a8,0xb872b61f
.long 0x39a8bc00,0xb9a80000,0x39a8bc00,0xb9a80000,0xb23e39a8,0x3aa7b61f,0x323eb9a8,0xbaa7361f
.long 0xb61f0000,0xbb6439a8,0xb61f0000,0xbb6439a8,0x3aa7b9a8,0x3bd9bb64,0xbaa739a8,0xbbd93b64
.long 0x0,0x0,0x0,0x0,0x323e0000,0x3872361f,0xb23e0000,0xb872b61f
.long 0x361f0000,0x3b6439a8,0x361f0000,0x3b6439a8,0x38720000,0x3bd93b64,0xb8720000,0xbbd9bb64
.long 0x39a80000,0x39a83c00,0x39a80000,0x39a83c00,0x3aa70000,0x323e3b64,0xbaa70000,0xb23ebb64
.long 0x3b640000,0xb61f39a8,0x3b640000,0xb61f39a8,0x3bd90000,0xbaa7361f,0xbbd90000,0x3aa7b61f
.long 0x3c000000,0xbc000000,0x3c000000,0xbc000000,0x3bd90000,0xbaa7b61f,0xbbd90000,0x3aa7361f
.long 0x3b640000,0xb61fb9a8,0x3b640000,0xb61fb9a8,0x3aa70000,0x323ebb64,0xbaa70000,0xb23e3b64
.long 0x39a80000,0x39a8bc00,0x39a80000,0x39a8bc00,0x38720000,0x3bd9bb64,0xb8720000,0xbbd93b64
.long 0x361f0000,0x3b64b9a8,0x361f0000,0x3b64b9a8,0x323e0000,0x3872b61f,0xb23e0000,0xb872361f
.long 0x0,0x0,0x0,0x0,0x3aa739a8,0x3bd93b64,0xbaa7b9a8,0xbbd9bb64
.long 0x3b643c00,0x361f39a8,0x3b643c00,0x361f39a8,0x323e39a8,0xbaa7b61f,0xb23eb9a8,0x3aa7361f
.long 0xb9a80000,0xb9a8bc00,0xb9a80000,0xb9a8bc00,0xbbd9b9a8,0x3872b61f,0x3bd939a8,0xb872361f
.long 0xb61fbc00,0x3b6439a8,0xb61fbc00,0x3b6439a8,0x3872b9a8,0xb23e3b64,0xb87239a8,0x323ebb64
.long 0x3c000000,0xbc000000,0x3c000000,0xbc000000,0x387239a8,0xb23ebb64,0xb872b9a8,0x323e3b64
.long 0xb61f3c00,0x3b64b9a8,0xb61f3c00,0x3b64b9a8,0xbbd939a8,0x3872361f,0x3bd9b9a8,0xb872b61f
.long 0xb9a80000,0xb9a83c00,0xb9a80000,0xb9a83c00,0x323eb9a8,0xbaa7361f,0xb23e39a8,0x3aa7b61f
.long 0x3b64bc00,0x361fb9a8,0x3b64bc00,0x361fb9a8,0x3aa7b9a8,0x3bd9bb64,0xbaa739a8,0xbbd93b64
.long 0x0,0x0,0x0,0x0,0x3bd93c00,0x3aa73b64,0xbbd9bc00,0xbaa7bb64
.long 0xb61f0000,0xbb64b9a8,0xb61f0000,0xbb64b9a8,0xbaa7bc00,0x323eb61f,0x3aa73c00,0xb23e361f
.long 0x39a80000,0x39a83c00,0x39a80000,0x39a83c00,0x38723c00,0xbbd9b61f,0xb872bc00,0x3bd9361f
.long 0xbb640000,0x361fb9a8,0xbb640000,0x361fb9a8,0xb23ebc00,0x38723b64,0x323e3c00,0xb872bb64
.long 0x3c000000,0xbc000000,0x3c000000,0xbc000000,0xb23e3c00,0x3872bb64,0x323ebc00,0xb8723b64
.long 0xbb640000,0x361f39a8,0xbb640000,0x361f39a8,0x3872bc00,0xbbd9361f,0xb8723c00,0x3bd9b61f
.long 0x39a80000,0x39a8bc00,0x39a80000,0x39a8bc00,0xbaa73c00,0x323e361f,0x3aa7bc00,0xb23eb61f
.long 0xb61f0000,0xbb6439a8,0xb61f0000,0xbb6439a8,0x3bd9bc00,0x3aa7bb64,0xbbd93c00,0xbaa73b64
.long 0x0,0x0,0x0,0x0,0x387239a8,0x323e361f,0xb872b9a8,0xb23eb61f
.long 0xbb64bc00,0xb61fb9a8,0xbb64bc00,0xb61fb9a8,0x3bd939a8,0x38723b64,0xbbd9b9a8,0xb872bb64
.long 0xb9a80000,0xb9a8bc00,0xb9a80000,0xb9a8bc00,0x323eb9a8,0x3aa73b64,0xb23e39a8,0xbaa7bb64
.long 0x361f3c00,0xbb64b9a8,0x361f3c00,0xbb64b9a8,0xbaa7b9a8,0x3bd9361f,0x3aa739a8,0xbbd9b61f
.long 0x3c000000,0xbc000000,0x3c000000,0xbc000000,0xbaa739a8,0x3bd9b61f,0x3aa7b9a8,0xbbd9361f
.long 0x361fbc00,0xbb6439a8,0x361fbc00,0xbb6439a8,0x323e39a8,0x3aa7bb64,0xb23eb9a8,0xbaa73b64
.long 0xb9a80000,0xb9a83c00,0xb9a80000,0xb9a83c00,0x3bd9b9a8,0x3872bb64,0xbbd939a8,0xb8723b64
.long 0xbb643c00,0xb61f39a8,0xbb643c00,0xb61f39a8,0x3872b9a8,0x323eb61f,0xb87239a8,0xb23e361f
.long 0x80008000,0x80008000,0x80008000,0x80008000,0xb23e8000,0xb872b61f,0x323e8000,0x3872361f
.long 0xb61f8000,0xbb64b9a8,0xb61f8000,0xbb64b9a8,0xb8728000,0xbbd9bb64,0x38728000,0x3bd93b64
.long 0xb9a88000,0xb9a8bc00,0xb9a88000,0xb9a8bc00,0xbaa78000,0xb23ebb64,0x3aa78000,0x323e3b64
.long 0xbb648000,0x361fb9a8,0xbb648000,0x361fb9a8,0xbbd98000,0x3aa7b61f,0x3bd98000,0xbaa7361f
.long 0xbc008000,0x3c008000,0xbc008000,0x3c008000,0xbbd98000,0x3aa7361f,0x3bd98000,0xbaa7b61f
.long 0xbb648000,0x361f39a8,0xbb648000,0x361f39a8,0xbaa78000,0xb23e3b64,0x3aa78000,0x323ebb64
.long 0xb9a88000,0xb9a83c00,0xb9a88000,0xb9a83c00,0xb8728000,0xbbd93b64,0x38728000,0x3bd9bb64
.long 0xb61f8000,0xbb6439a8,0xb61f8000,0xbb6439a8,0xb23e8000,0xb872361f,0x323e8000,0x3872b61f
.long 0x80008000,0x80008000,0x80008000,0x80008000,0xbaa7b9a8,0xbbd9bb64,0x3aa739a8,0x3bd93b64
.long 0xbb64bc00,0xb61fb9a8,0xbb64bc00,0xb61fb9a8,0xb23eb9a8,0x3aa7361f,0x323e39a8,0xbaa7b61f
.long 0x39a88000,0x39a83c00,0x39a88000,0x39a83c00,0x3bd939a8,0xb872361f,0xbbd9b9a8,0x3872b61f
.long 0x361f3c00,0xbb64b9a8,0x361f3c00,0xbb64b9a8,0xb87239a8,0x323ebb64,0x3872b9a8,0xb23e3b64
.long 0xbc008000,0x3c008000,0xbc008000,0x3c008000,0xb872b9a8,0x323e3b64,0x387239a8,0xb23ebb64
.long 0x361fbc00,0xbb6439a8,0x361fbc00,0xbb6439a8,0x3bd9b9a8,0xb872b61f,0xbbd939a8,0x3872361f
.long 0x39a88000,0x39a8bc00,0x39a88000,0x39a8bc00,0xb23e39a8,0x3aa7b61f,0x323eb9a8,0xbaa7361f
.long 0xbb643c00,0xb61f39a8,0xbb643c00,0xb61f39a8,0xbaa739a8,0xbbd93b64,0x3aa7b9a8,0x3bd9bb64
.long 0x80008000,0x80008000,0x80008000,0x80008000,0xbbd9bc00,0xbaa7bb64,0x3bd93c00,0x3aa73b64
.long 0x361f8000,0x3b6439a8,0x361f8000,0x3b6439a8,0x3aa73c00,0xb23e361f,0xbaa7bc00,0x323eb61f
.long 0xb9a88000,0xb9a8bc00,0xb9a88000,0xb9a8bc00,0xb872bc00,0x3bd9361f,0x38723c00,0xbbd9b61f
.long 0x3b648000,0xb61f39a8,0x3b648000,0xb61f39a8,0x323e3c00,0xb872bb64,0xb23ebc00,0x38723b64
.long 0xbc008000,0x3c008000,0xbc008000,0x3c008000,0x323ebc00,0xb8723b64,0xb23e3c00,0x3872bb64
.long 0x3b648000,0xb61fb9a8,0x3b648000,0xb61fb9a8,0xb8723c00,0x3bd9b61f,0x3872bc00,0xbbd9361f
.long 0xb9a88000,0xb9a83c00,0xb9a88000,0xb9a83c00,0x3aa7bc00,0xb23eb61f,0xbaa73c00,0x323e361f
.long 0x361f8000,0x3b64b9a8,0x361f8000,0x3b64b9a8,0xbbd93c00,0xbaa73b64,0x3bd9bc00,0x3aa7bb64
.long 0x80008000,0x80008000,0x80008000,0x80008000,0xb872b9a8,0xb23eb61f,0x387239a8,0x323e361f
.long 0x3b643c00,0x361f39a8,0x3b643c00,0x361f39a8,0xbbd9b9a8,0xb872bb64,0x3bd939a8,0x38723b64
.long 0x39a88000,0x39a83c00,0x39a88000,0x39a83c00,0xb23e39a8,0xbaa7bb64,0x323eb9a8,0x3aa73b64
.long 0xb61fbc00,0x3b6439a8,0xb61fbc00,0x3b6439a8,0x3aa739a8,0xbbd9b61f,0xbaa7b9a8,0x3bd9361f
.long 0xbc008000,0x3c008000,0xbc008000,0x3c008000,0x3aa7b9a8,0xbbd9361f,0xbaa739a8,0x3bd9b61f
.long 0xb61f3c00,0x3b64b9a8,0xb61f3c00,0x3b64b9a8,0xb23eb9a8,0xbaa73b64,0x323e39a8,0x3aa7bb64
.long 0x39a88000,0x39a8bc00,0x39a88000,0x39a8bc00,0xbbd939a8,0xb8723b64,0x3bd9b9a8,0x3872bb64
.long 0x3b64bc00,0x361fb9a8,0x3b64bc00,0x361fb9a8,0xb87239a8,0xb23e361f,0x3872b9a8,0x323eb61f
.long 0xbc003c00,0xbc003c00,0xbc003c00,0xbc003c00,0xbbd93c00,0xbaa73b64,0x3bd9bc00,0x3aa7bb64
.long 0xbb643c00,0xb61f39a8,0xbb643c00,0xb61f39a8,0xbaa73c00,0x323e361f,0x3aa7bc00,0xb23eb61f
.long 0xb9a83c00,0x39a80000,0xb9a83c00,0x39a80000,0xb8723c00,0x3bd9b61f,0x3872bc00,0xbbd9361f
.long 0xb61f3c00,0x3b64b9a8,0xb61f3c00,0x3b64b9a8,0xb23e3c00,0x3872bb64,0x323ebc00,0xb8723b64
.long 0x80003c00,0xbc00,0x80003c00,0xbc00,0x323e3c00,0xb872bb64,0xb23ebc00,0x38723b64
.long 0x361f3c00,0xbb64b9a8,0x361f3c00,0xbb64b9a8,0x38723c00,0xbbd9b61f,0xb872bc00,0x3bd9361f
.long 0x39a83c00,0xb9a88000,0x39a83c00,0xb9a88000,0x3aa73c00,0xb23e361f,0xbaa7bc00,0x323eb61f
.long 0x3b643c00,0x361f39a8,0x3b643c00,0x361f39a8,0x3bd93c00,0x3aa73b64,0xbbd9bc00,0xbaa7bb64
.long 0xbc003c00,0xbc003c00,0xbc003c00,0xbc003c00,0xb87239a8,0xb23e361f,0x3872b9a8,0x323eb61f
.long 0x361f0000,0x3b64b9a8,0x361f0000,0x3b64b9a8,0x3bd9b9a8,0x3872bb64,0xbbd939a8,0xb8723b64
.long 0x39a8bc00,0xb9a88000,0x39a8bc00,0xb9a88000,0xb23eb9a8,0xbaa73b64,0x323e39a8,0x3aa7bb64
.long 0xbb648000,0x361f39a8,0xbb648000,0x361f39a8,0xbaa739a8,0x3bd9b61f,0x3aa7b9a8,0xbbd9361f
.long 0x80003c00,0xbc00,0x80003c00,0xbc00,0x3aa739a8,0xbbd9b61f,0xbaa7b9a8,0x3bd9361f
.long 0x3b640000,0xb61f39a8,0x3b640000,0xb61f39a8,0x323eb9a8,0x3aa73b64,0xb23e39a8,0xbaa7bb64
.long 0xb9a8bc00,0x39a80000,0xb9a8bc00,0x39a80000,0xbbd9b9a8,0xb872bb64,0x3bd939a8,0x38723b64
.long 0xb61f8000,0xbb64b9a8,0xb61f8000,0xbb64b9a8,0x387239a8,0x323e361f,0xb872b9a8,0xb23eb61f
.long 0xbc003c00,0xbc003c00,0xbc003c00,0xbc003c00,0x323e0000,0x3872b61f,0xb23e8000,0xb872361f
.long 0x3b64bc00,0x361fb9a8,0x3b64bc00,0x361fb9a8,0xb8728000,0xbbd93b64,0x38720000,0x3bd9bb64
.long 0xb9a83c00,0x39a80000,0xb9a83c00,0x39a80000,0x3aa70000,0x323ebb64,0xbaa78000,0xb23e3b64
.long 0x361fbc00,0xbb6439a8,0x361fbc00,0xbb6439a8,0xbbd98000,0x3aa7361f,0x3bd90000,0xbaa7b61f
.long 0x80003c00,0xbc00,0x80003c00,0xbc00,0x3bd90000,0xbaa7361f,0xbbd98000,0x3aa7b61f
.long 0xb61fbc00,0x3b6439a8,0xb61fbc00,0x3b6439a8,0xbaa78000,0xb23ebb64,0x3aa70000,0x323e3b64
.long 0x39a83c00,0xb9a88000,0x39a83c00,0xb9a88000,0x38720000,0x3bd93b64,0xb8728000,0xbbd9bb64
.long 0xbb64bc00,0xb61fb9a8,0xbb64bc00,0xb61fb9a8,0xb23e8000,0xb872b61f,0x323e0000,0x3872361f
.long 0xbc003c00,0xbc003c00,0xbc003c00,0xbc003c00,0x3aa7b9a8,0x3bd9bb64,0xbaa739a8,0xbbd93b64
.long 0xb61f8000,0xbb6439a8,0xb61f8000,0xbb6439a8,0xb23e39a8,0x3aa7b61f,0x323eb9a8,0xbaa7361f
.long 0x39a8bc00,0xb9a88000,0x39a8bc00,0xb9a88000,0xbbd939a8,0x3872361f,0x3bd9b9a8,0xb872b61f
.long 0x3b640000,0xb61fb9a8,0x3b640000,0xb61fb9a8,0xb872b9a8,0x323e3b64,0x387239a8,0xb23ebb64
.long 0x80003c00,0xbc00,0x80003c00,0xbc00,0x3872b9a8,0xb23e3b64,0xb87239a8,0x323ebb64
.long 0xbb648000,0x361fb9a8,0xbb648000,0x361fb9a8,0x3bd939a8,0xb872361f,0xbbd9b9a8,0x3872b61f
.long 0xb9a8bc00,0x39a80000,0xb9a8bc00,0x39a80000,0x323e39a8,0xbaa7b61f,0xb23eb9a8,0x3aa7361f
.long 0x361f0000,0x3b6439a8,0x361f0000,0x3b6439a8,0xbaa7b9a8,0xbbd9bb64,0x3aa739a8,0x3bd93b64
.long 0x0,0x0,0x0,0x0,0xb23e0000,0xb872361f,0x323e0000,0x3872b61f
.long 0xb61f0000,0xbb6439a8,0xb61f0000,0xbb6439a8,0xb8720000,0xbbd93b64,0x38720000,0x3bd9bb64
.long 0xb9a80000,0xb9a83c00,0xb9a80000,0xb9a83c00,0xbaa70000,0xb23e3b64,0x3aa70000,0x323ebb64
.long 0xbb640000,0x361f39a8,0xbb640000,0x361f39a8,0xbbd90000,0x3aa7361f,0x3bd90000,0xbaa7b61f
.long 0xbc000000,0x3c000000,0xbc000000,0x3c000000,0xbbd90000,0x3aa7b61f,0x3bd90000,0xbaa7361f
.long 0xbb640000,0x361fb9a8,0xbb640000,0x361fb9a8,0xbaa70000,0xb23ebb64,0x3aa70000,0x323e3b64
.long 0xb9a80000,0xb9a8bc00,0xb9a80000,0xb9a8bc00,0xb8720000,0xbbd9bb64,0x38720000,0x3bd93b64
.long 0xb61f0000,0xbb64b9a8,0xb61f0000,0xbb64b9a8,0xb23e0000,0xb872b61f,0x323e0000,0x3872361f
.long 0x0,0x0,0x0,0x0,0xbaa739a8,0xbbd93b64,0x3aa7b9a8,0x3bd9bb64
.long 0xbb643c00,0xb61f39a8,0xbb643c00,0xb61f39a8,0xb23e39a8,0x3aa7b61f,0x323eb9a8,0xbaa7361f
.long 0x39a80000,0x39a8bc00,0x39a80000,0x39a8bc00,0x3bd9b9a8,0xb872b61f,0xbbd939a8,0x3872361f
.long 0x361fbc00,0xbb6439a8,0x361fbc00,0xbb6439a8,0xb872b9a8,0x323e3b64,0x387239a8,0xb23ebb64
.long 0xbc000000,0x3c000000,0xbc000000,0x3c000000,0xb87239a8,0x323ebb64,0x3872b9a8,0xb23e3b64
.long 0x361f3c00,0xbb64b9a8,0x361f3c00,0xbb64b9a8,0x3bd939a8,0xb872361f,0xbbd9b9a8,0x3872b61f
.long 0x39a80000,0x39a83c00,0x39a80000,0x39a83c00,0xb23eb9a8,0x3aa7361f,0x323e39a8,0xbaa7b61f
.long 0xbb64bc00,0xb61fb9a8,0xbb64bc00,0xb61fb9a8,0xbaa7b9a8,0xbbd9bb64,0x3aa739a8,0x3bd93b64
.long 0x0,0x0,0x0,0x0,0xbbd93c00,0xbaa73b64,0x3bd9bc00,0x3aa7bb64
.long 0x361f0000,0x3b64b9a8,0x361f0000,0x3b64b9a8,0x3aa7bc00,0xb23eb61f,0xbaa73c00,0x323e361f
.long 0xb9a80000,0xb9a83c00,0xb9a80000,0xb9a83c00,0xb8723c00,0x3bd9b61f,0x3872bc00,0xbbd9361f
.long 0x3b640000,0xb61fb9a8,0x3b640000,0xb61fb9a8,0x323ebc00,0xb8723b64,0xb23e3c00,0x3872bb64
.long 0xbc000000,0x3c000000,0xbc000000,0x3c000000,0x323e3c00,0xb872bb64,0xb23ebc00,0x38723b64
.long 0x3b640000,0xb61f39a8,0x3b640000,0xb61f39a8,0xb872bc00,0x3bd9361f,0x38723c00,0xbbd9b61f
.long 0xb9a80000,0xb9a8bc00,0xb9a80000,0xb9a8bc00,0x3aa73c00,0xb23e361f,0xbaa7bc00,0x323eb61f
.long 0x361f0000,0x3b6439a8,0x361f0000,0x3b6439a8,0xbbd9bc00,0xbaa7bb64,0x3bd93c00,0x3aa73b64
.long 0x0,0x0,0x0,0x0,0xb87239a8,0xb23e361f,0x3872b9a8,0x323eb61f
.long 0x3b64bc00,0x361fb9a8,0x3b64bc00,0x361fb9a8,0xbbd939a8,0xb8723b64,0x3bd9b9a8,0x3872bb64
.long 0x39a80000,0x39a8bc00,0x39a80000,0x39a8bc00,0xb23eb9a8,0xbaa73b64,0x323e39a8,0x3aa7bb64
.long 0xb61f3c00,0x3b64b9a8,0xb61f3c00,0x3b64b9a8,0x3aa7b9a8,0xbbd9361f,0xbaa739a8,0x3bd9b61f
.long 0xbc000000,0x3c000000,0xbc000000,0x3c000000,0x3aa739a8,0xbbd9b61f,0xbaa7b9a8,0x3bd9361f
.long 0xb61fbc00,0x3b6439a8,0xb61fbc00,0x3b6439a8,0xb23e39a8,0xbaa7bb64,0x323eb9a8,0x3aa73b64
.long 0x39a80000,0x39a83c00,0x39a80000,0x39a83c00,0xbbd9b9a8,0xb872bb64,0x3bd939a8,0x38723b64
.long 0x3b643c00,0x361f39a8,0x3b643c00,0x361f39a8,0xb872b9a8,0xb23eb61f,0x387239a8,0x323e361f
.long 0x80008000,0x80008000,0x80008000,0x80008000,0x323e8000,0x3872b61f,0xb23e8000,0xb872361f
.long 0x361f8000,0x3b64b9a8,0x361f8000,0x3b64b9a8,0x38728000,0x3bd9bb64,0xb8728000,0xbbd93b64
.long 0x39a88000,0x39a8bc00,0x39a88000,0x39a8bc00,0x3aa78000,0x323ebb64,0xbaa78000,0xb23e3b64
.long 0x3b648000,0xb61fb9a8,0x3b648000,0xb61fb9a8,0x3bd98000,0xbaa7b61f,0xbbd98000,0x3aa7361f
.long 0x3c008000,0xbc008000,0x3c008000,0xbc008000,0x3bd98000,0xbaa7361f,0xbbd98000,0x3aa7b61f
.long 0x3b648000,0xb61f39a8,0x3b648000,0xb61f39a8,0x3aa78000,0x323e3b64,0xbaa78000,0xb23ebb64
.long 0x39a88000,0x39a83c00,0x39a88000,0x39a83c00,0x38728000,0x3bd93b64,0xb8728000,0xbbd9bb64
.long 0x361f8000,0x3b6439a8,0x361f8000,0x3b6439a8,0x323e8000,0x3872361f,0xb23e8000,0xb872b61f
.long 0x80008000,0x80008000,0x80008000,0x80008000,0x3aa7b9a8,0x3bd9bb64,0xbaa739a8,0xbbd93b64
.long 0x3b64bc00,0x361fb9a8,0x3b64bc00,0x361fb9a8,0x323eb9a8,0xbaa7361f,0xb23e39a8,0x3aa7b61f
.long 0xb9a88000,0xb9a83c00,0xb9a88000,0xb9a83c00,0xbbd939a8,0x3872361f,0x3bd9b9a8,0xb872b61f
.long 0xb61f3c00,0x3b64b9a8,0xb61f3c00,0x3b64b9a8,0x387239a8,0xb23ebb64,0xb872b9a8,0x323e3b64
.long 0x3c008000,0xbc008000,0x3c008000,0xbc008000,0x3872b9a8,0xb23e3b64,0xb87239a8,0x323ebb64
.long 0xb61fbc00,0x3b6439a8,0xb61fbc00,0x3b6439a8,0xbbd9b9a8,0x3872b61f,0x3bd939a8,0xb872361f
.long 0xb9a88000,0xb9a8bc00,0xb9a88000,0xb9a8bc00,0x323e39a8,0xbaa7b61f,0xb23eb9a8,0x3aa7361f
.long 0x3b643c00,0x361f39a8,0x3b643c00,0x361f39a8,0x3aa739a8,0x3bd93b64,0xbaa7b9a8,0xbbd9bb64
.long 0x80008000,0x80008000,0x80008000,0x80008000,0x3bd9bc00,0x3aa7bb64,0xbbd93c00,0xbaa73b64
.long 0xb61f8000,0xbb6439a8,0xb61f8000,0xbb6439a8,0xbaa73c00,0x323e361f,0x3aa7bc00,0xb23eb61f
.long 0x39a88000,0x39a8bc00,0x39a88000,0x39a8bc00,0x3872bc00,0xbbd9361f,0xb8723c00,0x3bd9b61f
.long 0xbb648000,0x361f39a8,0xbb648000,0x361f39a8,0xb23e3c00,0x3872bb64,0x323ebc00,0xb8723b64
.long 0x3c008000,0xbc008000,0x3c008000,0xbc008000,0xb23ebc00,0x38723b64,0x323e3c00,0xb872bb64
.long 0xbb648000,0x361fb9a8,0xbb648000,0x361fb9a8,0x38723c00,0xbbd9b61f,0xb872bc00,0x3bd9361f
.long 0x39a88000,0x39a83c00,0x39a88000,0x39a83c00,0xbaa7bc00,0x323eb61f,0x3aa73c00,0xb23e361f
.long 0xb61f8000,0xbb64b9a8,0xb61f8000,0xbb64b9a8,0x3bd93c00,0x3aa73b64,0xbbd9bc00,0xbaa7bb64
.long 0x80008000,0x80008000,0x80008000,0x80008000,0x3872b9a8,0x323eb61f,0xb87239a8,0xb23e361f
.long 0xbb643c00,0xb61f39a8,0xbb643c00,0xb61f39a8,0x3bd9b9a8,0x3872bb64,0xbbd939a8,0xb8723b64
.long 0xb9a88000,0xb9a83c00,0xb9a88000,0xb9a83c00,0x323e39a8,0x3aa7bb64,0xb23eb9a8,0xbaa73b64
.long 0x361fbc00,0xbb6439a8,0x361fbc00,0xbb6439a8,0xbaa739a8,0x3bd9b61f,0x3aa7b9a8,0xbbd9361f
.long 0x3c008000,0xbc008000,0x3c008000,0xbc008000,0xbaa7b9a8,0x3bd9361f,0x3aa739a8,0xbbd9b61f
.long 0x361f3c00,0xbb64b9a8,0x361f3c00,0xbb64b9a8,0x323eb9a8,0x3aa73b64,0xb23e39a8,0xbaa7bb64
.long 0xb9a88000,0xb9a8bc00,0xb9a88000,0xb9a8bc00,0x3bd939a8,0x38723b64,0xbbd9b9a8,0xb872bb64
.long 0xbb64bc00,0xb61fb9a8,0xbb64bc00,0xb61fb9a8,0x387239a8,0x323e361f,0xb872b9a8,0xb23eb61f
.p2align 8
.type tbl_p3,@object
tbl_p3:
.long 0x80003c00,0x80003c00,0x80003c00,0x80003c00,0x80003c00,0xb23e3bd9,0xb61f3b64,0xb8723aa7
.long 0x80003c00,0xb61f3b64,0xb9a839a8,0xbb64361f,0x80003c00,0xb8723aa7,0xbb64361f,0xbbd9b23e
.long 0x80003c00,0xb9a839a8,0xbc000000,0xb9a8b9a8,0x80003c00,0xbaa73872,0xbb64b61f,0xb23ebbd9
.long 0x80003c00,0xbb64361f,0xb9a8b9a8,0x361fbb64,0x80003c00,0xbbd9323e,0xb61fbb64,0x3aa7b872
.long 0x80003c00,0xbc000000,0x8000bc00,0x3c008000,0x80003c00,0xbbd9b23e,0x361fbb64,0x3aa73872
.long 0x80003c00,0xbb64b61f,0x39a8b9a8,0x361f3b64,0x80003c00,0xbaa7b872,0x3b64b61f,0xb23e3bd9
.long 0x80003c00,0xb9a8b9a8,0x3c008000,0xb9a839a8,0x80003c00,0xb872baa7,0x3b64361f,0xbbd9323e
.long 0x80003c00,0xb61fbb64,0x39a839a8,0xbb64b61f,0x80003c00,0xb23ebbd9,0x361f3b64,0xb872baa7
.long 0x80003c00,0x80003c00,0x80003c00,0x80003c00,0xb9a839a8,0xbaa73872,0xbb64361f,0xbbd9323e
.long 0xbc000000,0xbb64b61f,0xb9a8b9a8,0xb61fbb64,0xb9a8b9a8,0xb23ebbd9,0x361fbb64,0x3aa7b872
.long 0x8000bc00,0x39a8b9a8,0x3c008000,0x39a839a8,0x39a8b9a8,0x3bd9323e,0x361f3b64,0xb8723aa7
.long 0x3c008000,0x361f3b64,0xb9a839a8,0xbb64b61f,0x39a839a8,0xb8723aa7,0xbb64b61f,0x323ebbd9
.long 0x80003c00,0xbc000000,0x8000bc00,0x3c008000,0xb9a839a8,0xb872baa7,0x3b64b61f,0x323e3bd9
.long 0xbc000000,0x361fbb64,0x39a839a8,0xbb64361f,0xb9a8b9a8,0x3bd9b23e,0xb61f3b64,0xb872baa7
.long 0x8000bc00,0x39a839a8,0xbc000000,0x39a8b9a8,0x39a8b9a8,0xb23e3bd9,0xb61fbb64,0x3aa73872
.long 0x3c008000,0xbb64361f,0x39a8b9a8,0xb61f3b64,0x39a839a8,0xbaa7b872,0x3b64361f,0xbbd9b23e
.long 0x80003c00,0x80003c00,0x80003c00,0x80003c00,0xbc000000,0xbbd9b23e,0xbb64b61f,0xbaa7b872
.long 0x8000bc00,0x361fbb64,0x39a8b9a8,0x3b64b61f,0x3c008000,0x3aa73872,0x361f3b64,0xb23e3bd9
.long 0x80003c00,0xb9a839a8,0xbc000000,0xb9a8b9a8,0xbc000000,0xb872baa7,0x361fbb64,0x3bd9b23e
.long 0x8000bc00,0x3b64b61f,0x39a839a8,0xb61f3b64,0x3c008000,0x323e3bd9,0xbb64361f,0xb872baa7
.long 0x80003c00,0xbc000000,0x8000bc00,0x3c008000,0xbc000000,0x323ebbd9,0x3b64361f,0xb8723aa7
.long 0x8000bc00,0x3b64361f,0xb9a839a8,0xb61fbb64,0x3c008000,0xb8723aa7,0xb61fbb64,0x3bd9323e
.long 0x80003c00,0xb9a8b9a8,0x3c008000,0xb9a839a8,0xbc000000,0x3aa7b872,0xb61f3b64,0xb23ebbd9
.long 0x8000bc00,0x361f3b64,0xb9a8b9a8,0x3b64361f,0x3c008000,0xbbd9323e,0x3b64b61f,0xbaa73872
.long 0x80003c00,0x80003c00,0x80003c00,0x80003c00,0xb9a8b9a8,0xb872baa7,0xb61fbb64,0xb23ebbd9
.long 0x3c008000,0x3b64361f,0x39a839a8,0x361f3b64,0xb9a839a8,0xbbd9323e,0xbb64b61f,0xb872baa7
.long 0x8000bc00,0x39a8b9a8,0x3c008000,0x39a839a8,0x39a839a8,0xb23e3bd9,0xbb64361f,0xbaa7b872
.long 0xbc000000,0xb61fbb64,0x39a8b9a8,0x3b64361f,0x39a8b9a8,0x3aa73872,0xb61f3b64,0xbbd9b23e
.long 0x80003c00,0xbc000000,0x8000bc00,0x3c008000,0xb9a8b9a8,0x3aa7b872,0x361f3b64,0xbbd9323e
.long 0x3c008000,0xb61f3b64,0xb9a8b9a8,0x3b64b61f,0xb9a839a8,0xb23ebbd9,0x3b64361f,0xbaa73872
.long 0x8000bc00,0x39a839a8,0xbc000000,0x39a8b9a8,0x39a839a8,0xbbd9b23e,0x3b64b61f,0xb8723aa7
.long 0xbc000000,0x3b64b61f,0xb9a839a8,0x361fbb64,0x39a8b9a8,0xb8723aa7,0x361fbb64,0xb23e3bd9
.long 0x3c000000,0x3c000000,0x3c000000,0x3c000000,0x3c000000,0x3bd9323e,0x3b64361f,0x3aa73872
.long 0x3c000000,0x3b64361f,0x39a839a8,0x361f3b64,0x3c000000,0x3aa73872,0x361f3b64,0xb23e3bd9
.long 0x3c000000,0x39a839a8,0x3c00,0xb9a839a8,0x3c000000,0x38723aa7,0xb61f3b64,0xbbd9323e
.long 0x3c000000,0x361f3b64,0xb9a839a8,0xbb64b61f,0x3c000000,0x323e3bd9,0xbb64361f,0xb872baa7
.long 0x3c000000,0x3c00,0xbc000000,0x8000bc00,0x3c000000,0xb23e3bd9,0xbb64b61f,0x3872baa7
.long 0x3c000000,0xb61f3b64,0xb9a8b9a8,0x3b64b61f,0x3c000000,0xb8723aa7,0xb61fbb64,0x3bd9323e
.long 0x3c000000,0xb9a839a8,0x8000bc00,0x39a839a8,0x3c000000,0xbaa73872,0x361fbb64,0x323e3bd9
.long 0x3c000000,0xbb64361f,0x39a8b9a8,0xb61f3b64,0x3c000000,0xbbd9323e,0x3b64b61f,0xbaa73872
.long 0x3c000000,0x3c000000,0x3c000000,0x3c000000,0x39a839a8,0x38723aa7,0x361f3b64,0x323e3bd9
.long 0x3c00,0xb61f3b64,0xb9a839a8,0xbb64361f,0xb9a839a8,0xbbd9323e,0xbb64b61f,0xb872baa7
.long 0xbc000000,0xb9a8b9a8,0x8000bc00,0x39a8b9a8,0xb9a8b9a8,0x323ebbd9,0x3b64b61f,0x3aa73872
.long 0x8000bc00,0x3b64b61f,0x39a839a8,0xb61f3b64,0x39a8b9a8,0x3aa73872,0xb61f3b64,0xbbd9b23e
.long 0x3c000000,0x3c00,0xbc000000,0x8000bc00,0x39a839a8,0xbaa73872,0xb61fbb64,0x3bd9b23e
.long 0x3c00,0xbb64b61f,0x39a8b9a8,0x361f3b64,0xb9a839a8,0xb23ebbd9,0x3b64361f,0xbaa73872
.long 0xbc000000,0x39a8b9a8,0x3c00,0xb9a8b9a8,0xb9a8b9a8,0x3bd9323e,0xbb64361f,0x3872baa7
.long 0x8000bc00,0x361f3b64,0xb9a8b9a8,0x3b64361f,0x39a8b9a8,0xb8723aa7,0x361fbb64,0xb23e3bd9
.long 0x3c000000,0x3c000000,0x3c000000,0x3c000000,0x3c00,0xb23e3bd9,0xb61f3b64,0xb8723aa7
.long 0xbc000000,0xbb64b61f,0xb9a8b9a8,0xb61fbb64,0x8000bc00,0x3872baa7,0x3b64b61f,0x3bd9323e
.long 0x3c000000,0x39a839a8,0x3c00,0xb9a839a8,0x3c00,0xbaa73872,0xbb64b61f,0xb23ebbd9
.long 0xbc000000,0xb61fbb64,0x39a8b9a8,0x3b64361f,0x8000bc00,0x3bd9b23e,0x361f3b64,0xbaa73872
.long 0x3c000000,0x3c00,0xbc000000,0x8000bc00,0x3c00,0xbbd9b23e,0x361fbb64,0x3aa73872
.long 0xbc000000,0x361fbb64,0x39a839a8,0xbb64361f,0x8000bc00,0x3aa73872,0xbb64361f,0x323ebbd9
.long 0x3c000000,0xb9a839a8,0x8000bc00,0x39a839a8,0x3c00,0xb872baa7,0x3b64361f,0xbbd9323e
.long 0xbc000000,0x3b64b61f,0xb9a839a8,0x361fbb64,0x8000bc00,0x323e3bd9,0xb61fbb64,0x38723aa7
.long 0x3c000000,0x3c000000,0x3c000000,0x3c000000,0xb9a839a8,0xbaa73872,0xbb64361f,0xbbd9323e
.long 0x8000bc00,0x361fbb64,0x39a8b9a8,0x3b64b61f,0x39a839a8,0x323e3bd9,0xb61f3b64,0xbaa73872
.long 0xbc000000,0xb9a8b9a8,0x8000bc00,0x39a8b9a8,0x39a8b9a8,0x3bd9323e,0x361f3b64,0xb8723aa7
.long 0x3c00,0xbb64361f,0xb9a8b9a8,0x361fbb64,0xb9a8b9a8,0x3872baa7,0x3b64361f,0xb23e3bd9
.long 0x3c000000,0x3c00,0xbc000000,0x8000bc00,0xb9a839a8,0xb872baa7,0x3b64b61f,0x323e3bd9
.long 0x8000bc00,0x3b64361f,0xb9a839a8,0xb61fbb64,0x39a839a8,0xbbd9323e,0x361fbb64,0x38723aa7
.long 0xbc000000,0x39a8b9a8,0x3c00,0xb9a8b9a8,0x39a8b9a8,0xb23e3bd9,0xb61fbb64,0x3aa73872
.long 0x3c00,0xb61fbb64,0x39a839a8,0xbb64b61f,0xb9a8b9a8,0x3aa73872,0xbb64b61f,0x3bd9323e
.long 0x80003c00,0x8000bc00,0x80003c00,0x8000bc00,0x80003c00,0x323ebbd9,0xb61f3b64,0x3872baa7
.long 0x80003c00,0x361fbb64,0xb9a839a8,0x3b64b61f,0x80003c00,0x3872baa7,0xbb64361f,0x3bd9323e
.long 0x80003c00,0x39a8b9a8,0xbc000000,0x39a839a8,0x80003c00,0x3aa7b872,0xbb64b61f,0x323e3bd9
.long 0x80003c00,0x3b64b61f,0xb9a8b9a8,0xb61f3b64,0x80003c00,0x3bd9b23e,0xb61fbb64,0xbaa73872
.long 0x80003c00,0x3c008000,0x8000bc00,0xbc000000,0x80003c00,0x3bd9323e,0x361fbb64,0xbaa7b872
.long 0x80003c00,0x3b64361f,0x39a8b9a8,0xb61fbb64,0x80003c00,0x3aa73872,0x3b64b61f,0x323ebbd9
.long 0x80003c00,0x39a839a8,0x3c008000,0x39a8b9a8,0x80003c00,0x38723aa7,0x3b64361f,0x3bd9b23e
.long 0x80003c00,0x361f3b64,0x39a839a8,0x3b64361f,0x80003c00,0x323e3bd9,0x361f3b64,0x38723aa7
.long 0x80003c00,0x8000bc00,0x80003c00,0x8000bc00,0xb9a839a8,0x3aa7b872,0xbb64361f,0x3bd9b23e
.long 0xbc000000,0x3b64361f,0xb9a8b9a8,0x361f3b64,0xb9a8b9a8,0x323e3bd9,0x361fbb64,0xbaa73872
.long 0x8000bc00,0xb9a839a8,0x3c008000,0xb9a8b9a8,0x39a8b9a8,0xbbd9b23e,0x361f3b64,0x3872baa7
.long 0x3c008000,0xb61fbb64,0xb9a839a8,0x3b64361f,0x39a839a8,0x3872baa7,0xbb64b61f,0xb23e3bd9
.long 0x80003c00,0x3c008000,0x8000bc00,0xbc000000,0xb9a839a8,0x38723aa7,0x3b64b61f,0xb23ebbd9
.long 0xbc000000,0xb61f3b64,0x39a839a8,0x3b64b61f,0xb9a8b9a8,0xbbd9323e,0xb61f3b64,0x38723aa7
.long 0x8000bc00,0xb9a8b9a8,0xbc000000,0xb9a839a8,0x39a8b9a8,0x323ebbd9,0xb61fbb64,0xbaa7b872
.long 0x3c008000,0x3b64b61f,0x39a8b9a8,0x361fbb64,0x39a839a8,0x3aa73872,0x3b64361f,0x3bd9323e
.long 0x80003c00,0x8000bc00,0x80003c00,0x8000bc00,0xbc000000,0x3bd9323e,0xbb64b61f,0x3aa73872
.long 0x8000bc00,0xb61f3b64,0x39a8b9a8,0xbb64361f,0x3c008000,0xbaa7b872,0x361f3b64,0x323ebbd9
.long 0x80003c00,0x39a8b9a8,0xbc000000,0x39a839a8,0xbc000000,0x38723aa7,0x361fbb64,0xbbd9323e
.long 0x8000bc00,0xbb64361f,0x39a839a8,0x361fbb64,0x3c008000,0xb23ebbd9,0xbb64361f,0x38723aa7
.long 0x80003c00,0x3c008000,0x8000bc00,0xbc000000,0xbc000000,0xb23e3bd9,0x3b64361f,0x3872baa7
.long 0x8000bc00,0xbb64b61f,0xb9a839a8,0x361f3b64,0x3c008000,0x3872baa7,0xb61fbb64,0xbbd9b23e
.long 0x80003c00,0x39a839a8,0x3c008000,0x39a8b9a8,0xbc000000,0xbaa73872,0xb61f3b64,0x323e3bd9
.long 0x8000bc00,0xb61fbb64,0xb9a8b9a8,0xbb64b61f,0x3c008000,0x3bd9b23e,0x3b64b61f,0x3aa7b872
.long 0x80003c00,0x8000bc00,0x80003c00,0x8000bc00,0xb9a8b9a8,0x38723aa7,0xb61fbb64,0x323e3bd9
.long 0x3c008000,0xbb64b61f,0x39a839a8,0xb61fbb64,0xb9a839a8,0x3bd9b23e,0xbb64b61f,0x38723aa7
.long 0x8000bc00,0xb9a839a8,0x3c008000,0xb9a8b9a8,0x39a839a8,0x323ebbd9,0xbb64361f,0x3aa73872
.long 0xbc000000,0x361f3b64,0x39a8b9a8,0xbb64b61f,0x39a8b9a8,0xbaa7b872,0xb61f3b64,0x3bd9323e
.long 0x80003c00,0x3c008000,0x8000bc00,0xbc000000,0xb9a8b9a8,0xbaa73872,0x361f3b64,0x3bd9b23e
.long 0x3c008000,0x361fbb64,0xb9a8b9a8,0xbb64361f,0xb9a839a8,0x323e3bd9,0x3b64361f,0x3aa7b872
.long 0x8000bc00,0xb9a8b9a8,0xbc000000,0xb9a839a8,0x39a839a8,0x3bd9323e,0x3b64b61f,0x3872baa7
.long 0xbc000000,0xbb64361f,0xb9a839a8,0xb61f3b64,0x39a8b9a8,0x3872baa7,0x361fbb64,0x323ebbd9
.long 0x3c000000,0xbc000000,0x3c000000,0xbc000000,0x3c000000,0xbbd9b23e,0x3b64361f,0xbaa7b872
.long 0x3c000000,0xbb64b61f,0x39a839a8,0xb61fbb64,0x3c000000,0xbaa7b872,0x361f3b64,0x323ebbd9
.long 0x3c000000,0xb9a8b9a8,0x3c00,0x39a8b9a8,0x3c000000,0xb872baa7,0xb61f3b64,0x3bd9b23e
.long 0x3c000000,0xb61fbb64,0xb9a839a8,0x3b64361f,0x3c000000,0xb23ebbd9,0xbb64361f,0x38723aa7
.long 0x3c000000,0x8000bc00,0xbc000000,0x3c00,0x3c000000,0x323ebbd9,0xbb64b61f,0xb8723aa7
.long 0x3c000000,0x361fbb64,0xb9a8b9a8,0xbb64361f,0x3c000000,0x3872baa7,0xb61fbb64,0xbbd9b23e
.long 0x3c000000,0x39a8b9a8,0x8000bc00,0xb9a8b9a8,0x3c000000,0x3aa7b872,0x361fbb64,0xb23ebbd9
.long 0x3c000000,0x3b64b61f,0x39a8b9a8,0x361fbb64,0x3c000000,0x3bd9b23e,0x3b64b61f,0x3aa7b872
.long 0x3c000000,0xbc000000,0x3c000000,0xbc000000,0x39a839a8,0xb872baa7,0x361f3b64,0xb23ebbd9
.long 0x3c00,0x361fbb64,0xb9a839a8,0x3b64b61f,0xb9a839a8,0x3bd9b23e,0xbb64b61f,0x38723aa7
.long 0xbc000000,0x39a839a8,0x8000bc00,0xb9a839a8,0xb9a8b9a8,0xb23e3bd9,0x3b64b61f,0xbaa7b872
.long 0x8000bc00,0xbb64361f,0x39a839a8,0x361fbb64,0x39a8b9a8,0xbaa7b872,0xb61f3b64,0x3bd9323e
.long 0x3c000000,0x8000bc00,0xbc000000,0x3c00,0x39a839a8,0x3aa7b872,0xb61fbb64,0xbbd9323e
.long 0x3c00,0x3b64361f,0x39a8b9a8,0xb61fbb64,0xb9a839a8,0x323e3bd9,0x3b64361f,0x3aa7b872
.long 0xbc000000,0xb9a839a8,0x3c00,0x39a839a8,0xb9a8b9a8,0xbbd9b23e,0xbb64361f,0xb8723aa7
.long 0x8000bc00,0xb61fbb64,0xb9a8b9a8,0xbb64b61f,0x39a8b9a8,0x3872baa7,0x361fbb64,0x323ebbd9
.long 0x3c000000,0xbc000000,0x3c000000,0xbc000000,0x3c00,0x323ebbd9,0xb61f3b64,0x3872baa7
.long 0xbc000000,0x3b64361f,0xb9a8b9a8,0x361f3b64,0x8000bc00,0xb8723aa7,0x3b64b61f,0xbbd9b23e
.long 0x3c000000,0xb9a8b9a8,0x3c00,0x39a8b9a8,0x3c00,0x3aa7b872,0xbb64b61f,0x323e3bd9
.long 0xbc000000,0x361f3b64,0x39a8b9a8,0xbb64b61f,0x8000bc00,0xbbd9323e,0x361f3b64,0x3aa7b872
.long 0x3c000000,0x8000bc00,0xbc000000,0x3c00,0x3c00,0x3bd9323e,0x361fbb64,0xbaa7b872
.long 0xbc000000,0xb61f3b64,0x39a839a8,0x3b64b61f,0x8000bc00,0xbaa7b872,0xbb64361f,0xb23e3bd9
.long 0x3c000000,0x39a8b9a8,0x8000bc00,0xb9a8b9a8,0x3c00,0x38723aa7,0x3b64361f,0x3bd9b23e
.long 0xbc000000,0xbb64361f,0xb9a839a8,0xb61f3b64,0x8000bc00,0xb23ebbd9,0xb61fbb64,0xb872baa7
.long 0x3c000000,0xbc000000,0x3c000000,0xbc000000,0xb9a839a8,0x3aa7b872,0xbb64361f,0x3bd9b23e
.long 0x8000bc00,0xb61f3b64,0x39a8b9a8,0xbb64361f,0x39a839a8,0xb23ebbd9,0xb61f3b64,0x3aa7b872
.long 0xbc000000,0x39a839a8,0x8000bc00,0xb9a839a8,0x39a8b9a8,0xbbd9b23e,0x361f3b64,0x3872baa7
.long 0x3c00,0x3b64b61f,0xb9a8b9a8,0xb61f3b64,0xb9a8b9a8,0xb8723aa7,0x3b64361f,0x323ebbd9
.long 0x3c000000,0x8000bc00,0xbc000000,0x3c00,0xb9a839a8,0x38723aa7,0x3b64b61f,0xb23ebbd9
.long 0x8000bc00,0xbb64b61f,0xb9a839a8,0x361f3b64,0x39a839a8,0x3bd9b23e,0x361fbb64,0xb872baa7
.long 0xbc000000,0xb9a839a8,0x3c00,0x39a839a8,0x39a8b9a8,0x323ebbd9,0xb61fbb64,0xbaa7b872
.long 0x3c00,0x361f3b64,0x39a839a8,0x3b64361f,0xb9a8b9a8,0xbaa7b872,0xbb64b61f,0xbbd9b23e
.long 0x80002400,0x80002400,0x80002400,0x80002400,0x80002400,0x9e1f2364,0xa1a821a8,0xa3641e1f
.long 0x80002400,0xa1a821a8,0xa4000000,0xa1a8a1a8,0x80002400,0xa3641e1f,0xa1a8a1a8,0x1e1fa364
.long 0x80002400,0xa4000000,0x8000a400,0x24008000,0x80002400,0xa3649e1f,0x21a8a1a8,0x1e1f2364
.long 0x80002400,0xa1a8a1a8,0x24008000,0xa1a821a8,0x80002400,0x9e1fa364,0x21a821a8,0xa3649e1f
.long 0x80002400,0x8000a400,0x80002400,0x8000a400,0x80002400,0x1e1fa364,0xa1a821a8,0x23649e1f
.long 0x80002400,0x21a8a1a8,0xa4000000,0x21a821a8,0x80002400,0x23649e1f,0xa1a8a1a8,0x9e1f2364
.long 0x80002400,0x24008000,0x8000a400,0xa4000000,0x80002400,0x23641e1f,0x21a8a1a8,0x9e1fa364
.long 0x80002400,0x21a821a8,0x24008000,0x21a8a1a8,0x80002400,0x1e1f2364,0x21a821a8,0x23641e1f
.long 0x80002400,0x80002400,0x80002400,0x80002400,0xa4000000,0xa3649e1f,0xa1a8a1a8,0x9e1fa364
.long 0x8000a400,0x21a8a1a8,0x24008000,0x21a821a8,0x24008000,0x1e1f2364,0xa1a821a8,0xa3649e1f
.long 0x80002400,0xa4000000,0x8000a400,0x24008000,0xa4000000,0x1e1fa364,0x21a821a8,0xa3641e1f
.long 0x8000a400,0x21a821a8,0xa4000000,0x21a8a1a8,0x24008000,0xa3641e1f,0x21a8a1a8,0x9e1f2364
.long 0x80002400,0x8000a400,0x80002400,0x8000a400,0xa4000000,0x23641e1f,0xa1a8a1a8,0x1e1f2364
.long 0x8000a400,0xa1a821a8,0x24008000,0xa1a8a1a8,0x24008000,0x9e1fa364,0xa1a821a8,0x23641e1f
.long 0x80002400,0x24008000,0x8000a400,0xa4000000,0xa4000000,0x9e1f2364,0x21a821a8,0x23649e1f
.long 0x8000a400,0xa1a8a1a8,0xa4000000,0xa1a821a8,0x24008000,0x23649e1f,0x21a8a1a8,0x1e1fa364
.long 0x80002400,0x80002400,0x80002400,0x80002400,0x8000a400,0x1e1fa364,0x21a8a1a8,0x23649e1f
.long 0x80002400,0xa1a821a8,0xa4000000,0xa1a8a1a8,0x8000a400,0x23649e1f,0x21a821a8,0x9e1f2364
.long 0x80002400,0xa4000000,0x8000a400,0x24008000,0x8000a400,0x23641e1f,0xa1a821a8,0x9e1fa364
.long 0x80002400,0xa1a8a1a8,0x24008000,0xa1a821a8,0x8000a400,0x1e1f2364,0xa1a8a1a8,0x23641e1f
.long 0x80002400,0x8000a400,0x80002400,0x8000a400,0x8000a400,0x9e1f2364,0x21a8a1a8,0xa3641e1f
.long 0x80002400,0x21a8a1a8,0xa4000000,0x21a821a8,0x8000a400,0xa3641e1f,0x21a821a8,0x1e1fa364
.long 0x80002400,0x24008000,0x8000a400,0xa4000000,0x8000a400,0xa3649e1f,0xa1a821a8,0x1e1f2364
.long 0x80002400,0x21a821a8,0x24008000,0x21a8a1a8,0x8000a400,0x9e1fa364,0xa1a8a1a8,0xa3649e1f
.long 0x80002400,0x80002400,0x80002400,0x80002400,0x24008000,0x23641e1f,0x21a821a8,0x1e1f2364
.long 0x8000a400,0x21a8a1a8,0x24008000,0x21a821a8,0xa4000000,0x9e1fa364,0x21a8a1a8,0x23641e1f
.long 0x80002400,0xa4000000,0x8000a400,0x24008000,0x24008000,0x9e1f2364,0xa1a8a1a8,0x23649e1f
.long 0x8000a400,0x21a821a8,0xa4000000,0x21a8a1a8,0xa4000000,0x23649e1f,0xa1a821a8,0x1e1fa364
.long 0x80002400,0x8000a400,0x80002400,0x8000a400,0x24008000,0xa3649e1f,0x21a821a8,0x9e1fa364
.long 0x8000a400,0xa1a821a8,0x24008000,0xa1a8a1a8,0xa4000000,0x1e1f2364,0x21a8a1a8,0xa3649e1f
.long 0x80002400,0x24008000,0x8000a400,0xa4000000,0x24008000,0x1e1fa364,0xa1a8a1a8,0xa3641e1f
.long 0x8000a400,0xa1a8a1a8,0xa4000000,0xa1a821a8,0xa4000000,0xa3641e1f,0xa1a821a8,0x9e1f2364
.long 0x3e800000,0x0,0x3e800000,0x0,0x3e800000,0x0,0x3e7ffb11,0x3b490e90
.long 0x3e800000,0x0,0x3e7fec43,0x3bc90ab0,0x3e800000,0x0,0x3e7fd397,0x3c16c32c
.long 0x3e800000,0x0,0x3e7fb10f,0x3c48fb30,0x3e800000,0x0,0x3e7f84ab,0x3c7b2b74
.long 0x3e800000,0x0,0x3e7f4e6d,0x3c96a905,0x3e800000,0x0,0x3e7f0e58,0x3cafb680
.long 0x3e800000,0x0,0x3e7ec46d,0x3cc8bd36,0x3e800000,0x0,0x3e7e70b0,0x3ce1bc2e
.long 0x3e800000,0x0,0x3e7e1324,0x3cfab273,0x3e800000,0x0,0x3e7dabcc,0x3d09cf86
.long 0x3e800000,0x0,0x3e7d3aac,0x3d164083,0x3e800000,0x0,0x3e7cbfc9,0x3d22abb6
.long 0x3e800000,0x0,0x3e7c3b28,0x3d2f10a2,0x3e800000,0x0,0x3e7baccd,0x3d3b6ecf
.long 0x3e800000,0x0,0x3e800000,0x0,0x3e7fb10f,0x3c48fb30,0x3e7f84ab,0x3c7b2b74
.long 0x3e7ec46d,0x3cc8bd36,0x3e7e1324,0x3cfab273,0x3e7d3aac,0x3d164083,0x3e7baccd,0x3d3b6ecf
.long 0x3e7b14be,0x3d47c5c2,0x3e7853f8,0x3d78cfcc,0x3e7853f8,0x3d78cfcc,0x3e740bdd,0x3d9aa086
.long 0x3e74fa0b,0x3d94a031,0x3e6ed89e,0x3db8442a,0x3e710908,0x3dac7cd4,0x3e68bf3c,0x3dd53641
.long 0x3e6c835e,0x3dc3ef15,0x3e61c598,0x3df15aea,0x3e676bd8,0x3ddae880,0x3e59f26a,0x3e064b82
.long 0x3e61c598,0x3df15aea,0x3e514d3d,0x3e13682a,0x3e5b941a,0x3e039c3d,0x3e47de65,0x3e1ff6cb
.long 0x3e54db31,0x3e0e39da,0x3e3daef9,0x3e2beb4a,0x3e4d9f02,0x3e187fc0,0x3e32c8c9,0x3e373a23
.long 0x3e45e403,0x3e226799,0x3e273656,0x3e41d870,0x3e3daef9,0x3e2beb4a,0x3e1b02c6,0x3e4bbbf8
.long 0x3e800000,0x0,0x3e800000,0x0,0x3e7ec46d,0x3cc8bd36,0x3e7e70b0,0x3ce1bc2e
.long 0x3e7b14be,0x3d47c5c2,0x3e79c79d,0x3d605c13,0x3e74fa0b,0x3d94a031,0x3e721352,0x3da68f12
.long 0x3e6c835e,0x3dc3ef15,0x3e676bd8,0x3ddae880,0x3e61c598,0x3df15aea,0x3e59f26a,0x3e064b82
.long 0x3e54db31,0x3e0e39da,0x3e49d112,0x3e1d7fd1,0x3e45e403,0x3e226799,0x3e373a23,0x3e32c8c9
.long 0x3e3504f3,0x3e3504f3,0x3e226799,0x3e45e403,0x3e226799,0x3e45e403,0x3e0b9a6b,0x3e5695e5
.long 0x3e0e39da,0x3e54db31,0x3de63375,0x3e64aa59,0x3df15aea,0x3e61c598,0x3db263ef,0x3e6ff573
.long 0x3dc3ef15,0x3e6c835e,0x3d78cfcc,0x3e7853f8,0x3d94a031,0x3e74fa0b,0x3d09cf86,0x3e7dabcc
.long 0x3d47c5c2,0x3e7b14be,0x3bc90ab0,0x3e7fec43,0x3cc8bd36,0x3e7ec46d,0xbcafb680,0x3e7f0e58
.long 0x3e800000,0x0,0x3e800000,0x0,0x3e7d3aac,0x3d164083,0x3e7cbfc9,0x3d22abb6
.long 0x3e74fa0b,0x3d94a031,0x3e731447,0x3da09ae5,0x3e676bd8,0x3ddae880,0x3e633c5a,0x3debcbbb
.long 0x3e54db31,0x3e0e39da,0x3e4d9f02,0x3e187fc0,0x3e3daef9,0x3e2beb4a,0x3e32c8c9,0x3e373a23
.long 0x3e226799,0x3e45e403,0x3e13682a,0x3e514d3d,0x3e039c3d,0x3e5b941a,0x3de0924f,0x3e660f88
.long 0x3dc3ef15,0x3e6c835e,0x3d94a031,0x3e74fa0b,0x3d78cfcc,0x3e7853f8,0x3d09cf86,0x3e7dabcc
.long 0x3cc8bd36,0x3e7ec46d,0xbbc90ab0,0x3e7fec43,0xbc48fb30,0x3e7fb10f,0xbd3b6ecf,0x3e7baccd
.long 0xbd47c5c2,0x3e7b14be,0xbdac7cd4,0x3e710908,0xbdac7cd4,0x3e710908,0xbdf6e0cb,0x3e604621
.long 0xbdf15aea,0x3e61c598,0xbe1d7fd1,0x3e49d112,0xbe187fc0,0x3e4d9f02,0xbe3b8f3b,0x3e2e3bde
.long 0x3e800000,0x0,0x3e800000,0x0,0x3e7fec43,0x3bc90ab0,0x3e7fd397,0x3c16c32c
.long 0x3e7fb10f,0x3c48fb30,0x3e7f4e6d,0x3c96a905,0x3e7f4e6d,0x3c96a905,0x3e7e70b0,0x3ce1bc2e
.long 0x3e7ec46d,0x3cc8bd36,0x3e7d3aac,0x3d164083,0x3e7e1324,0x3cfab273,0x3e7baccd,0x3d3b6ecf
.long 0x3e7d3aac,0x3d164083,0x3e79c79d,0x3d605c13,0x3e7c3b28,0x3d2f10a2,0x3e778bc5,0x3d827dc0
.long 0x3e7b14be,0x3d47c5c2,0x3e74fa0b,0x3d94a031,0x3e79c79d,0x3d605c13,0x3e721352,0x3da68f12
.long 0x3e7853f8,0x3d78cfcc,0x3e6ed89e,0x3db8442a,0x3e76ba07,0x3d888e93,0x3e6b4b0c,0x3dc9b953
.long 0x3e74fa0b,0x3d94a031,0x3e676bd8,0x3ddae880,0x3e731447,0x3da09ae5,0x3e633c5a,0x3debcbbb
.long 0x3e710908,0x3dac7cd4,0x3e5ebe05,0x3dfc5d27,0x3e6ed89e,0x3db8442a,0x3e59f26a,0x3e064b82
.long 0x3e800000,0x0,0x3e800000,0x0,0x3e7f4e6d,0x3c96a905,0x3e7f0e58,0x3cafb680
.long 0x3e7d3aac,0x3d164083,0x3e7c3b28,0x3d2f10a2,0x3e79c79d,0x3d605c13,0x3e778bc5,0x3d827dc0
.long 0x3e74fa0b,0x3d94a031,0x3e710908,0x3dac7cd4,0x3e6ed89e,0x3db8442a,0x3e68bf3c,0x3dd53641
.long 0x3e676bd8,0x3ddae880,0x3e5ebe05,0x3dfc5d27,0x3e5ebe05,0x3dfc5d27,0x3e531849,0x3e10d3cd
.long 0x3e54db31,0x3e0e39da,0x3e45e403,0x3e226799,0x3e49d112,0x3e1d7fd1,0x3e373a23,0x3e32c8c9
.long 0x3e3daef9,0x3e2beb4a,0x3e273656,0x3e41d870,0x3e3085bb,0x3e396842,0x3e15f6d9,0x3e4f7a1f
.long 0x3e226799,0x3e45e403,0x3e039c3d,0x3e5b941a,0x3e13682a,0x3e514d3d,0x3de0924f,0x3e660f88
.long 0x3e039c3d,0x3e5b941a,0x3db8442a,0x3e6ed89e,0x3de63375,0x3e64aa59,0x3d8e9a22,0x3e75dec6
.long 0x3e800000,0x0,0x3e800000,0x0,0x3e7e1324,0x3cfab273,0x3e7dabcc,0x3d09cf86
.long 0x3e7853f8,0x3d78cfcc,0x3e76ba07,0x3d888e93,0x3e6ed89e,0x3db8442a,0x3e6b4b0c,0x3dc9b953
.long 0x3e61c598,0x3df15aea,0x3e5b941a,0x3e039c3d,0x3e514d3d,0x3e13682a,0x3e47de65,0x3e1ff6cb
.long 0x3e3daef9,0x3e2beb4a,0x3e3085bb,0x3e396842,0x3e273656,0x3e41d870,0x3e15f6d9,0x3e4f7a1f
.long 0x3e0e39da,0x3e54db31,0x3df15aea,0x3e61c598,0x3de63375,0x3e64aa59,0x3db263ef,0x3e6ff573
.long 0x3dac7cd4,0x3e710908,0x3d605c13,0x3e79c79d,0x3d605c13,0x3e79c79d,0x3cafb680,0x3e7f0e58
.long 0x3cc8bd36,0x3e7ec46d,0xbc48fb30,0x3e7fb10f,0xbbc90ab0,0x3e7fec43,0xbd3b6ecf,0x3e7baccd
.long 0xbd164083,0x3e7d3aac,0xbda09ae5,0x3e731447,0xbd888e93,0x3e76ba07,0xbde0924f,0x3e660f88
.long 0x3e800000,0x0,0x3e800000,0x0,0x3e7c3b28,0x3d2f10a2,0x3e7baccd,0x3d3b6ecf
.long 0x3e710908,0x3dac7cd4,0x3e6ed89e,0x3db8442a,0x3e5ebe05,0x3dfc5d27,0x3e59f26a,0x3e064b82
.long 0x3e45e403,0x3e226799,0x3e3daef9,0x3e2beb4a,0x3e273656,0x3e41d870,0x3e1b02c6,0x3e4bbbf8
.long 0x3e039c3d,0x3e5b941a,0x3de63375,0x3e64aa59,0x3db8442a,0x3e6ed89e,0x3d8e9a22,0x3e75dec6
.long 0x3d47c5c2,0x3e7b14be,0x3cc8bd36,0x3e7ec46d,0x3bc90ab0,0x3e7fec43,0xbcafb680,0x3e7f0e58
.long 0xbd164083,0x3e7d3aac,0xbd888e93,0x3e76ba07,0xbda09ae5,0x3e731447,0xbde0924f,0x3e660f88
.long 0xbdf15aea,0x3e61c598,0xbe187fc0,0x3e4d9f02,0xbe1d7fd1,0x3e49d112,0xbe3b8f3b,0x3e2e3bde
.long 0xbe3daef9,0x3e2beb4a,0xbe584853,0x3e08f59b,0xbe584853,0x3e08f59b,0xbe6db293,0x3dbe1d4a
.long 0x3e800000,0x0,0x3e7b14be,0x3d47c5c2,0x3e800000,0x0,0x3e7a7302,0x3d541501
.long 0x3e800000,0x0,0x3e79c79d,0x3d605c13,0x3e800000,0x0,0x3e791298,0x3d6c9a7f
.long 0x3e800000,0x0,0x3e7853f8,0x3d78cfcc,0x3e800000,0x0,0x3e778bc5,0x3d827dc0
.long 0x3e800000,0x0,0x3e76ba07,0x3d888e93,0x3e800000,0x0,0x3e75dec6,0x3d8e9a22
.long 0x3e800000,0x0,0x3e74fa0b,0x3d94a031,0x3e800000,0x0,0x3e740bdd,0x3d9aa086
.long 0x3e800000,0x0,0x3e731447,0x3da09ae5,0x3e800000,0x0,0x3e721352,0x3da68f12
.long 0x3e800000,0x0,0x3e710908,0x3dac7cd4,0x3e800000,0x0,0x3e6ff573,0x3db263ef
.long 0x3e800000,0x0,0x3e6ed89e,0x3db8442a,0x3e800000,0x0,0x3e6db293,0x3dbe1d4a
.long 0x3e3504f3,0x3e3504f3,0x3e0e39da,0x3e54db31,0x3e2beb4a,0x3e3daef9,0x3e00e7e4,0x3e5d2d53
.long 0x3e226799,0x3e45e403,0x3de63375,0x3e64aa59,0x3e187fc0,0x3e4d9f02,0x3dc9b953,0x3e6b4b0c
.long 0x3e0e39da,0x3e54db31,0x3dac7cd4,0x3e710908,0x3e039c3d,0x3e5b941a,0x3d8e9a22,0x3e75dec6
.long 0x3df15aea,0x3e61c598,0x3d605c13,0x3e79c79d,0x3ddae880,0x3e676bd8,0x3d22abb6,0x3e7cbfc9
.long 0x3dc3ef15,0x3e6c835e,0x3cc8bd36,0x3e7ec46d,0x3dac7cd4,0x3e710908,0x3c16c32c,0x3e7fd397
.long 0x3d94a031,0x3e74fa0b,0xbbc90ab0,0x3e7fec43,0x3d78cfcc,0x3e7853f8,0xbcafb680,0x3e7f0e58
.long 0x3d47c5c2,0x3e7b14be,0xbd164083,0x3e7d3aac,0x3d164083,0x3e7d3aac,0xbd541501,0x3e7a7302
.long 0x3cc8bd36,0x3e7ec46d,0xbd888e93,0x3e76ba07,0x3c48fb30,0x3e7fb10f,0xbda68f12,0x3e721352
.long 0x238d3132,0x3e800000,0xbd47c5c2,0x3e7b14be,0xbcc8bd36,0x3e7ec46d,0xbd9aa086,0x3e740bdd
.long 0xbd47c5c2,0x3e7b14be,0xbdcf7bca,0x3e6a09a7,0xbd94a031,0x3e74fa0b,0xbe00e7e4,0x3e5d2d53
.long 0xbdc3ef15,0x3e6c835e,0xbe187fc0,0x3e4d9f02,0xbdf15aea,0x3e61c598,0xbe2e3bde,0x3e3b8f3b
.long 0xbe0e39da,0x3e54db31,0xbe41d870,0x3e273656,0xbe226799,0x3e45e403,0xbe531849,0x3e10d3cd
.long 0xbe3504f3,0x3e3504f3,0xbe61c598,0x3df15aea,0xbe45e403,0x3e226799,0xbe6db293,0x3dbe1d4a
.long 0xbe54db31,0x3e0e39da,0xbe76ba07,0x3d888e93,0xbe61c598,0x3df15aea,0xbe7cbfc9,0x3d22abb6
.long 0xbe6c835e,0x3dc3ef15,0xbe7fb10f,0x3c48fb30,0xbe74fa0b,0x3d94a031,0xbe7f84ab,0xbc7b2b74
.long 0xbe7b14be,0x3d47c5c2,0xbe7c3b28,0xbd2f10a2,0xbe7ec46d,0x3cc8bd36,0xbe75dec6,0xbd8e9a22
.long 0xbe3504f3,0x3e3504f3,0xbe54db31,0x3e0e39da,0xbe4d9f02,0x3e187fc0,0xbe68bf3c,0x3dd53641
.long 0xbe61c598,0x3df15aea,0xbe76ba07,0x3d888e93,0xbe710908,0x3dac7cd4,0xbe7e70b0,0x3ce1bc2e
.long 0xbe7b14be,0x3d47c5c2,0xbe7fb10f,0xbc48fb30,0xbe7fb10f,0x3c48fb30,0xbe7a7302,0xbd541501
.long 0xbe7ec46d,0xbcc8bd36,0xbe6ed89e,0xbdb8442a,0xbe7853f8,0xbd78cfcc,0xbe5d2d53,0xbe00e7e4
.long 0xbe6c835e,0xbdc3ef15,0xbe45e403,0xbe226799,0xbe5b941a,0xbe039c3d,0xbe299415,0xbe3fc767
.long 0xbe45e403,0xbe226799,0xbe08f59b,0xbe584853,0xbe2beb4a,0xbe3daef9,0xbdc9b953,0xbe6b4b0c
.long 0xbe0e39da,0xbe54db31,0xbd78cfcc,0xbe7853f8,0xbddae880,0xbe676bd8,0xbcafb680,0xbe7f0e58
.long 0xbd94a031,0xbe74fa0b,0x3c96a905,0xbe7f4e6d,0xbd164083,0xbe7d3aac,0x3d6c9a7f,0xbe791298
.long 0x3e6c835e,0x3dc3ef15,0x3e54db31,0x3e0e39da,0x3e6a09a7,0x3dcf7bca,0x3e4f7a1f,0x3e15f6d9
.long 0x3e676bd8,0x3ddae880,0x3e49d112,0x3e1d7fd1,0x3e64aa59,0x3de63375,0x3e43e200,0x3e24d225
.long 0x3e61c598,0x3df15aea,0x3e3daef9,0x3e2beb4a,0x3e5ebe05,0x3dfc5d27,0x3e373a23,0x3e32c8c9
.long 0x3e5b941a,0x3e039c3d,0x3e3085bb,0x3e396842,0x3e584853,0x3e08f59b,0x3e299415,0x3e3fc767
.long 0x3e54db31,0x3e0e39da,0x3e226799,0x3e45e403,0x3e514d3d,0x3e13682a,0x3e1b02c6,0x3e4bbbf8
.long 0x3e4d9f02,0x3e187fc0,0x3e13682a,0x3e514d3d,0x3e49d112,0x3e1d7fd1,0x3e0b9a6b,0x3e5695e5
.long 0x3e45e403,0x3e226799,0x3e039c3d,0x3e5b941a,0x3e41d870,0x3e273656,0x3df6e0cb,0x3e604621
.long 0x3e3daef9,0x3e2beb4a,0x3de63375,0x3e64aa59,0x3e396842,0x3e3085bb,0x3dd53641,0x3e68bf3c
.long 0x3dc3ef15,0x3e6c835e,0x3d47c5c2,0x3e7b14be,0x3da09ae5,0x3e731447,0x3ce1bc2e,0x3e7e70b0
.long 0x3d78cfcc,0x3e7853f8,0x3bc90ab0,0x3e7fec43,0x3d2f10a2,0x3e7c3b28,0xbc7b2b74,0x3e7f84ab
.long 0x3cc8bd36,0x3e7ec46d,0xbd164083,0x3e7d3aac,0x3bc90ab0,0x3e7fec43,0xbd6c9a7f,0x3e791298
.long 0xbc48fb30,0x3e7fb10f,0xbda09ae5,0x3e731447,0xbcfab273,0x3e7e1324,0xbdc9b953,0x3e6b4b0c
.long 0xbd47c5c2,0x3e7b14be,0xbdf15aea,0x3e61c598,0xbd888e93,0x3e76ba07,0xbe0b9a6b,0x3e5695e5
.long 0xbdac7cd4,0x3e710908,0xbe1d7fd1,0x3e49d112,0xbdcf7bca,0x3e6a09a7,0xbe2e3bde,0x3e3b8f3b
.long 0xbdf15aea,0x3e61c598,0xbe3daef9,0x3e2beb4a,0xbe08f59b,0x3e584853,0xbe4bbbf8,0x3e1b02c6
.long 0xbe187fc0,0x3e4d9f02,0xbe584853,0x3e08f59b,0xbe273656,0x3e41d870,0xbe633c5a,0x3debcbbb
.long 0xbdc3ef15,0x3e6c835e,0xbe0e39da,0x3e54db31,0xbdfc5d27,0x3e5ebe05,0xbe299415,0x3e3fc767
.long 0xbe187fc0,0x3e4d9f02,0xbe41d870,0x3e273656,0xbe3085bb,0x3e396842,0xbe5695e5,0x3e0b9a6b
.long 0xbe45e403,0x3e226799,0xbe676bd8,0x3ddae880,0xbe584853,0x3e08f59b,0xbe740bdd,0x3d9aa086
.long 0xbe676bd8,0x3ddae880,0xbe7c3b28,0x3d2f10a2,0xbe731447,0x3da09ae5,0xbe7fd397,0x3c16c32c
.long 0xbe7b14be,0x3d47c5c2,0xbe7ec46d,0xbcc8bd36,0xbe7f4e6d,0x3c96a905,0xbe791298,0xbd6c9a7f
.long 0xbe7fb10f,0xbc48fb30,0xbe6ed89e,0xbdb8442a,0xbe7c3b28,0xbd2f10a2,0xbe604621,0xbdf6e0cb
.long 0xbe74fa0b,0xbd94a031,0xbe4d9f02,0xbe187fc0,0xbe6a09a7,0xbdcf7bca,0xbe373a23,0xbe32c8c9
.long 0xbe5b941a,0xbe039c3d,0xbe1d7fd1,0xbe49d112,0xbe49d112,0xbe1d7fd1,0xbe00e7e4,0xbe5d2d53
.long 0xbe6c835e,0x3dc3ef15,0xbe7b14be,0x3d47c5c2,0xbe79c79d,0x3d605c13,0xbe7ffb11,0x3b490e90
.long 0xbe7fb10f,0x3c48fb30,0xbe7c3b28,0xbd2f10a2,0xbe7e1324,0xbcfab273,0xbe6ff573,0xbdb263ef
.long 0xbe74fa0b,0xbd94a031,0xbe5b941a,0xbe039c3d,0xbe64aa59,0xbde63375,0xbe3fc767,0xbe299415
.long 0xbe4d9f02,0xbe187fc0,0xbe1d7fd1,0xbe49d112,0xbe3085bb,0xbe396842,0xbdebcbbb,0xbe633c5a
.long 0xbe0e39da,0xbe54db31,0xbd94a031,0xbe74fa0b,0xbdcf7bca,0xbe6a09a7,0xbce1bc2e,0xbe7e70b0
.long 0xbd78cfcc,0xbe7853f8,0x3c96a905,0xbe7f4e6d,0xbc96a905,0xbe7f4e6d,0x3d827dc0,0xbe778bc5
.long 0x3cc8bd36,0xbe7ec46d,0x3ddae880,0xbe676bd8,0x3d888e93,0xbe76ba07,0x3e15f6d9,0xbe4f7a1f
.long 0x3ddae880,0xbe676bd8,0x3e396842,0xbe3085bb,0x3e13682a,0xbe514d3d,0x3e5695e5,0xbe0b9a6b
.p2align 12
code_end:
.long 0
.section .rodata,"a"
.p2align 6
.amdhsa_kernel prep_kernel
  .amdhsa_next_free_vgpr 96
  .amdhsa_next_free_sgpr 48
  .amdhsa_accum_offset 96
  .amdhsa_group_segment_fixed_size 0
  .amdhsa_kernarg_size 88
  .amdhsa_user_sgpr_count 2
  .amdhsa_user_sgpr_kernarg_segment_ptr 1
  .amdhsa_system_sgpr_workgroup_id_x 1
.end_amdhsa_kernel
.p2align 6
.amdhsa_kernel p1_kernel
  .amdhsa_next_free_vgpr 160
  .amdhsa_next_free_sgpr 48
  .amdhsa_accum_offset 160
  .amdhsa_group_segment_fixed_size 0
  .amdhsa_kernarg_size 88
  .amdhsa_user_sgpr_count 2
  .amdhsa_user_sgpr_kernarg_segment_ptr 1
  .amdhsa_system_sgpr_workgroup_id_x 1
.end_amdhsa_kernel
.p2align 6
.amdhsa_kernel p2_kernel
  .amdhsa_next_free_vgpr 200
  .amdhsa_next_free_sgpr 48
  .amdhsa_accum_offset 200
  .amdhsa_group_segment_fixed_size 0
  .amdhsa_kernarg_size 88
  .amdhsa_user_sgpr_count 2
  .amdhsa_user_sgpr_kernarg_segment_ptr 1
  .amdhsa_system_sgpr_workgroup_id_x 1
.end_amdhsa_kernel
.p2align 6
.amdhsa_kernel p3_kernel
  .amdhsa_next_free_vgpr 128
  .amdhsa_next_free_sgpr 48
  .amdhsa_accum_offset 128
  .amdhsa_group_segment_fixed_size 0
  .amdhsa_kernarg_size 88
  .amdhsa_user_sgpr_count 2
  .amdhsa_user_sgpr_kernarg_segment_ptr 1
  .amdhsa_system_sgpr_workgroup_id_x 1
.end_amdhsa_kernel
.p2align 6
.amdhsa_kernel g1_kernel
  .amdhsa_next_free_vgpr 248
  .amdhsa_next_free_sgpr 64
  .amdhsa_accum_offset 248
  .amdhsa_group_segment_fixed_size 0
  .amdhsa_kernarg_size 88
  .amdhsa_user_sgpr_count 2
  .amdhsa_user_sgpr_kernarg_segment_ptr 1
  .amdhsa_system_sgpr_workgroup_id_x 1
.end_amdhsa_kernel
.p2align 6
.amdhsa_kernel adaLN_cond__spectral_gfnet__dense_activation_silu__prompt_kernel
  .amdhsa_next_free_vgpr 96
  .amdhsa_next_free_sgpr 64
  .amdhsa_accum_offset 96
  .amdhsa_group_segment_fixed_size 0
  .amdhsa_kernarg_size 88
  .amdhsa_user_sgpr_count 2
  .amdhsa_user_sgpr_kernarg_segment_ptr 1
  .amdhsa_system_sgpr_workgroup_id_x 1
.end_amdhsa_kernel
```
